```python
import torch

def _softmax(x, axis=-1):
    return torch.softmax(x, dim=axis)
def _gelu(x):
    return torch.nn.functional.gelu(x, approximate="tanh")
def _silu(x):
    return torch.nn.functional.silu(x)
def _sigmoid(x):
    return torch.sigmoid(x)
def _layernorm(x, axis=-1, eps=1e-5):
    m = x.mean(dim=axis, keepdim=True)
    v = x.var(dim=axis, keepdim=True, unbiased=False)
    return (x - m) / torch.sqrt(v + eps)
def _scatter_add(tgt, idx, src, axis=0):
    return tgt.clone().index_add_(axis, idx, src)
def _segment_sum(src, seg, n):
    out = torch.zeros((n,) + src.shape[1:], dtype=src.dtype)
    return out.index_add_(0, seg, src)
def _pad(x, pw):
    flat = tuple(v for pair in reversed(pw) for v in pair)
    return torch.nn.functional.pad(x, flat)

kernel_name = 'parallel_sum__compressed_kv_cla__glu_gated_glu__prompt'

def setup_inputs():

    _w = (lambda a: (lambda t: t.to(torch.bfloat16) if t.is_floating_point() else t)(torch.as_tensor(a)))
    def _A_setup():
        B, H, Sq, Sk, D, M = 1, 32, 2048, 2048, 128, 512
        Dc = 4 * D
        return {
            "x": _w((lambda *s: torch.randn(*s, dtype=torch.bfloat16) * 0.05)(B, Sq, M)),
            "c_kv": _w((lambda *s: torch.randn(*s, dtype=torch.bfloat16) * 1.6)(B, Sk, Dc)),
            "w_q": _w((lambda *s: torch.randn(*s, dtype=torch.bfloat16) * 0.8)(M, H, D) * (M ** -0.5)),
            "w_uk": _w((lambda *s: torch.randn(*s, dtype=torch.bfloat16) * 0.8)(Dc, H, D) * (Dc ** -0.5)),
            "w_uv": _w((lambda *s: torch.randn(*s, dtype=torch.bfloat16) * 1.6)(Dc, H, D) * (Dc ** -0.5)),
            "w_o": _w((lambda *s: torch.randn(*s, dtype=torch.bfloat16) * 1.6)(H, D, M) * ((H * D) ** -0.5)),
        }
    _A_in = _A_setup()

    def _B_setup():
        B, S, D, F = 1, 2048, 512, 1376
        return {
            "x": _w((lambda *s: torch.randn(*s, dtype=torch.bfloat16) * 0.05)(B, S, D)),
            "w_gate": _w((lambda *s: torch.randn(*s, dtype=torch.bfloat16) * 0.05)(D, F)),
            "w_up": _w((lambda *s: torch.randn(*s, dtype=torch.bfloat16) * 0.05)(D, F)),
            "w_down": _w((lambda *s: torch.randn(*s, dtype=torch.bfloat16) * 0.05)(F, D)),
        }
    _B_in = _B_setup()

    return {
        "A_x": _A_in["x"],
        "A_c_kv": _A_in["c_kv"],
        "A_w_q": _A_in["w_q"],
        "A_w_uk": _A_in["w_uk"],
        "A_w_uv": _A_in["w_uv"],
        "A_w_o": _A_in["w_o"],
        "B_x": _B_in["x"],
        "B_w_gate": _B_in["w_gate"],
        "B_w_up": _B_in["w_up"],
        "B_w_down": _B_in["w_down"],
    }

def reference(A_x, A_c_kv, A_w_q, A_w_uk, A_w_uv, A_w_o, B_x, B_w_gate, B_w_up, B_w_down):
    def _A_ref(x, c_kv, w_q, w_uk, w_uv, w_o):
        B, Sq, M = x.shape[0], x.shape[1], x.shape[2]
        Sk = c_kv.shape[1]
        H, D = w_q.shape[1], w_q.shape[2]
        q = torch.einsum("bqm,mhd->bhqd", x, w_q)
        k = torch.einsum("bkc,chd->bhkd", c_kv, w_uk)
        v = torch.einsum("bkc,chd->bhkd", c_kv, w_uv)
        scores = torch.einsum("bhqd,bhkd->bhqk", q, k) * (D ** -0.5)
        off = Sk - Sq
        qi = torch.arange(Sq)[:, None]
        kj = torch.arange(Sk)[None, :]
        cmask = kj <= (qi + off)
        scores = torch.where(cmask[None, None], scores, -1e9)
        p = _softmax(scores, axis=-1)
        ctx = torch.einsum("bhqk,bhkd->bhqd", p, v)
        return torch.einsum("bhqd,hdm->bqm", ctx, w_o)

    def _B_ref(x, w_gate, w_up, w_down):
        g = torch.einsum("bsd,df->bsf", x, w_gate)
        u = torch.einsum("bsd,df->bsf", x, w_up)
        h = _sigmoid(g) * u
        return torch.einsum("bsf,fd->bsd", h, w_down)

    x = A_x
    xn = _layernorm(x, axis=-1)
    return x + _A_ref(xn, A_c_kv, A_w_q, A_w_uk, A_w_uv, A_w_o) + _B_ref(xn, B_w_gate, B_w_up, B_w_down)
```

```asm
; @launch grid=(256,1,1) block=(256,1,1) lds=163840
.amdgcn_target "amdgcn-amd-amdhsa--gfx950"
.text
.globl parallel_sum__compressed_kv_cla__glu_gated_glu__prompt_kernel
.p2align 8
.type parallel_sum__compressed_kv_cla__glu_gated_glu__prompt_kernel,@function
parallel_sum__compressed_kv_cla__glu_gated_glu__prompt_kernel:
  s_cmp_ge_u32 s2, 256
  s_cbranch_scc1 L_end
  s_load_dwordx16 s[4:19], s[0:1], 0
  s_load_dwordx8 s[20:27], s[0:1], 64
  s_load_dwordx2 s[28:29], s[0:1], 96
  v_lshrrev_b32 v1, 6, v0
  v_and_b32 v0, 63, v0
  v_readfirstlane_b32 s76, v1
  s_getpc_b64 s[30:31]
L_pc:
  s_lshr_b32 s80, s2, 3
  s_lshl_b32 s80, s80, 2
  s_add_u32 s80, s80, s76
  s_lshl_b32 s80, s80, 7
  v_min_u32 v2, 4, v0
  v_lshlrev_b32 v2, 14, v2
  v_add_u32 v3, s80, v2
  v_min_u32 v3, L_pad-L_pc, v3
  global_load_dword v80, v3, s[30:31]
  s_lshl_b32 s80, s76, 12
  s_add_u32 s80, s80, L_main-L_pc
  v_add_u32 v3, s80, v2
  v_min_u32 v3, L_pad-L_pc, v3
  global_load_dword v81, v3, s[30:31]
  s_mov_b32 s79, s2
  s_and_b32 s80, s2, 7
  s_lshr_b32 s81, s2, 3
  s_and_b32 s82, s81, 3
  s_lshl_b32 s77, s80, 2
  s_add_u32 s77, s77, s82
  s_lshr_b32 s78, s81, 2
  v_lshrrev_b32 v5, 3, v0
  v_and_b32 v6, 7, v0
  v_xor_b32 v7, v5, v6
  v_lshlrev_b32 v7, 4, v7
  v_lshl_add_u32 v14, v5, 10, v7
  v_lshrrev_b32 v7, 1, v5
  v_and_b32 v7, 3, v7
  v_lshlrev_b32 v7, 1, v7
  v_xor_b32 v7, v7, v6
  v_lshlrev_b32 v7, 4, v7
  v_lshrrev_b32 v8, 2, v5
  v_lshlrev_b32 v8, 3, v8
  v_and_b32 v9, 3, v5
  v_add_u32 v8, v8, v9
  v_lshl_add_u32 v15, v8, 13, v7
  v_lshl_add_u32 v16, v5, 10, v7
  s_lshl_b32 s86, s78, 18
  s_lshl_b32 s82, s77, 13
  s_add_u32 s95, s86, s82
  s_lshl_b32 s82, s76, 11
  s_add_u32 s95, s95, s82
  s_lshl_b32 s80, s76, 16
  s_add_u32 s86, s86, s80
  s_and_b32 s82, s77, 28
  s_and_b32 s80, s76, 1
  s_lshl_b32 s81, s81, 1
  s_add_u32 s81, s81, s80
  s_lshl_b32 s81, s81, 13
  s_lshl_b32 s82, s82, 8
  s_add_u32 s94, s81, s82
  s_lshr_b32 s81, s76, 1
  s_lshl_b32 s82, s81, 18
  s_lshl_b32 s87, s77, 8
  s_add_u32 s87, s87, s82
  s_lshl_b32 s82, s80, 7
  s_add_u32 s87, s87, s82
  s_lshl_b32 s80, s80, 13
  s_lshl_b32 s81, s81, 12
  s_add_u32 s83, s80, s81
  v_min_u32 v5, 7, v0
  v_lshrrev_b32 v8, 3, v5
  v_and_b32 v5, 7, v5
  v_lshlrev_b32 v5, 7, v5
  v_lshl_add_u32 v5, v8, 19, v5
  v_min_u32 v6, 1, v0
  v_and_b32 v8, 1, v6
  v_lshrrev_b32 v6, 1, v6
  v_lshlrev_b32 v6, 7, v6
  v_lshl_add_u32 v6, v8, 10, v6
  s_waitcnt lgkmcnt(0)
  s_mov_b32 s36, s6
  s_mov_b32 s37, s7
  s_mov_b32 s38, 2097152
  s_mov_b32 s39, 0x00020000
  s_cmp_lt_u32 s76, 2
  s_cselect_b32 s96, s10, s12
  s_cselect_b32 s97, s11, s13
  s_mov_b32 s98, 4194304
  s_mov_b32 s99, 0x00020000
  s_mov_b32 s89, s83
  s_lshl_b32 s88, s76, 13
  buffer_load_dword v84, v6, s[36:39], s95 offen
  buffer_load_dword v85, v5, s[96:99], s94 offen
  s_add_u32 m0, s88, 0
  s_add_u32 s85, s86, 0
  buffer_load_dwordx4 v14, s[36:39], s85 offen lds
  s_add_u32 m0, s88, 1024
  s_add_u32 s85, s86, 8192
  buffer_load_dwordx4 v14, s[36:39], s85 offen lds
  s_add_u32 m0, s88, 2048
  s_add_u32 s85, s86, 16384
  buffer_load_dwordx4 v14, s[36:39], s85 offen lds
  s_add_u32 m0, s88, 3072
  s_add_u32 s85, s86, 24576
  buffer_load_dwordx4 v14, s[36:39], s85 offen lds
  s_mov_b32 s44, s10
  s_mov_b32 s45, s11
  s_mov_b32 s46, 4194304
  s_mov_b32 s47, 0x00020000
  s_mov_b32 s48, s12
  s_mov_b32 s49, s13
  s_mov_b32 s50, 4194304
  s_mov_b32 s51, 0x00020000
  s_mov_b32 s32, s4
  s_mov_b32 s33, s5
  s_mov_b32 s34, 2097152
  s_mov_b32 s35, 0x00020000
  s_mov_b32 s68, s28
  s_mov_b32 s69, s29
  s_mov_b32 s70, 68222976
  s_mov_b32 s71, 0x00020000
  v_min_u32 v2, 7, v0
  v_lshlrev_b32 v2, 7, v2
  v_min_u32 v3, 1, v0
  v_lshlrev_b32 v3, 10, v3
  s_lshl_b32 s80, s2, 13
  s_lshl_b32 s81, s76, 11
  s_add_u32 s16, s80, s81
  v_lshlrev_b32 v12, 5, v0
  v_and_b32 v5, 15, v0
  v_lshrrev_b32 v6, 4, v0
  v_and_b32 v8, 7, v0
  v_xor_b32 v8, v8, v6
  v_lshlrev_b32 v8, 4, v8
  v_lshl_add_u32 v8, v5, 7, v8
  s_and_b32 s81, s76, 1
  s_lshl_b32 s81, s81, 14
  v_add_u32 v18, s81, v8
  v_xor_b32 v19, 64, v18
  v_lshrrev_b32 v8, 2, v0
  v_lshrrev_b32 v9, 3, v0
  v_and_b32 v9, 3, v9
  v_lshlrev_b32 v9, 5, v9
  v_lshl_add_u32 v8, v8, 7, v9
  v_and_b32 v9, 3, v0
  v_lshl_add_u32 v8, v9, 3, v8
  s_lshr_b32 s81, s76, 1
  s_lshl_b32 s81, s81, 13
  s_add_u32 s81, s81, 0x18000
  v_add_u32 v20, s81, v8
  v_xor_b32 v21, 32, v20
  v_xor_b32 v22, 64, v20
  v_xor_b32 v23, 0x60, v20
  s_add_u32 s85, s95, 128
  buffer_load_dword a194, v3, s[36:39], s85 offen
  s_add_u32 s85, s94, 524288
  buffer_load_dword a195, v2, s[96:99], s85 offen
  s_add_u32 m0, s88, 4096
  s_add_u32 s85, s86, 32768
  buffer_load_dwordx4 v14, s[36:39], s85 offen lds
  s_add_u32 m0, s88, 5120
  s_add_u32 s85, s86, 40960
  buffer_load_dwordx4 v14, s[36:39], s85 offen lds
  s_add_u32 m0, s88, 6144
  s_add_u32 s85, s86, 49152
  buffer_load_dwordx4 v14, s[36:39], s85 offen lds
  s_add_u32 m0, s88, 7168
  s_add_u32 s85, s86, 57344
  buffer_load_dwordx4 v14, s[36:39], s85 offen lds
  s_add_u32 m0, s89, 98304
  s_add_u32 s84, s87, 0
  buffer_load_dwordx4 v15, s[44:47], s84 offen offset:0 lds
  s_add_u32 m0, s89, 98304
  s_add_u32 s84, s87, 130048
  buffer_load_dwordx4 v15, s[44:47], s84 offen offset:1024 lds
  s_add_u32 m0, s89, 98304
  s_add_u32 s84, s87, 30720
  buffer_load_dwordx4 v15, s[44:47], s84 offen offset:2048 lds
  s_add_u32 m0, s89, 98304
  s_add_u32 s84, s87, 160768
  buffer_load_dwordx4 v15, s[44:47], s84 offen offset:3072 lds
  s_add_u32 m0, s89, 114688
  s_add_u32 s84, s87, 0
  buffer_load_dwordx4 v15, s[48:51], s84 offen offset:0 lds
  s_add_u32 m0, s89, 114688
  s_add_u32 s84, s87, 130048
  buffer_load_dwordx4 v15, s[48:51], s84 offen offset:1024 lds
  s_add_u32 m0, s89, 114688
  s_add_u32 s84, s87, 30720
  buffer_load_dwordx4 v15, s[48:51], s84 offen offset:2048 lds
  s_add_u32 m0, s89, 114688
  s_add_u32 s84, s87, 160768
  buffer_load_dwordx4 v15, s[48:51], s84 offen offset:3072 lds
  buffer_load_dwordx4 v[4:7], v12, s[32:35], s16 offen offset:0
  buffer_load_dwordx4 v[8:11], v12, s[32:35], s16 offen offset:16
  s_waitcnt vmcnt(22)
  s_mov_b32 s93, 2
  s_mov_b64 exec, 0
  s_cmp_eq_u32 s76, 1
  s_cbranch_scc1 L_hop1
  s_cmp_eq_u32 s76, 2
  s_cbranch_scc1 L_hop2
  s_cmp_eq_u32 s76, 3
  s_cbranch_scc1 L_hop3
  s_branch L_hop4
.p2align 12
L_main:
  s_mov_b64 exec, -1
  s_cmp_eq_u32 s93, 2
  s_cbranch_scc0 L_end
  s_mov_b32 s93, 0
  s_add_u32 m0, s88, 32768
  s_add_u32 s85, s86, 128
  buffer_load_dwordx4 v14, s[36:39], s85 offen lds
  s_add_u32 m0, s88, 33792
  s_add_u32 s85, s86, 8320
  buffer_load_dwordx4 v14, s[36:39], s85 offen lds
  s_add_u32 m0, s88, 34816
  s_add_u32 s85, s86, 16512
  buffer_load_dwordx4 v14, s[36:39], s85 offen lds
  s_add_u32 m0, s88, 35840
  s_add_u32 s85, s86, 24704
  buffer_load_dwordx4 v14, s[36:39], s85 offen lds
  s_waitcnt vmcnt(10)
  s_barrier
  ds_read_b64_tr_b16 a[128:129], v20 offset:0
  ds_read_b64_tr_b16 a[130:131], v20 offset:2048
  ds_read_b64_tr_b16 a[132:133], v20 offset:4096
  ds_read_b64_tr_b16 a[134:135], v20 offset:6144
  ds_read_b128 a[0:3], v18 offset:0
  ds_read_b128 a[4:7], v19 offset:0
  ds_read_b128 a[8:11], v18 offset:2048
  ds_read_b128 a[12:15], v19 offset:2048
  ds_read_b128 a[16:19], v18 offset:4096
  ds_read_b128 a[20:23], v19 offset:4096
  ds_read_b128 a[24:27], v18 offset:6144
  ds_read_b128 a[28:31], v19 offset:6144
  ds_read_b128 a[32:35], v18 offset:8192
  ds_read_b128 a[36:39], v19 offset:8192
  ds_read_b128 a[40:43], v18 offset:10240
  ds_read_b128 a[44:47], v19 offset:10240
  ds_read_b128 a[48:51], v18 offset:12288
  ds_read_b128 a[52:55], v19 offset:12288
  ds_read_b128 a[56:59], v18 offset:14336
  ds_read_b128 a[60:63], v19 offset:14336
  ds_read_b64_tr_b16 a[136:137], v21 offset:0
  ds_read_b64_tr_b16 a[138:139], v21 offset:2048
  ds_read_b64_tr_b16 a[140:141], v21 offset:4096
  ds_read_b64_tr_b16 a[142:143], v21 offset:6144
  s_waitcnt lgkmcnt(0)
  v_mfma_f32_16x16x32_bf16 v[32:35], a[128:131], a[0:3], 0
  s_add_u32 s85, s95, 256
  v_mfma_f32_16x16x32_bf16 v[32:35], a[132:135], a[4:7], v[32:35]
  v_add_u32 v18, 32768, v18
  v_add_u32 v19, 32768, v19
  v_mfma_f32_16x16x32_bf16 v[40:43], a[128:131], a[8:11], 0
  ds_read_b64_tr_b16 a[144:145], v22 offset:0
  ds_read_b64_tr_b16 a[146:147], v22 offset:2048
  v_mfma_f32_16x16x32_bf16 v[40:43], a[132:135], a[12:15], v[40:43]
  buffer_load_dword a196, v3, s[36:39], s85 offen
  v_mfma_f32_16x16x32_bf16 v[48:51], a[128:131], a[16:19], 0
  s_add_u32 s85, s94, 1048576
  v_mfma_f32_16x16x32_bf16 v[48:51], a[132:135], a[20:23], v[48:51]
  buffer_load_dword a197, v2, s[96:99], s85 offen
  v_mfma_f32_16x16x32_bf16 v[56:59], a[128:131], a[24:27], 0
  s_add_u32 m0, s88, 36864
  s_add_u32 s85, s86, 32896
  v_mfma_f32_16x16x32_bf16 v[56:59], a[132:135], a[28:31], v[56:59]
  v_mfma_f32_16x16x32_bf16 v[64:67], a[128:131], a[32:35], 0
  ds_read_b64_tr_b16 a[148:149], v22 offset:4096
  ds_read_b64_tr_b16 a[150:151], v22 offset:6144
  v_mfma_f32_16x16x32_bf16 v[64:67], a[132:135], a[36:39], v[64:67]
  buffer_load_dwordx4 v14, s[36:39], s85 offen lds
  v_mfma_f32_16x16x32_bf16 v[72:75], a[128:131], a[40:43], 0
  s_add_u32 m0, s88, 37888
  s_add_u32 s85, s86, 41088
  v_mfma_f32_16x16x32_bf16 v[72:75], a[132:135], a[44:47], v[72:75]
  v_mfma_f32_16x16x32_bf16 v[80:83], a[128:131], a[48:51], 0
  v_mfma_f32_16x16x32_bf16 v[80:83], a[132:135], a[52:55], v[80:83]
  buffer_load_dwordx4 v14, s[36:39], s85 offen lds
  v_mfma_f32_16x16x32_bf16 v[88:91], a[128:131], a[56:59], 0
  s_add_u32 m0, s88, 38912
  ds_read_b64_tr_b16 a[152:153], v23 offset:0
  ds_read_b64_tr_b16 a[154:155], v23 offset:2048
  v_mfma_f32_16x16x32_bf16 v[88:91], a[132:135], a[60:63], v[88:91]
  s_add_u32 s85, s86, 49280
  v_mfma_f32_16x16x32_bf16 v[36:39], a[136:139], a[0:3], 0
  v_mfma_f32_16x16x32_bf16 v[36:39], a[140:143], a[4:7], v[36:39]
  buffer_load_dwordx4 v14, s[36:39], s85 offen lds
  v_mfma_f32_16x16x32_bf16 v[44:47], a[136:139], a[8:11], 0
  s_add_u32 s85, s95, 384
  v_mfma_f32_16x16x32_bf16 v[44:47], a[140:143], a[12:15], v[44:47]
  buffer_load_dword a198, v3, s[36:39], s85 offen
  v_mfma_f32_16x16x32_bf16 v[52:55], a[136:139], a[16:19], 0
  s_add_u32 s85, s94, 1572864
  ds_read_b64_tr_b16 a[156:157], v23 offset:4096
  ds_read_b64_tr_b16 a[158:159], v23 offset:6144
  v_mfma_f32_16x16x32_bf16 v[52:55], a[140:143], a[20:23], v[52:55]
  buffer_load_dword a199, v2, s[96:99], s85 offen
  v_mfma_f32_16x16x32_bf16 v[60:63], a[136:139], a[24:27], 0
  s_add_u32 m0, s88, 39936
  s_add_u32 s85, s86, 57472
  v_mfma_f32_16x16x32_bf16 v[60:63], a[140:143], a[28:31], v[60:63]
  v_mfma_f32_16x16x32_bf16 v[68:71], a[136:139], a[32:35], 0
  v_mfma_f32_16x16x32_bf16 v[68:71], a[140:143], a[36:39], v[68:71]
  buffer_load_dwordx4 v14, s[36:39], s85 offen lds
  v_mfma_f32_16x16x32_bf16 v[76:79], a[136:139], a[40:43], 0
  s_add_u32 m0, s89, 131072
  s_add_u32 s84, s87, 524288
  v_mfma_f32_16x16x32_bf16 v[76:79], a[140:143], a[44:47], v[76:79]
  v_mfma_f32_16x16x32_bf16 v[84:87], a[136:139], a[48:51], 0
  v_mfma_f32_16x16x32_bf16 v[84:87], a[140:143], a[52:55], v[84:87]
  buffer_load_dwordx4 v15, s[44:47], s84 offen offset:0 lds
  v_mfma_f32_16x16x32_bf16 v[92:95], a[136:139], a[56:59], 0
  s_add_u32 m0, s89, 131072
  s_add_u32 s84, s87, 654336
  v_mfma_f32_16x16x32_bf16 v[92:95], a[140:143], a[60:63], v[92:95]
  s_waitcnt lgkmcnt(0)
  v_mfma_f32_16x16x32_bf16 v[96:99], a[144:147], a[0:3], 0
  s_waitcnt vmcnt(15)
  s_barrier
  v_mfma_f32_16x16x32_bf16 v[96:99], a[148:151], a[4:7], v[96:99]
  v_mfma_f32_16x16x32_bf16 v[104:107], a[144:147], a[8:11], 0
  ds_read_b64_tr_b16 a[128:129], v20 offset:16384
  ds_read_b64_tr_b16 a[130:131], v20 offset:18432
  v_mfma_f32_16x16x32_bf16 v[104:107], a[148:151], a[12:15], v[104:107]
  buffer_load_dwordx4 v15, s[44:47], s84 offen offset:1024 lds
  v_mfma_f32_16x16x32_bf16 v[112:115], a[144:147], a[16:19], 0
  s_add_u32 m0, s89, 131072
  s_add_u32 s84, s87, 555008
  v_mfma_f32_16x16x32_bf16 v[112:115], a[148:151], a[20:23], v[112:115]
  v_mfma_f32_16x16x32_bf16 v[120:123], a[144:147], a[24:27], 0
  v_mfma_f32_16x16x32_bf16 v[120:123], a[148:151], a[28:31], v[120:123]
  buffer_load_dwordx4 v15, s[44:47], s84 offen offset:2048 lds
  v_mfma_f32_16x16x32_bf16 v[192:195], a[144:147], a[32:35], 0
  s_add_u32 m0, s89, 131072
  ds_read_b64_tr_b16 a[132:133], v20 offset:20480
  ds_read_b64_tr_b16 a[134:135], v20 offset:22528
  v_mfma_f32_16x16x32_bf16 v[192:195], a[148:151], a[36:39], v[192:195]
  s_add_u32 s84, s87, 685056
  v_mfma_f32_16x16x32_bf16 v[128:131], a[144:147], a[40:43], 0
  v_mfma_f32_16x16x32_bf16 v[128:131], a[148:151], a[44:47], v[128:131]
  buffer_load_dwordx4 v15, s[44:47], s84 offen offset:3072 lds
  v_mfma_f32_16x16x32_bf16 v[200:203], a[144:147], a[48:51], 0
  s_add_u32 m0, s89, 147456
  s_add_u32 s84, s87, 524288
  v_mfma_f32_16x16x32_bf16 v[200:203], a[148:151], a[52:55], v[200:203]
  v_mfma_f32_16x16x32_bf16 v[136:139], a[144:147], a[56:59], 0
  ds_read_b64_tr_b16 a[136:137], v21 offset:16384
  ds_read_b64_tr_b16 a[138:139], v21 offset:18432
  v_mfma_f32_16x16x32_bf16 v[136:139], a[148:151], a[60:63], v[136:139]
  buffer_load_dwordx4 v15, s[48:51], s84 offen offset:0 lds
  v_mfma_f32_16x16x32_bf16 v[100:103], a[152:155], a[0:3], 0
  s_add_u32 m0, s89, 147456
  s_add_u32 s84, s87, 654336
  v_mfma_f32_16x16x32_bf16 v[100:103], a[156:159], a[4:7], v[100:103]
  v_mfma_f32_16x16x32_bf16 v[108:111], a[152:155], a[8:11], 0
  v_mfma_f32_16x16x32_bf16 v[108:111], a[156:159], a[12:15], v[108:111]
  buffer_load_dwordx4 v15, s[48:51], s84 offen offset:1024 lds
  v_mfma_f32_16x16x32_bf16 v[116:119], a[152:155], a[16:19], 0
  s_add_u32 m0, s89, 147456
  ds_read_b64_tr_b16 a[140:141], v21 offset:20480
  ds_read_b64_tr_b16 a[142:143], v21 offset:22528
  v_mfma_f32_16x16x32_bf16 v[116:119], a[156:159], a[20:23], v[116:119]
  s_add_u32 s84, s87, 555008
  v_mfma_f32_16x16x32_bf16 v[124:127], a[152:155], a[24:27], 0
  v_mfma_f32_16x16x32_bf16 v[124:127], a[156:159], a[28:31], v[124:127]
  buffer_load_dwordx4 v15, s[48:51], s84 offen offset:2048 lds
  v_mfma_f32_16x16x32_bf16 v[196:199], a[152:155], a[32:35], 0
  s_add_u32 m0, s89, 147456
  s_add_u32 s84, s87, 685056
  v_mfma_f32_16x16x32_bf16 v[196:199], a[156:159], a[36:39], v[196:199]
  v_mfma_f32_16x16x32_bf16 v[132:135], a[152:155], a[40:43], 0
  v_mfma_f32_16x16x32_bf16 v[132:135], a[156:159], a[44:47], v[132:135]
  buffer_load_dwordx4 v15, s[48:51], s84 offen offset:3072 lds
  v_mfma_f32_16x16x32_bf16 v[204:207], a[152:155], a[48:51], 0
  s_add_u32 m0, s89, 98304
  s_add_u32 s84, s87, 1048576
  v_mfma_f32_16x16x32_bf16 v[204:207], a[156:159], a[52:55], v[204:207]
  v_mfma_f32_16x16x32_bf16 v[140:143], a[152:155], a[56:59], 0
  v_mfma_f32_16x16x32_bf16 v[140:143], a[156:159], a[60:63], v[140:143]
  s_waitcnt lgkmcnt(0)
  v_mfma_f32_16x16x32_bf16 v[208:211], a[0:3], a[128:131], 0
  buffer_load_dwordx4 v15, s[44:47], s84 offen offset:0 lds
  v_mfma_f32_16x16x32_bf16 v[208:211], a[4:7], a[132:135], v[208:211]
  s_add_u32 m0, s89, 98304
  s_add_u32 s84, s87, 1178624
  v_mfma_f32_16x16x32_bf16 v[212:215], a[8:11], a[128:131], 0
  ds_read_b64_tr_b16 a[144:145], v22 offset:16384
  ds_read_b64_tr_b16 a[146:147], v22 offset:18432
  v_mfma_f32_16x16x32_bf16 v[212:215], a[12:15], a[132:135], v[212:215]
  v_mfma_f32_16x16x32_bf16 v[224:227], a[16:19], a[128:131], 0
  buffer_load_dwordx4 v15, s[44:47], s84 offen offset:1024 lds
  v_mfma_f32_16x16x32_bf16 v[224:227], a[20:23], a[132:135], v[224:227]
  s_add_u32 m0, s89, 98304
  s_add_u32 s84, s87, 1079296
  v_mfma_f32_16x16x32_bf16 v[228:231], a[24:27], a[128:131], 0
  v_mfma_f32_16x16x32_bf16 v[228:231], a[28:31], a[132:135], v[228:231]
  v_mfma_f32_16x16x32_bf16 v[240:243], a[32:35], a[128:131], 0
  ds_read_b64_tr_b16 a[148:149], v22 offset:20480
  ds_read_b64_tr_b16 a[150:151], v22 offset:22528
  v_mfma_f32_16x16x32_bf16 v[240:243], a[36:39], a[132:135], v[240:243]
  buffer_load_dwordx4 v15, s[44:47], s84 offen offset:2048 lds
  v_mfma_f32_16x16x32_bf16 v[244:247], a[40:43], a[128:131], 0
  s_add_u32 m0, s89, 98304
  s_add_u32 s84, s87, 1209344
  v_mfma_f32_16x16x32_bf16 v[244:247], a[44:47], a[132:135], v[244:247]
  v_mfma_f32_16x16x32_bf16 a[224:227], a[48:51], a[128:131], 0
  v_mfma_f32_16x16x32_bf16 a[224:227], a[52:55], a[132:135], a[224:227]
  buffer_load_dwordx4 v15, s[44:47], s84 offen offset:3072 lds
  v_mfma_f32_16x16x32_bf16 a[228:231], a[56:59], a[128:131], 0
  s_add_u32 m0, s88, 65536
  ds_read_b64_tr_b16 a[152:153], v23 offset:16384
  ds_read_b64_tr_b16 a[154:155], v23 offset:18432
  v_mfma_f32_16x16x32_bf16 a[228:231], a[60:63], a[132:135], a[228:231]
  s_add_u32 s85, s86, 256
  v_mfma_f32_16x16x32_bf16 v[144:147], a[0:3], a[136:139], 0
  v_mfma_f32_16x16x32_bf16 v[144:147], a[4:7], a[140:143], v[144:147]
  buffer_load_dwordx4 v14, s[36:39], s85 offen lds
  v_mfma_f32_16x16x32_bf16 v[148:151], a[8:11], a[136:139], 0
  s_add_u32 m0, s88, 66560
  s_add_u32 s85, s86, 8448
  v_mfma_f32_16x16x32_bf16 v[148:151], a[12:15], a[140:143], v[148:151]
  v_mfma_f32_16x16x32_bf16 v[160:163], a[16:19], a[136:139], 0
  ds_read_b64_tr_b16 a[156:157], v23 offset:20480
  ds_read_b64_tr_b16 a[158:159], v23 offset:22528
  v_mfma_f32_16x16x32_bf16 v[160:163], a[20:23], a[140:143], v[160:163]
  buffer_load_dwordx4 v14, s[36:39], s85 offen lds
  s_waitcnt vmcnt(26)
  v_lshlrev_b32 v26, 16, v4
  v_and_b32 v27, 0xffff0000, v4
  v_add_f32 v1, v26, v27
  v_lshlrev_b32 v26, 16, v5
  v_and_b32 v27, 0xffff0000, v5
  v_mfma_f32_16x16x32_bf16 v[164:167], a[24:27], a[136:139], 0
  s_add_u32 m0, s88, 67584
  s_add_u32 s85, s86, 16640
  v_add_f32 v1, v1, v26
  v_add_f32 v1, v1, v27
  v_lshlrev_b32 v26, 16, v6
  v_and_b32 v27, 0xffff0000, v6
  v_add_f32 v1, v1, v26
  v_add_f32 v1, v1, v27
  v_lshlrev_b32 v26, 16, v7
  v_mfma_f32_16x16x32_bf16 v[164:167], a[28:31], a[140:143], v[164:167]
  v_and_b32 v27, 0xffff0000, v7
  v_add_f32 v1, v1, v26
  v_add_f32 v1, v1, v27
  v_lshlrev_b32 v26, 16, v8
  v_and_b32 v27, 0xffff0000, v8
  v_add_f32 v1, v1, v26
  v_add_f32 v1, v1, v27
  v_lshlrev_b32 v26, 16, v9
  v_mfma_f32_16x16x32_bf16 v[176:179], a[32:35], a[136:139], 0
  v_and_b32 v27, 0xffff0000, v9
  v_add_f32 v1, v1, v26
  v_add_f32 v1, v1, v27
  v_lshlrev_b32 v26, 16, v10
  v_and_b32 v27, 0xffff0000, v10
  v_add_f32 v1, v1, v26
  v_add_f32 v1, v1, v27
  v_lshlrev_b32 v26, 16, v11
  v_mfma_f32_16x16x32_bf16 v[176:179], a[36:39], a[140:143], v[176:179]
  buffer_load_dwordx4 v14, s[36:39], s85 offen lds
  v_and_b32 v27, 0xffff0000, v11
  v_add_f32 v1, v1, v26
  v_add_f32 v1, v1, v27
  s_nop 1
  v_add_f32_dpp v1, v1, v1 quad_perm:[1,0,3,2] row_mask:0xf bank_mask:0xf
  s_nop 1
  v_add_f32_dpp v1, v1, v1 quad_perm:[2,3,0,1] row_mask:0xf bank_mask:0xf
  s_nop 1
  v_add_f32_dpp v1, v1, v1 row_half_mirror row_mask:0xf bank_mask:0xf
  v_mfma_f32_16x16x32_bf16 v[180:183], a[40:43], a[136:139], 0
  s_add_u32 m0, s88, 68608
  s_add_u32 s85, s86, 24832
  v_add_f32_dpp v1, v1, v1 row_mirror row_mask:0xf bank_mask:0xf
  v_mov_b32 v26, v1
  s_nop 1
  v_permlane16_swap_b32 v1, v26
  v_add_f32 v1, v1, v26
  v_mul_f32 v1, 0x3b000000, v1
  v_mov_b32 v12, 0
  v_mfma_f32_16x16x32_bf16 v[180:183], a[44:47], a[140:143], v[180:183]
  v_lshlrev_b32 v26, 16, v4
  v_and_b32 v27, 0xffff0000, v4
  v_sub_f32 v26, v26, v1
  v_sub_f32 v27, v27, v1
  v_fmac_f32 v12, v26, v26
  v_fmac_f32 v12, v27, v27
  v_lshlrev_b32 v26, 16, v5
  v_and_b32 v27, 0xffff0000, v5
  v_mfma_f32_16x16x32_bf16 a[232:235], a[48:51], a[136:139], 0
  v_sub_f32 v26, v26, v1
  v_sub_f32 v27, v27, v1
  v_fmac_f32 v12, v26, v26
  v_fmac_f32 v12, v27, v27
  v_lshlrev_b32 v26, 16, v6
  v_and_b32 v27, 0xffff0000, v6
  v_sub_f32 v26, v26, v1
  v_sub_f32 v27, v27, v1
  v_mfma_f32_16x16x32_bf16 a[232:235], a[52:55], a[140:143], a[232:235]
  buffer_load_dwordx4 v14, s[36:39], s85 offen lds
  v_fmac_f32 v12, v26, v26
  v_fmac_f32 v12, v27, v27
  v_lshlrev_b32 v26, 16, v7
  v_and_b32 v27, 0xffff0000, v7
  v_sub_f32 v26, v26, v1
  v_sub_f32 v27, v27, v1
  v_mfma_f32_16x16x32_bf16 a[236:239], a[56:59], a[136:139], 0
  s_add_u32 m0, s88, 69632
  s_add_u32 s85, s86, 33024
  v_fmac_f32 v12, v26, v26
  v_fmac_f32 v12, v27, v27
  v_lshlrev_b32 v26, 16, v8
  v_and_b32 v27, 0xffff0000, v8
  v_sub_f32 v26, v26, v1
  v_sub_f32 v27, v27, v1
  v_fmac_f32 v12, v26, v26
  v_mfma_f32_16x16x32_bf16 a[236:239], a[60:63], a[140:143], a[236:239]
  s_waitcnt lgkmcnt(0)
  v_fmac_f32 v12, v27, v27
  v_lshlrev_b32 v26, 16, v9
  v_and_b32 v27, 0xffff0000, v9
  v_sub_f32 v26, v26, v1
  v_sub_f32 v27, v27, v1
  v_fmac_f32 v12, v26, v26
  v_fmac_f32 v12, v27, v27
  v_lshlrev_b32 v26, 16, v10
  v_mfma_f32_16x16x32_bf16 v[216:219], a[0:3], a[144:147], 0
  s_waitcnt vmcnt(12)
  s_barrier
  v_mfma_f32_16x16x32_bf16 v[216:219], a[4:7], a[148:151], v[216:219]
  v_and_b32 v27, 0xffff0000, v10
  v_sub_f32 v26, v26, v1
  v_sub_f32 v27, v27, v1
  v_fmac_f32 v12, v26, v26
  v_fmac_f32 v12, v27, v27
  v_lshlrev_b32 v26, 16, v11
  v_and_b32 v27, 0xffff0000, v11
  v_sub_f32 v26, v26, v1
  v_mfma_f32_16x16x32_bf16 v[220:223], a[8:11], a[144:147], 0
  ds_read_b64_tr_b16 a[128:129], v20 offset:32768
  ds_read_b64_tr_b16 a[130:131], v20 offset:34816
  v_sub_f32 v27, v27, v1
  v_fmac_f32 v12, v26, v26
  v_fmac_f32 v12, v27, v27
  s_nop 1
  v_add_f32_dpp v12, v12, v12 quad_perm:[1,0,3,2] row_mask:0xf bank_mask:0xf
  s_nop 1
  v_add_f32_dpp v12, v12, v12 quad_perm:[2,3,0,1] row_mask:0xf bank_mask:0xf
  s_nop 1
  v_add_f32_dpp v12, v12, v12 row_half_mirror row_mask:0xf bank_mask:0xf
  v_mfma_f32_16x16x32_bf16 v[220:223], a[12:15], a[148:151], v[220:223]
  buffer_load_dwordx4 v14, s[36:39], s85 offen lds
  v_add_f32_dpp v12, v12, v12 row_mirror row_mask:0xf bank_mask:0xf
  v_mov_b32 v26, v12
  s_nop 1
  v_permlane16_swap_b32 v12, v26
  v_add_f32 v12, v12, v26
  v_mul_f32 v12, 0x3b000000, v12
  v_mfma_f32_16x16x32_bf16 v[232:235], a[16:19], a[144:147], 0
  s_add_u32 m0, s88, 70656
  ds_read_b128 a[64:67], v18 offset:0
  s_add_u32 s85, s86, 41216
  v_cvt_pk_bf16_f32 v12, v12, v12
  v_lshlrev_b32 v12, 16, v12
  v_add_f32 v12, 0x3727c5ac, v12
  v_cvt_pk_bf16_f32 v12, v12, v12
  v_lshlrev_b32 v12, 16, v12
  v_mfma_f32_16x16x32_bf16 v[232:235], a[20:23], a[148:151], v[232:235]
  ds_read_b128 a[68:71], v19 offset:0
  v_sqrt_f32 v12, v12
  v_cvt_pk_bf16_f32 v1, v1, v1
  v_lshlrev_b32 v1, 16, v1
  v_cvt_pk_bf16_f32 v12, v12, v12
  v_lshlrev_b32 v12, 16, v12
  v_mfma_f32_16x16x32_bf16 v[236:239], a[24:27], a[144:147], 0
  ds_read_b128 a[72:75], v18 offset:2048
  v_rcp_f32 v12, v12
  v_lshlrev_b32 v26, 16, v4
  v_and_b32 v27, 0xffff0000, v4
  v_sub_f32 v26, v26, v1
  v_sub_f32 v27, v27, v1
  v_cvt_pk_bf16_f32 v4, v26, v27
  v_mfma_f32_16x16x32_bf16 v[236:239], a[28:31], a[148:151], v[236:239]
  buffer_load_dwordx4 v14, s[36:39], s85 offen lds
  v_lshlrev_b32 v26, 16, v4
  v_and_b32 v27, 0xffff0000, v4
  v_mul_f32 v26, v26, v12
  v_mul_f32 v27, v27, v12
  v_cvt_pk_bf16_f32 v4, v26, v27
  v_lshlrev_b32 v26, 16, v5
  v_mfma_f32_16x16x32_bf16 v[248:251], a[32:35], a[144:147], 0
  s_add_u32 m0, s88, 71680
  ds_read_b64_tr_b16 a[132:133], v20 offset:36864
  ds_read_b64_tr_b16 a[134:135], v20 offset:38912
  v_and_b32 v27, 0xffff0000, v5
  v_sub_f32 v26, v26, v1
  v_sub_f32 v27, v27, v1
  v_cvt_pk_bf16_f32 v5, v26, v27
  v_lshlrev_b32 v26, 16, v5
  v_and_b32 v27, 0xffff0000, v5
  v_mfma_f32_16x16x32_bf16 v[248:251], a[36:39], a[148:151], v[248:251]
  s_add_u32 s85, s86, 49408
  v_mul_f32 v26, v26, v12
  v_mul_f32 v27, v27, v12
  v_cvt_pk_bf16_f32 v5, v26, v27
  v_lshlrev_b32 v26, 16, v6
  v_and_b32 v27, 0xffff0000, v6
  v_sub_f32 v26, v26, v1
  v_sub_f32 v27, v27, v1
  v_cvt_pk_bf16_f32 v6, v26, v27
  v_mfma_f32_16x16x32_bf16 v[252:255], a[40:43], a[144:147], 0
  ds_read_b128 a[76:79], v19 offset:2048
  v_lshlrev_b32 v26, 16, v6
  v_and_b32 v27, 0xffff0000, v6
  v_mul_f32 v26, v26, v12
  v_mul_f32 v27, v27, v12
  v_cvt_pk_bf16_f32 v6, v26, v27
  v_lshlrev_b32 v26, 16, v7
  v_and_b32 v27, 0xffff0000, v7
  v_mfma_f32_16x16x32_bf16 v[252:255], a[44:47], a[148:151], v[252:255]
  ds_read_b128 a[80:83], v18 offset:4096
  v_sub_f32 v26, v26, v1
  v_sub_f32 v27, v27, v1
  v_cvt_pk_bf16_f32 v7, v26, v27
  v_lshlrev_b32 v26, 16, v7
  v_and_b32 v27, 0xffff0000, v7
  v_mul_f32 v26, v26, v12
  v_mul_f32 v27, v27, v12
  v_mfma_f32_16x16x32_bf16 a[240:243], a[48:51], a[144:147], 0
  ds_read_b128 a[84:87], v19 offset:4096
  v_cvt_pk_bf16_f32 v7, v26, v27
  v_lshlrev_b32 v26, 16, v8
  v_and_b32 v27, 0xffff0000, v8
  v_sub_f32 v26, v26, v1
  v_sub_f32 v27, v27, v1
  v_cvt_pk_bf16_f32 v8, v26, v27
  v_lshlrev_b32 v26, 16, v8
  v_mfma_f32_16x16x32_bf16 a[240:243], a[52:55], a[148:151], a[240:243]
  buffer_load_dwordx4 v14, s[36:39], s85 offen lds
  v_and_b32 v27, 0xffff0000, v8
  v_mul_f32 v26, v26, v12
  v_mul_f32 v27, v27, v12
  v_cvt_pk_bf16_f32 v8, v26, v27
  v_lshlrev_b32 v26, 16, v9
  v_and_b32 v27, 0xffff0000, v9
  v_mfma_f32_16x16x32_bf16 a[244:247], a[56:59], a[144:147], 0
  s_add_u32 m0, s88, 72704
  ds_read_b64_tr_b16 a[136:137], v21 offset:32768
  ds_read_b64_tr_b16 a[138:139], v21 offset:34816
  v_sub_f32 v26, v26, v1
  v_sub_f32 v27, v27, v1
  v_cvt_pk_bf16_f32 v9, v26, v27
  v_lshlrev_b32 v26, 16, v9
  v_and_b32 v27, 0xffff0000, v9
  v_mul_f32 v26, v26, v12
  v_mfma_f32_16x16x32_bf16 a[244:247], a[60:63], a[148:151], a[244:247]
  s_add_u32 s85, s86, 57600
  v_mul_f32 v27, v27, v12
  v_cvt_pk_bf16_f32 v9, v26, v27
  v_lshlrev_b32 v26, 16, v10
  v_and_b32 v27, 0xffff0000, v10
  v_sub_f32 v26, v26, v1
  v_sub_f32 v27, v27, v1
  v_cvt_pk_bf16_f32 v10, v26, v27
  v_lshlrev_b32 v26, 16, v10
  v_mfma_f32_16x16x32_bf16 v[152:155], a[0:3], a[152:155], 0
  ds_read_b128 a[88:91], v18 offset:6144
  v_and_b32 v27, 0xffff0000, v10
  v_mul_f32 v26, v26, v12
  v_mul_f32 v27, v27, v12
  v_cvt_pk_bf16_f32 v10, v26, v27
  v_lshlrev_b32 v26, 16, v11
  v_and_b32 v27, 0xffff0000, v11
  v_sub_f32 v26, v26, v1
  v_mfma_f32_16x16x32_bf16 v[152:155], a[4:7], a[156:159], v[152:155]
  ds_read_b128 a[92:95], v19 offset:6144
  v_sub_f32 v27, v27, v1
  v_cvt_pk_bf16_f32 v11, v26, v27
  v_lshlrev_b32 v26, 16, v11
  v_and_b32 v27, 0xffff0000, v11
  v_mul_f32 v26, v26, v12
  v_mul_f32 v27, v27, v12
  v_cvt_pk_bf16_f32 v11, v26, v27
  v_mfma_f32_16x16x32_bf16 v[156:159], a[8:11], a[152:155], 0
  s_lshl_b32 s80, s76, 1
  ds_read_b128 a[96:99], v18 offset:8192
  v_lshrrev_b32 v26, 5, v0
  v_add_u32 v26, s80, v26
  v_mul_u32_u24 v26, 1040, v26
  v_and_b32 v27, 31, v0
  v_lshl_add_u32 v26, v27, 5, v26
  v_add_u32 v26, 131072, v26
  v_and_b32 v1, 7, v0
  v_mfma_f32_16x16x32_bf16 v[156:159], a[12:15], a[156:159], v[156:159]
  buffer_load_dwordx4 v14, s[36:39], s85 offen lds
  v_lshrrev_b32 v12, 3, v0
  v_mul_u32_u24 v27, 1040, v1
  v_lshl_add_u32 v27, v12, 4, v27
  s_lshl_b32 s80, s76, 8
  s_add_u32 s80, s80, 131072
  v_add_u32 v27, s80, v27
  v_mfma_f32_16x16x32_bf16 v[168:171], a[16:19], a[152:155], 0
  s_add_u32 m0, s89, 114688
  ds_read_b64_tr_b16 a[140:141], v21 offset:36864
  ds_read_b64_tr_b16 a[142:143], v21 offset:38912
  v_lshlrev_b32 v28, 8, v12
  v_lshl_add_u32 v28, v1, 4, v28
  s_lshr_b32 s80, s79, 1
  s_lshl_b32 s80, s80, 14
  s_and_b32 s81, s79, 1
  s_lshl_b32 s81, s81, 7
  v_mfma_f32_16x16x32_bf16 v[168:171], a[20:23], a[156:159], v[168:171]
  s_add_u32 s84, s87, 1048576
  s_add_u32 s80, s80, s81
  s_lshl_b32 s81, s76, 12
  s_add_u32 s17, s80, s81
  v_mfma_f32_16x16x32_bf16 v[172:175], a[24:27], a[152:155], 0
  ds_read_b128 a[100:103], v19 offset:8192
  v_mfma_f32_16x16x32_bf16 v[172:175], a[28:31], a[156:159], v[172:175]
  ds_read_b128 a[104:107], v18 offset:10240
  v_mfma_f32_16x16x32_bf16 v[184:187], a[32:35], a[152:155], 0
  ds_read_b128 a[108:111], v19 offset:10240
  v_mfma_f32_16x16x32_bf16 v[184:187], a[36:39], a[156:159], v[184:187]
  buffer_load_dwordx4 v15, s[48:51], s84 offen offset:0 lds
  v_mfma_f32_16x16x32_bf16 v[188:191], a[40:43], a[152:155], 0
  s_add_u32 m0, s89, 114688
  ds_read_b128 a[112:115], v18 offset:12288
  s_add_u32 s84, s87, 1178624
  v_mfma_f32_16x16x32_bf16 v[188:191], a[44:47], a[156:159], v[188:191]
  v_mfma_f32_16x16x32_bf16 a[248:251], a[48:51], a[152:155], 0
  ds_read_b128 a[116:119], v19 offset:12288
  v_mfma_f32_16x16x32_bf16 a[248:251], a[52:55], a[156:159], a[248:251]
  buffer_load_dwordx4 v15, s[48:51], s84 offen offset:1024 lds
  v_mfma_f32_16x16x32_bf16 a[252:255], a[56:59], a[152:155], 0
  s_add_u32 m0, s89, 114688
  ds_read_b128 a[120:123], v18 offset:14336
  s_add_u32 s84, s87, 1079296
  v_mfma_f32_16x16x32_bf16 a[252:255], a[60:63], a[156:159], a[252:255]
  s_waitcnt lgkmcnt(6)
  v_mfma_f32_16x16x32_bf16 v[32:35], a[128:131], a[64:67], v[32:35]
  ds_read_b128 a[124:127], v19 offset:14336
  v_mfma_f32_16x16x32_bf16 v[32:35], a[132:135], a[68:71], v[32:35]
  v_add_u32 v18, 32768, v18
  v_add_u32 v19, 32768, v19
  v_mfma_f32_16x16x32_bf16 v[40:43], a[128:131], a[72:75], v[40:43]
  ds_read_b64_tr_b16 a[144:145], v22 offset:32768
  ds_read_b64_tr_b16 a[146:147], v22 offset:34816
  v_mfma_f32_16x16x32_bf16 v[40:43], a[132:135], a[76:79], v[40:43]
  buffer_load_dwordx4 v15, s[48:51], s84 offen offset:2048 lds
  v_mfma_f32_16x16x32_bf16 v[48:51], a[128:131], a[80:83], v[48:51]
  s_add_u32 m0, s89, 114688
  s_add_u32 s84, s87, 1209344
  v_mfma_f32_16x16x32_bf16 v[48:51], a[132:135], a[84:87], v[48:51]
  v_mfma_f32_16x16x32_bf16 v[56:59], a[128:131], a[88:91], v[56:59]
  v_mfma_f32_16x16x32_bf16 v[56:59], a[132:135], a[92:95], v[56:59]
  s_waitcnt lgkmcnt(2)
  v_mfma_f32_16x16x32_bf16 v[64:67], a[128:131], a[96:99], v[64:67]
  ds_read_b64_tr_b16 a[148:149], v22 offset:36864
  ds_read_b64_tr_b16 a[150:151], v22 offset:38912
  v_mfma_f32_16x16x32_bf16 v[64:67], a[132:135], a[100:103], v[64:67]
  buffer_load_dwordx4 v15, s[48:51], s84 offen offset:3072 lds
  v_mfma_f32_16x16x32_bf16 v[72:75], a[128:131], a[104:107], v[72:75]
  s_add_u32 m0, s88, 0
  s_add_u32 s85, s86, 384
  v_mfma_f32_16x16x32_bf16 v[72:75], a[132:135], a[108:111], v[72:75]
  v_mfma_f32_16x16x32_bf16 v[80:83], a[128:131], a[112:115], v[80:83]
  v_mfma_f32_16x16x32_bf16 v[80:83], a[132:135], a[116:119], v[80:83]
  buffer_load_dwordx4 v14, s[36:39], s85 offen lds
  v_mfma_f32_16x16x32_bf16 v[88:91], a[128:131], a[120:123], v[88:91]
  s_add_u32 m0, s88, 1024
  ds_read_b64_tr_b16 a[152:153], v23 offset:32768
  ds_read_b64_tr_b16 a[154:155], v23 offset:34816
  v_mfma_f32_16x16x32_bf16 v[88:91], a[132:135], a[124:127], v[88:91]
  s_add_u32 s85, s86, 8576
  v_mfma_f32_16x16x32_bf16 v[36:39], a[136:139], a[64:67], v[36:39]
  v_mfma_f32_16x16x32_bf16 v[36:39], a[140:143], a[68:71], v[36:39]
  buffer_load_dwordx4 v14, s[36:39], s85 offen lds
  v_mfma_f32_16x16x32_bf16 v[44:47], a[136:139], a[72:75], v[44:47]
  s_add_u32 s85, s95, 512
  v_mfma_f32_16x16x32_bf16 v[44:47], a[140:143], a[76:79], v[44:47]
  buffer_load_dword a200, v3, s[36:39], s85 offen
  v_mfma_f32_16x16x32_bf16 v[52:55], a[136:139], a[80:83], v[52:55]
  s_add_u32 s85, s94, 2097152
  ds_read_b64_tr_b16 a[156:157], v23 offset:36864
  ds_read_b64_tr_b16 a[158:159], v23 offset:38912
  v_mfma_f32_16x16x32_bf16 v[52:55], a[140:143], a[84:87], v[52:55]
  buffer_load_dword a201, v2, s[96:99], s85 offen
  v_mfma_f32_16x16x32_bf16 v[60:63], a[136:139], a[88:91], v[60:63]
  s_add_u32 m0, s88, 2048
  s_add_u32 s85, s86, 16768
  v_mfma_f32_16x16x32_bf16 v[60:63], a[140:143], a[92:95], v[60:63]
  v_mfma_f32_16x16x32_bf16 v[68:71], a[136:139], a[96:99], v[68:71]
  v_mfma_f32_16x16x32_bf16 v[68:71], a[140:143], a[100:103], v[68:71]
  buffer_load_dwordx4 v14, s[36:39], s85 offen lds
  v_mfma_f32_16x16x32_bf16 v[76:79], a[136:139], a[104:107], v[76:79]
  s_add_u32 m0, s88, 3072
  s_add_u32 s85, s86, 24960
  v_mfma_f32_16x16x32_bf16 v[76:79], a[140:143], a[108:111], v[76:79]
  v_mfma_f32_16x16x32_bf16 v[84:87], a[136:139], a[112:115], v[84:87]
L_hop1:
  s_cbranch_execz L_hop5
  v_mfma_f32_16x16x32_bf16 v[84:87], a[140:143], a[116:119], v[84:87]
  buffer_load_dwordx4 v14, s[36:39], s85 offen lds
  v_mfma_f32_16x16x32_bf16 v[92:95], a[136:139], a[120:123], v[92:95]
  s_add_u32 m0, s88, 4096
  s_add_u32 s85, s86, 33152
  v_mfma_f32_16x16x32_bf16 v[92:95], a[140:143], a[124:127], v[92:95]
  s_waitcnt lgkmcnt(0)
  v_mfma_f32_16x16x32_bf16 v[96:99], a[144:147], a[64:67], v[96:99]
  s_waitcnt vmcnt(22)
  s_barrier
  v_mfma_f32_16x16x32_bf16 v[96:99], a[148:151], a[68:71], v[96:99]
  v_mfma_f32_16x16x32_bf16 v[104:107], a[144:147], a[72:75], v[104:107]
  ds_read_b64_tr_b16 a[128:129], v20 offset:49152
  ds_read_b64_tr_b16 a[130:131], v20 offset:51200
  v_mfma_f32_16x16x32_bf16 v[104:107], a[148:151], a[76:79], v[104:107]
  buffer_load_dwordx4 v14, s[36:39], s85 offen lds
  v_mfma_f32_16x16x32_bf16 v[112:115], a[144:147], a[80:83], v[112:115]
  s_add_u32 m0, s88, 5120
  s_add_u32 s85, s86, 41344
  v_mfma_f32_16x16x32_bf16 v[112:115], a[148:151], a[84:87], v[112:115]
  v_mfma_f32_16x16x32_bf16 v[120:123], a[144:147], a[88:91], v[120:123]
  v_mfma_f32_16x16x32_bf16 v[120:123], a[148:151], a[92:95], v[120:123]
  buffer_load_dwordx4 v14, s[36:39], s85 offen lds
  v_mfma_f32_16x16x32_bf16 v[192:195], a[144:147], a[96:99], v[192:195]
  s_add_u32 m0, s88, 6144
  ds_read_b64_tr_b16 a[132:133], v20 offset:53248
  ds_read_b64_tr_b16 a[134:135], v20 offset:55296
  v_mfma_f32_16x16x32_bf16 v[192:195], a[148:151], a[100:103], v[192:195]
  s_add_u32 s85, s86, 49536
  v_mfma_f32_16x16x32_bf16 v[128:131], a[144:147], a[104:107], v[128:131]
  v_mfma_f32_16x16x32_bf16 v[128:131], a[148:151], a[108:111], v[128:131]
  buffer_load_dwordx4 v14, s[36:39], s85 offen lds
  v_mfma_f32_16x16x32_bf16 v[200:203], a[144:147], a[112:115], v[200:203]
  s_add_u32 m0, s88, 7168
  s_add_u32 s85, s86, 57728
  v_mfma_f32_16x16x32_bf16 v[200:203], a[148:151], a[116:119], v[200:203]
  v_mfma_f32_16x16x32_bf16 v[136:139], a[144:147], a[120:123], v[136:139]
  ds_read_b64_tr_b16 a[136:137], v21 offset:49152
  ds_read_b64_tr_b16 a[138:139], v21 offset:51200
  v_mfma_f32_16x16x32_bf16 v[136:139], a[148:151], a[124:127], v[136:139]
  buffer_load_dwordx4 v14, s[36:39], s85 offen lds
  v_mfma_f32_16x16x32_bf16 v[100:103], a[152:155], a[64:67], v[100:103]
  s_add_u32 m0, s88, 32768
  s_add_u32 s85, s86, 512
  v_mfma_f32_16x16x32_bf16 v[100:103], a[156:159], a[68:71], v[100:103]
  v_mfma_f32_16x16x32_bf16 v[108:111], a[152:155], a[72:75], v[108:111]
  v_mfma_f32_16x16x32_bf16 v[108:111], a[156:159], a[76:79], v[108:111]
  buffer_load_dwordx4 v14, s[36:39], s85 offen lds
  v_mfma_f32_16x16x32_bf16 v[116:119], a[152:155], a[80:83], v[116:119]
  s_add_u32 m0, s88, 33792
  ds_read_b64_tr_b16 a[140:141], v21 offset:53248
  ds_read_b64_tr_b16 a[142:143], v21 offset:55296
  v_mfma_f32_16x16x32_bf16 v[116:119], a[156:159], a[84:87], v[116:119]
  s_add_u32 s85, s86, 8704
  v_mfma_f32_16x16x32_bf16 v[124:127], a[152:155], a[88:91], v[124:127]
  v_mfma_f32_16x16x32_bf16 v[124:127], a[156:159], a[92:95], v[124:127]
  buffer_load_dwordx4 v14, s[36:39], s85 offen lds
  v_mfma_f32_16x16x32_bf16 v[196:199], a[152:155], a[96:99], v[196:199]
  s_add_u32 m0, s88, 34816
  s_add_u32 s85, s86, 16896
  v_mfma_f32_16x16x32_bf16 v[196:199], a[156:159], a[100:103], v[196:199]
  s_mov_b32 s40, s8
  ds_write_b128 v26, v[4:7] offset:0
  s_mov_b32 s41, s9
  v_mfma_f32_16x16x32_bf16 v[132:135], a[152:155], a[104:107], v[132:135]
  s_mov_b32 s42, 4194304
  s_mov_b32 s43, 0x00020000
  s_mov_b32 s52, s14
  v_mfma_f32_16x16x32_bf16 v[132:135], a[156:159], a[108:111], v[132:135]
  s_mov_b32 s53, s15
  ds_write_b128 v26, v[8:11] offset:16
  s_mov_b32 s54, 4194304
  v_mfma_f32_16x16x32_bf16 v[204:207], a[152:155], a[112:115], v[204:207]
  buffer_load_dwordx4 v14, s[36:39], s85 offen lds
  v_mfma_f32_16x16x32_bf16 v[204:207], a[156:159], a[116:119], v[204:207]
  s_add_u32 m0, s88, 35840
  s_add_u32 s85, s86, 25088
  s_mov_b32 s55, 0x00020000
  v_mfma_f32_16x16x32_bf16 v[140:143], a[152:155], a[120:123], v[140:143]
  s_mov_b32 s60, s22
  s_mov_b32 s61, s23
  s_mov_b32 s62, 1409024
  v_mfma_f32_16x16x32_bf16 v[140:143], a[156:159], a[124:127], v[140:143]
  s_mov_b32 s63, 0x00020000
  s_mov_b32 s64, s24
  s_waitcnt lgkmcnt(0)
  v_mfma_f32_16x16x32_bf16 v[208:211], a[64:67], a[128:131], v[208:211]
  buffer_load_dwordx4 v14, s[36:39], s85 offen lds
  v_mfma_f32_16x16x32_bf16 v[208:211], a[68:71], a[132:135], v[208:211]
  s_add_u32 m0, s88, 36864
  s_add_u32 s85, s86, 33280
  s_mov_b32 s65, s25
  v_mfma_f32_16x16x32_bf16 v[212:215], a[72:75], a[128:131], v[212:215]
  s_mov_b32 s66, 2097152
  ds_read_b64_tr_b16 a[144:145], v22 offset:49152
  ds_read_b64_tr_b16 a[146:147], v22 offset:51200
  v_mfma_f32_16x16x32_bf16 v[212:215], a[76:79], a[132:135], v[212:215]
  s_mov_b32 s67, 0x00020000
  s_mov_b32 s72, s26
  s_mov_b32 s73, s27
  v_mfma_f32_16x16x32_bf16 v[224:227], a[80:83], a[128:131], v[224:227]
  buffer_load_dwordx4 v14, s[36:39], s85 offen lds
  v_mfma_f32_16x16x32_bf16 v[224:227], a[84:87], a[132:135], v[224:227]
  s_add_u32 m0, s88, 37888
  s_add_u32 s85, s86, 41472
  s_mov_b32 s74, 256
  v_mfma_f32_16x16x32_bf16 v[228:231], a[88:91], a[128:131], v[228:231]
  s_mov_b32 s75, 0x00020000
  s_cmp_lt_u32 s76, 2
  s_cselect_b32 s56, s18, s20
  v_mfma_f32_16x16x32_bf16 v[228:231], a[92:95], a[132:135], v[228:231]
  s_cmp_lt_u32 s76, 2
  s_cselect_b32 s57, s19, s21
  v_mfma_f32_16x16x32_bf16 v[240:243], a[96:99], a[128:131], v[240:243]
  s_mov_b32 s58, 1409024
  ds_read_b64_tr_b16 a[148:149], v22 offset:53248
  ds_read_b64_tr_b16 a[150:151], v22 offset:55296
  v_mfma_f32_16x16x32_bf16 v[240:243], a[100:103], a[132:135], v[240:243]
  buffer_load_dwordx4 v14, s[36:39], s85 offen lds
  v_mfma_f32_16x16x32_bf16 v[244:247], a[104:107], a[128:131], v[244:247]
  s_add_u32 m0, s88, 38912
  s_add_u32 s85, s86, 49664
  s_mov_b32 s59, 0x00020000
  v_mfma_f32_16x16x32_bf16 v[244:247], a[108:111], a[132:135], v[244:247]
  s_lshl_b32 s20, s79, 7
  s_add_u32 s20, s20, 67108864
  s_lshr_b32 s80, s79, 7
  v_mfma_f32_16x16x32_bf16 a[224:227], a[112:115], a[128:131], a[224:227]
  s_add_u32 s80, s80, s76
  s_min_u32 s80, s80, 1
  s_lshl_b32 s80, s80, 30
  v_mfma_f32_16x16x32_bf16 a[224:227], a[116:119], a[132:135], a[224:227]
  buffer_load_dwordx4 v14, s[36:39], s85 offen lds
  v_mfma_f32_16x16x32_bf16 a[228:231], a[120:123], a[128:131], a[228:231]
  s_add_u32 m0, s88, 39936
  ds_read_b64_tr_b16 a[152:153], v23 offset:49152
  ds_read_b64_tr_b16 a[154:155], v23 offset:51200
  v_mfma_f32_16x16x32_bf16 a[228:231], a[124:127], a[132:135], a[228:231]
  s_add_u32 s85, s86, 57856
  s_add_u32 s20, s20, s80
  v_add_u32 v17, s76, v0
  v_mfma_f32_16x16x32_bf16 v[144:147], a[64:67], a[136:139], v[144:147]
  v_min_u32 v17, 1, v17
  v_lshlrev_b32 v17, 30, v17
  v_mfma_f32_16x16x32_bf16 v[144:147], a[68:71], a[140:143], v[144:147]
  buffer_load_dwordx4 v14, s[36:39], s85 offen lds
  v_mfma_f32_16x16x32_bf16 v[148:151], a[72:75], a[136:139], v[148:151]
  v_and_b32 v24, 7, v0
  v_lshrrev_b32 v25, 2, v24
  v_mfma_f32_16x16x32_bf16 v[148:151], a[76:79], a[140:143], v[148:151]
  v_mul_u32_u24 v25, 2752, v25
  v_and_b32 v13, 3, v0
  v_mfma_f32_16x16x32_bf16 v[160:163], a[80:83], a[136:139], v[160:163]
  ds_read_b64_tr_b16 a[156:157], v23 offset:53248
  ds_read_b64_tr_b16 a[158:159], v23 offset:55296
  v_mfma_f32_16x16x32_bf16 v[160:163], a[84:87], a[140:143], v[160:163]
  v_lshl_add_u32 v25, v13, 7, v25
  v_lshrrev_b32 v13, 3, v24
  v_mfma_f32_16x16x32_bf16 v[164:167], a[88:91], a[136:139], v[164:167]
  v_and_b32 v24, 7, v24
  v_lshlrev_b32 v24, 7, v24
  v_mfma_f32_16x16x32_bf16 v[164:167], a[92:95], a[140:143], v[164:167]
  v_lshl_add_u32 v24, v13, 13, v24
  v_min_u32 v1, 31, v0
  v_mfma_f32_16x16x32_bf16 v[176:179], a[96:99], a[136:139], v[176:179]
  s_lshr_b32 s80, s79, 3
  v_lshlrev_b32 v1, 2, v1
  v_mov_b32 v13, 0
  v_mfma_f32_16x16x32_bf16 v[176:179], a[100:103], a[140:143], v[176:179]
  s_lshl_b32 s80, s80, 2
  s_add_u32 s80, s80, s76
  s_mul_i32 s80, s80, 8192
  v_mfma_f32_16x16x32_bf16 v[180:183], a[104:107], a[136:139], v[180:183]
  s_and_b32 s81, s77, 28
  s_lshl_b32 s81, s81, 8
  s_add_u32 s18, s80, s81
  v_mfma_f32_16x16x32_bf16 v[180:183], a[108:111], a[140:143], v[180:183]
  s_lshr_b32 s81, s79, 3
  s_lshl_b32 s81, s81, 1
  s_and_b32 s82, s76, 1
  v_mfma_f32_16x16x32_bf16 a[232:235], a[112:115], a[136:139], a[232:235]
  s_add_u32 s81, s81, s82
  s_mul_i32 s19, s81, 5504
  s_lshr_b32 s80, s77, 2
  v_mfma_f32_16x16x32_bf16 a[232:235], a[116:119], a[140:143], a[232:235]
  s_mul_i32 s81, s80, 11
  s_lshr_b32 s82, s80, 2
  s_sub_u32 s81, s81, s82
  v_mfma_f32_16x16x32_bf16 a[236:239], a[120:123], a[136:139], a[236:239]
  s_lshl_b32 s3, s81, 5
  s_add_u32 s19, s19, s3
  s_and_b32 s82, s77, 3
  v_mfma_f32_16x16x32_bf16 a[236:239], a[124:127], a[140:143], a[236:239]
  s_mul_i32 s80, s82, 3
  s_add_u32 s81, s81, s80
  s_waitcnt lgkmcnt(0)
  v_mfma_f32_16x16x32_bf16 v[216:219], a[64:67], a[144:147], v[216:219]
  s_waitcnt vmcnt(22)
  s_barrier
  v_mfma_f32_16x16x32_bf16 v[216:219], a[68:71], a[148:151], v[216:219]
  s_add_u32 m0, s89, 147456
  ds_read_b128 v[4:7], v27 offset:0
  ds_read_b128 v[8:11], v27 offset:128
  v_mfma_f32_16x16x32_bf16 v[220:223], a[72:75], a[144:147], v[220:223]
  s_add_u32 s84, s87, 1572864
  ds_read_b64_tr_b16 a[128:129], v20 offset:0
  ds_read_b64_tr_b16 a[130:131], v20 offset:2048
  v_mfma_f32_16x16x32_bf16 v[220:223], a[76:79], a[148:151], v[220:223]
  buffer_load_dwordx4 v15, s[48:51], s84 offen offset:0 lds
  v_mfma_f32_16x16x32_bf16 v[232:235], a[80:83], a[144:147], v[232:235]
  s_add_u32 m0, s89, 147456
  ds_read_b128 a[0:3], v18 offset:0
  s_add_u32 s84, s87, 1702912
  v_mfma_f32_16x16x32_bf16 v[232:235], a[84:87], a[148:151], v[232:235]
  s_lshr_b32 s80, s82, 1
  ds_read_b128 a[4:7], v19 offset:0
  s_sub_u32 s28, s81, s80
  v_mfma_f32_16x16x32_bf16 v[236:239], a[88:91], a[144:147], v[236:239]
  ds_read_b128 a[8:11], v18 offset:2048
  v_mfma_f32_16x16x32_bf16 v[236:239], a[92:95], a[148:151], v[236:239]
  buffer_load_dwordx4 v15, s[48:51], s84 offen offset:1024 lds
  v_mfma_f32_16x16x32_bf16 v[248:251], a[96:99], a[144:147], v[248:251]
  s_add_u32 m0, s89, 147456
  ds_read_b64_tr_b16 a[132:133], v20 offset:4096
  ds_read_b64_tr_b16 a[134:135], v20 offset:6144
  v_mfma_f32_16x16x32_bf16 v[248:251], a[100:103], a[148:151], v[248:251]
  s_add_u32 s84, s87, 1603584
  s_cmp_eq_u32 s82, 1
  s_cselect_b32 s29, 2, 3
  v_mfma_f32_16x16x32_bf16 v[252:255], a[104:107], a[144:147], v[252:255]
  s_and_b32 s82, s77, 15
  ds_read_b128 a[12:15], v19 offset:2048
  v_mfma_f32_16x16x32_bf16 v[252:255], a[108:111], a[148:151], v[252:255]
  ds_read_b128 a[16:19], v18 offset:4096
  v_mfma_f32_16x16x32_bf16 a[240:243], a[112:115], a[144:147], a[240:243]
  ds_read_b128 a[20:23], v19 offset:4096
  v_mfma_f32_16x16x32_bf16 a[240:243], a[116:119], a[148:151], a[240:243]
  buffer_load_dwordx4 v15, s[48:51], s84 offen offset:2048 lds
  v_mfma_f32_16x16x32_bf16 a[244:247], a[120:123], a[144:147], a[244:247]
  s_waitcnt lgkmcnt(10)
  ds_read_b64_tr_b16 a[136:137], v21 offset:0
  ds_read_b64_tr_b16 a[138:139], v21 offset:2048
  v_mfma_f32_16x16x32_bf16 a[244:247], a[124:127], a[148:151], a[244:247]
  buffer_store_dwordx4 v[4:7], v28, s[68:71], s17 offen offset:0 sc1
  v_mfma_f32_16x16x32_bf16 v[152:155], a[64:67], a[152:155], v[152:155]
  ds_read_b128 a[24:27], v18 offset:6144
  v_mfma_f32_16x16x32_bf16 v[152:155], a[68:71], a[156:159], v[152:155]
  ds_read_b128 a[28:31], v19 offset:6144
  v_mfma_f32_16x16x32_bf16 v[156:159], a[72:75], a[152:155], v[156:159]
  ds_read_b128 a[32:35], v18 offset:8192
  v_mfma_f32_16x16x32_bf16 v[156:159], a[76:79], a[156:159], v[156:159]
  buffer_store_dwordx4 v[8:11], v28, s[68:71], s17 offen offset:2048 sc1
  v_mfma_f32_16x16x32_bf16 v[168:171], a[80:83], a[152:155], v[168:171]
  s_add_u32 m0, s89, 147456
  ds_read_b64_tr_b16 a[140:141], v21 offset:4096
  ds_read_b64_tr_b16 a[142:143], v21 offset:6144
  v_mfma_f32_16x16x32_bf16 v[168:171], a[84:87], a[156:159], v[168:171]
  s_add_u32 s84, s87, 1733632
  s_cmp_eq_u32 s82, 15
  s_cselect_b32 s29, 2, s29
  v_mfma_f32_16x16x32_bf16 v[172:175], a[88:91], a[152:155], v[172:175]
  ds_read_b128 a[36:39], v19 offset:8192
  v_mfma_f32_16x16x32_bf16 v[172:175], a[92:95], a[156:159], v[172:175]
  ds_read_b128 a[40:43], v18 offset:10240
  v_mfma_f32_16x16x32_bf16 v[184:187], a[96:99], a[152:155], v[184:187]
  ds_read_b128 a[44:47], v19 offset:10240
  v_mfma_f32_16x16x32_bf16 v[184:187], a[100:103], a[156:159], v[184:187]
  buffer_load_dwordx4 v15, s[48:51], s84 offen offset:3072 lds
  v_mfma_f32_16x16x32_bf16 v[188:191], a[104:107], a[152:155], v[188:191]
  ds_read_b128 a[48:51], v18 offset:12288
  v_mfma_f32_16x16x32_bf16 v[188:191], a[108:111], a[156:159], v[188:191]
  v_mfma_f32_16x16x32_bf16 a[248:251], a[112:115], a[152:155], a[248:251]
  ds_read_b128 a[52:55], v19 offset:12288
  v_mfma_f32_16x16x32_bf16 a[248:251], a[116:119], a[156:159], a[248:251]
  v_mfma_f32_16x16x32_bf16 a[252:255], a[120:123], a[152:155], a[252:255]
  ds_read_b128 a[56:59], v18 offset:14336
  v_mfma_f32_16x16x32_bf16 a[252:255], a[124:127], a[156:159], a[252:255]
  s_waitcnt lgkmcnt(6)
  v_mfma_f32_16x16x32_bf16 v[32:35], a[128:131], a[0:3], v[32:35]
  ds_read_b128 a[60:63], v19 offset:14336
  v_mfma_f32_16x16x32_bf16 v[32:35], a[132:135], a[4:7], v[32:35]
  v_subrev_u32 v18, 65536, v18
  v_subrev_u32 v19, 65536, v19
  v_mfma_f32_16x16x32_bf16 v[40:43], a[128:131], a[8:11], v[40:43]
  ds_read_b64_tr_b16 a[144:145], v22 offset:0
  ds_read_b64_tr_b16 a[146:147], v22 offset:2048
  v_mfma_f32_16x16x32_bf16 v[40:43], a[132:135], a[12:15], v[40:43]
  v_mfma_f32_16x16x32_bf16 v[48:51], a[128:131], a[16:19], v[48:51]
  v_mfma_f32_16x16x32_bf16 v[48:51], a[132:135], a[20:23], v[48:51]
  v_mfma_f32_16x16x32_bf16 v[56:59], a[128:131], a[24:27], v[56:59]
  v_mfma_f32_16x16x32_bf16 v[56:59], a[132:135], a[28:31], v[56:59]
  s_waitcnt lgkmcnt(2)
  v_mfma_f32_16x16x32_bf16 v[64:67], a[128:131], a[32:35], v[64:67]
  ds_read_b64_tr_b16 a[148:149], v22 offset:4096
  ds_read_b64_tr_b16 a[150:151], v22 offset:6144
  v_mfma_f32_16x16x32_bf16 v[64:67], a[132:135], a[36:39], v[64:67]
  v_mfma_f32_16x16x32_bf16 v[72:75], a[128:131], a[40:43], v[72:75]
  v_mfma_f32_16x16x32_bf16 v[72:75], a[132:135], a[44:47], v[72:75]
  v_mfma_f32_16x16x32_bf16 v[80:83], a[128:131], a[48:51], v[80:83]
  v_mfma_f32_16x16x32_bf16 v[80:83], a[132:135], a[52:55], v[80:83]
  v_mfma_f32_16x16x32_bf16 v[88:91], a[128:131], a[56:59], v[88:91]
  ds_read_b64_tr_b16 a[152:153], v23 offset:0
  ds_read_b64_tr_b16 a[154:155], v23 offset:2048
  v_mfma_f32_16x16x32_bf16 v[88:91], a[132:135], a[60:63], v[88:91]
  v_mfma_f32_16x16x32_bf16 v[36:39], a[136:139], a[0:3], v[36:39]
  v_mfma_f32_16x16x32_bf16 v[36:39], a[140:143], a[4:7], v[36:39]
  v_mfma_f32_16x16x32_bf16 v[44:47], a[136:139], a[8:11], v[44:47]
  v_mfma_f32_16x16x32_bf16 v[44:47], a[140:143], a[12:15], v[44:47]
  v_mfma_f32_16x16x32_bf16 v[52:55], a[136:139], a[16:19], v[52:55]
  ds_read_b64_tr_b16 a[156:157], v23 offset:4096
  ds_read_b64_tr_b16 a[158:159], v23 offset:6144
  v_mfma_f32_16x16x32_bf16 v[52:55], a[140:143], a[20:23], v[52:55]
  buffer_store_dword v13, v1, s[68:71], s20 offen sc1
  v_mfma_f32_16x16x32_bf16 v[60:63], a[136:139], a[24:27], v[60:63]
  s_and_b32 s26, s77, 28
  s_lshl_b32 s26, s26, 20
  s_lshl_b32 s80, s78, 17
  v_mfma_f32_16x16x32_bf16 v[60:63], a[140:143], a[28:31], v[60:63]
  s_add_u32 s26, s26, s80
  s_and_b32 s80, s76, 1
  s_lshl_b32 s80, s80, 16
  v_mfma_f32_16x16x32_bf16 v[68:71], a[136:139], a[32:35], v[68:71]
  s_add_u32 s26, s26, s80
  s_add_u32 s26, s26, 33554432
  s_lshr_b32 s80, s76, 1
  v_mfma_f32_16x16x32_bf16 v[68:71], a[140:143], a[36:39], v[68:71]
  s_lshl_b32 s81, s80, 12
  s_add_u32 s27, s26, s81
  s_add_u32 s27, s27, 16384
  v_mfma_f32_16x16x32_bf16 v[76:79], a[136:139], a[40:43], v[76:79]
  s_lshl_b32 s81, s80, 11
  s_add_u32 s26, s26, s81
  s_add_u32 s80, s77, 0
  v_mfma_f32_16x16x32_bf16 v[76:79], a[140:143], a[44:47], v[76:79]
  s_and_b32 s80, s80, 3
  s_lshl_b32 s80, s80, 20
  s_add_u32 s26, s26, s80
  v_mfma_f32_16x16x32_bf16 v[84:87], a[136:139], a[48:51], v[84:87]
  s_add_u32 s80, s77, 0
  s_and_b32 s80, s80, 3
  s_lshl_b32 s80, s80, 20
  v_mfma_f32_16x16x32_bf16 v[84:87], a[140:143], a[52:55], v[84:87]
  s_add_u32 s27, s27, s80
  v_lshlrev_b32 v12, 4, v0
  s_sub_u32 s80, 15, s78
  v_mfma_f32_16x16x32_bf16 v[92:95], a[136:139], a[56:59], v[92:95]
  s_lshl_b32 s80, s80, 17
  s_lshl_b32 s81, s76, 14
  s_add_u32 s4, s80, s81
  v_mfma_f32_16x16x32_bf16 v[92:95], a[140:143], a[60:63], v[92:95]
  s_lshl_b32 s80, s78, 17
  s_add_u32 s5, s80, s81
  s_waitcnt lgkmcnt(0)
  v_mfma_f32_16x16x32_bf16 v[96:99], a[144:147], a[0:3], v[96:99]
  s_waitcnt vmcnt(25)
  s_barrier
  v_mfma_f32_16x16x32_bf16 v[96:99], a[148:151], a[4:7], v[96:99]
  s_add_u32 m0, s89, 131072
  s_add_u32 s84, s87, 1572864
  s_lshl_b32 s7, s28, 5
  v_mfma_f32_16x16x32_bf16 v[104:107], a[144:147], a[8:11], v[104:107]
  s_sub_u32 s9, 3, s29
  ds_read_b64_tr_b16 a[128:129], v20 offset:16384
  ds_read_b64_tr_b16 a[130:131], v20 offset:18432
  v_mfma_f32_16x16x32_bf16 v[104:107], a[148:151], a[12:15], v[104:107]
  buffer_load_dwordx4 v15, s[44:47], s84 offen offset:0 lds
  v_mfma_f32_16x16x32_bf16 v[112:115], a[144:147], a[16:19], v[112:115]
  s_add_u32 m0, s89, 131072
  s_add_u32 s84, s87, 1702912
  s_lshl_b32 s9, s9, 28
  v_mfma_f32_16x16x32_bf16 v[112:115], a[148:151], a[20:23], v[112:115]
  s_and_b32 s80, s76, 1
  s_mul_i32 s80, s80, 88064
  s_add_u32 s7, s7, s80
  v_mfma_f32_16x16x32_bf16 v[120:123], a[144:147], a[24:27], v[120:123]
  s_mul_i32 s8, s76, 3072
  s_add_u32 s8, s8, 16384
  v_add_u32 v4, 0, v0
  v_mfma_f32_16x16x32_bf16 v[120:123], a[148:151], a[28:31], v[120:123]
  buffer_load_dwordx4 v15, s[44:47], s84 offen offset:1024 lds
  v_mfma_f32_16x16x32_bf16 v[192:195], a[144:147], a[32:35], v[192:195]
  s_add_u32 m0, s89, 131072
  ds_read_b64_tr_b16 a[132:133], v20 offset:20480
  ds_read_b64_tr_b16 a[134:135], v20 offset:22528
  v_mfma_f32_16x16x32_bf16 v[192:195], a[148:151], a[36:39], v[192:195]
  s_add_u32 s84, s87, 1603584
  v_mul_u32_u24 v5, 10923, v4
  v_lshrrev_b32 v5, 16, v5
  v_mfma_f32_16x16x32_bf16 v[128:131], a[144:147], a[40:43], v[128:131]
  v_mul_u32_u24 v6, 6, v5
  v_sub_u32 v4, v4, v6
  v_mfma_f32_16x16x32_bf16 v[128:131], a[148:151], a[44:47], v[128:131]
  buffer_load_dwordx4 v15, s[44:47], s84 offen offset:2048 lds
  v_mfma_f32_16x16x32_bf16 v[200:203], a[144:147], a[48:51], v[200:203]
  s_add_u32 m0, s89, 131072
  s_add_u32 s84, s87, 1733632
  v_bfe_u32 v6, v5, 2, 2
  v_mfma_f32_16x16x32_bf16 v[200:203], a[148:151], a[52:55], v[200:203]
  v_lshlrev_b32 v6, 3, v6
  v_lshrrev_b32 v7, 4, v5
  v_mfma_f32_16x16x32_bf16 v[136:139], a[144:147], a[56:59], v[136:139]
  ds_read_b64_tr_b16 a[136:137], v21 offset:16384
  ds_read_b64_tr_b16 a[138:139], v21 offset:18432
  v_mfma_f32_16x16x32_bf16 v[136:139], a[148:151], a[60:63], v[136:139]
  buffer_load_dwordx4 v15, s[44:47], s84 offen offset:3072 lds
  v_mfma_f32_16x16x32_bf16 v[100:103], a[152:155], a[0:3], v[100:103]
  s_add_u32 m0, s89, 98304
  s_add_u32 s84, s87, 2097152
  v_lshl_add_u32 v6, v7, 2, v6
  v_mfma_f32_16x16x32_bf16 v[100:103], a[156:159], a[4:7], v[100:103]
  v_and_b32 v7, 3, v5
  v_add_u32 v6, v6, v7
  v_mfma_f32_16x16x32_bf16 v[108:111], a[152:155], a[8:11], v[108:111]
  v_mul_u32_u24 v6, 2752, v6
  v_lshl_add_u32 v26, v4, 4, v6
  v_mfma_f32_16x16x32_bf16 v[108:111], a[156:159], a[12:15], v[108:111]
  buffer_load_dwordx4 v15, s[44:47], s84 offen offset:0 lds
  v_mfma_f32_16x16x32_bf16 v[116:119], a[152:155], a[16:19], v[116:119]
  s_add_u32 m0, s89, 98304
  ds_read_b64_tr_b16 a[140:141], v21 offset:20480
  ds_read_b64_tr_b16 a[142:143], v21 offset:22528
  v_mfma_f32_16x16x32_bf16 v[116:119], a[156:159], a[20:23], v[116:119]
  s_add_u32 s84, s87, 2227200
  v_lshrrev_b32 v4, 2, v4
  v_mul_lo_u32 v4, s9, v4
  v_mfma_f32_16x16x32_bf16 v[124:127], a[152:155], a[24:27], v[124:127]
  v_add_u32 v26, v26, v4
  v_add_u32 v4, 64, v0
  v_mfma_f32_16x16x32_bf16 v[124:127], a[156:159], a[28:31], v[124:127]
  buffer_load_dwordx4 v15, s[44:47], s84 offen offset:1024 lds
  v_mfma_f32_16x16x32_bf16 v[196:199], a[152:155], a[32:35], v[196:199]
  s_add_u32 m0, s89, 98304
  s_add_u32 s84, s87, 2127872
  v_mul_u32_u24 v5, 10923, v4
  v_mfma_f32_16x16x32_bf16 v[196:199], a[156:159], a[36:39], v[196:199]
  v_lshrrev_b32 v5, 16, v5
  v_mul_u32_u24 v6, 6, v5
  v_mfma_f32_16x16x32_bf16 v[132:135], a[152:155], a[40:43], v[132:135]
  v_sub_u32 v4, v4, v6
  v_bfe_u32 v6, v5, 2, 2
  v_mfma_f32_16x16x32_bf16 v[132:135], a[156:159], a[44:47], v[132:135]
  buffer_load_dwordx4 v15, s[44:47], s84 offen offset:2048 lds
  v_mfma_f32_16x16x32_bf16 v[204:207], a[152:155], a[48:51], v[204:207]
  s_add_u32 m0, s89, 98304
  s_add_u32 s84, s87, 2257920
  v_lshlrev_b32 v6, 3, v6
  v_mfma_f32_16x16x32_bf16 v[204:207], a[156:159], a[52:55], v[204:207]
  v_lshrrev_b32 v7, 4, v5
  v_lshl_add_u32 v6, v7, 2, v6
  v_mfma_f32_16x16x32_bf16 v[140:143], a[152:155], a[56:59], v[140:143]
  v_and_b32 v7, 3, v5
  v_add_u32 v6, v6, v7
  v_mfma_f32_16x16x32_bf16 v[140:143], a[156:159], a[60:63], v[140:143]
  s_waitcnt lgkmcnt(0)
  v_mul_u32_u24 v6, 2752, v6
  v_lshl_add_u32 v27, v4, 4, v6
  v_mfma_f32_16x16x32_bf16 v[208:211], a[0:3], a[128:131], v[208:211]
  buffer_load_dwordx4 v15, s[44:47], s84 offen offset:3072 lds
  v_mfma_f32_16x16x32_bf16 v[208:211], a[4:7], a[132:135], v[208:211]
  v_lshrrev_b32 v4, 2, v4
  v_mul_lo_u32 v4, s9, v4
  v_mfma_f32_16x16x32_bf16 v[212:215], a[8:11], a[128:131], v[212:215]
  ds_read_b64_tr_b16 a[144:145], v22 offset:16384
  ds_read_b64_tr_b16 a[146:147], v22 offset:18432
  v_mfma_f32_16x16x32_bf16 v[212:215], a[12:15], a[132:135], v[212:215]
  v_add_u32 v27, v27, v4
  v_add_u32 v4, 128, v0
  v_mfma_f32_16x16x32_bf16 v[224:227], a[16:19], a[128:131], v[224:227]
  v_mul_u32_u24 v5, 10923, v4
  v_lshrrev_b32 v5, 16, v5
  v_mfma_f32_16x16x32_bf16 v[224:227], a[20:23], a[132:135], v[224:227]
  v_mul_u32_u24 v6, 6, v5
  v_sub_u32 v4, v4, v6
  v_mfma_f32_16x16x32_bf16 v[228:231], a[24:27], a[128:131], v[228:231]
  v_bfe_u32 v6, v5, 2, 2
  v_lshlrev_b32 v6, 3, v6
  v_mfma_f32_16x16x32_bf16 v[228:231], a[28:31], a[132:135], v[228:231]
  v_lshrrev_b32 v7, 4, v5
  v_lshl_add_u32 v6, v7, 2, v6
  v_mfma_f32_16x16x32_bf16 v[240:243], a[32:35], a[128:131], v[240:243]
  ds_read_b64_tr_b16 a[148:149], v22 offset:20480
  ds_read_b64_tr_b16 a[150:151], v22 offset:22528
  v_mfma_f32_16x16x32_bf16 v[240:243], a[36:39], a[132:135], v[240:243]
  v_and_b32 v7, 3, v5
  v_add_u32 v6, v6, v7
  v_mfma_f32_16x16x32_bf16 v[244:247], a[40:43], a[128:131], v[244:247]
  s_add_u32 s85, s95, 640
  v_mul_u32_u24 v6, 2752, v6
  v_lshl_add_u32 v28, v4, 4, v6
  v_mfma_f32_16x16x32_bf16 v[244:247], a[44:47], a[132:135], v[244:247]
  v_lshrrev_b32 v4, 2, v4
  v_mul_lo_u32 v4, s9, v4
  v_mfma_f32_16x16x32_bf16 a[224:227], a[48:51], a[128:131], a[224:227]
  buffer_load_dword a202, v3, s[36:39], s85 offen
  v_mfma_f32_16x16x32_bf16 a[224:227], a[52:55], a[132:135], a[224:227]
  s_add_u32 s85, s94, 2621440
  v_add_u32 v28, v28, v4
  v_lshrrev_b32 v4, 2, v0
  v_mfma_f32_16x16x32_bf16 a[228:231], a[56:59], a[128:131], a[228:231]
  ds_read_b64_tr_b16 a[152:153], v23 offset:16384
  ds_read_b64_tr_b16 a[154:155], v23 offset:18432
  v_mfma_f32_16x16x32_bf16 a[228:231], a[60:63], a[132:135], a[228:231]
  buffer_load_dword a203, v2, s[96:99], s85 offen
  v_mfma_f32_16x16x32_bf16 v[144:147], a[0:3], a[136:139], v[144:147]
  s_add_u32 s85, s95, 768
  v_mul_u32_u24 v4, 96, v4
  v_and_b32 v5, 3, v0
  v_mfma_f32_16x16x32_bf16 v[144:147], a[4:7], a[140:143], v[144:147]
  buffer_load_dword a204, v3, s[36:39], s85 offen
  v_mfma_f32_16x16x32_bf16 v[148:151], a[8:11], a[136:139], v[148:151]
  s_add_u32 s85, s94, 3145728
  v_lshl_add_u32 v4, v5, 3, v4
  v_add_u32 v1, 81920, v4
  v_mfma_f32_16x16x32_bf16 v[148:151], a[12:15], a[140:143], v[148:151]
  buffer_load_dword a205, v2, s[96:99], s85 offen
  v_mfma_f32_16x16x32_bf16 v[160:163], a[16:19], a[136:139], v[160:163]
  s_add_u32 s85, s95, 896
  ds_read_b64_tr_b16 a[156:157], v23 offset:20480
  ds_read_b64_tr_b16 a[158:159], v23 offset:22528
  v_mfma_f32_16x16x32_bf16 v[160:163], a[20:23], a[140:143], v[160:163]
  buffer_load_dword a206, v3, s[36:39], s85 offen
  v_mfma_f32_16x16x32_bf16 v[164:167], a[24:27], a[136:139], v[164:167]
  s_add_u32 s85, s94, 3670016
  v_and_b32 v4, 1, v0
  v_lshlrev_b32 v4, 7, v4
  v_mfma_f32_16x16x32_bf16 v[164:167], a[28:31], a[140:143], v[164:167]
  buffer_load_dword a207, v2, s[96:99], s85 offen
  v_mfma_f32_16x16x32_bf16 v[176:179], a[32:35], a[136:139], v[176:179]
  s_add_u32 s85, s18, 0
  s_add_u32 s10, s26, 0
  s_add_u32 s14, s27, 0
  v_mfma_f32_16x16x32_bf16 v[176:179], a[36:39], a[140:143], v[176:179]
  buffer_load_dword a220, v24, s[40:43], s85 offen
  v_mfma_f32_16x16x32_bf16 v[180:183], a[40:43], a[136:139], v[180:183]
  s_add_u32 s85, s19, 0
  s_add_u32 s11, s26, 8192
  s_add_u32 s15, s27, 8192
  v_mfma_f32_16x16x32_bf16 v[180:183], a[44:47], a[140:143], v[180:183]
  buffer_load_dword a221, v25, s[56:59], s85 offen
  v_mfma_f32_16x16x32_bf16 a[232:235], a[48:51], a[136:139], a[232:235]
  s_add_u32 s85, s18, 1048576
  s_add_u32 s12, s26, 32768
  s_add_u32 s16, s27, 32768
  v_mfma_f32_16x16x32_bf16 a[232:235], a[52:55], a[140:143], a[232:235]
  buffer_load_dword a222, v24, s[40:43], s85 offen
  v_mfma_f32_16x16x32_bf16 a[236:239], a[56:59], a[136:139], a[236:239]
  s_add_u32 s85, s19, 352256
  s_add_u32 s13, s26, 40960
  s_add_u32 s17, s27, 40960
  v_mfma_f32_16x16x32_bf16 a[236:239], a[60:63], a[140:143], a[236:239]
  s_waitcnt lgkmcnt(0)
  v_mfma_f32_16x16x32_bf16 v[216:219], a[0:3], a[144:147], v[216:219]
  s_waitcnt vmcnt(13)
  s_barrier
  v_mfma_f32_16x16x32_bf16 v[216:219], a[4:7], a[148:151], v[216:219]
  v_mfma_f32_16x16x32_bf16 v[220:223], a[8:11], a[144:147], v[220:223]
  ds_read_b64_tr_b16 a[128:129], v20 offset:32768
  ds_read_b64_tr_b16 a[130:131], v20 offset:34816
  v_mfma_f32_16x16x32_bf16 v[220:223], a[12:15], a[148:151], v[220:223]
  buffer_load_dword a223, v25, s[56:59], s85 offen
  v_mfma_f32_16x16x32_bf16 v[232:235], a[16:19], a[144:147], v[232:235]
  s_and_b32 s22, s79, 1
  ds_read_b128 a[64:67], v18 offset:0
  s_lshl_b32 s22, s22, 7
  v_mfma_f32_16x16x32_bf16 v[232:235], a[20:23], a[148:151], v[232:235]
  s_bfe_u32 s23, s79, 131075
  ds_read_b128 a[68:71], v19 offset:0
  v_mov_b32 v13, 1
  v_mfma_f32_16x16x32_bf16 v[236:239], a[24:27], a[144:147], v[236:239]
  ds_read_b128 a[72:75], v18 offset:2048
  s_cmp_eq_u32 s23, 0
  s_cselect_b32 s85, s22, 1073741824
  v_mfma_f32_16x16x32_bf16 v[236:239], a[28:31], a[148:151], v[236:239]
  buffer_atomic_add v13, v17, s[72:75], s85 offen sc1
  v_mfma_f32_16x16x32_bf16 v[248:251], a[32:35], a[144:147], v[248:251]
  ds_read_b64_tr_b16 a[132:133], v20 offset:36864
  ds_read_b64_tr_b16 a[134:135], v20 offset:38912
  v_mfma_f32_16x16x32_bf16 v[248:251], a[36:39], a[148:151], v[248:251]
  v_mfma_f32_16x16x32_bf16 v[252:255], a[40:43], a[144:147], v[252:255]
  ds_read_b128 a[76:79], v19 offset:2048
  v_mfma_f32_16x16x32_bf16 v[252:255], a[44:47], a[148:151], v[252:255]
  ds_read_b128 a[80:83], v18 offset:4096
  v_mfma_f32_16x16x32_bf16 a[240:243], a[48:51], a[144:147], a[240:243]
  ds_read_b128 a[84:87], v19 offset:4096
  v_mfma_f32_16x16x32_bf16 a[240:243], a[52:55], a[148:151], a[240:243]
  v_mfma_f32_16x16x32_bf16 a[244:247], a[56:59], a[144:147], a[244:247]
L_hop2:
  s_cbranch_execz L_hop6
  ds_read_b64_tr_b16 a[136:137], v21 offset:32768
  ds_read_b64_tr_b16 a[138:139], v21 offset:34816
  v_mfma_f32_16x16x32_bf16 a[244:247], a[60:63], a[148:151], a[244:247]
  v_mfma_f32_16x16x32_bf16 v[152:155], a[0:3], a[152:155], v[152:155]
  ds_read_b128 a[88:91], v18 offset:6144
  v_mfma_f32_16x16x32_bf16 v[152:155], a[4:7], a[156:159], v[152:155]
  ds_read_b128 a[92:95], v19 offset:6144
  v_mfma_f32_16x16x32_bf16 v[156:159], a[8:11], a[152:155], v[156:159]
  ds_read_b128 a[96:99], v18 offset:8192
  v_mfma_f32_16x16x32_bf16 v[156:159], a[12:15], a[156:159], v[156:159]
  v_mfma_f32_16x16x32_bf16 v[168:171], a[16:19], a[152:155], v[168:171]
  ds_read_b64_tr_b16 a[140:141], v21 offset:36864
  ds_read_b64_tr_b16 a[142:143], v21 offset:38912
  v_mfma_f32_16x16x32_bf16 v[168:171], a[20:23], a[156:159], v[168:171]
  v_mfma_f32_16x16x32_bf16 v[172:175], a[24:27], a[152:155], v[172:175]
  ds_read_b128 a[100:103], v19 offset:8192
  v_mfma_f32_16x16x32_bf16 v[172:175], a[28:31], a[156:159], v[172:175]
  ds_read_b128 a[104:107], v18 offset:10240
  v_mfma_f32_16x16x32_bf16 v[184:187], a[32:35], a[152:155], v[184:187]
  ds_read_b128 a[108:111], v19 offset:10240
  v_mfma_f32_16x16x32_bf16 v[184:187], a[36:39], a[156:159], v[184:187]
  v_mfma_f32_16x16x32_bf16 v[188:191], a[40:43], a[152:155], v[188:191]
  ds_read_b128 a[112:115], v18 offset:12288
  v_mfma_f32_16x16x32_bf16 v[188:191], a[44:47], a[156:159], v[188:191]
  v_mfma_f32_16x16x32_bf16 a[248:251], a[48:51], a[152:155], a[248:251]
  ds_read_b128 a[116:119], v19 offset:12288
  v_mfma_f32_16x16x32_bf16 a[248:251], a[52:55], a[156:159], a[248:251]
  v_mfma_f32_16x16x32_bf16 a[252:255], a[56:59], a[152:155], a[252:255]
  ds_read_b128 a[120:123], v18 offset:14336
  v_mfma_f32_16x16x32_bf16 a[252:255], a[60:63], a[156:159], a[252:255]
  s_waitcnt lgkmcnt(6)
  v_mfma_f32_16x16x32_bf16 v[32:35], a[128:131], a[64:67], v[32:35]
  ds_read_b128 a[124:127], v19 offset:14336
  v_mfma_f32_16x16x32_bf16 v[32:35], a[132:135], a[68:71], v[32:35]
  v_add_u32 v18, 32768, v18
  v_add_u32 v19, 32768, v19
  v_mfma_f32_16x16x32_bf16 v[40:43], a[128:131], a[72:75], v[40:43]
  ds_read_b64_tr_b16 a[144:145], v22 offset:32768
  ds_read_b64_tr_b16 a[146:147], v22 offset:34816
  v_mfma_f32_16x16x32_bf16 v[40:43], a[132:135], a[76:79], v[40:43]
  v_mfma_f32_16x16x32_bf16 v[48:51], a[128:131], a[80:83], v[48:51]
  v_mfma_f32_16x16x32_bf16 v[48:51], a[132:135], a[84:87], v[48:51]
  v_mfma_f32_16x16x32_bf16 v[56:59], a[128:131], a[88:91], v[56:59]
  v_mfma_f32_16x16x32_bf16 v[56:59], a[132:135], a[92:95], v[56:59]
  s_waitcnt lgkmcnt(2)
  v_mfma_f32_16x16x32_bf16 v[64:67], a[128:131], a[96:99], v[64:67]
  ds_read_b64_tr_b16 a[148:149], v22 offset:36864
  ds_read_b64_tr_b16 a[150:151], v22 offset:38912
  v_mfma_f32_16x16x32_bf16 v[64:67], a[132:135], a[100:103], v[64:67]
  v_mfma_f32_16x16x32_bf16 v[72:75], a[128:131], a[104:107], v[72:75]
  v_mfma_f32_16x16x32_bf16 v[72:75], a[132:135], a[108:111], v[72:75]
  v_mfma_f32_16x16x32_bf16 v[80:83], a[128:131], a[112:115], v[80:83]
  v_mfma_f32_16x16x32_bf16 v[80:83], a[132:135], a[116:119], v[80:83]
  v_mfma_f32_16x16x32_bf16 v[88:91], a[128:131], a[120:123], v[88:91]
  ds_read_b64_tr_b16 a[152:153], v23 offset:32768
  ds_read_b64_tr_b16 a[154:155], v23 offset:34816
  v_mfma_f32_16x16x32_bf16 v[88:91], a[132:135], a[124:127], v[88:91]
  v_mfma_f32_16x16x32_bf16 v[36:39], a[136:139], a[64:67], v[36:39]
  v_mfma_f32_16x16x32_bf16 v[36:39], a[140:143], a[68:71], v[36:39]
  v_mfma_f32_16x16x32_bf16 v[44:47], a[136:139], a[72:75], v[44:47]
  v_mfma_f32_16x16x32_bf16 v[44:47], a[140:143], a[76:79], v[44:47]
  v_mfma_f32_16x16x32_bf16 v[52:55], a[136:139], a[80:83], v[52:55]
  ds_read_b64_tr_b16 a[156:157], v23 offset:36864
  ds_read_b64_tr_b16 a[158:159], v23 offset:38912
  v_mfma_f32_16x16x32_bf16 v[52:55], a[140:143], a[84:87], v[52:55]
  v_mfma_f32_16x16x32_bf16 v[60:63], a[136:139], a[88:91], v[60:63]
  v_mfma_f32_16x16x32_bf16 v[60:63], a[140:143], a[92:95], v[60:63]
  v_mfma_f32_16x16x32_bf16 v[68:71], a[136:139], a[96:99], v[68:71]
  v_mfma_f32_16x16x32_bf16 v[68:71], a[140:143], a[100:103], v[68:71]
  v_mfma_f32_16x16x32_bf16 v[76:79], a[136:139], a[104:107], v[76:79]
  v_mfma_f32_16x16x32_bf16 v[76:79], a[140:143], a[108:111], v[76:79]
  v_mfma_f32_16x16x32_bf16 v[84:87], a[136:139], a[112:115], v[84:87]
  v_mfma_f32_16x16x32_bf16 v[84:87], a[140:143], a[116:119], v[84:87]
  v_mfma_f32_16x16x32_bf16 v[92:95], a[136:139], a[120:123], v[92:95]
  v_mfma_f32_16x16x32_bf16 v[92:95], a[140:143], a[124:127], v[92:95]
  s_waitcnt lgkmcnt(0)
  v_mfma_f32_16x16x32_bf16 v[96:99], a[144:147], a[64:67], v[96:99]
  s_waitcnt vmcnt(63)
  s_barrier
  v_mfma_f32_16x16x32_bf16 v[96:99], a[148:151], a[68:71], v[96:99]
  v_mfma_f32_16x16x32_bf16 v[104:107], a[144:147], a[72:75], v[104:107]
  ds_read_b64_tr_b16 a[128:129], v20 offset:49152
  ds_read_b64_tr_b16 a[130:131], v20 offset:51200
  v_mfma_f32_16x16x32_bf16 v[104:107], a[148:151], a[76:79], v[104:107]
  s_cmp_eq_u32 s23, 1
  s_cselect_b32 s85, s22, 1073741824
  v_mfma_f32_16x16x32_bf16 v[112:115], a[144:147], a[80:83], v[112:115]
  buffer_atomic_add v13, v17, s[72:75], s85 offen sc1
  v_mfma_f32_16x16x32_bf16 v[112:115], a[148:151], a[84:87], v[112:115]
  v_mfma_f32_16x16x32_bf16 v[120:123], a[144:147], a[88:91], v[120:123]
  v_mfma_f32_16x16x32_bf16 v[120:123], a[148:151], a[92:95], v[120:123]
  v_mfma_f32_16x16x32_bf16 v[192:195], a[144:147], a[96:99], v[192:195]
  ds_read_b64_tr_b16 a[132:133], v20 offset:53248
  ds_read_b64_tr_b16 a[134:135], v20 offset:55296
  v_mfma_f32_16x16x32_bf16 v[192:195], a[148:151], a[100:103], v[192:195]
  v_mfma_f32_16x16x32_bf16 v[128:131], a[144:147], a[104:107], v[128:131]
  v_mfma_f32_16x16x32_bf16 v[128:131], a[148:151], a[108:111], v[128:131]
  v_mfma_f32_16x16x32_bf16 v[200:203], a[144:147], a[112:115], v[200:203]
  v_mfma_f32_16x16x32_bf16 v[200:203], a[148:151], a[116:119], v[200:203]
  v_mfma_f32_16x16x32_bf16 v[136:139], a[144:147], a[120:123], v[136:139]
  ds_read_b64_tr_b16 a[136:137], v21 offset:49152
  ds_read_b64_tr_b16 a[138:139], v21 offset:51200
  v_mfma_f32_16x16x32_bf16 v[136:139], a[148:151], a[124:127], v[136:139]
  v_mfma_f32_16x16x32_bf16 v[100:103], a[152:155], a[64:67], v[100:103]
  v_mfma_f32_16x16x32_bf16 v[100:103], a[156:159], a[68:71], v[100:103]
  v_mfma_f32_16x16x32_bf16 v[108:111], a[152:155], a[72:75], v[108:111]
  v_mfma_f32_16x16x32_bf16 v[108:111], a[156:159], a[76:79], v[108:111]
  v_mfma_f32_16x16x32_bf16 v[116:119], a[152:155], a[80:83], v[116:119]
  ds_read_b64_tr_b16 a[140:141], v21 offset:53248
  ds_read_b64_tr_b16 a[142:143], v21 offset:55296
  v_mfma_f32_16x16x32_bf16 v[116:119], a[156:159], a[84:87], v[116:119]
  v_mfma_f32_16x16x32_bf16 v[124:127], a[152:155], a[88:91], v[124:127]
  v_mfma_f32_16x16x32_bf16 v[124:127], a[156:159], a[92:95], v[124:127]
  v_mfma_f32_16x16x32_bf16 v[196:199], a[152:155], a[96:99], v[196:199]
  v_mfma_f32_16x16x32_bf16 v[196:199], a[156:159], a[100:103], v[196:199]
  v_mfma_f32_16x16x32_bf16 v[132:135], a[152:155], a[104:107], v[132:135]
  v_mfma_f32_16x16x32_bf16 v[132:135], a[156:159], a[108:111], v[132:135]
  v_mfma_f32_16x16x32_bf16 v[204:207], a[152:155], a[112:115], v[204:207]
  v_mfma_f32_16x16x32_bf16 v[204:207], a[156:159], a[116:119], v[204:207]
  v_mfma_f32_16x16x32_bf16 v[140:143], a[152:155], a[120:123], v[140:143]
  v_mfma_f32_16x16x32_bf16 v[140:143], a[156:159], a[124:127], v[140:143]
  s_waitcnt lgkmcnt(0)
  v_mfma_f32_16x16x32_bf16 v[208:211], a[64:67], a[128:131], v[208:211]
  v_mfma_f32_16x16x32_bf16 v[208:211], a[68:71], a[132:135], v[208:211]
  v_mfma_f32_16x16x32_bf16 v[212:215], a[72:75], a[128:131], v[212:215]
  ds_read_b64_tr_b16 a[144:145], v22 offset:49152
  ds_read_b64_tr_b16 a[146:147], v22 offset:51200
  v_mfma_f32_16x16x32_bf16 v[212:215], a[76:79], a[132:135], v[212:215]
  v_mfma_f32_16x16x32_bf16 v[224:227], a[80:83], a[128:131], v[224:227]
  v_mfma_f32_16x16x32_bf16 v[224:227], a[84:87], a[132:135], v[224:227]
  v_mfma_f32_16x16x32_bf16 v[228:231], a[88:91], a[128:131], v[228:231]
  v_mfma_f32_16x16x32_bf16 v[228:231], a[92:95], a[132:135], v[228:231]
  v_mfma_f32_16x16x32_bf16 v[240:243], a[96:99], a[128:131], v[240:243]
  ds_read_b64_tr_b16 a[148:149], v22 offset:53248
  ds_read_b64_tr_b16 a[150:151], v22 offset:55296
  v_mfma_f32_16x16x32_bf16 v[240:243], a[100:103], a[132:135], v[240:243]
  v_mfma_f32_16x16x32_bf16 v[244:247], a[104:107], a[128:131], v[244:247]
  v_mfma_f32_16x16x32_bf16 v[244:247], a[108:111], a[132:135], v[244:247]
  v_mfma_f32_16x16x32_bf16 a[224:227], a[112:115], a[128:131], a[224:227]
  v_mfma_f32_16x16x32_bf16 a[224:227], a[116:119], a[132:135], a[224:227]
  v_mfma_f32_16x16x32_bf16 a[228:231], a[120:123], a[128:131], a[228:231]
  ds_read_b64_tr_b16 a[152:153], v23 offset:49152
  ds_read_b64_tr_b16 a[154:155], v23 offset:51200
  v_mfma_f32_16x16x32_bf16 a[228:231], a[124:127], a[132:135], a[228:231]
  v_mfma_f32_16x16x32_bf16 v[144:147], a[64:67], a[136:139], v[144:147]
  v_mfma_f32_16x16x32_bf16 v[144:147], a[68:71], a[140:143], v[144:147]
  v_mfma_f32_16x16x32_bf16 v[148:151], a[72:75], a[136:139], v[148:151]
  v_mfma_f32_16x16x32_bf16 v[148:151], a[76:79], a[140:143], v[148:151]
  v_mfma_f32_16x16x32_bf16 v[160:163], a[80:83], a[136:139], v[160:163]
  ds_read_b64_tr_b16 a[156:157], v23 offset:53248
  ds_read_b64_tr_b16 a[158:159], v23 offset:55296
  v_mfma_f32_16x16x32_bf16 v[160:163], a[84:87], a[140:143], v[160:163]
  v_mfma_f32_16x16x32_bf16 v[164:167], a[88:91], a[136:139], v[164:167]
  v_mfma_f32_16x16x32_bf16 v[164:167], a[92:95], a[140:143], v[164:167]
  v_mfma_f32_16x16x32_bf16 v[176:179], a[96:99], a[136:139], v[176:179]
  v_mfma_f32_16x16x32_bf16 v[176:179], a[100:103], a[140:143], v[176:179]
  v_mfma_f32_16x16x32_bf16 v[180:183], a[104:107], a[136:139], v[180:183]
  v_mfma_f32_16x16x32_bf16 v[180:183], a[108:111], a[140:143], v[180:183]
  v_mfma_f32_16x16x32_bf16 a[232:235], a[112:115], a[136:139], a[232:235]
  v_mfma_f32_16x16x32_bf16 a[232:235], a[116:119], a[140:143], a[232:235]
  v_mfma_f32_16x16x32_bf16 a[236:239], a[120:123], a[136:139], a[236:239]
  v_mfma_f32_16x16x32_bf16 a[236:239], a[124:127], a[140:143], a[236:239]
  s_waitcnt lgkmcnt(0)
  v_mfma_f32_16x16x32_bf16 v[216:219], a[64:67], a[144:147], v[216:219]
  s_waitcnt vmcnt(12)
  s_barrier
  v_mfma_f32_16x16x32_bf16 v[216:219], a[68:71], a[148:151], v[216:219]
  v_mfma_f32_16x16x32_bf16 v[220:223], a[72:75], a[144:147], v[220:223]
  ds_read_b64_tr_b16 a[128:129], v20 offset:0
  ds_read_b64_tr_b16 a[130:131], v20 offset:2048
  v_mfma_f32_16x16x32_bf16 v[220:223], a[76:79], a[148:151], v[220:223]
  s_cmp_eq_u32 s23, 2
  s_cselect_b32 s85, s22, 1073741824
  v_mfma_f32_16x16x32_bf16 v[232:235], a[80:83], a[144:147], v[232:235]
  ds_read_b128 a[0:3], v18 offset:0
  v_mfma_f32_16x16x32_bf16 v[232:235], a[84:87], a[148:151], v[232:235]
  ds_read_b128 a[4:7], v19 offset:0
  v_mfma_f32_16x16x32_bf16 v[236:239], a[88:91], a[144:147], v[236:239]
  ds_read_b128 a[8:11], v18 offset:2048
  v_mfma_f32_16x16x32_bf16 v[236:239], a[92:95], a[148:151], v[236:239]
  buffer_atomic_add v13, v17, s[72:75], s85 offen sc1
  v_mfma_f32_16x16x32_bf16 v[248:251], a[96:99], a[144:147], v[248:251]
  s_add_u32 m0, s89, 114688
  ds_read_b64_tr_b16 a[132:133], v20 offset:4096
  ds_read_b64_tr_b16 a[134:135], v20 offset:6144
  v_mfma_f32_16x16x32_bf16 v[248:251], a[100:103], a[148:151], v[248:251]
  s_add_u32 s84, s87, 2097152
  v_mfma_f32_16x16x32_bf16 v[252:255], a[104:107], a[144:147], v[252:255]
  ds_read_b128 a[12:15], v19 offset:2048
  v_mfma_f32_16x16x32_bf16 v[252:255], a[108:111], a[148:151], v[252:255]
  ds_read_b128 a[16:19], v18 offset:4096
  v_mfma_f32_16x16x32_bf16 a[240:243], a[112:115], a[144:147], a[240:243]
  ds_read_b128 a[20:23], v19 offset:4096
  v_mfma_f32_16x16x32_bf16 a[240:243], a[116:119], a[148:151], a[240:243]
  buffer_load_dwordx4 v15, s[48:51], s84 offen offset:0 lds
  v_mfma_f32_16x16x32_bf16 a[244:247], a[120:123], a[144:147], a[244:247]
  s_add_u32 m0, s89, 114688
  ds_read_b64_tr_b16 a[136:137], v21 offset:0
  ds_read_b64_tr_b16 a[138:139], v21 offset:2048
  v_mfma_f32_16x16x32_bf16 a[244:247], a[124:127], a[148:151], a[244:247]
  s_add_u32 s84, s87, 2227200
  v_mfma_f32_16x16x32_bf16 v[152:155], a[64:67], a[152:155], v[152:155]
  ds_read_b128 a[24:27], v18 offset:6144
  v_mfma_f32_16x16x32_bf16 v[152:155], a[68:71], a[156:159], v[152:155]
  ds_read_b128 a[28:31], v19 offset:6144
  v_mfma_f32_16x16x32_bf16 v[156:159], a[72:75], a[152:155], v[156:159]
  ds_read_b128 a[32:35], v18 offset:8192
  v_mfma_f32_16x16x32_bf16 v[156:159], a[76:79], a[156:159], v[156:159]
  buffer_load_dwordx4 v15, s[48:51], s84 offen offset:1024 lds
  v_mfma_f32_16x16x32_bf16 v[168:171], a[80:83], a[152:155], v[168:171]
  s_add_u32 m0, s89, 114688
  ds_read_b64_tr_b16 a[140:141], v21 offset:4096
  ds_read_b64_tr_b16 a[142:143], v21 offset:6144
  v_mfma_f32_16x16x32_bf16 v[168:171], a[84:87], a[156:159], v[168:171]
  s_add_u32 s84, s87, 2127872
  v_mfma_f32_16x16x32_bf16 v[172:175], a[88:91], a[152:155], v[172:175]
  ds_read_b128 a[36:39], v19 offset:8192
  v_mfma_f32_16x16x32_bf16 v[172:175], a[92:95], a[156:159], v[172:175]
  ds_read_b128 a[40:43], v18 offset:10240
  v_mfma_f32_16x16x32_bf16 v[184:187], a[96:99], a[152:155], v[184:187]
  ds_read_b128 a[44:47], v19 offset:10240
  v_mfma_f32_16x16x32_bf16 v[184:187], a[100:103], a[156:159], v[184:187]
  buffer_load_dwordx4 v15, s[48:51], s84 offen offset:2048 lds
  v_mfma_f32_16x16x32_bf16 v[188:191], a[104:107], a[152:155], v[188:191]
  s_add_u32 m0, s89, 114688
  ds_read_b128 a[48:51], v18 offset:12288
  s_add_u32 s84, s87, 2257920
  v_mfma_f32_16x16x32_bf16 v[188:191], a[108:111], a[156:159], v[188:191]
  v_mfma_f32_16x16x32_bf16 a[248:251], a[112:115], a[152:155], a[248:251]
  ds_read_b128 a[52:55], v19 offset:12288
  v_mfma_f32_16x16x32_bf16 a[248:251], a[116:119], a[156:159], a[248:251]
  buffer_load_dwordx4 v15, s[48:51], s84 offen offset:3072 lds
  v_mfma_f32_16x16x32_bf16 a[252:255], a[120:123], a[152:155], a[252:255]
  s_add_u32 m0, s88, 65536
  ds_read_b128 a[56:59], v18 offset:14336
  s_add_u32 s85, s86, 640
  v_mfma_f32_16x16x32_bf16 a[252:255], a[124:127], a[156:159], a[252:255]
  s_waitcnt lgkmcnt(6)
  v_mfma_f32_16x16x32_bf16 v[32:35], a[128:131], a[0:3], v[32:35]
  ds_read_b128 a[60:63], v19 offset:14336
  v_mfma_f32_16x16x32_bf16 v[32:35], a[132:135], a[4:7], v[32:35]
  v_add_u32 v18, 32768, v18
  v_add_u32 v19, 32768, v19
  v_mfma_f32_16x16x32_bf16 v[40:43], a[128:131], a[8:11], v[40:43]
  ds_read_b64_tr_b16 a[144:145], v22 offset:0
  ds_read_b64_tr_b16 a[146:147], v22 offset:2048
  v_mfma_f32_16x16x32_bf16 v[40:43], a[132:135], a[12:15], v[40:43]
  buffer_load_dwordx4 v14, s[36:39], s85 offen lds
  v_mfma_f32_16x16x32_bf16 v[48:51], a[128:131], a[16:19], v[48:51]
  s_add_u32 m0, s88, 66560
  s_add_u32 s85, s86, 8832
  v_mfma_f32_16x16x32_bf16 v[48:51], a[132:135], a[20:23], v[48:51]
  v_mfma_f32_16x16x32_bf16 v[56:59], a[128:131], a[24:27], v[56:59]
  v_mfma_f32_16x16x32_bf16 v[56:59], a[132:135], a[28:31], v[56:59]
  s_waitcnt lgkmcnt(2)
  v_mfma_f32_16x16x32_bf16 v[64:67], a[128:131], a[32:35], v[64:67]
  ds_read_b64_tr_b16 a[148:149], v22 offset:4096
  ds_read_b64_tr_b16 a[150:151], v22 offset:6144
  v_mfma_f32_16x16x32_bf16 v[64:67], a[132:135], a[36:39], v[64:67]
  buffer_load_dwordx4 v14, s[36:39], s85 offen lds
  v_mfma_f32_16x16x32_bf16 v[72:75], a[128:131], a[40:43], v[72:75]
  s_add_u32 m0, s88, 67584
  s_add_u32 s85, s86, 17024
  v_mfma_f32_16x16x32_bf16 v[72:75], a[132:135], a[44:47], v[72:75]
  v_mfma_f32_16x16x32_bf16 v[80:83], a[128:131], a[48:51], v[80:83]
  v_mfma_f32_16x16x32_bf16 v[80:83], a[132:135], a[52:55], v[80:83]
  buffer_load_dwordx4 v14, s[36:39], s85 offen lds
  v_mfma_f32_16x16x32_bf16 v[88:91], a[128:131], a[56:59], v[88:91]
  s_add_u32 m0, s88, 68608
  ds_read_b64_tr_b16 a[152:153], v23 offset:0
  ds_read_b64_tr_b16 a[154:155], v23 offset:2048
  v_mfma_f32_16x16x32_bf16 v[88:91], a[132:135], a[60:63], v[88:91]
  s_add_u32 s85, s86, 25216
  v_mfma_f32_16x16x32_bf16 v[36:39], a[136:139], a[0:3], v[36:39]
  v_mfma_f32_16x16x32_bf16 v[36:39], a[140:143], a[4:7], v[36:39]
  buffer_load_dwordx4 v14, s[36:39], s85 offen lds
  v_mfma_f32_16x16x32_bf16 v[44:47], a[136:139], a[8:11], v[44:47]
  s_add_u32 m0, s88, 69632
  s_add_u32 s85, s86, 33408
  v_mfma_f32_16x16x32_bf16 v[44:47], a[140:143], a[12:15], v[44:47]
  v_mfma_f32_16x16x32_bf16 v[52:55], a[136:139], a[16:19], v[52:55]
  ds_read_b64_tr_b16 a[156:157], v23 offset:4096
  ds_read_b64_tr_b16 a[158:159], v23 offset:6144
  v_mfma_f32_16x16x32_bf16 v[52:55], a[140:143], a[20:23], v[52:55]
  buffer_load_dwordx4 v14, s[36:39], s85 offen lds
  v_mfma_f32_16x16x32_bf16 v[60:63], a[136:139], a[24:27], v[60:63]
  s_add_u32 m0, s88, 70656
  s_add_u32 s85, s86, 41600
  v_mfma_f32_16x16x32_bf16 v[60:63], a[140:143], a[28:31], v[60:63]
  v_mfma_f32_16x16x32_bf16 v[68:71], a[136:139], a[32:35], v[68:71]
  v_mfma_f32_16x16x32_bf16 v[68:71], a[140:143], a[36:39], v[68:71]
  buffer_load_dwordx4 v14, s[36:39], s85 offen lds
  v_mfma_f32_16x16x32_bf16 v[76:79], a[136:139], a[40:43], v[76:79]
  s_add_u32 m0, s88, 71680
  s_add_u32 s85, s86, 49792
  v_mfma_f32_16x16x32_bf16 v[76:79], a[140:143], a[44:47], v[76:79]
  v_mfma_f32_16x16x32_bf16 v[84:87], a[136:139], a[48:51], v[84:87]
  v_mfma_f32_16x16x32_bf16 v[84:87], a[140:143], a[52:55], v[84:87]
  buffer_load_dwordx4 v14, s[36:39], s85 offen lds
  v_mfma_f32_16x16x32_bf16 v[92:95], a[136:139], a[56:59], v[92:95]
  s_add_u32 m0, s88, 72704
  s_add_u32 s85, s86, 57984
  v_mfma_f32_16x16x32_bf16 v[92:95], a[140:143], a[60:63], v[92:95]
  s_waitcnt lgkmcnt(0)
  v_mfma_f32_16x16x32_bf16 v[96:99], a[144:147], a[0:3], v[96:99]
  s_waitcnt vmcnt(7)
  s_barrier
  v_mfma_f32_16x16x32_bf16 v[96:99], a[148:151], a[4:7], v[96:99]
  v_mfma_f32_16x16x32_bf16 v[104:107], a[144:147], a[8:11], v[104:107]
  ds_read_b64_tr_b16 a[128:129], v20 offset:16384
  ds_read_b64_tr_b16 a[130:131], v20 offset:18432
  v_mfma_f32_16x16x32_bf16 v[104:107], a[148:151], a[12:15], v[104:107]
  buffer_load_dwordx4 v14, s[36:39], s85 offen lds
  v_mfma_f32_16x16x32_bf16 v[112:115], a[144:147], a[16:19], v[112:115]
  s_cmp_eq_u32 s23, 3
  s_cselect_b32 s85, s22, 1073741824
  v_mfma_f32_16x16x32_bf16 v[112:115], a[148:151], a[20:23], v[112:115]
  buffer_atomic_add v13, v17, s[72:75], s85 offen sc1
  v_mfma_f32_16x16x32_bf16 v[120:123], a[144:147], a[24:27], v[120:123]
  s_add_u32 m0, s89, 131072
  s_add_u32 s84, s87, 2621440
  v_mfma_f32_16x16x32_bf16 v[120:123], a[148:151], a[28:31], v[120:123]
  v_mfma_f32_16x16x32_bf16 v[192:195], a[144:147], a[32:35], v[192:195]
  ds_read_b64_tr_b16 a[132:133], v20 offset:20480
  ds_read_b64_tr_b16 a[134:135], v20 offset:22528
  v_mfma_f32_16x16x32_bf16 v[192:195], a[148:151], a[36:39], v[192:195]
  buffer_load_dwordx4 v15, s[44:47], s84 offen offset:0 lds
  v_mfma_f32_16x16x32_bf16 v[128:131], a[144:147], a[40:43], v[128:131]
  s_add_u32 m0, s89, 131072
  s_add_u32 s84, s87, 2751488
  v_mfma_f32_16x16x32_bf16 v[128:131], a[148:151], a[44:47], v[128:131]
  v_mfma_f32_16x16x32_bf16 v[200:203], a[144:147], a[48:51], v[200:203]
  v_mfma_f32_16x16x32_bf16 v[200:203], a[148:151], a[52:55], v[200:203]
  buffer_load_dwordx4 v15, s[44:47], s84 offen offset:1024 lds
  v_mfma_f32_16x16x32_bf16 v[136:139], a[144:147], a[56:59], v[136:139]
  s_add_u32 m0, s89, 131072
  ds_read_b64_tr_b16 a[136:137], v21 offset:16384
  ds_read_b64_tr_b16 a[138:139], v21 offset:18432
  v_mfma_f32_16x16x32_bf16 v[136:139], a[148:151], a[60:63], v[136:139]
  s_add_u32 s84, s87, 2652160
  v_mfma_f32_16x16x32_bf16 v[100:103], a[152:155], a[0:3], v[100:103]
  v_mfma_f32_16x16x32_bf16 v[100:103], a[156:159], a[4:7], v[100:103]
  buffer_load_dwordx4 v15, s[44:47], s84 offen offset:2048 lds
  v_mfma_f32_16x16x32_bf16 v[108:111], a[152:155], a[8:11], v[108:111]
  s_add_u32 m0, s89, 131072
  s_add_u32 s84, s87, 2782208
  v_mfma_f32_16x16x32_bf16 v[108:111], a[156:159], a[12:15], v[108:111]
  v_mfma_f32_16x16x32_bf16 v[116:119], a[152:155], a[16:19], v[116:119]
  ds_read_b64_tr_b16 a[140:141], v21 offset:20480
  ds_read_b64_tr_b16 a[142:143], v21 offset:22528
  v_mfma_f32_16x16x32_bf16 v[116:119], a[156:159], a[20:23], v[116:119]
  buffer_load_dwordx4 v15, s[44:47], s84 offen offset:3072 lds
  v_mfma_f32_16x16x32_bf16 v[124:127], a[152:155], a[24:27], v[124:127]
  s_add_u32 m0, s89, 147456
  s_add_u32 s84, s87, 2621440
  v_mfma_f32_16x16x32_bf16 v[124:127], a[156:159], a[28:31], v[124:127]
  v_mfma_f32_16x16x32_bf16 v[196:199], a[152:155], a[32:35], v[196:199]
  v_mfma_f32_16x16x32_bf16 v[196:199], a[156:159], a[36:39], v[196:199]
  buffer_load_dwordx4 v15, s[48:51], s84 offen offset:0 lds
  v_mfma_f32_16x16x32_bf16 v[132:135], a[152:155], a[40:43], v[132:135]
  s_add_u32 m0, s89, 147456
  s_add_u32 s84, s87, 2751488
  v_mfma_f32_16x16x32_bf16 v[132:135], a[156:159], a[44:47], v[132:135]
  v_mfma_f32_16x16x32_bf16 v[204:207], a[152:155], a[48:51], v[204:207]
  v_mfma_f32_16x16x32_bf16 v[204:207], a[156:159], a[52:55], v[204:207]
  buffer_load_dwordx4 v15, s[48:51], s84 offen offset:1024 lds
  v_mfma_f32_16x16x32_bf16 v[140:143], a[152:155], a[56:59], v[140:143]
  s_add_u32 m0, s89, 147456
  s_add_u32 s84, s87, 2652160
  v_mfma_f32_16x16x32_bf16 v[140:143], a[156:159], a[60:63], v[140:143]
  s_waitcnt lgkmcnt(0)
  v_mfma_f32_16x16x32_bf16 v[208:211], a[0:3], a[128:131], v[208:211]
  v_mfma_f32_16x16x32_bf16 v[208:211], a[4:7], a[132:135], v[208:211]
  buffer_load_dwordx4 v15, s[48:51], s84 offen offset:2048 lds
  v_mfma_f32_16x16x32_bf16 v[212:215], a[8:11], a[128:131], v[212:215]
  s_add_u32 m0, s89, 147456
  ds_read_b64_tr_b16 a[144:145], v22 offset:16384
  ds_read_b64_tr_b16 a[146:147], v22 offset:18432
  v_mfma_f32_16x16x32_bf16 v[212:215], a[12:15], a[132:135], v[212:215]
  s_add_u32 s84, s87, 2782208
  v_mfma_f32_16x16x32_bf16 v[224:227], a[16:19], a[128:131], v[224:227]
  v_mfma_f32_16x16x32_bf16 v[224:227], a[20:23], a[132:135], v[224:227]
  buffer_load_dwordx4 v15, s[48:51], s84 offen offset:3072 lds
  v_mfma_f32_16x16x32_bf16 v[228:231], a[24:27], a[128:131], v[228:231]
  s_add_u32 m0, s88, 0
  s_add_u32 s85, s86, 768
  v_mfma_f32_16x16x32_bf16 v[228:231], a[28:31], a[132:135], v[228:231]
  v_mfma_f32_16x16x32_bf16 v[240:243], a[32:35], a[128:131], v[240:243]
  ds_read_b64_tr_b16 a[148:149], v22 offset:20480
  ds_read_b64_tr_b16 a[150:151], v22 offset:22528
  v_mfma_f32_16x16x32_bf16 v[240:243], a[36:39], a[132:135], v[240:243]
  buffer_load_dwordx4 v14, s[36:39], s85 offen lds
  v_mfma_f32_16x16x32_bf16 v[244:247], a[40:43], a[128:131], v[244:247]
  s_add_u32 m0, s88, 1024
  s_add_u32 s85, s86, 8960
  v_mfma_f32_16x16x32_bf16 v[244:247], a[44:47], a[132:135], v[244:247]
  v_mfma_f32_16x16x32_bf16 a[224:227], a[48:51], a[128:131], a[224:227]
  v_mfma_f32_16x16x32_bf16 a[224:227], a[52:55], a[132:135], a[224:227]
  buffer_load_dwordx4 v14, s[36:39], s85 offen lds
  v_mfma_f32_16x16x32_bf16 a[228:231], a[56:59], a[128:131], a[228:231]
  s_add_u32 m0, s88, 2048
  ds_read_b64_tr_b16 a[152:153], v23 offset:16384
  ds_read_b64_tr_b16 a[154:155], v23 offset:18432
  v_mfma_f32_16x16x32_bf16 a[228:231], a[60:63], a[132:135], a[228:231]
  s_add_u32 s85, s86, 17152
  v_mfma_f32_16x16x32_bf16 v[144:147], a[0:3], a[136:139], v[144:147]
  v_mfma_f32_16x16x32_bf16 v[144:147], a[4:7], a[140:143], v[144:147]
  buffer_load_dwordx4 v14, s[36:39], s85 offen lds
  v_mfma_f32_16x16x32_bf16 v[148:151], a[8:11], a[136:139], v[148:151]
  s_add_u32 m0, s88, 3072
  s_add_u32 s85, s86, 25344
  v_mfma_f32_16x16x32_bf16 v[148:151], a[12:15], a[140:143], v[148:151]
  v_mfma_f32_16x16x32_bf16 v[160:163], a[16:19], a[136:139], v[160:163]
  ds_read_b64_tr_b16 a[156:157], v23 offset:20480
  ds_read_b64_tr_b16 a[158:159], v23 offset:22528
  v_mfma_f32_16x16x32_bf16 v[160:163], a[20:23], a[140:143], v[160:163]
  buffer_load_dwordx4 v14, s[36:39], s85 offen lds
  v_mfma_f32_16x16x32_bf16 v[164:167], a[24:27], a[136:139], v[164:167]
  s_add_u32 m0, s88, 4096
  s_add_u32 s85, s86, 33536
  v_mfma_f32_16x16x32_bf16 v[164:167], a[28:31], a[140:143], v[164:167]
  v_mfma_f32_16x16x32_bf16 v[176:179], a[32:35], a[136:139], v[176:179]
  v_mfma_f32_16x16x32_bf16 v[176:179], a[36:39], a[140:143], v[176:179]
  buffer_load_dwordx4 v14, s[36:39], s85 offen lds
  v_mfma_f32_16x16x32_bf16 v[180:183], a[40:43], a[136:139], v[180:183]
  s_add_u32 m0, s88, 5120
  s_add_u32 s85, s86, 41728
  v_mfma_f32_16x16x32_bf16 v[180:183], a[44:47], a[140:143], v[180:183]
  v_mfma_f32_16x16x32_bf16 a[232:235], a[48:51], a[136:139], a[232:235]
  v_mfma_f32_16x16x32_bf16 a[232:235], a[52:55], a[140:143], a[232:235]
  buffer_load_dwordx4 v14, s[36:39], s85 offen lds
  v_mfma_f32_16x16x32_bf16 a[236:239], a[56:59], a[136:139], a[236:239]
  s_add_u32 m0, s88, 6144
  s_add_u32 s85, s86, 49920
  v_mfma_f32_16x16x32_bf16 a[236:239], a[60:63], a[140:143], a[236:239]
  s_waitcnt lgkmcnt(0)
  v_mfma_f32_16x16x32_bf16 v[216:219], a[0:3], a[144:147], v[216:219]
  s_waitcnt vmcnt(10)
  s_barrier
  v_mfma_f32_16x16x32_bf16 v[216:219], a[4:7], a[148:151], v[216:219]
  v_mfma_f32_16x16x32_bf16 v[220:223], a[8:11], a[144:147], v[220:223]
  ds_read_b64_tr_b16 a[128:129], v20 offset:32768
  ds_read_b64_tr_b16 a[130:131], v20 offset:34816
  v_mfma_f32_16x16x32_bf16 v[220:223], a[12:15], a[148:151], v[220:223]
  buffer_load_dwordx4 v14, s[36:39], s85 offen lds
  v_mfma_f32_16x16x32_bf16 v[232:235], a[16:19], a[144:147], v[232:235]
  s_add_u32 m0, s88, 7168
  ds_read_b128 a[64:67], v18 offset:0
  s_add_u32 s85, s86, 58112
  v_mfma_f32_16x16x32_bf16 v[232:235], a[20:23], a[148:151], v[232:235]
  ds_read_b128 a[68:71], v19 offset:0
  v_mfma_f32_16x16x32_bf16 v[236:239], a[24:27], a[144:147], v[236:239]
  ds_read_b128 a[72:75], v18 offset:2048
  v_mfma_f32_16x16x32_bf16 v[236:239], a[28:31], a[148:151], v[236:239]
  buffer_load_dwordx4 v14, s[36:39], s85 offen lds
  v_mfma_f32_16x16x32_bf16 v[248:251], a[32:35], a[144:147], v[248:251]
  s_add_u32 m0, s89, 98304
  ds_read_b64_tr_b16 a[132:133], v20 offset:36864
  ds_read_b64_tr_b16 a[134:135], v20 offset:38912
  v_mfma_f32_16x16x32_bf16 v[248:251], a[36:39], a[148:151], v[248:251]
  s_add_u32 s84, s87, 3145728
  v_mfma_f32_16x16x32_bf16 v[252:255], a[40:43], a[144:147], v[252:255]
  ds_read_b128 a[76:79], v19 offset:2048
  v_mfma_f32_16x16x32_bf16 v[252:255], a[44:47], a[148:151], v[252:255]
  ds_read_b128 a[80:83], v18 offset:4096
  v_mfma_f32_16x16x32_bf16 a[240:243], a[48:51], a[144:147], a[240:243]
  ds_read_b128 a[84:87], v19 offset:4096
  v_mfma_f32_16x16x32_bf16 a[240:243], a[52:55], a[148:151], a[240:243]
  buffer_load_dwordx4 v15, s[44:47], s84 offen offset:0 lds
  v_mfma_f32_16x16x32_bf16 a[244:247], a[56:59], a[144:147], a[244:247]
  s_add_u32 m0, s89, 98304
  ds_read_b64_tr_b16 a[136:137], v21 offset:32768
  ds_read_b64_tr_b16 a[138:139], v21 offset:34816
  v_mfma_f32_16x16x32_bf16 a[244:247], a[60:63], a[148:151], a[244:247]
  s_add_u32 s84, s87, 3275776
  v_mfma_f32_16x16x32_bf16 v[152:155], a[0:3], a[152:155], v[152:155]
  ds_read_b128 a[88:91], v18 offset:6144
  v_mfma_f32_16x16x32_bf16 v[152:155], a[4:7], a[156:159], v[152:155]
  ds_read_b128 a[92:95], v19 offset:6144
  v_mfma_f32_16x16x32_bf16 v[156:159], a[8:11], a[152:155], v[156:159]
  ds_read_b128 a[96:99], v18 offset:8192
  v_mfma_f32_16x16x32_bf16 v[156:159], a[12:15], a[156:159], v[156:159]
  buffer_load_dwordx4 v15, s[44:47], s84 offen offset:1024 lds
  v_mfma_f32_16x16x32_bf16 v[168:171], a[16:19], a[152:155], v[168:171]
  s_add_u32 m0, s89, 98304
  ds_read_b64_tr_b16 a[140:141], v21 offset:36864
  ds_read_b64_tr_b16 a[142:143], v21 offset:38912
  v_mfma_f32_16x16x32_bf16 v[168:171], a[20:23], a[156:159], v[168:171]
  s_add_u32 s84, s87, 3176448
  v_mfma_f32_16x16x32_bf16 v[172:175], a[24:27], a[152:155], v[172:175]
  ds_read_b128 a[100:103], v19 offset:8192
  v_mfma_f32_16x16x32_bf16 v[172:175], a[28:31], a[156:159], v[172:175]
  ds_read_b128 a[104:107], v18 offset:10240
  v_mfma_f32_16x16x32_bf16 v[184:187], a[32:35], a[152:155], v[184:187]
  ds_read_b128 a[108:111], v19 offset:10240
  v_mfma_f32_16x16x32_bf16 v[184:187], a[36:39], a[156:159], v[184:187]
  buffer_load_dwordx4 v15, s[44:47], s84 offen offset:2048 lds
  v_mfma_f32_16x16x32_bf16 v[188:191], a[40:43], a[152:155], v[188:191]
  s_add_u32 m0, s89, 98304
  ds_read_b128 a[112:115], v18 offset:12288
  s_add_u32 s84, s87, 3306496
  v_mfma_f32_16x16x32_bf16 v[188:191], a[44:47], a[156:159], v[188:191]
  v_mfma_f32_16x16x32_bf16 a[248:251], a[48:51], a[152:155], a[248:251]
  ds_read_b128 a[116:119], v19 offset:12288
  v_mfma_f32_16x16x32_bf16 a[248:251], a[52:55], a[156:159], a[248:251]
  buffer_load_dwordx4 v15, s[44:47], s84 offen offset:3072 lds
  v_mfma_f32_16x16x32_bf16 a[252:255], a[56:59], a[152:155], a[252:255]
  s_add_u32 m0, s89, 114688
  ds_read_b128 a[120:123], v18 offset:14336
  s_add_u32 s84, s87, 3145728
  v_mfma_f32_16x16x32_bf16 a[252:255], a[60:63], a[156:159], a[252:255]
  s_waitcnt lgkmcnt(6)
  v_mfma_f32_16x16x32_bf16 v[32:35], a[128:131], a[64:67], v[32:35]
  ds_read_b128 a[124:127], v19 offset:14336
  v_mfma_f32_16x16x32_bf16 v[32:35], a[132:135], a[68:71], v[32:35]
  v_subrev_u32 v18, 65536, v18
  v_subrev_u32 v19, 65536, v19
  v_mfma_f32_16x16x32_bf16 v[40:43], a[128:131], a[72:75], v[40:43]
  ds_read_b64_tr_b16 a[144:145], v22 offset:32768
  ds_read_b64_tr_b16 a[146:147], v22 offset:34816
  v_mfma_f32_16x16x32_bf16 v[40:43], a[132:135], a[76:79], v[40:43]
  buffer_load_dwordx4 v15, s[48:51], s84 offen offset:0 lds
  v_mfma_f32_16x16x32_bf16 v[48:51], a[128:131], a[80:83], v[48:51]
  s_add_u32 m0, s89, 114688
  s_add_u32 s84, s87, 3275776
  v_mfma_f32_16x16x32_bf16 v[48:51], a[132:135], a[84:87], v[48:51]
L_hop3:
  s_cbranch_execz L_hop7
  v_mfma_f32_16x16x32_bf16 v[56:59], a[128:131], a[88:91], v[56:59]
  v_mfma_f32_16x16x32_bf16 v[56:59], a[132:135], a[92:95], v[56:59]
  s_waitcnt lgkmcnt(2)
  v_mfma_f32_16x16x32_bf16 v[64:67], a[128:131], a[96:99], v[64:67]
  ds_read_b64_tr_b16 a[148:149], v22 offset:36864
  ds_read_b64_tr_b16 a[150:151], v22 offset:38912
  v_mfma_f32_16x16x32_bf16 v[64:67], a[132:135], a[100:103], v[64:67]
  buffer_load_dwordx4 v15, s[48:51], s84 offen offset:1024 lds
  v_mfma_f32_16x16x32_bf16 v[72:75], a[128:131], a[104:107], v[72:75]
  s_add_u32 m0, s89, 114688
  s_add_u32 s84, s87, 3176448
  v_mfma_f32_16x16x32_bf16 v[72:75], a[132:135], a[108:111], v[72:75]
  v_mfma_f32_16x16x32_bf16 v[80:83], a[128:131], a[112:115], v[80:83]
  v_mfma_f32_16x16x32_bf16 v[80:83], a[132:135], a[116:119], v[80:83]
  buffer_load_dwordx4 v15, s[48:51], s84 offen offset:2048 lds
  v_mfma_f32_16x16x32_bf16 v[88:91], a[128:131], a[120:123], v[88:91]
  s_add_u32 m0, s89, 114688
  ds_read_b64_tr_b16 a[152:153], v23 offset:32768
  ds_read_b64_tr_b16 a[154:155], v23 offset:34816
  v_mfma_f32_16x16x32_bf16 v[88:91], a[132:135], a[124:127], v[88:91]
  s_add_u32 s84, s87, 3306496
  v_mfma_f32_16x16x32_bf16 v[36:39], a[136:139], a[64:67], v[36:39]
  v_mfma_f32_16x16x32_bf16 v[36:39], a[140:143], a[68:71], v[36:39]
  buffer_load_dwordx4 v15, s[48:51], s84 offen offset:3072 lds
  v_mfma_f32_16x16x32_bf16 v[44:47], a[136:139], a[72:75], v[44:47]
  s_add_u32 m0, s88, 32768
  s_add_u32 s85, s86, 896
  v_mfma_f32_16x16x32_bf16 v[44:47], a[140:143], a[76:79], v[44:47]
  v_mfma_f32_16x16x32_bf16 v[52:55], a[136:139], a[80:83], v[52:55]
  ds_read_b64_tr_b16 a[156:157], v23 offset:36864
  ds_read_b64_tr_b16 a[158:159], v23 offset:38912
  v_mfma_f32_16x16x32_bf16 v[52:55], a[140:143], a[84:87], v[52:55]
  buffer_load_dwordx4 v14, s[36:39], s85 offen lds
  v_mfma_f32_16x16x32_bf16 v[60:63], a[136:139], a[88:91], v[60:63]
  s_add_u32 s85, s18, 2097152
  v_mfma_f32_16x16x32_bf16 v[60:63], a[140:143], a[92:95], v[60:63]
  buffer_load_dword a220, v24, s[40:43], s85 offen
  v_mfma_f32_16x16x32_bf16 v[68:71], a[136:139], a[96:99], v[68:71]
  s_add_u32 s85, s19, 704512
  v_mfma_f32_16x16x32_bf16 v[68:71], a[140:143], a[100:103], v[68:71]
  buffer_load_dword a221, v25, s[56:59], s85 offen
  v_mfma_f32_16x16x32_bf16 v[76:79], a[136:139], a[104:107], v[76:79]
  s_add_u32 s85, s18, 3145728
  v_mfma_f32_16x16x32_bf16 v[76:79], a[140:143], a[108:111], v[76:79]
  buffer_load_dword a222, v24, s[40:43], s85 offen
  v_mfma_f32_16x16x32_bf16 v[84:87], a[136:139], a[112:115], v[84:87]
  s_add_u32 s85, s19, 1056768
  v_mfma_f32_16x16x32_bf16 v[84:87], a[140:143], a[116:119], v[84:87]
  buffer_load_dword a223, v25, s[56:59], s85 offen
  v_mfma_f32_16x16x32_bf16 v[92:95], a[136:139], a[120:123], v[92:95]
  s_add_u32 m0, s88, 33792
  s_add_u32 s85, s86, 9088
  v_mfma_f32_16x16x32_bf16 v[92:95], a[140:143], a[124:127], v[92:95]
  s_waitcnt lgkmcnt(0)
  v_mfma_f32_16x16x32_bf16 v[96:99], a[144:147], a[64:67], v[96:99]
  s_waitcnt vmcnt(21)
  s_barrier
  v_mfma_f32_16x16x32_bf16 v[96:99], a[148:151], a[68:71], v[96:99]
  v_mfma_f32_16x16x32_bf16 v[104:107], a[144:147], a[72:75], v[104:107]
  ds_read_b64_tr_b16 a[128:129], v20 offset:49152
  ds_read_b64_tr_b16 a[130:131], v20 offset:51200
  v_mfma_f32_16x16x32_bf16 v[104:107], a[148:151], a[76:79], v[104:107]
  buffer_load_dwordx4 v14, s[36:39], s85 offen lds
  v_mfma_f32_16x16x32_bf16 v[112:115], a[144:147], a[80:83], v[112:115]
  s_add_u32 m0, s88, 34816
  s_add_u32 s85, s86, 17280
  v_mfma_f32_16x16x32_bf16 v[112:115], a[148:151], a[84:87], v[112:115]
  v_mfma_f32_16x16x32_bf16 v[120:123], a[144:147], a[88:91], v[120:123]
  v_mfma_f32_16x16x32_bf16 v[120:123], a[148:151], a[92:95], v[120:123]
  buffer_load_dwordx4 v14, s[36:39], s85 offen lds
  v_mfma_f32_16x16x32_bf16 v[192:195], a[144:147], a[96:99], v[192:195]
  s_add_u32 m0, s88, 35840
  ds_read_b64_tr_b16 a[132:133], v20 offset:53248
  ds_read_b64_tr_b16 a[134:135], v20 offset:55296
  v_mfma_f32_16x16x32_bf16 v[192:195], a[148:151], a[100:103], v[192:195]
  s_add_u32 s85, s86, 25472
  v_mfma_f32_16x16x32_bf16 v[128:131], a[144:147], a[104:107], v[128:131]
  v_mfma_f32_16x16x32_bf16 v[128:131], a[148:151], a[108:111], v[128:131]
  buffer_load_dwordx4 v14, s[36:39], s85 offen lds
  v_mfma_f32_16x16x32_bf16 v[200:203], a[144:147], a[112:115], v[200:203]
  s_add_u32 m0, s88, 36864
  s_add_u32 s85, s86, 33664
  v_mfma_f32_16x16x32_bf16 v[200:203], a[148:151], a[116:119], v[200:203]
  v_mfma_f32_16x16x32_bf16 v[136:139], a[144:147], a[120:123], v[136:139]
  ds_read_b64_tr_b16 a[136:137], v21 offset:49152
  ds_read_b64_tr_b16 a[138:139], v21 offset:51200
  v_mfma_f32_16x16x32_bf16 v[136:139], a[148:151], a[124:127], v[136:139]
  buffer_load_dwordx4 v14, s[36:39], s85 offen lds
  v_mfma_f32_16x16x32_bf16 v[100:103], a[152:155], a[64:67], v[100:103]
  s_add_u32 m0, s88, 37888
  s_add_u32 s85, s86, 41856
  v_mfma_f32_16x16x32_bf16 v[100:103], a[156:159], a[68:71], v[100:103]
  v_mfma_f32_16x16x32_bf16 v[108:111], a[152:155], a[72:75], v[108:111]
  v_mfma_f32_16x16x32_bf16 v[108:111], a[156:159], a[76:79], v[108:111]
  buffer_load_dwordx4 v14, s[36:39], s85 offen lds
  v_mfma_f32_16x16x32_bf16 v[116:119], a[152:155], a[80:83], v[116:119]
  s_add_u32 m0, s88, 38912
  ds_read_b64_tr_b16 a[140:141], v21 offset:53248
  ds_read_b64_tr_b16 a[142:143], v21 offset:55296
  v_mfma_f32_16x16x32_bf16 v[116:119], a[156:159], a[84:87], v[116:119]
  s_add_u32 s85, s86, 50048
  v_mfma_f32_16x16x32_bf16 v[124:127], a[152:155], a[88:91], v[124:127]
  v_mfma_f32_16x16x32_bf16 v[124:127], a[156:159], a[92:95], v[124:127]
  buffer_load_dwordx4 v14, s[36:39], s85 offen lds
  v_mfma_f32_16x16x32_bf16 v[196:199], a[152:155], a[96:99], v[196:199]
  s_add_u32 m0, s88, 39936
  s_add_u32 s85, s86, 58240
  v_mfma_f32_16x16x32_bf16 v[196:199], a[156:159], a[100:103], v[196:199]
  v_mfma_f32_16x16x32_bf16 v[132:135], a[152:155], a[104:107], v[132:135]
  v_mfma_f32_16x16x32_bf16 v[132:135], a[156:159], a[108:111], v[132:135]
  buffer_load_dwordx4 v14, s[36:39], s85 offen lds
  v_mfma_f32_16x16x32_bf16 v[204:207], a[152:155], a[112:115], v[204:207]
  v_mfma_f32_16x16x32_bf16 v[204:207], a[156:159], a[116:119], v[204:207]
  v_mfma_f32_16x16x32_bf16 v[140:143], a[152:155], a[120:123], v[140:143]
  v_mfma_f32_16x16x32_bf16 v[140:143], a[156:159], a[124:127], v[140:143]
  s_waitcnt lgkmcnt(0)
  v_mfma_f32_16x16x32_bf16 v[208:211], a[64:67], a[128:131], v[208:211]
  v_mfma_f32_16x16x32_bf16 v[208:211], a[68:71], a[132:135], v[208:211]
  v_mfma_f32_16x16x32_bf16 v[212:215], a[72:75], a[128:131], v[212:215]
  ds_read_b64_tr_b16 a[144:145], v22 offset:49152
  ds_read_b64_tr_b16 a[146:147], v22 offset:51200
  v_mfma_f32_16x16x32_bf16 v[212:215], a[76:79], a[132:135], v[212:215]
  v_mfma_f32_16x16x32_bf16 v[224:227], a[80:83], a[128:131], v[224:227]
  v_mfma_f32_16x16x32_bf16 v[224:227], a[84:87], a[132:135], v[224:227]
  v_mfma_f32_16x16x32_bf16 v[228:231], a[88:91], a[128:131], v[228:231]
  v_mfma_f32_16x16x32_bf16 v[228:231], a[92:95], a[132:135], v[228:231]
  v_mfma_f32_16x16x32_bf16 v[240:243], a[96:99], a[128:131], v[240:243]
  ds_read_b64_tr_b16 a[148:149], v22 offset:53248
  ds_read_b64_tr_b16 a[150:151], v22 offset:55296
  v_mfma_f32_16x16x32_bf16 v[240:243], a[100:103], a[132:135], v[240:243]
  v_mfma_f32_16x16x32_bf16 v[244:247], a[104:107], a[128:131], v[244:247]
  v_mfma_f32_16x16x32_bf16 v[244:247], a[108:111], a[132:135], v[244:247]
  v_mfma_f32_16x16x32_bf16 a[224:227], a[112:115], a[128:131], a[224:227]
  v_mfma_f32_16x16x32_bf16 a[224:227], a[116:119], a[132:135], a[224:227]
  v_mfma_f32_16x16x32_bf16 a[228:231], a[120:123], a[128:131], a[228:231]
  ds_read_b64_tr_b16 a[152:153], v23 offset:49152
  ds_read_b64_tr_b16 a[154:155], v23 offset:51200
  v_mfma_f32_16x16x32_bf16 a[228:231], a[124:127], a[132:135], a[228:231]
  v_mfma_f32_16x16x32_bf16 v[144:147], a[64:67], a[136:139], v[144:147]
  v_mfma_f32_16x16x32_bf16 v[144:147], a[68:71], a[140:143], v[144:147]
  v_mfma_f32_16x16x32_bf16 v[148:151], a[72:75], a[136:139], v[148:151]
  v_mfma_f32_16x16x32_bf16 v[148:151], a[76:79], a[140:143], v[148:151]
  v_mfma_f32_16x16x32_bf16 v[160:163], a[80:83], a[136:139], v[160:163]
  ds_read_b64_tr_b16 a[156:157], v23 offset:53248
  ds_read_b64_tr_b16 a[158:159], v23 offset:55296
  v_mfma_f32_16x16x32_bf16 v[160:163], a[84:87], a[140:143], v[160:163]
  v_mfma_f32_16x16x32_bf16 v[164:167], a[88:91], a[136:139], v[164:167]
  v_mfma_f32_16x16x32_bf16 v[164:167], a[92:95], a[140:143], v[164:167]
  v_mfma_f32_16x16x32_bf16 v[176:179], a[96:99], a[136:139], v[176:179]
  v_mfma_f32_16x16x32_bf16 v[176:179], a[100:103], a[140:143], v[176:179]
  v_mfma_f32_16x16x32_bf16 v[180:183], a[104:107], a[136:139], v[180:183]
  v_mfma_f32_16x16x32_bf16 v[180:183], a[108:111], a[140:143], v[180:183]
  v_mfma_f32_16x16x32_bf16 a[232:235], a[112:115], a[136:139], a[232:235]
  v_mfma_f32_16x16x32_bf16 a[232:235], a[116:119], a[140:143], a[232:235]
  v_mfma_f32_16x16x32_bf16 a[236:239], a[120:123], a[136:139], a[236:239]
  v_mfma_f32_16x16x32_bf16 a[236:239], a[124:127], a[140:143], a[236:239]
  s_waitcnt lgkmcnt(0)
  v_mfma_f32_16x16x32_bf16 v[216:219], a[64:67], a[144:147], v[216:219]
  s_waitcnt vmcnt(16)
  s_barrier
  v_mfma_f32_16x16x32_bf16 v[216:219], a[68:71], a[148:151], v[216:219]
  v_mfma_f32_16x16x32_bf16 v[220:223], a[72:75], a[144:147], v[220:223]
  ds_read_b64_tr_b16 a[128:129], v20 offset:0
  ds_read_b64_tr_b16 a[130:131], v20 offset:2048
  v_mfma_f32_16x16x32_bf16 v[220:223], a[76:79], a[148:151], v[220:223]
  v_mfma_f32_16x16x32_bf16 v[232:235], a[80:83], a[144:147], v[232:235]
  ds_read_b128 a[0:3], v18 offset:0
  v_mfma_f32_16x16x32_bf16 v[232:235], a[84:87], a[148:151], v[232:235]
  ds_read_b128 a[4:7], v19 offset:0
  v_mfma_f32_16x16x32_bf16 v[236:239], a[88:91], a[144:147], v[236:239]
  ds_read_b128 a[8:11], v18 offset:2048
  v_mfma_f32_16x16x32_bf16 v[236:239], a[92:95], a[148:151], v[236:239]
  v_mfma_f32_16x16x32_bf16 v[248:251], a[96:99], a[144:147], v[248:251]
  ds_read_b64_tr_b16 a[132:133], v20 offset:4096
  ds_read_b64_tr_b16 a[134:135], v20 offset:6144
  v_mfma_f32_16x16x32_bf16 v[248:251], a[100:103], a[148:151], v[248:251]
  buffer_load_dword v13, v4, s[72:75], 0 offen sc1
  v_mfma_f32_16x16x32_bf16 v[252:255], a[104:107], a[144:147], v[252:255]
  ds_read_b128 a[12:15], v19 offset:2048
  v_mfma_f32_16x16x32_bf16 v[252:255], a[108:111], a[148:151], v[252:255]
  ds_read_b128 a[16:19], v18 offset:4096
  v_mfma_f32_16x16x32_bf16 a[240:243], a[112:115], a[144:147], a[240:243]
  ds_read_b128 a[20:23], v19 offset:4096
  v_mfma_f32_16x16x32_bf16 a[240:243], a[116:119], a[148:151], a[240:243]
  v_mfma_f32_16x16x32_bf16 a[244:247], a[120:123], a[144:147], a[244:247]
  ds_read_b64_tr_b16 a[136:137], v21 offset:0
  ds_read_b64_tr_b16 a[138:139], v21 offset:2048
  v_mfma_f32_16x16x32_bf16 a[244:247], a[124:127], a[148:151], a[244:247]
  v_mfma_f32_16x16x32_bf16 v[152:155], a[64:67], a[152:155], v[152:155]
  ds_read_b128 a[24:27], v18 offset:6144
  v_mfma_f32_16x16x32_bf16 v[152:155], a[68:71], a[156:159], v[152:155]
  ds_read_b128 a[28:31], v19 offset:6144
  v_mfma_f32_16x16x32_bf16 v[156:159], a[72:75], a[152:155], v[156:159]
  ds_read_b128 a[32:35], v18 offset:8192
  v_mfma_f32_16x16x32_bf16 v[156:159], a[76:79], a[156:159], v[156:159]
  v_mfma_f32_16x16x32_bf16 v[168:171], a[80:83], a[152:155], v[168:171]
  ds_read_b64_tr_b16 a[140:141], v21 offset:4096
  ds_read_b64_tr_b16 a[142:143], v21 offset:6144
  v_mfma_f32_16x16x32_bf16 v[168:171], a[84:87], a[156:159], v[168:171]
  v_mfma_f32_16x16x32_bf16 v[172:175], a[88:91], a[152:155], v[172:175]
  s_add_u32 m0, s89, 131072
  ds_read_b128 a[36:39], v19 offset:8192
  s_add_u32 s84, s87, 3670016
  v_mfma_f32_16x16x32_bf16 v[172:175], a[92:95], a[156:159], v[172:175]
  ds_read_b128 a[40:43], v18 offset:10240
  v_mfma_f32_16x16x32_bf16 v[184:187], a[96:99], a[152:155], v[184:187]
  ds_read_b128 a[44:47], v19 offset:10240
  v_mfma_f32_16x16x32_bf16 v[184:187], a[100:103], a[156:159], v[184:187]
  buffer_load_dwordx4 v15, s[44:47], s84 offen offset:0 lds
  v_mfma_f32_16x16x32_bf16 v[188:191], a[104:107], a[152:155], v[188:191]
  s_add_u32 m0, s89, 131072
  ds_read_b128 a[48:51], v18 offset:12288
  s_add_u32 s84, s87, 3800064
  v_mfma_f32_16x16x32_bf16 v[188:191], a[108:111], a[156:159], v[188:191]
  v_mfma_f32_16x16x32_bf16 a[248:251], a[112:115], a[152:155], a[248:251]
  ds_read_b128 a[52:55], v19 offset:12288
  v_mfma_f32_16x16x32_bf16 a[248:251], a[116:119], a[156:159], a[248:251]
  buffer_load_dwordx4 v15, s[44:47], s84 offen offset:1024 lds
  v_mfma_f32_16x16x32_bf16 a[252:255], a[120:123], a[152:155], a[252:255]
  s_add_u32 m0, s89, 131072
  ds_read_b128 a[56:59], v18 offset:14336
  s_add_u32 s84, s87, 3700736
  v_mfma_f32_16x16x32_bf16 a[252:255], a[124:127], a[156:159], a[252:255]
  s_waitcnt lgkmcnt(6)
  v_mfma_f32_16x16x32_bf16 v[32:35], a[128:131], a[0:3], v[32:35]
  ds_read_b128 a[60:63], v19 offset:14336
  v_mfma_f32_16x16x32_bf16 v[32:35], a[132:135], a[4:7], v[32:35]
  v_add_u32 v18, 32768, v18
  v_add_u32 v19, 32768, v19
  v_mfma_f32_16x16x32_bf16 v[40:43], a[128:131], a[8:11], v[40:43]
  ds_read_b64_tr_b16 a[144:145], v22 offset:0
  ds_read_b64_tr_b16 a[146:147], v22 offset:2048
  v_mfma_f32_16x16x32_bf16 v[40:43], a[132:135], a[12:15], v[40:43]
  buffer_load_dwordx4 v15, s[44:47], s84 offen offset:2048 lds
  v_mfma_f32_16x16x32_bf16 v[48:51], a[128:131], a[16:19], v[48:51]
  s_add_u32 m0, s89, 131072
  s_add_u32 s84, s87, 3830784
  v_mfma_f32_16x16x32_bf16 v[48:51], a[132:135], a[20:23], v[48:51]
  v_mfma_f32_16x16x32_bf16 v[56:59], a[128:131], a[24:27], v[56:59]
  v_mfma_f32_16x16x32_bf16 v[56:59], a[132:135], a[28:31], v[56:59]
  s_waitcnt lgkmcnt(2)
  v_mfma_f32_16x16x32_bf16 v[64:67], a[128:131], a[32:35], v[64:67]
  ds_read_b64_tr_b16 a[148:149], v22 offset:4096
  ds_read_b64_tr_b16 a[150:151], v22 offset:6144
  v_mfma_f32_16x16x32_bf16 v[64:67], a[132:135], a[36:39], v[64:67]
  buffer_load_dwordx4 v15, s[44:47], s84 offen offset:3072 lds
  v_mfma_f32_16x16x32_bf16 v[72:75], a[128:131], a[40:43], v[72:75]
  s_add_u32 m0, s8, 65536
  s_add_u32 s85, s7, 0
  v_mfma_f32_16x16x32_bf16 v[72:75], a[132:135], a[44:47], v[72:75]
  v_mfma_f32_16x16x32_bf16 v[80:83], a[128:131], a[48:51], v[80:83]
  v_mfma_f32_16x16x32_bf16 v[80:83], a[132:135], a[52:55], v[80:83]
  v_mfma_f32_16x16x32_bf16 v[88:91], a[128:131], a[56:59], v[88:91]
  ds_read_b64_tr_b16 a[152:153], v23 offset:0
  ds_read_b64_tr_b16 a[154:155], v23 offset:2048
  v_mfma_f32_16x16x32_bf16 v[88:91], a[132:135], a[60:63], v[88:91]
  buffer_load_dwordx4 v26, s[56:59], s85 offen lds
  v_mfma_f32_16x16x32_bf16 v[36:39], a[136:139], a[0:3], v[36:39]
  s_add_u32 m0, s8, 66560
  s_add_u32 s85, s7, 0
  v_mfma_f32_16x16x32_bf16 v[36:39], a[140:143], a[4:7], v[36:39]
  v_mfma_f32_16x16x32_bf16 v[44:47], a[136:139], a[8:11], v[44:47]
  v_mfma_f32_16x16x32_bf16 v[44:47], a[140:143], a[12:15], v[44:47]
  v_mfma_f32_16x16x32_bf16 v[52:55], a[136:139], a[16:19], v[52:55]
  ds_read_b64_tr_b16 a[156:157], v23 offset:4096
  ds_read_b64_tr_b16 a[158:159], v23 offset:6144
  v_mfma_f32_16x16x32_bf16 v[52:55], a[140:143], a[20:23], v[52:55]
  buffer_load_dwordx4 v27, s[56:59], s85 offen lds
  v_mfma_f32_16x16x32_bf16 v[60:63], a[136:139], a[24:27], v[60:63]
  s_add_u32 m0, s8, 67584
  s_add_u32 s85, s7, 0
  v_mfma_f32_16x16x32_bf16 v[60:63], a[140:143], a[28:31], v[60:63]
  v_mfma_f32_16x16x32_bf16 v[68:71], a[136:139], a[32:35], v[68:71]
  v_mfma_f32_16x16x32_bf16 v[68:71], a[140:143], a[36:39], v[68:71]
  v_mfma_f32_16x16x32_bf16 v[76:79], a[136:139], a[40:43], v[76:79]
  buffer_load_dwordx4 v28, s[56:59], s85 offen lds
  v_mfma_f32_16x16x32_bf16 v[76:79], a[140:143], a[44:47], v[76:79]
  s_add_u32 m0, s89, 147456
  s_add_u32 s84, s87, 3670016
  v_mfma_f32_16x16x32_bf16 v[84:87], a[136:139], a[48:51], v[84:87]
  v_mfma_f32_16x16x32_bf16 v[84:87], a[140:143], a[52:55], v[84:87]
  v_mfma_f32_16x16x32_bf16 v[92:95], a[136:139], a[56:59], v[92:95]
  buffer_load_dwordx4 v15, s[48:51], s84 offen offset:0 lds
  v_mfma_f32_16x16x32_bf16 v[92:95], a[140:143], a[60:63], v[92:95]
  s_add_u32 m0, s89, 147456
  s_add_u32 s84, s87, 3800064
  s_waitcnt lgkmcnt(0)
  v_mfma_f32_16x16x32_bf16 v[96:99], a[144:147], a[0:3], v[96:99]
  s_waitcnt vmcnt(21)
  s_barrier
  v_mfma_f32_16x16x32_bf16 v[96:99], a[148:151], a[4:7], v[96:99]
  v_mfma_f32_16x16x32_bf16 v[104:107], a[144:147], a[8:11], v[104:107]
  ds_read_b64_tr_b16 a[128:129], v20 offset:16384
  ds_read_b64_tr_b16 a[130:131], v20 offset:18432
  v_mfma_f32_16x16x32_bf16 v[104:107], a[148:151], a[12:15], v[104:107]
  buffer_load_dwordx4 v15, s[48:51], s84 offen offset:1024 lds
  v_mfma_f32_16x16x32_bf16 v[112:115], a[144:147], a[16:19], v[112:115]
  s_add_u32 m0, s89, 147456
  s_add_u32 s84, s87, 3700736
  v_mfma_f32_16x16x32_bf16 v[112:115], a[148:151], a[20:23], v[112:115]
  v_mfma_f32_16x16x32_bf16 v[120:123], a[144:147], a[24:27], v[120:123]
  v_mfma_f32_16x16x32_bf16 v[120:123], a[148:151], a[28:31], v[120:123]
  buffer_load_dwordx4 v15, s[48:51], s84 offen offset:2048 lds
  v_mfma_f32_16x16x32_bf16 v[192:195], a[144:147], a[32:35], v[192:195]
  s_add_u32 m0, s89, 147456
  ds_read_b64_tr_b16 a[132:133], v20 offset:20480
  ds_read_b64_tr_b16 a[134:135], v20 offset:22528
  v_mfma_f32_16x16x32_bf16 v[192:195], a[148:151], a[36:39], v[192:195]
  s_add_u32 s84, s87, 3830784
  v_mfma_f32_16x16x32_bf16 v[128:131], a[144:147], a[40:43], v[128:131]
  v_mfma_f32_16x16x32_bf16 v[128:131], a[148:151], a[44:47], v[128:131]
  buffer_load_dwordx4 v15, s[48:51], s84 offen offset:3072 lds
  v_mfma_f32_16x16x32_bf16 v[200:203], a[144:147], a[48:51], v[200:203]
  v_mfma_f32_16x16x32_bf16 v[200:203], a[148:151], a[52:55], v[200:203]
  v_mfma_f32_16x16x32_bf16 v[136:139], a[144:147], a[56:59], v[136:139]
  ds_read_b64_tr_b16 a[136:137], v21 offset:16384
  ds_read_b64_tr_b16 a[138:139], v21 offset:18432
  v_mfma_f32_16x16x32_bf16 v[136:139], a[148:151], a[60:63], v[136:139]
  v_mfma_f32_16x16x32_bf16 v[100:103], a[152:155], a[0:3], v[100:103]
  v_mfma_f32_16x16x32_bf16 v[100:103], a[156:159], a[4:7], v[100:103]
  v_mfma_f32_16x16x32_bf16 v[108:111], a[152:155], a[8:11], v[108:111]
  v_mfma_f32_16x16x32_bf16 v[108:111], a[156:159], a[12:15], v[108:111]
  v_mfma_f32_16x16x32_bf16 v[116:119], a[152:155], a[16:19], v[116:119]
  ds_read_b64_tr_b16 a[140:141], v21 offset:20480
  ds_read_b64_tr_b16 a[142:143], v21 offset:22528
  v_mfma_f32_16x16x32_bf16 v[116:119], a[156:159], a[20:23], v[116:119]
  v_mfma_f32_16x16x32_bf16 v[124:127], a[152:155], a[24:27], v[124:127]
  v_mfma_f32_16x16x32_bf16 v[124:127], a[156:159], a[28:31], v[124:127]
  v_mfma_f32_16x16x32_bf16 v[196:199], a[152:155], a[32:35], v[196:199]
  v_mfma_f32_16x16x32_bf16 v[196:199], a[156:159], a[36:39], v[196:199]
  v_mfma_f32_16x16x32_bf16 v[132:135], a[152:155], a[40:43], v[132:135]
  v_mfma_f32_16x16x32_bf16 v[132:135], a[156:159], a[44:47], v[132:135]
  s_waitcnt vmcnt(11)
  v_readlane_b32 s80, v13, 0
  v_readlane_b32 s81, v13, 1
  s_nop 0
  s_add_u32 s80, s80, s81
  s_cmp_ge_u32 s80, 256
  s_cbranch_scc0 L_xn_spin
L_xn_ok:
  v_mfma_f32_16x16x32_bf16 v[204:207], a[152:155], a[48:51], v[204:207]
  s_add_u32 s85, s4, 0
  v_mfma_f32_16x16x32_bf16 v[204:207], a[156:159], a[52:55], v[204:207]
  buffer_load_dwordx4 a[160:163], v12, s[68:71], s85 offen sc1
  v_mfma_f32_16x16x32_bf16 v[140:143], a[152:155], a[56:59], v[140:143]
  s_add_u32 s85, s4, 65536
  v_mfma_f32_16x16x32_bf16 v[140:143], a[156:159], a[60:63], v[140:143]
  s_waitcnt lgkmcnt(0)
  v_mfma_f32_16x16x32_bf16 v[208:211], a[0:3], a[128:131], v[208:211]
  v_mfma_f32_16x16x32_bf16 v[208:211], a[4:7], a[132:135], v[208:211]
  v_mfma_f32_16x16x32_bf16 v[212:215], a[8:11], a[128:131], v[212:215]
  ds_read_b64_tr_b16 a[144:145], v22 offset:16384
  ds_read_b64_tr_b16 a[146:147], v22 offset:18432
  v_mfma_f32_16x16x32_bf16 v[212:215], a[12:15], a[132:135], v[212:215]
  buffer_load_dwordx4 a[164:167], v12, s[68:71], s85 offen sc1
  v_mfma_f32_16x16x32_bf16 v[224:227], a[16:19], a[128:131], v[224:227]
  s_add_u32 s85, s5, 0
  v_mfma_f32_16x16x32_bf16 v[224:227], a[20:23], a[132:135], v[224:227]
  v_mfma_f32_16x16x32_bf16 v[228:231], a[24:27], a[128:131], v[228:231]
  v_mfma_f32_16x16x32_bf16 v[228:231], a[28:31], a[132:135], v[228:231]
  v_mfma_f32_16x16x32_bf16 v[240:243], a[32:35], a[128:131], v[240:243]
  ds_read_b64_tr_b16 a[148:149], v22 offset:20480
  ds_read_b64_tr_b16 a[150:151], v22 offset:22528
  v_mfma_f32_16x16x32_bf16 v[240:243], a[36:39], a[132:135], v[240:243]
  buffer_load_dwordx4 a[168:171], v12, s[68:71], s85 offen sc1
  v_mfma_f32_16x16x32_bf16 v[244:247], a[40:43], a[128:131], v[244:247]
  s_add_u32 s85, s5, 65536
  v_mfma_f32_16x16x32_bf16 v[244:247], a[44:47], a[132:135], v[244:247]
  v_mfma_f32_16x16x32_bf16 a[224:227], a[48:51], a[128:131], a[224:227]
  v_mfma_f32_16x16x32_bf16 a[224:227], a[52:55], a[132:135], a[224:227]
  v_mfma_f32_16x16x32_bf16 a[228:231], a[56:59], a[128:131], a[228:231]
  ds_read_b64_tr_b16 a[152:153], v23 offset:16384
  ds_read_b64_tr_b16 a[154:155], v23 offset:18432
  v_mfma_f32_16x16x32_bf16 a[228:231], a[60:63], a[132:135], a[228:231]
  buffer_load_dwordx4 a[172:175], v12, s[68:71], s85 offen sc1
  v_mfma_f32_16x16x32_bf16 v[144:147], a[0:3], a[136:139], v[144:147]
  s_add_u32 s85, s4, 1024
  v_mfma_f32_16x16x32_bf16 v[144:147], a[4:7], a[140:143], v[144:147]
  v_mfma_f32_16x16x32_bf16 v[148:151], a[8:11], a[136:139], v[148:151]
  v_mfma_f32_16x16x32_bf16 v[148:151], a[12:15], a[140:143], v[148:151]
  v_mfma_f32_16x16x32_bf16 v[160:163], a[16:19], a[136:139], v[160:163]
  ds_read_b64_tr_b16 a[156:157], v23 offset:20480
  ds_read_b64_tr_b16 a[158:159], v23 offset:22528
  v_mfma_f32_16x16x32_bf16 v[160:163], a[20:23], a[140:143], v[160:163]
  buffer_load_dwordx4 a[176:179], v12, s[68:71], s85 offen sc1
  v_mfma_f32_16x16x32_bf16 v[164:167], a[24:27], a[136:139], v[164:167]
  s_add_u32 s85, s4, 66560
  v_mfma_f32_16x16x32_bf16 v[164:167], a[28:31], a[140:143], v[164:167]
  v_mfma_f32_16x16x32_bf16 v[176:179], a[32:35], a[136:139], v[176:179]
  v_mfma_f32_16x16x32_bf16 v[176:179], a[36:39], a[140:143], v[176:179]
  v_mfma_f32_16x16x32_bf16 v[180:183], a[40:43], a[136:139], v[180:183]
  buffer_load_dwordx4 a[180:183], v12, s[68:71], s85 offen sc1
  v_mfma_f32_16x16x32_bf16 v[180:183], a[44:47], a[140:143], v[180:183]
  v_mfma_f32_16x16x32_bf16 a[232:235], a[48:51], a[136:139], a[232:235]
  v_mfma_f32_16x16x32_bf16 a[232:235], a[52:55], a[140:143], a[232:235]
  s_add_u32 s85, s5, 1024
  v_mfma_f32_16x16x32_bf16 a[236:239], a[56:59], a[136:139], a[236:239]
  v_add_u32 v24, 4096, v12
  v_mfma_f32_16x16x32_bf16 a[236:239], a[60:63], a[140:143], a[236:239]
  s_waitcnt lgkmcnt(0)
  v_mfma_f32_16x16x32_bf16 v[216:219], a[0:3], a[144:147], v[216:219]
  s_waitcnt vmcnt(13)
  s_barrier
  v_mfma_f32_16x16x32_bf16 v[216:219], a[4:7], a[148:151], v[216:219]
  v_mfma_f32_16x16x32_bf16 v[220:223], a[8:11], a[144:147], v[220:223]
  ds_read_b64_tr_b16 a[128:129], v20 offset:32768
  ds_read_b64_tr_b16 a[130:131], v20 offset:34816
  v_mfma_f32_16x16x32_bf16 v[220:223], a[12:15], a[148:151], v[220:223]
  buffer_load_dwordx4 a[184:187], v12, s[68:71], s85 offen sc1
  v_mfma_f32_16x16x32_bf16 v[232:235], a[16:19], a[144:147], v[232:235]
  s_add_u32 s85, s5, 66560
  ds_read_b128 a[64:67], v18 offset:0
  v_mfma_f32_16x16x32_bf16 v[232:235], a[20:23], a[148:151], v[232:235]
  ds_read_b128 a[68:71], v19 offset:0
  v_mfma_f32_16x16x32_bf16 v[236:239], a[24:27], a[144:147], v[236:239]
  ds_read_b128 a[72:75], v18 offset:2048
  v_mfma_f32_16x16x32_bf16 v[236:239], a[28:31], a[148:151], v[236:239]
  v_mfma_f32_16x16x32_bf16 v[248:251], a[32:35], a[144:147], v[248:251]
  ds_read_b64_tr_b16 a[132:133], v20 offset:36864
  ds_read_b64_tr_b16 a[134:135], v20 offset:38912
  v_mfma_f32_16x16x32_bf16 v[248:251], a[36:39], a[148:151], v[248:251]
  buffer_load_dwordx4 a[188:191], v12, s[68:71], s85 offen sc1
  v_mfma_f32_16x16x32_bf16 v[252:255], a[40:43], a[144:147], v[252:255]
  s_add_u32 m0, s8, 0
  ds_read_b128 a[76:79], v19 offset:2048
  s_add_u32 s85, s7, 176128
  v_mfma_f32_16x16x32_bf16 v[252:255], a[44:47], a[148:151], v[252:255]
  ds_read_b128 a[80:83], v18 offset:4096
  v_mfma_f32_16x16x32_bf16 a[240:243], a[48:51], a[144:147], a[240:243]
  ds_read_b128 a[84:87], v19 offset:4096
  v_mfma_f32_16x16x32_bf16 a[240:243], a[52:55], a[148:151], a[240:243]
  v_mfma_f32_16x16x32_bf16 a[244:247], a[56:59], a[144:147], a[244:247]
  ds_read_b64_tr_b16 a[136:137], v21 offset:32768
  ds_read_b64_tr_b16 a[138:139], v21 offset:34816
  v_mfma_f32_16x16x32_bf16 a[244:247], a[60:63], a[148:151], a[244:247]
  buffer_load_dwordx4 v26, s[56:59], s85 offen lds
  v_mfma_f32_16x16x32_bf16 v[152:155], a[0:3], a[152:155], v[152:155]
  s_add_u32 m0, s8, 1024
  ds_read_b128 a[88:91], v18 offset:6144
  s_add_u32 s85, s7, 176128
  v_mfma_f32_16x16x32_bf16 v[152:155], a[4:7], a[156:159], v[152:155]
  ds_read_b128 a[92:95], v19 offset:6144
  v_mfma_f32_16x16x32_bf16 v[156:159], a[8:11], a[152:155], v[156:159]
  ds_read_b128 a[96:99], v18 offset:8192
  v_mfma_f32_16x16x32_bf16 v[156:159], a[12:15], a[156:159], v[156:159]
  v_mfma_f32_16x16x32_bf16 v[168:171], a[16:19], a[152:155], v[168:171]
  ds_read_b64_tr_b16 a[140:141], v21 offset:36864
  ds_read_b64_tr_b16 a[142:143], v21 offset:38912
  v_mfma_f32_16x16x32_bf16 v[168:171], a[20:23], a[156:159], v[168:171]
  buffer_load_dwordx4 v27, s[56:59], s85 offen lds
  v_mfma_f32_16x16x32_bf16 v[172:175], a[24:27], a[152:155], v[172:175]
  s_add_u32 m0, s8, 2048
  ds_read_b128 a[100:103], v19 offset:8192
  s_add_u32 s85, s7, 176128
  v_mfma_f32_16x16x32_bf16 v[172:175], a[28:31], a[156:159], v[172:175]
  ds_read_b128 a[104:107], v18 offset:10240
  v_mfma_f32_16x16x32_bf16 v[184:187], a[32:35], a[152:155], v[184:187]
  ds_read_b128 a[108:111], v19 offset:10240
  v_mfma_f32_16x16x32_bf16 v[184:187], a[36:39], a[156:159], v[184:187]
  v_mfma_f32_16x16x32_bf16 v[188:191], a[40:43], a[152:155], v[188:191]
  ds_read_b128 a[112:115], v18 offset:12288
  v_mfma_f32_16x16x32_bf16 v[188:191], a[44:47], a[156:159], v[188:191]
  buffer_load_dwordx4 v28, s[56:59], s85 offen lds
  v_mfma_f32_16x16x32_bf16 a[248:251], a[48:51], a[152:155], a[248:251]
  s_add_u32 m0, s89, 0
  ds_read_b128 a[116:119], v19 offset:12288
  s_add_u32 s85, s87, 0
  v_mfma_f32_16x16x32_bf16 a[248:251], a[52:55], a[156:159], a[248:251]
  v_mfma_f32_16x16x32_bf16 a[252:255], a[56:59], a[152:155], a[252:255]
  ds_read_b128 a[120:123], v18 offset:14336
  v_mfma_f32_16x16x32_bf16 a[252:255], a[60:63], a[156:159], a[252:255]
  s_waitcnt lgkmcnt(6)
  v_mfma_f32_16x16x32_bf16 v[32:35], a[128:131], a[64:67], v[32:35]
  s_mov_b32 s83, 0x3e0293ee
  ds_read_b128 a[124:127], v19 offset:14336
  v_mfma_f32_16x16x32_bf16 v[32:35], a[132:135], a[68:71], v[32:35]
  buffer_load_dwordx4 v15, s[40:43], s85 offen lds
  v_mfma_f32_16x16x32_bf16 v[40:43], a[128:131], a[72:75], v[40:43]
  s_add_u32 m0, s89, 1024
  ds_read_b64_tr_b16 a[144:145], v22 offset:32768
  ds_read_b64_tr_b16 a[146:147], v22 offset:34816
  v_mfma_f32_16x16x32_bf16 v[40:43], a[132:135], a[76:79], v[40:43]
  s_add_u32 s85, s87, 131072
  v_mfma_f32_16x16x32_bf16 v[48:51], a[128:131], a[80:83], v[48:51]
  v_mfma_f32_16x16x32_bf16 v[48:51], a[132:135], a[84:87], v[48:51]
  v_mul_f32 v32, s83, v32
  v_mul_f32 v33, s83, v33
  v_mfma_f32_16x16x32_bf16 v[56:59], a[128:131], a[88:91], v[56:59]
  buffer_load_dwordx4 v15, s[40:43], s85 offen lds
  v_mfma_f32_16x16x32_bf16 v[56:59], a[132:135], a[92:95], v[56:59]
  s_add_u32 m0, s89, 2048
  s_add_u32 s85, s87, 32768
  s_waitcnt lgkmcnt(2)
  v_mfma_f32_16x16x32_bf16 v[64:67], a[128:131], a[96:99], v[64:67]
  ds_read_b64_tr_b16 a[148:149], v22 offset:36864
  ds_read_b64_tr_b16 a[150:151], v22 offset:38912
  v_mfma_f32_16x16x32_bf16 v[64:67], a[132:135], a[100:103], v[64:67]
  v_mul_f32 v34, s83, v34
  v_mul_f32 v35, s83, v35
  v_mfma_f32_16x16x32_bf16 v[72:75], a[128:131], a[104:107], v[72:75]
  v_mul_f32 v40, s83, v40
  v_mul_f32 v41, s83, v41
  v_mfma_f32_16x16x32_bf16 v[72:75], a[132:135], a[108:111], v[72:75]
  buffer_load_dwordx4 v15, s[40:43], s85 offen lds
  v_mfma_f32_16x16x32_bf16 v[80:83], a[128:131], a[112:115], v[80:83]
  s_add_u32 m0, s89, 3072
  s_add_u32 s85, s87, 163840
  v_mul_f32 v42, s83, v42
  v_mfma_f32_16x16x32_bf16 v[80:83], a[132:135], a[116:119], v[80:83]
  v_mul_f32 v43, s83, v43
  v_mul_f32 v48, s83, v48
  v_mfma_f32_16x16x32_bf16 v[88:91], a[128:131], a[120:123], v[88:91]
  ds_read_b64_tr_b16 a[152:153], v23 offset:32768
  ds_read_b64_tr_b16 a[154:155], v23 offset:34816
  v_mfma_f32_16x16x32_bf16 v[88:91], a[132:135], a[124:127], v[88:91]
  v_mul_f32 v49, s83, v49
  v_mul_f32 v50, s83, v50
  v_mfma_f32_16x16x32_bf16 v[36:39], a[136:139], a[64:67], v[36:39]
  buffer_load_dwordx4 v15, s[40:43], s85 offen lds
  v_mfma_f32_16x16x32_bf16 v[36:39], a[140:143], a[68:71], v[36:39]
  s_add_u32 s85, s4, 2048
  v_mul_f32 v51, s83, v51
  v_mul_f32 v56, s83, v56
  v_mfma_f32_16x16x32_bf16 v[44:47], a[136:139], a[72:75], v[44:47]
  v_mul_f32 v57, s83, v57
  v_mul_f32 v58, s83, v58
  v_mfma_f32_16x16x32_bf16 v[44:47], a[140:143], a[76:79], v[44:47]
  v_mul_f32 v59, s83, v59
  v_mul_f32 v64, s83, v64
  v_mfma_f32_16x16x32_bf16 v[52:55], a[136:139], a[80:83], v[52:55]
  ds_read_b64_tr_b16 a[156:157], v23 offset:36864
  ds_read_b64_tr_b16 a[158:159], v23 offset:38912
  v_mfma_f32_16x16x32_bf16 v[52:55], a[140:143], a[84:87], v[52:55]
  buffer_load_dwordx4 a[192:195], v12, s[68:71], s85 offen sc1
  v_mfma_f32_16x16x32_bf16 v[60:63], a[136:139], a[88:91], v[60:63]
  s_add_u32 s85, s4, 67584
  v_mul_f32 v65, s83, v65
  v_mul_f32 v66, s83, v66
  v_mfma_f32_16x16x32_bf16 v[60:63], a[140:143], a[92:95], v[60:63]
L_hop4:
  s_cbranch_execz L_hop8
  v_mul_f32 v67, s83, v67
  v_mul_f32 v72, s83, v72
  v_mfma_f32_16x16x32_bf16 v[68:71], a[136:139], a[96:99], v[68:71]
  v_mul_f32 v73, s83, v73
  v_mul_f32 v74, s83, v74
  v_mfma_f32_16x16x32_bf16 v[68:71], a[140:143], a[100:103], v[68:71]
  v_mul_f32 v75, s83, v75
  v_mul_f32 v80, s83, v80
  v_mfma_f32_16x16x32_bf16 v[76:79], a[136:139], a[104:107], v[76:79]
  buffer_load_dwordx4 a[196:199], v12, s[68:71], s85 offen sc1
  v_mfma_f32_16x16x32_bf16 v[76:79], a[140:143], a[108:111], v[76:79]
  v_mul_f32 v81, s83, v81
  v_mul_f32 v82, s83, v82
  v_mfma_f32_16x16x32_bf16 v[84:87], a[136:139], a[112:115], v[84:87]
  v_mul_f32 v83, s83, v83
  v_mul_f32 v88, s83, v88
  v_mfma_f32_16x16x32_bf16 v[84:87], a[140:143], a[116:119], v[84:87]
  s_add_u32 s85, s5, 2048
  v_mul_f32 v89, s83, v89
  v_mul_f32 v90, s83, v90
  v_mfma_f32_16x16x32_bf16 v[92:95], a[136:139], a[120:123], v[92:95]
  v_mul_f32 v91, s83, v91
  v_mul_f32 v36, s83, v36
  v_mfma_f32_16x16x32_bf16 v[92:95], a[140:143], a[124:127], v[92:95]
  s_waitcnt lgkmcnt(0)
  v_mul_f32 v37, s83, v37
  v_mul_f32 v38, s83, v38
  v_mfma_f32_16x16x32_bf16 v[96:99], a[144:147], a[64:67], v[96:99]
  s_waitcnt vmcnt(17)
  s_barrier
  v_mfma_f32_16x16x32_bf16 v[96:99], a[148:151], a[68:71], v[96:99]
  v_mul_f32 v39, s83, v39
  v_mul_f32 v44, s83, v44
  v_mfma_f32_16x16x32_bf16 v[104:107], a[144:147], a[72:75], v[104:107]
  ds_read_b64_tr_b16 a[128:129], v20 offset:49152
  ds_read_b64_tr_b16 a[130:131], v20 offset:51200
  v_mfma_f32_16x16x32_bf16 v[104:107], a[148:151], a[76:79], v[104:107]
  buffer_load_dwordx4 a[200:203], v12, s[68:71], s85 offen sc1
  v_mfma_f32_16x16x32_bf16 v[112:115], a[144:147], a[80:83], v[112:115]
  s_add_u32 s85, s5, 67584
  v_mul_f32 v45, s83, v45
  v_mul_f32 v46, s83, v46
  v_mfma_f32_16x16x32_bf16 v[112:115], a[148:151], a[84:87], v[112:115]
  v_mul_f32 v47, s83, v47
  v_mul_f32 v52, s83, v52
  v_mfma_f32_16x16x32_bf16 v[120:123], a[144:147], a[88:91], v[120:123]
  v_mul_f32 v53, s83, v53
  v_mul_f32 v54, s83, v54
  v_mfma_f32_16x16x32_bf16 v[120:123], a[148:151], a[92:95], v[120:123]
  v_mul_f32 v55, s83, v55
  v_mul_f32 v60, s83, v60
  v_mfma_f32_16x16x32_bf16 v[192:195], a[144:147], a[96:99], v[192:195]
  ds_read_b64_tr_b16 a[132:133], v20 offset:53248
  ds_read_b64_tr_b16 a[134:135], v20 offset:55296
  v_mfma_f32_16x16x32_bf16 v[192:195], a[148:151], a[100:103], v[192:195]
  buffer_load_dwordx4 a[204:207], v12, s[68:71], s85 offen sc1
  v_mfma_f32_16x16x32_bf16 v[128:131], a[144:147], a[104:107], v[128:131]
  s_add_u32 s85, s4, 3072
  v_mul_f32 v61, s83, v61
  v_mul_f32 v62, s83, v62
  v_mfma_f32_16x16x32_bf16 v[128:131], a[148:151], a[108:111], v[128:131]
  v_mul_f32 v63, s83, v63
  v_mul_f32 v68, s83, v68
  v_mfma_f32_16x16x32_bf16 v[200:203], a[144:147], a[112:115], v[200:203]
  v_mul_f32 v69, s83, v69
  v_mul_f32 v70, s83, v70
  v_mfma_f32_16x16x32_bf16 v[200:203], a[148:151], a[116:119], v[200:203]
  v_mul_f32 v71, s83, v71
  v_mul_f32 v76, s83, v76
  v_mfma_f32_16x16x32_bf16 v[136:139], a[144:147], a[120:123], v[136:139]
  ds_read_b64_tr_b16 a[136:137], v21 offset:49152
  ds_read_b64_tr_b16 a[138:139], v21 offset:51200
  v_mfma_f32_16x16x32_bf16 v[136:139], a[148:151], a[124:127], v[136:139]
  buffer_load_dwordx4 a[208:211], v12, s[68:71], s85 offen sc1
  v_mfma_f32_16x16x32_bf16 v[100:103], a[152:155], a[64:67], v[100:103]
  s_add_u32 s85, s4, 68608
  v_mul_f32 v77, s83, v77
  v_mul_f32 v78, s83, v78
  v_mfma_f32_16x16x32_bf16 v[100:103], a[156:159], a[68:71], v[100:103]
  v_mul_f32 v79, s83, v79
  v_mul_f32 v84, s83, v84
  v_mfma_f32_16x16x32_bf16 v[108:111], a[152:155], a[72:75], v[108:111]
  v_mul_f32 v85, s83, v85
  v_mul_f32 v86, s83, v86
  v_mfma_f32_16x16x32_bf16 v[108:111], a[156:159], a[76:79], v[108:111]
  v_mul_f32 v87, s83, v87
  v_mul_f32 v92, s83, v92
  v_mfma_f32_16x16x32_bf16 v[116:119], a[152:155], a[80:83], v[116:119]
  ds_read_b64_tr_b16 a[140:141], v21 offset:53248
  ds_read_b64_tr_b16 a[142:143], v21 offset:55296
  v_mfma_f32_16x16x32_bf16 v[116:119], a[156:159], a[84:87], v[116:119]
  buffer_load_dwordx4 a[212:215], v12, s[68:71], s85 offen sc1
  v_mfma_f32_16x16x32_bf16 v[124:127], a[152:155], a[88:91], v[124:127]
  s_add_u32 s85, s5, 3072
  v_mul_f32 v93, s83, v93
  v_mul_f32 v94, s83, v94
  v_mfma_f32_16x16x32_bf16 v[124:127], a[156:159], a[92:95], v[124:127]
  v_mul_f32 v95, s83, v95
  v_mul_f32 v96, s83, v96
  v_mfma_f32_16x16x32_bf16 v[196:199], a[152:155], a[96:99], v[196:199]
  v_mul_f32 v97, s83, v97
  v_mul_f32 v98, s83, v98
  v_mfma_f32_16x16x32_bf16 v[196:199], a[156:159], a[100:103], v[196:199]
  v_mul_f32 v99, s83, v99
  v_mul_f32 v104, s83, v104
  v_mfma_f32_16x16x32_bf16 v[132:135], a[152:155], a[104:107], v[132:135]
  buffer_load_dwordx4 a[216:219], v12, s[68:71], s85 offen sc1
  v_mfma_f32_16x16x32_bf16 v[132:135], a[156:159], a[108:111], v[132:135]
  s_add_u32 s85, s5, 68608
  v_mul_f32 v105, s83, v105
  v_mul_f32 v106, s83, v106
  v_mfma_f32_16x16x32_bf16 v[204:207], a[152:155], a[112:115], v[204:207]
  v_mul_f32 v107, s83, v107
  v_mul_f32 v112, s83, v112
  v_mfma_f32_16x16x32_bf16 v[204:207], a[156:159], a[116:119], v[204:207]
  v_mul_f32 v113, s83, v113
  v_mul_f32 v114, s83, v114
  v_mfma_f32_16x16x32_bf16 v[140:143], a[152:155], a[120:123], v[140:143]
  v_mul_f32 v115, s83, v115
  v_mul_f32 v120, s83, v120
  v_mfma_f32_16x16x32_bf16 v[140:143], a[156:159], a[124:127], v[140:143]
  s_waitcnt lgkmcnt(0)
  v_mul_f32 v121, s83, v121
  v_mul_f32 v122, s83, v122
  v_mfma_f32_16x16x32_bf16 v[208:211], a[64:67], a[128:131], v[208:211]
  buffer_load_dwordx4 a[220:223], v12, s[68:71], s85 offen sc1
  v_mfma_f32_16x16x32_bf16 v[208:211], a[68:71], a[132:135], v[208:211]
  s_add_u32 m0, s8, 98304
  s_add_u32 s85, s7, 352256
  v_mul_f32 v123, s83, v123
  v_mfma_f32_16x16x32_bf16 v[212:215], a[72:75], a[128:131], v[212:215]
  ds_read_b64_tr_b16 a[144:145], v22 offset:49152
  ds_read_b64_tr_b16 a[146:147], v22 offset:51200
  v_mfma_f32_16x16x32_bf16 v[212:215], a[76:79], a[132:135], v[212:215]
  v_mul_f32 v192, s83, v192
  v_mul_f32 v193, s83, v193
  v_mfma_f32_16x16x32_bf16 v[224:227], a[80:83], a[128:131], v[224:227]
  v_mul_f32 v194, s83, v194
  v_mul_f32 v195, s83, v195
  v_mfma_f32_16x16x32_bf16 v[224:227], a[84:87], a[132:135], v[224:227]
  buffer_load_dwordx4 v26, s[56:59], s85 offen lds
  v_mfma_f32_16x16x32_bf16 v[228:231], a[88:91], a[128:131], v[228:231]
  s_add_u32 m0, s8, 99328
  s_add_u32 s85, s7, 352256
  v_mul_f32 v128, s83, v128
  v_mfma_f32_16x16x32_bf16 v[228:231], a[92:95], a[132:135], v[228:231]
  v_mul_f32 v129, s83, v129
  v_mul_f32 v130, s83, v130
  v_mfma_f32_16x16x32_bf16 v[240:243], a[96:99], a[128:131], v[240:243]
  ds_read_b64_tr_b16 a[148:149], v22 offset:53248
  ds_read_b64_tr_b16 a[150:151], v22 offset:55296
  v_mfma_f32_16x16x32_bf16 v[240:243], a[100:103], a[132:135], v[240:243]
  v_mul_f32 v131, s83, v131
  v_mul_f32 v200, s83, v200
  v_mfma_f32_16x16x32_bf16 v[244:247], a[104:107], a[128:131], v[244:247]
  buffer_load_dwordx4 v27, s[56:59], s85 offen lds
  v_mfma_f32_16x16x32_bf16 v[244:247], a[108:111], a[132:135], v[244:247]
  s_add_u32 m0, s8, 100352
  s_add_u32 s85, s7, 352256
  v_mul_f32 v201, s83, v201
  v_mfma_f32_16x16x32_bf16 a[224:227], a[112:115], a[128:131], a[224:227]
  v_mul_f32 v202, s83, v202
  v_mul_f32 v203, s83, v203
  v_mfma_f32_16x16x32_bf16 a[224:227], a[116:119], a[132:135], a[224:227]
  v_mul_f32 v136, s83, v136
  v_mul_f32 v137, s83, v137
  v_mfma_f32_16x16x32_bf16 a[228:231], a[120:123], a[128:131], a[228:231]
  ds_read_b64_tr_b16 a[152:153], v23 offset:49152
  ds_read_b64_tr_b16 a[154:155], v23 offset:51200
  v_mfma_f32_16x16x32_bf16 a[228:231], a[124:127], a[132:135], a[228:231]
  buffer_load_dwordx4 v28, s[56:59], s85 offen lds
  v_mfma_f32_16x16x32_bf16 v[144:147], a[64:67], a[136:139], v[144:147]
  s_add_u32 m0, s89, 98304
  s_add_u32 s85, s87, 524288
  v_mul_f32 v138, s83, v138
  v_mfma_f32_16x16x32_bf16 v[144:147], a[68:71], a[140:143], v[144:147]
  v_mul_f32 v139, s83, v139
  v_mul_f32 v100, s83, v100
  v_mfma_f32_16x16x32_bf16 v[148:151], a[72:75], a[136:139], v[148:151]
  v_mul_f32 v101, s83, v101
  v_mul_f32 v102, s83, v102
  v_mfma_f32_16x16x32_bf16 v[148:151], a[76:79], a[140:143], v[148:151]
  v_mul_f32 v103, s83, v103
  v_mul_f32 v108, s83, v108
  v_mfma_f32_16x16x32_bf16 v[160:163], a[80:83], a[136:139], v[160:163]
  ds_read_b64_tr_b16 a[156:157], v23 offset:53248
  ds_read_b64_tr_b16 a[158:159], v23 offset:55296
  v_mfma_f32_16x16x32_bf16 v[160:163], a[84:87], a[140:143], v[160:163]
  buffer_load_dwordx4 v15, s[40:43], s85 offen lds
  v_mfma_f32_16x16x32_bf16 v[164:167], a[88:91], a[136:139], v[164:167]
  s_add_u32 m0, s89, 99328
  s_add_u32 s85, s87, 655360
  v_mul_f32 v109, s83, v109
  v_mfma_f32_16x16x32_bf16 v[164:167], a[92:95], a[140:143], v[164:167]
  v_mul_f32 v110, s83, v110
  v_mul_f32 v111, s83, v111
  v_mfma_f32_16x16x32_bf16 v[176:179], a[96:99], a[136:139], v[176:179]
  s_lshr_b32 s80, s76, 1
  s_lshl_b32 s80, s80, 13
  s_sub_u32 s80, -98304, s80
  v_mfma_f32_16x16x32_bf16 v[176:179], a[100:103], a[140:143], v[176:179]
  v_add_u32 v20, s80, v20
  v_add_u32 v21, s80, v21
  v_mfma_f32_16x16x32_bf16 v[180:183], a[104:107], a[136:139], v[180:183]
  buffer_load_dwordx4 v15, s[40:43], s85 offen lds
  v_mfma_f32_16x16x32_bf16 v[180:183], a[108:111], a[140:143], v[180:183]
  s_add_u32 m0, s89, 100352
  s_add_u32 s85, s87, 557056
  v_add_u32 v22, s80, v22
  v_mfma_f32_16x16x32_bf16 a[232:235], a[112:115], a[136:139], a[232:235]
  v_add_u32 v23, s80, v23
  v_mul_f32 v116, s83, v116
  v_mfma_f32_16x16x32_bf16 a[232:235], a[116:119], a[140:143], a[232:235]
  v_mul_f32 v117, s83, v117
  v_mul_f32 v118, s83, v118
  v_mfma_f32_16x16x32_bf16 a[236:239], a[120:123], a[136:139], a[236:239]
  v_mul_f32 v119, s83, v119
  v_mul_f32 v124, s83, v124
  v_mfma_f32_16x16x32_bf16 a[236:239], a[124:127], a[140:143], a[236:239]
  s_waitcnt lgkmcnt(0)
  v_mul_f32 v125, s83, v125
  v_mul_f32 v126, s83, v126
  v_mfma_f32_16x16x32_bf16 v[216:219], a[64:67], a[144:147], v[216:219]
  ds_read_b64_tr_b16 a[0:1], v1 offset:0
  ds_read_b64_tr_b16 a[2:3], v1 offset:1536
  v_mfma_f32_16x16x32_bf16 v[216:219], a[68:71], a[148:151], v[216:219]
  buffer_load_dwordx4 v15, s[40:43], s85 offen lds
  v_mfma_f32_16x16x32_bf16 v[220:223], a[72:75], a[144:147], v[220:223]
  s_add_u32 m0, s89, 101376
  s_add_u32 s85, s87, 688128
  v_mul_f32 v127, s83, v127
  v_mfma_f32_16x16x32_bf16 v[220:223], a[76:79], a[148:151], v[220:223]
  v_mul_f32 v196, s83, v196
  v_mul_f32 v197, s83, v197
  v_mfma_f32_16x16x32_bf16 v[232:235], a[80:83], a[144:147], v[232:235]
  ds_read_b64_tr_b16 a[4:5], v1 offset:3072
  ds_read_b64_tr_b16 a[6:7], v1 offset:4608
  v_mfma_f32_16x16x32_bf16 v[232:235], a[84:87], a[148:151], v[232:235]
  v_mul_f32 v198, s83, v198
  v_mul_f32 v199, s83, v199
  v_mfma_f32_16x16x32_bf16 v[236:239], a[88:91], a[144:147], v[236:239]
  buffer_load_dwordx4 v15, s[40:43], s85 offen lds
  v_mfma_f32_16x16x32_bf16 v[236:239], a[92:95], a[148:151], v[236:239]
  v_mul_f32 v132, s83, v132
  v_mul_f32 v133, s83, v133
  v_mfma_f32_16x16x32_bf16 v[248:251], a[96:99], a[144:147], v[248:251]
  ds_read_b64_tr_b16 a[8:9], v1 offset:6144
  ds_read_b64_tr_b16 a[10:11], v1 offset:7680
  v_mfma_f32_16x16x32_bf16 v[248:251], a[100:103], a[148:151], v[248:251]
  v_mul_f32 v134, s83, v134
  v_mul_f32 v135, s83, v135
  v_mfma_f32_16x16x32_bf16 v[252:255], a[104:107], a[144:147], v[252:255]
  v_mul_f32 v204, s83, v204
  v_mul_f32 v205, s83, v205
  v_mfma_f32_16x16x32_bf16 v[252:255], a[108:111], a[148:151], v[252:255]
  v_mul_f32 v206, s83, v206
  v_mul_f32 v207, s83, v207
  v_mfma_f32_16x16x32_bf16 a[240:243], a[112:115], a[144:147], a[240:243]
  ds_read_b64_tr_b16 a[12:13], v1 offset:9216
  ds_read_b64_tr_b16 a[14:15], v1 offset:10752
  v_mfma_f32_16x16x32_bf16 a[240:243], a[116:119], a[148:151], a[240:243]
  v_mul_f32 v140, s83, v140
  v_mul_f32 v141, s83, v141
  v_mfma_f32_16x16x32_bf16 a[244:247], a[120:123], a[144:147], a[244:247]
  v_mul_f32 v142, s83, v142
  v_mul_f32 v143, s83, v143
  v_mfma_f32_16x16x32_bf16 a[244:247], a[124:127], a[148:151], a[244:247]
  v_cvt_pk_bf16_f32 v4, v32, v33
  v_cvt_pk_bf16_f32 v5, v34, v35
  v_mfma_f32_16x16x32_bf16 v[152:155], a[64:67], a[152:155], v[152:155]
  ds_read_b64_tr_b16 a[16:17], v1 offset:32
  ds_read_b64_tr_b16 a[18:19], v1 offset:1568
  v_mfma_f32_16x16x32_bf16 v[152:155], a[68:71], a[156:159], v[152:155]
  v_cvt_pk_bf16_f32 v6, v36, v37
  v_cvt_pk_bf16_f32 v7, v38, v39
  v_mfma_f32_16x16x32_bf16 v[156:159], a[72:75], a[152:155], v[156:159]
  buffer_store_dwordx4 v[4:7], v12, s[68:71], s10 offen offset:0 sc1
  v_mfma_f32_16x16x32_bf16 v[156:159], a[76:79], a[156:159], v[156:159]
  v_cvt_pk_bf16_f32 v8, v40, v41
  v_cvt_pk_bf16_f32 v9, v42, v43
  v_mfma_f32_16x16x32_bf16 v[168:171], a[80:83], a[152:155], v[168:171]
  ds_read_b64_tr_b16 a[20:21], v1 offset:3104
  ds_read_b64_tr_b16 a[22:23], v1 offset:4640
  v_mfma_f32_16x16x32_bf16 v[168:171], a[84:87], a[156:159], v[168:171]
  v_cvt_pk_bf16_f32 v10, v44, v45
  v_cvt_pk_bf16_f32 v11, v46, v47
  v_mfma_f32_16x16x32_bf16 v[172:175], a[88:91], a[152:155], v[172:175]
  v_accvgpr_write_b32 a40, v8
  v_accvgpr_write_b32 a41, v9
  v_mfma_f32_16x16x32_bf16 v[172:175], a[92:95], a[156:159], v[172:175]
  v_accvgpr_write_b32 a42, v10
  v_accvgpr_write_b32 a43, v11
  v_mfma_f32_16x16x32_bf16 v[184:187], a[96:99], a[152:155], v[184:187]
  ds_read_b64_tr_b16 a[24:25], v1 offset:6176
  ds_read_b64_tr_b16 a[26:27], v1 offset:7712
  v_mfma_f32_16x16x32_bf16 v[184:187], a[100:103], a[156:159], v[184:187]
  v_cvt_pk_bf16_f32 v4, v48, v49
  v_cvt_pk_bf16_f32 v5, v50, v51
  v_mfma_f32_16x16x32_bf16 v[188:191], a[104:107], a[152:155], v[188:191]
  v_cvt_pk_bf16_f32 v6, v52, v53
  v_cvt_pk_bf16_f32 v7, v54, v55
  v_mfma_f32_16x16x32_bf16 v[188:191], a[108:111], a[156:159], v[188:191]
  v_accvgpr_write_b32 a44, v4
  v_accvgpr_write_b32 a45, v5
  v_mfma_f32_16x16x32_bf16 a[248:251], a[112:115], a[152:155], a[248:251]
  ds_read_b64_tr_b16 a[28:29], v1 offset:9248
  ds_read_b64_tr_b16 a[30:31], v1 offset:10784
  v_mfma_f32_16x16x32_bf16 a[248:251], a[116:119], a[156:159], a[248:251]
  v_accvgpr_write_b32 a46, v6
  v_accvgpr_write_b32 a47, v7
  v_mfma_f32_16x16x32_bf16 a[252:255], a[120:123], a[152:155], a[252:255]
  v_cvt_pk_bf16_f32 v8, v56, v57
  v_cvt_pk_bf16_f32 v9, v58, v59
  v_mfma_f32_16x16x32_bf16 a[252:255], a[124:127], a[156:159], a[252:255]
  s_waitcnt vmcnt(23) lgkmcnt(8)
  v_cvt_pk_bf16_f32 v10, v60, v61
  v_cvt_pk_bf16_f32 v11, v62, v63
  v_mfma_f32_16x16x32_bf16 v[32:35], a[0:3], a[160:163], 0
  s_add_u32 s85, s4, 4096
  ds_read_b64_tr_b16 a[32:33], v1 offset:64
  ds_read_b64_tr_b16 a[34:35], v1 offset:1600
  v_mfma_f32_16x16x32_bf16 v[32:35], a[4:7], a[176:179], v[32:35]
  v_accvgpr_write_b32 a48, v8
  v_accvgpr_write_b32 a49, v9
  v_mfma_f32_16x16x32_bf16 v[36:39], a[0:3], a[164:167], 0
  buffer_load_dwordx4 a[128:131], v12, s[68:71], s85 offen sc1
  v_mfma_f32_16x16x32_bf16 v[36:39], a[4:7], a[180:183], v[36:39]
  s_add_u32 s85, s4, 69632
  v_accvgpr_write_b32 a50, v10
  v_accvgpr_write_b32 a51, v11
  v_mfma_f32_16x16x32_bf16 v[40:43], a[0:3], a[168:171], 0
  ds_read_b64_tr_b16 a[36:37], v1 offset:3136
  ds_read_b64_tr_b16 a[38:39], v1 offset:4672
  v_mfma_f32_16x16x32_bf16 v[40:43], a[4:7], a[184:187], v[40:43]
  v_cvt_pk_bf16_f32 v4, v64, v65
  v_cvt_pk_bf16_f32 v5, v66, v67
  v_mfma_f32_16x16x32_bf16 v[44:47], a[0:3], a[172:175], 0
  v_cvt_pk_bf16_f32 v6, v68, v69
  v_cvt_pk_bf16_f32 v7, v70, v71
  v_mfma_f32_16x16x32_bf16 v[44:47], a[4:7], a[188:191], v[44:47]
  buffer_load_dwordx4 a[132:135], v12, s[68:71], s85 offen sc1
  v_mfma_f32_16x16x32_bf16 v[48:51], a[8:11], a[160:163], 0
  s_add_u32 s85, s5, 4096
  ds_read_b64_tr_b16 a[0:1], v1 offset:6208
  ds_read_b64_tr_b16 a[2:3], v1 offset:7744
  v_mfma_f32_16x16x32_bf16 v[48:51], a[12:15], a[176:179], v[48:51]
  buffer_store_dwordx4 v[4:7], v12, s[68:71], s12 offen offset:0 sc1
  v_mfma_f32_16x16x32_bf16 v[52:55], a[8:11], a[164:167], 0
  v_cvt_pk_bf16_f32 v8, v72, v73
  v_cvt_pk_bf16_f32 v9, v74, v75
  v_mfma_f32_16x16x32_bf16 v[52:55], a[12:15], a[180:183], v[52:55]
  v_cvt_pk_bf16_f32 v10, v76, v77
  v_cvt_pk_bf16_f32 v11, v78, v79
  v_mfma_f32_16x16x32_bf16 v[56:59], a[8:11], a[168:171], 0
  ds_read_b64_tr_b16 a[4:5], v1 offset:9280
  ds_read_b64_tr_b16 a[6:7], v1 offset:10816
  v_mfma_f32_16x16x32_bf16 v[56:59], a[12:15], a[184:187], v[56:59]
  buffer_load_dwordx4 a[136:139], v12, s[68:71], s85 offen sc1
  v_mfma_f32_16x16x32_bf16 v[60:63], a[8:11], a[172:175], 0
  s_add_u32 s85, s5, 69632
  v_accvgpr_write_b32 a52, v8
  v_accvgpr_write_b32 a53, v9
  v_mfma_f32_16x16x32_bf16 v[60:63], a[12:15], a[188:191], v[60:63]
  s_waitcnt vmcnt(20)
  v_subrev_u32 v1, 65536, v1
  s_barrier
  s_waitcnt lgkmcnt(8)
  v_mfma_f32_16x16x32_bf16 v[64:67], a[16:19], a[160:163], 0
  ds_read_b64_tr_b16 a[8:9], v1 offset:0
  ds_read_b64_tr_b16 a[10:11], v1 offset:1536
  v_mfma_f32_16x16x32_bf16 v[64:67], a[20:23], a[176:179], v[64:67]
  v_accvgpr_write_b32 a54, v10
  v_accvgpr_write_b32 a55, v11
  v_mfma_f32_16x16x32_bf16 v[68:71], a[16:19], a[164:167], 0
  buffer_load_dwordx4 a[140:143], v12, s[68:71], s85 offen sc1
  v_mfma_f32_16x16x32_bf16 v[68:71], a[20:23], a[180:183], v[68:71]
  s_add_u32 s85, s4, 5120
  v_cvt_pk_bf16_f32 v4, v80, v81
  v_cvt_pk_bf16_f32 v5, v82, v83
  v_mfma_f32_16x16x32_bf16 v[72:75], a[16:19], a[168:171], 0
  ds_read_b64_tr_b16 a[12:13], v1 offset:3072
  ds_read_b64_tr_b16 a[14:15], v1 offset:4608
  v_mfma_f32_16x16x32_bf16 v[72:75], a[20:23], a[184:187], v[72:75]
  v_cvt_pk_bf16_f32 v6, v84, v85
  v_cvt_pk_bf16_f32 v7, v86, v87
  v_mfma_f32_16x16x32_bf16 v[76:79], a[16:19], a[172:175], 0
  v_accvgpr_write_b32 a56, v4
  v_accvgpr_write_b32 a57, v5
  v_mfma_f32_16x16x32_bf16 v[76:79], a[20:23], a[188:191], v[76:79]
  buffer_load_dwordx4 a[144:147], v12, s[68:71], s85 offen sc1
  v_accvgpr_write_b32 a58, v6
  v_accvgpr_write_b32 a59, v7
  v_mfma_f32_16x16x32_bf16 v[80:83], a[24:27], a[160:163], 0
  s_add_u32 s85, s4, 70656
  ds_read_b64_tr_b16 a[16:17], v1 offset:6144
  ds_read_b64_tr_b16 a[18:19], v1 offset:7680
  v_mfma_f32_16x16x32_bf16 v[80:83], a[28:31], a[176:179], v[80:83]
  v_cvt_pk_bf16_f32 v8, v88, v89
  v_cvt_pk_bf16_f32 v9, v90, v91
  v_mfma_f32_16x16x32_bf16 v[84:87], a[24:27], a[164:167], 0
  v_cvt_pk_bf16_f32 v10, v92, v93
  v_cvt_pk_bf16_f32 v11, v94, v95
  v_mfma_f32_16x16x32_bf16 v[84:87], a[28:31], a[180:183], v[84:87]
  v_accvgpr_write_b32 a60, v8
  v_accvgpr_write_b32 a61, v9
  v_accvgpr_write_b32 a62, v10
  v_accvgpr_write_b32 a63, v11
  v_mfma_f32_16x16x32_bf16 v[88:91], a[24:27], a[168:171], 0
  ds_read_b64_tr_b16 a[20:21], v1 offset:9216
  ds_read_b64_tr_b16 a[22:23], v1 offset:10752
  v_mfma_f32_16x16x32_bf16 v[88:91], a[28:31], a[184:187], v[88:91]
  buffer_load_dwordx4 a[148:151], v12, s[68:71], s85 offen sc1
  v_mfma_f32_16x16x32_bf16 v[92:95], a[24:27], a[172:175], 0
  s_add_u32 s85, s5, 5120
  v_cvt_pk_bf16_f32 v4, v96, v97
  v_cvt_pk_bf16_f32 v5, v98, v99
  v_mfma_f32_16x16x32_bf16 v[92:95], a[28:31], a[188:191], v[92:95]
  s_waitcnt lgkmcnt(8)
  v_cvt_pk_bf16_f32 v6, v100, v101
  v_cvt_pk_bf16_f32 v7, v102, v103
  v_accvgpr_write_b32 a64, v4
  v_accvgpr_write_b32 a65, v5
  v_accvgpr_write_b32 a66, v6
  v_accvgpr_write_b32 a67, v7
  v_mfma_f32_16x16x32_bf16 v[96:99], a[32:35], a[160:163], 0
  ds_read_b64_tr_b16 a[24:25], v1 offset:32
  ds_read_b64_tr_b16 a[26:27], v1 offset:1568
  v_mfma_f32_16x16x32_bf16 v[96:99], a[36:39], a[176:179], v[96:99]
  v_cvt_pk_bf16_f32 v8, v104, v105
  v_cvt_pk_bf16_f32 v9, v106, v107
  v_mfma_f32_16x16x32_bf16 v[100:103], a[32:35], a[164:167], 0
  buffer_load_dwordx4 a[152:155], v12, s[68:71], s85 offen sc1
  v_mfma_f32_16x16x32_bf16 v[100:103], a[36:39], a[180:183], v[100:103]
  s_add_u32 s85, s5, 70656
  v_cvt_pk_bf16_f32 v10, v108, v109
  v_cvt_pk_bf16_f32 v11, v110, v111
  buffer_store_dwordx4 v[8:11], v24, s[68:71], s10 offen offset:1024 sc1
  v_mfma_f32_16x16x32_bf16 v[104:107], a[32:35], a[168:171], 0
  ds_read_b64_tr_b16 a[28:29], v1 offset:3104
  ds_read_b64_tr_b16 a[30:31], v1 offset:4640
  v_mfma_f32_16x16x32_bf16 v[104:107], a[36:39], a[184:187], v[104:107]
  v_cvt_pk_bf16_f32 v4, v112, v113
  v_cvt_pk_bf16_f32 v5, v114, v115
  v_mfma_f32_16x16x32_bf16 v[108:111], a[32:35], a[172:175], 0
  v_cvt_pk_bf16_f32 v6, v116, v117
  v_cvt_pk_bf16_f32 v7, v118, v119
  v_mfma_f32_16x16x32_bf16 v[108:111], a[36:39], a[188:191], v[108:111]
  buffer_load_dwordx4 a[156:159], v12, s[68:71], s85 offen sc1
  v_accvgpr_write_b32 a68, v4
  v_accvgpr_write_b32 a69, v5
  v_accvgpr_write_b32 a70, v6
  v_accvgpr_write_b32 a71, v7
  v_mfma_f32_16x16x32_bf16 v[112:115], a[0:3], a[160:163], 0
  s_add_u32 m0, s8, 131072
  ds_read_b64_tr_b16 a[32:33], v1 offset:6176
  ds_read_b64_tr_b16 a[34:35], v1 offset:7712
  v_mfma_f32_16x16x32_bf16 v[112:115], a[4:7], a[176:179], v[112:115]
  s_add_u32 s85, s7, 528384
  v_cvt_pk_bf16_f32 v8, v120, v121
  v_cvt_pk_bf16_f32 v9, v122, v123
  v_mfma_f32_16x16x32_bf16 v[116:119], a[0:3], a[164:167], 0
  v_cvt_pk_bf16_f32 v10, v124, v125
  v_cvt_pk_bf16_f32 v11, v126, v127
  v_mfma_f32_16x16x32_bf16 v[116:119], a[4:7], a[180:183], v[116:119]
  buffer_load_dwordx4 v26, s[56:59], s85 offen lds
  v_accvgpr_write_b32 a72, v8
  v_accvgpr_write_b32 a73, v9
  v_accvgpr_write_b32 a74, v10
  v_accvgpr_write_b32 a75, v11
  v_mfma_f32_16x16x32_bf16 v[120:123], a[0:3], a[168:171], 0
  s_add_u32 m0, s8, 132096
  ds_read_b64_tr_b16 a[36:37], v1 offset:9248
  ds_read_b64_tr_b16 a[38:39], v1 offset:10784
  v_mfma_f32_16x16x32_bf16 v[120:123], a[4:7], a[184:187], v[120:123]
  s_add_u32 s85, s7, 528384
  v_cvt_pk_bf16_f32 v4, v192, v193
  v_cvt_pk_bf16_f32 v5, v194, v195
  v_mfma_f32_16x16x32_bf16 v[124:127], a[0:3], a[172:175], 0
  v_cvt_pk_bf16_f32 v6, v196, v197
  v_cvt_pk_bf16_f32 v7, v198, v199
  v_mfma_f32_16x16x32_bf16 v[124:127], a[4:7], a[188:191], v[124:127]
  s_waitcnt vmcnt(19) lgkmcnt(8)
  v_accvgpr_write_b32 a76, v4
  v_accvgpr_write_b32 a77, v5
  v_mfma_f32_16x16x32_bf16 v[32:35], a[8:11], a[192:195], v[32:35]
  ds_read_b64_tr_b16 a[0:1], v1 offset:64
  ds_read_b64_tr_b16 a[2:3], v1 offset:1600
  v_mfma_f32_16x16x32_bf16 v[32:35], a[12:15], a[208:211], v[32:35]
  buffer_load_dwordx4 v27, s[56:59], s85 offen lds
  v_mfma_f32_16x16x32_bf16 v[36:39], a[8:11], a[196:199], v[36:39]
  s_add_u32 m0, s8, 133120
  s_add_u32 s85, s7, 528384
  v_accvgpr_write_b32 a78, v6
  v_mfma_f32_16x16x32_bf16 v[36:39], a[12:15], a[212:215], v[36:39]
  v_accvgpr_write_b32 a79, v7
  v_cvt_pk_bf16_f32 v8, v128, v129
  v_mfma_f32_16x16x32_bf16 v[40:43], a[8:11], a[200:203], v[40:43]
  ds_read_b64_tr_b16 a[4:5], v1 offset:3136
  ds_read_b64_tr_b16 a[6:7], v1 offset:4672
  v_mfma_f32_16x16x32_bf16 v[40:43], a[12:15], a[216:219], v[40:43]
  buffer_load_dwordx4 v28, s[56:59], s85 offen lds
  v_mfma_f32_16x16x32_bf16 v[44:47], a[8:11], a[204:207], v[44:47]
  v_cvt_pk_bf16_f32 v9, v130, v131
  v_cvt_pk_bf16_f32 v10, v132, v133
  v_mfma_f32_16x16x32_bf16 v[44:47], a[12:15], a[220:223], v[44:47]
  v_cvt_pk_bf16_f32 v11, v134, v135
  v_accvgpr_write_b32 a80, v8
  v_mfma_f32_16x16x32_bf16 v[48:51], a[16:19], a[192:195], v[48:51]
  ds_read_b64_tr_b16 a[8:9], v1 offset:6208
  ds_read_b64_tr_b16 a[10:11], v1 offset:7744
  v_mfma_f32_16x16x32_bf16 v[48:51], a[20:23], a[208:211], v[48:51]
  s_add_u32 m0, s89, 131072
  s_add_u32 s85, s87, 1048576
  v_accvgpr_write_b32 a81, v9
  v_mfma_f32_16x16x32_bf16 v[52:55], a[16:19], a[196:199], v[52:55]
  v_accvgpr_write_b32 a82, v10
  v_accvgpr_write_b32 a83, v11
  v_mfma_f32_16x16x32_bf16 v[52:55], a[20:23], a[212:215], v[52:55]
  buffer_load_dwordx4 v15, s[40:43], s85 offen lds
  v_mfma_f32_16x16x32_bf16 v[56:59], a[16:19], a[200:203], v[56:59]
  ds_read_b64_tr_b16 a[12:13], v1 offset:9280
  ds_read_b64_tr_b16 a[14:15], v1 offset:10816
  v_mfma_f32_16x16x32_bf16 v[56:59], a[20:23], a[216:219], v[56:59]
  v_cvt_pk_bf16_f32 v4, v200, v201
  v_cvt_pk_bf16_f32 v5, v202, v203
  v_mfma_f32_16x16x32_bf16 v[60:63], a[16:19], a[204:207], v[60:63]
  v_cvt_pk_bf16_f32 v6, v204, v205
  v_cvt_pk_bf16_f32 v7, v206, v207
  v_mfma_f32_16x16x32_bf16 v[60:63], a[20:23], a[220:223], v[60:63]
  buffer_store_dwordx4 v[4:7], v12, s[68:71], s13 offen offset:1024 sc1
  s_waitcnt lgkmcnt(8)
  v_mfma_f32_16x16x32_bf16 v[64:67], a[24:27], a[192:195], v[64:67]
  ds_read_b64_tr_b16 a[16:17], v20 offset:0
  ds_read_b64_tr_b16 a[18:19], v20 offset:2048
  v_mfma_f32_16x16x32_bf16 v[64:67], a[28:31], a[208:211], v[64:67]
  v_cvt_pk_bf16_f32 v8, v136, v137
  v_cvt_pk_bf16_f32 v9, v138, v139
  v_mfma_f32_16x16x32_bf16 v[68:71], a[24:27], a[196:199], v[68:71]
  v_cvt_pk_bf16_f32 v10, v140, v141
  v_cvt_pk_bf16_f32 v11, v142, v143
  v_mfma_f32_16x16x32_bf16 v[68:71], a[28:31], a[212:215], v[68:71]
  v_accvgpr_write_b32 a84, v8
  v_accvgpr_write_b32 a85, v9
  v_mfma_f32_16x16x32_bf16 v[72:75], a[24:27], a[200:203], v[72:75]
  ds_read_b64_tr_b16 a[20:21], v20 offset:4096
  ds_read_b64_tr_b16 a[22:23], v20 offset:6144
  v_mfma_f32_16x16x32_bf16 v[72:75], a[28:31], a[216:219], v[72:75]
  v_accvgpr_write_b32 a86, v10
  v_accvgpr_write_b32 a87, v11
  v_mfma_f32_16x16x32_bf16 v[76:79], a[24:27], a[204:207], v[76:79]
  v_cvt_pk_bf16_f32 v4, v208, v209
  v_cvt_pk_bf16_f32 v5, v210, v211
  v_mfma_f32_16x16x32_bf16 v[76:79], a[28:31], a[220:223], v[76:79]
  s_add_u32 m0, s89, 132096
  s_add_u32 s85, s87, 1179648
  v_cvt_pk_bf16_f32 v6, v212, v213
  v_mfma_f32_16x16x32_bf16 v[80:83], a[32:35], a[192:195], v[80:83]
  ds_read_b64_tr_b16 a[24:25], v21 offset:0
  ds_read_b64_tr_b16 a[26:27], v21 offset:2048
  v_mfma_f32_16x16x32_bf16 v[80:83], a[36:39], a[208:211], v[80:83]
  buffer_load_dwordx4 v15, s[40:43], s85 offen lds
  v_mfma_f32_16x16x32_bf16 v[84:87], a[32:35], a[196:199], v[84:87]
  v_cvt_pk_bf16_f32 v7, v214, v215
  v_accvgpr_write_b32 a88, v4
  v_mfma_f32_16x16x32_bf16 v[84:87], a[36:39], a[212:215], v[84:87]
  v_accvgpr_write_b32 a89, v5
  v_accvgpr_write_b32 a90, v6
  v_mfma_f32_16x16x32_bf16 v[88:91], a[32:35], a[200:203], v[88:91]
  ds_read_b64_tr_b16 a[28:29], v21 offset:4096
  ds_read_b64_tr_b16 a[30:31], v21 offset:6144
  v_mfma_f32_16x16x32_bf16 v[88:91], a[36:39], a[216:219], v[88:91]
  v_accvgpr_write_b32 a91, v7
  v_cvt_pk_bf16_f32 v8, v144, v145
  v_mfma_f32_16x16x32_bf16 v[92:95], a[32:35], a[204:207], v[92:95]
L_hop5:
  s_cbranch_execz L_hop9
  v_cvt_pk_bf16_f32 v9, v146, v147
  v_cvt_pk_bf16_f32 v10, v148, v149
  v_mfma_f32_16x16x32_bf16 v[92:95], a[36:39], a[220:223], v[92:95]
  s_waitcnt lgkmcnt(8)
  v_cvt_pk_bf16_f32 v11, v150, v151
  v_accvgpr_write_b32 a92, v8
  v_mfma_f32_16x16x32_bf16 v[96:99], a[0:3], a[192:195], v[96:99]
  ds_read_b64_tr_b16 a[32:33], v22 offset:0
  ds_read_b64_tr_b16 a[34:35], v22 offset:2048
  v_mfma_f32_16x16x32_bf16 v[96:99], a[4:7], a[208:211], v[96:99]
  v_accvgpr_write_b32 a93, v9
  v_accvgpr_write_b32 a94, v10
  v_mfma_f32_16x16x32_bf16 v[100:103], a[0:3], a[196:199], v[100:103]
  v_accvgpr_write_b32 a95, v11
  v_cvt_pk_bf16_f32 v4, v216, v217
  v_mfma_f32_16x16x32_bf16 v[100:103], a[4:7], a[212:215], v[100:103]
  v_cvt_pk_bf16_f32 v5, v218, v219
  v_cvt_pk_bf16_f32 v6, v220, v221
  v_mfma_f32_16x16x32_bf16 v[104:107], a[0:3], a[200:203], v[104:107]
  ds_read_b64_tr_b16 a[36:37], v22 offset:4096
  ds_read_b64_tr_b16 a[38:39], v22 offset:6144
  v_mfma_f32_16x16x32_bf16 v[104:107], a[4:7], a[216:219], v[104:107]
  s_add_u32 m0, s89, 133120
  s_add_u32 s85, s87, 1081344
  v_cvt_pk_bf16_f32 v7, v222, v223
  v_mfma_f32_16x16x32_bf16 v[108:111], a[0:3], a[204:207], v[108:111]
  buffer_store_dwordx4 v[4:7], v12, s[68:71], s14 offen offset:2048 sc1
  v_mfma_f32_16x16x32_bf16 v[108:111], a[4:7], a[220:223], v[108:111]
  buffer_load_dwordx4 v15, s[40:43], s85 offen lds
  v_mfma_f32_16x16x32_bf16 v[112:115], a[8:11], a[192:195], v[112:115]
  ds_read_b64_tr_b16 a[0:1], v23 offset:0
  ds_read_b64_tr_b16 a[2:3], v23 offset:2048
  v_mfma_f32_16x16x32_bf16 v[112:115], a[12:15], a[208:211], v[112:115]
  v_cvt_pk_bf16_f32 v8, v152, v153
  v_cvt_pk_bf16_f32 v9, v154, v155
  v_mfma_f32_16x16x32_bf16 v[116:119], a[8:11], a[196:199], v[116:119]
  v_cvt_pk_bf16_f32 v10, v156, v157
  v_cvt_pk_bf16_f32 v11, v158, v159
  v_mfma_f32_16x16x32_bf16 v[116:119], a[12:15], a[212:215], v[116:119]
  v_accvgpr_write_b32 a96, v8
  v_accvgpr_write_b32 a97, v9
  v_mfma_f32_16x16x32_bf16 v[120:123], a[8:11], a[200:203], v[120:123]
  ds_read_b64_tr_b16 a[4:5], v23 offset:4096
  ds_read_b64_tr_b16 a[6:7], v23 offset:6144
  v_mfma_f32_16x16x32_bf16 v[120:123], a[12:15], a[216:219], v[120:123]
  v_accvgpr_write_b32 a98, v10
  v_accvgpr_write_b32 a99, v11
  v_mfma_f32_16x16x32_bf16 v[124:127], a[8:11], a[204:207], v[124:127]
  v_cvt_pk_bf16_f32 v4, v224, v225
  v_cvt_pk_bf16_f32 v5, v226, v227
  v_mfma_f32_16x16x32_bf16 v[124:127], a[12:15], a[220:223], v[124:127]
  s_waitcnt lgkmcnt(8)
  v_cvt_pk_bf16_f32 v6, v228, v229
  v_cvt_pk_bf16_f32 v7, v230, v231
  v_mfma_f32_16x16x32_bf16 v[192:195], a[16:19], a[160:163], 0
  ds_read_b64_tr_b16 a[8:9], v20 offset:8192
  ds_read_b64_tr_b16 a[10:11], v20 offset:10240
  v_mfma_f32_16x16x32_bf16 v[192:195], a[20:23], a[176:179], v[192:195]
  v_accvgpr_write_b32 a100, v4
  v_accvgpr_write_b32 a101, v5
  v_mfma_f32_16x16x32_bf16 v[196:199], a[16:19], a[164:167], 0
  v_accvgpr_write_b32 a102, v6
  v_accvgpr_write_b32 a103, v7
  v_mfma_f32_16x16x32_bf16 v[196:199], a[20:23], a[180:183], v[196:199]
  s_add_u32 m0, s89, 134144
  s_add_u32 s85, s87, 1212416
  v_cvt_pk_bf16_f32 v8, v160, v161
  v_mfma_f32_16x16x32_bf16 v[128:131], a[16:19], a[168:171], 0
  ds_read_b64_tr_b16 a[12:13], v20 offset:12288
  ds_read_b64_tr_b16 a[14:15], v20 offset:14336
  v_mfma_f32_16x16x32_bf16 v[128:131], a[20:23], a[184:187], v[128:131]
  buffer_load_dwordx4 v15, s[40:43], s85 offen lds
  v_mfma_f32_16x16x32_bf16 v[132:135], a[16:19], a[172:175], 0
  v_cvt_pk_bf16_f32 v9, v162, v163
  v_cvt_pk_bf16_f32 v10, v164, v165
  v_mfma_f32_16x16x32_bf16 v[132:135], a[20:23], a[188:191], v[132:135]
  v_cvt_pk_bf16_f32 v11, v166, v167
  v_accvgpr_write_b32 a104, v8
  v_mfma_f32_16x16x32_bf16 v[200:203], a[24:27], a[160:163], 0
  ds_read_b64_tr_b16 a[16:17], v21 offset:8192
  ds_read_b64_tr_b16 a[18:19], v21 offset:10240
  v_mfma_f32_16x16x32_bf16 v[200:203], a[28:31], a[176:179], v[200:203]
  v_accvgpr_write_b32 a105, v9
  v_accvgpr_write_b32 a106, v10
  v_mfma_f32_16x16x32_bf16 v[204:207], a[24:27], a[164:167], 0
  v_accvgpr_write_b32 a107, v11
  v_cvt_pk_bf16_f32 v4, v232, v233
  v_mfma_f32_16x16x32_bf16 v[204:207], a[28:31], a[180:183], v[204:207]
  v_cvt_pk_bf16_f32 v5, v234, v235
  v_cvt_pk_bf16_f32 v6, v236, v237
  v_mfma_f32_16x16x32_bf16 v[136:139], a[24:27], a[168:171], 0
  ds_read_b64_tr_b16 a[20:21], v21 offset:12288
  ds_read_b64_tr_b16 a[22:23], v21 offset:14336
  v_mfma_f32_16x16x32_bf16 v[136:139], a[28:31], a[184:187], v[136:139]
  v_cvt_pk_bf16_f32 v7, v238, v239
  buffer_store_dwordx4 v[4:7], v12, s[68:71], s15 offen offset:2048 sc1
  v_mfma_f32_16x16x32_bf16 v[140:143], a[24:27], a[172:175], 0
  v_cvt_pk_bf16_f32 v8, v168, v169
  v_cvt_pk_bf16_f32 v9, v170, v171
  v_mfma_f32_16x16x32_bf16 v[140:143], a[28:31], a[188:191], v[140:143]
  s_waitcnt lgkmcnt(8)
  v_cvt_pk_bf16_f32 v10, v172, v173
  v_cvt_pk_bf16_f32 v11, v174, v175
  v_mfma_f32_16x16x32_bf16 v[208:211], a[32:35], a[160:163], 0
  ds_read_b64_tr_b16 a[24:25], v22 offset:8192
  ds_read_b64_tr_b16 a[26:27], v22 offset:10240
  v_mfma_f32_16x16x32_bf16 v[208:211], a[36:39], a[176:179], v[208:211]
  v_accvgpr_write_b32 a108, v8
  v_accvgpr_write_b32 a109, v9
  v_mfma_f32_16x16x32_bf16 v[212:215], a[32:35], a[164:167], 0
  v_accvgpr_write_b32 a110, v10
  v_accvgpr_write_b32 a111, v11
  v_mfma_f32_16x16x32_bf16 v[212:215], a[36:39], a[180:183], v[212:215]
  v_cvt_pk_bf16_f32 v4, v240, v241
  v_cvt_pk_bf16_f32 v5, v242, v243
  v_mfma_f32_16x16x32_bf16 v[144:147], a[32:35], a[168:171], 0
  ds_read_b64_tr_b16 a[28:29], v22 offset:12288
  ds_read_b64_tr_b16 a[30:31], v22 offset:14336
  v_mfma_f32_16x16x32_bf16 v[144:147], a[36:39], a[184:187], v[144:147]
  v_cvt_pk_bf16_f32 v6, v244, v245
  v_cvt_pk_bf16_f32 v7, v246, v247
  v_mfma_f32_16x16x32_bf16 v[148:151], a[32:35], a[172:175], 0
  v_accvgpr_write_b32 a112, v4
  v_accvgpr_write_b32 a113, v5
  v_mfma_f32_16x16x32_bf16 v[148:151], a[36:39], a[188:191], v[148:151]
  v_accvgpr_write_b32 a114, v6
  v_accvgpr_write_b32 a115, v7
  v_mfma_f32_16x16x32_bf16 v[216:219], a[0:3], a[160:163], 0
  ds_read_b64_tr_b16 a[32:33], v23 offset:8192
  ds_read_b64_tr_b16 a[34:35], v23 offset:10240
  v_mfma_f32_16x16x32_bf16 v[216:219], a[4:7], a[176:179], v[216:219]
  v_cvt_pk_bf16_f32 v8, v176, v177
  v_cvt_pk_bf16_f32 v9, v178, v179
  v_mfma_f32_16x16x32_bf16 v[220:223], a[0:3], a[164:167], 0
  v_cvt_pk_bf16_f32 v10, v180, v181
  v_cvt_pk_bf16_f32 v11, v182, v183
  v_mfma_f32_16x16x32_bf16 v[220:223], a[4:7], a[180:183], v[220:223]
  v_accvgpr_write_b32 a116, v8
  v_accvgpr_write_b32 a117, v9
  v_mfma_f32_16x16x32_bf16 v[152:155], a[0:3], a[168:171], 0
  ds_read_b64_tr_b16 a[36:37], v23 offset:12288
  ds_read_b64_tr_b16 a[38:39], v23 offset:14336
  v_mfma_f32_16x16x32_bf16 v[152:155], a[4:7], a[184:187], v[152:155]
  v_accvgpr_write_b32 a118, v10
  v_accvgpr_write_b32 a119, v11
  v_mfma_f32_16x16x32_bf16 v[156:159], a[0:3], a[172:175], 0
  v_cvt_pk_bf16_f32 v4, v248, v249
  v_cvt_pk_bf16_f32 v5, v250, v251
  v_mfma_f32_16x16x32_bf16 v[156:159], a[4:7], a[188:191], v[156:159]
  s_waitcnt vmcnt(21)
  v_add_u32 v1, 98304, v1
  s_barrier
  s_waitcnt lgkmcnt(8)
  v_mfma_f32_16x16x32_bf16 v[224:227], a[8:11], a[160:163], 0
  s_add_u32 m0, s8, 65536
  ds_read_b64_tr_b16 a[0:1], v1 offset:0
  ds_read_b64_tr_b16 a[2:3], v1 offset:1536
  v_mfma_f32_16x16x32_bf16 v[224:227], a[12:15], a[176:179], v[224:227]
  s_add_u32 s85, s7, 704512
  v_add_u32 v20, 98304, v20
  v_cvt_pk_bf16_f32 v6, v252, v253
  v_mfma_f32_16x16x32_bf16 v[228:231], a[8:11], a[164:167], 0
  buffer_load_dwordx4 v26, s[56:59], s85 offen lds
  v_mfma_f32_16x16x32_bf16 v[228:231], a[12:15], a[180:183], v[228:231]
  v_add_u32 v21, 98304, v21
  v_cvt_pk_bf16_f32 v7, v254, v255
  v_mfma_f32_16x16x32_bf16 v[160:163], a[8:11], a[168:171], 0
  ds_read_b64_tr_b16 a[4:5], v1 offset:3072
  ds_read_b64_tr_b16 a[6:7], v1 offset:4608
  v_mfma_f32_16x16x32_bf16 v[160:163], a[12:15], a[184:187], v[160:163]
  v_add_u32 v22, 98304, v22
  v_accvgpr_write_b32 a120, v4
  v_mfma_f32_16x16x32_bf16 v[164:167], a[8:11], a[172:175], 0
  v_accvgpr_write_b32 a121, v5
  v_accvgpr_write_b32 a122, v6
  v_mfma_f32_16x16x32_bf16 v[164:167], a[12:15], a[188:191], v[164:167]
  v_add_u32 v23, 98304, v23
  v_accvgpr_write_b32 a123, v7
  v_mfma_f32_16x16x32_bf16 v[232:235], a[16:19], a[160:163], 0
  ds_read_b64_tr_b16 a[8:9], v1 offset:6144
  ds_read_b64_tr_b16 a[10:11], v1 offset:7680
  v_mfma_f32_16x16x32_bf16 v[232:235], a[20:23], a[176:179], v[232:235]
  v_cvt_pk_bf16_f32 v8, v184, v185
  v_cvt_pk_bf16_f32 v9, v186, v187
  v_mfma_f32_16x16x32_bf16 v[236:239], a[16:19], a[164:167], 0
  v_cvt_pk_bf16_f32 v10, v188, v189
  v_cvt_pk_bf16_f32 v11, v190, v191
  v_mfma_f32_16x16x32_bf16 v[236:239], a[20:23], a[180:183], v[236:239]
  v_accvgpr_write_b32 a124, v8
  v_accvgpr_write_b32 a125, v9
  v_mfma_f32_16x16x32_bf16 v[168:171], a[16:19], a[168:171], 0
  ds_read_b64_tr_b16 a[12:13], v1 offset:9216
  ds_read_b64_tr_b16 a[14:15], v1 offset:10752
  v_mfma_f32_16x16x32_bf16 v[168:171], a[20:23], a[184:187], v[168:171]
  s_add_u32 m0, s8, 66560
  s_add_u32 s85, s7, 704512
  v_accvgpr_write_b32 a126, v10
  v_mfma_f32_16x16x32_bf16 v[172:175], a[16:19], a[172:175], 0
  v_accvgpr_write_b32 a127, v11
  v_mfma_f32_16x16x32_bf16 v[172:175], a[20:23], a[188:191], v[172:175]
  s_waitcnt lgkmcnt(8)
  v_mfma_f32_16x16x32_bf16 v[240:243], a[24:27], a[160:163], 0
  ds_read_b64_tr_b16 a[16:17], v1 offset:32
  ds_read_b64_tr_b16 a[18:19], v1 offset:1568
  v_mfma_f32_16x16x32_bf16 v[240:243], a[28:31], a[176:179], v[240:243]
  buffer_load_dwordx4 v27, s[56:59], s85 offen lds
  v_mfma_f32_16x16x32_bf16 v[244:247], a[24:27], a[164:167], 0
  v_mfma_f32_16x16x32_bf16 v[244:247], a[28:31], a[180:183], v[244:247]
  v_mfma_f32_16x16x32_bf16 v[176:179], a[24:27], a[168:171], 0
  ds_read_b64_tr_b16 a[20:21], v1 offset:3104
  ds_read_b64_tr_b16 a[22:23], v1 offset:4640
  v_mfma_f32_16x16x32_bf16 v[176:179], a[28:31], a[184:187], v[176:179]
  buffer_store_dwordx4 a[40:43], v24, s[68:71], s10 offen offset:0 sc1
  v_mfma_f32_16x16x32_bf16 v[180:183], a[24:27], a[172:175], 0
  v_mfma_f32_16x16x32_bf16 v[180:183], a[28:31], a[188:191], v[180:183]
  v_mfma_f32_16x16x32_bf16 v[248:251], a[32:35], a[160:163], 0
  ds_read_b64_tr_b16 a[24:25], v1 offset:6176
  ds_read_b64_tr_b16 a[26:27], v1 offset:7712
  v_mfma_f32_16x16x32_bf16 v[248:251], a[36:39], a[176:179], v[248:251]
  v_mfma_f32_16x16x32_bf16 v[252:255], a[32:35], a[164:167], 0
  v_mfma_f32_16x16x32_bf16 v[252:255], a[36:39], a[180:183], v[252:255]
  s_add_u32 m0, s8, 67584
  s_add_u32 s85, s7, 704512
  v_mfma_f32_16x16x32_bf16 v[184:187], a[32:35], a[168:171], 0
  ds_read_b64_tr_b16 a[28:29], v1 offset:9248
  ds_read_b64_tr_b16 a[30:31], v1 offset:10784
  v_mfma_f32_16x16x32_bf16 v[184:187], a[36:39], a[184:187], v[184:187]
  buffer_load_dwordx4 v28, s[56:59], s85 offen lds
  v_mfma_f32_16x16x32_bf16 v[188:191], a[32:35], a[172:175], 0
  v_mfma_f32_16x16x32_bf16 v[188:191], a[36:39], a[188:191], v[188:191]
  s_add_u32 s85, s4, 6144
  s_waitcnt vmcnt(14) lgkmcnt(8)
  v_mfma_f32_16x16x32_bf16 v[32:35], a[0:3], a[128:131], v[32:35]
  s_lshl_b32 s80, s77, 7
  ds_read_b64_tr_b16 a[32:33], v1 offset:64
  ds_read_b64_tr_b16 a[34:35], v1 offset:1600
  v_mfma_f32_16x16x32_bf16 v[32:35], a[4:7], a[144:147], v[32:35]
  buffer_load_dwordx4 a[160:163], v12, s[68:71], s85 offen sc1
  v_mfma_f32_16x16x32_bf16 v[36:39], a[0:3], a[132:135], v[36:39]
  s_add_u32 s82, s80, 67108864
  s_lshl_b32 s80, s78, 2
  s_add_u32 s47, s80, s82
  v_mfma_f32_16x16x32_bf16 v[36:39], a[4:7], a[148:151], v[36:39]
  s_and_b32 s82, s82, 0xfffffe00
  v_bfe_u32 v19, v0, 3, 1
  v_mul_u32_u24 v19, 0, v19
  v_mfma_f32_16x16x32_bf16 v[40:43], a[0:3], a[136:139], v[40:43]
  s_sub_u32 s80, s77, 0
  ds_read_b64_tr_b16 a[36:37], v1 offset:3136
  ds_read_b64_tr_b16 a[38:39], v1 offset:4672
  v_mfma_f32_16x16x32_bf16 v[40:43], a[4:7], a[152:155], v[40:43]
  s_add_u32 s85, s4, 71680
  v_sub_u32 v19, s80, v19
  v_and_b32 v19, 3, v19
  v_mfma_f32_16x16x32_bf16 v[44:47], a[0:3], a[140:143], v[44:47]
  v_and_b32 v18, 7, v0
  v_lshlrev_b32 v18, 2, v18
  v_mfma_f32_16x16x32_bf16 v[44:47], a[4:7], a[156:159], v[44:47]
  buffer_load_dwordx4 a[164:167], v12, s[68:71], s85 offen sc1
  v_mfma_f32_16x16x32_bf16 v[48:51], a[8:11], a[128:131], v[48:51]
  ds_read_b64_tr_b16 a[0:1], v1 offset:6208
  ds_read_b64_tr_b16 a[2:3], v1 offset:7744
  v_mfma_f32_16x16x32_bf16 v[48:51], a[12:15], a[144:147], v[48:51]
  s_add_u32 m0, s89, 65536
  s_add_u32 s85, s87, 1572864
  v_lshl_add_u32 v18, v19, 7, v18
  v_mfma_f32_16x16x32_bf16 v[52:55], a[8:11], a[132:135], v[52:55]
  s_lshl_b32 s38, s77, 20
  v_min_u32 v19, 10, v0
  v_lshlrev_b32 v19, 7, v19
  v_mfma_f32_16x16x32_bf16 v[52:55], a[12:15], a[148:151], v[52:55]
  buffer_load_dwordx4 v15, s[40:43], s85 offen lds
  v_mfma_f32_16x16x32_bf16 v[56:59], a[8:11], a[136:139], v[56:59]
  s_lshl_b32 s80, s76, 12
  ds_read_b64_tr_b16 a[4:5], v1 offset:9280
  ds_read_b64_tr_b16 a[6:7], v1 offset:10816
  v_mfma_f32_16x16x32_bf16 v[56:59], a[12:15], a[152:155], v[56:59]
  s_add_u32 s38, s38, s80
  s_add_u32 s38, s38, 33554432
  s_add_u32 s81, s78, 1
  v_mfma_f32_16x16x32_bf16 v[60:63], a[8:11], a[140:143], v[60:63]
  s_and_b32 s81, s81, 1
  s_lshl_b32 s81, s81, 16
  s_add_u32 s49, s80, s81
  v_mfma_f32_16x16x32_bf16 v[60:63], a[12:15], a[156:159], v[60:63]
  s_add_u32 s39, s38, 32768
  s_add_u32 s48, s38, 16384
  s_waitcnt lgkmcnt(8)
  v_mfma_f32_16x16x32_bf16 v[64:67], a[16:19], a[128:131], v[64:67]
  s_sub_u32 s80, 15, s78
  ds_read_b64_tr_b16 a[8:9], v20 offset:0
  ds_read_b64_tr_b16 a[10:11], v20 offset:2048
  v_mfma_f32_16x16x32_bf16 v[64:67], a[20:23], a[144:147], v[64:67]
  buffer_store_dwordx4 a[44:47], v12, s[68:71], s11 offen offset:0 sc1
  v_mfma_f32_16x16x32_bf16 v[68:71], a[16:19], a[132:135], v[68:71]
  s_add_u32 s85, s5, 6144
  s_lshl_b32 s80, s80, 3
  s_mov_b32 s81, s76
  v_mfma_f32_16x16x32_bf16 v[68:71], a[20:23], a[148:151], v[68:71]
  s_add_u32 s80, s80, s81
  s_mul_i32 s36, s80, 176128
  s_add_u32 s36, s36, 2097152
  v_mfma_f32_16x16x32_bf16 v[72:75], a[16:19], a[136:139], v[72:75]
  s_lshl_b32 s80, s78, 3
  ds_read_b64_tr_b16 a[12:13], v20 offset:4096
  ds_read_b64_tr_b16 a[14:15], v20 offset:6144
  v_mfma_f32_16x16x32_bf16 v[72:75], a[20:23], a[152:155], v[72:75]
  buffer_load_dwordx4 a[168:171], v12, s[68:71], s85 offen sc1
  v_mfma_f32_16x16x32_bf16 v[76:79], a[16:19], a[140:143], v[76:79]
  s_add_u32 s85, s5, 71680
  s_add_u32 s80, s80, s81
  s_mul_i32 s37, s80, 176128
  v_mfma_f32_16x16x32_bf16 v[76:79], a[20:23], a[156:159], v[76:79]
  s_add_u32 s37, s37, 2097152
  s_mov_b32 s83, 0xbfb8aa3b
  s_mov_b32 s84, 0x3e0293ee
  v_mfma_f32_16x16x32_bf16 v[80:83], a[24:27], a[128:131], v[80:83]
  ds_read_b64_tr_b16 a[16:17], v21 offset:0
  ds_read_b64_tr_b16 a[18:19], v21 offset:2048
  v_mfma_f32_16x16x32_bf16 v[80:83], a[28:31], a[144:147], v[80:83]
  buffer_load_dwordx4 a[172:175], v12, s[68:71], s85 offen sc1
  v_mfma_f32_16x16x32_bf16 v[84:87], a[24:27], a[132:135], v[84:87]
  s_add_u32 s85, s4, 7168
  v_and_b32 v2, 31, v0
  v_lshrrev_b32 v3, 5, v0
  v_mfma_f32_16x16x32_bf16 v[84:87], a[28:31], a[148:151], v[84:87]
  s_lshl_b32 s46, s28, 9
  v_mul_u32_u24 v3, 704512, v3
  v_lshl_add_u32 v14, v2, 4, v3
  v_mfma_f32_16x16x32_bf16 v[88:91], a[24:27], a[136:139], v[88:91]
  s_add_u32 s46, s46, 131075
  ds_read_b64_tr_b16 a[20:21], v21 offset:4096
  ds_read_b64_tr_b16 a[22:23], v21 offset:6144
  v_mfma_f32_16x16x32_bf16 v[88:91], a[28:31], a[152:155], v[88:91]
  buffer_load_dwordx4 a[176:179], v12, s[68:71], s85 offen sc1
  v_mfma_f32_16x16x32_bf16 v[92:95], a[24:27], a[140:143], v[92:95]
  s_add_u32 s85, s4, 72704
  s_sub_u32 s46, s46, s29
  s_mov_b32 s44, 0x49800000
  v_mfma_f32_16x16x32_bf16 v[92:95], a[28:31], a[156:159], v[92:95]
  s_sub_u32 s45, s78, 2
  s_sub_u32 s50, s78, 1
  s_waitcnt lgkmcnt(8)
  v_mfma_f32_16x16x32_bf16 v[96:99], a[32:35], a[128:131], v[96:99]
  s_bfe_i64 s[96:97], s[50:51], 0x1001f
  ds_read_b64_tr_b16 a[24:25], v22 offset:0
  ds_read_b64_tr_b16 a[26:27], v22 offset:2048
  v_mfma_f32_16x16x32_bf16 v[96:99], a[36:39], a[144:147], v[96:99]
  buffer_load_dwordx4 a[180:183], v12, s[68:71], s85 offen sc1
  v_mfma_f32_16x16x32_bf16 v[100:103], a[32:35], a[132:135], v[100:103]
  s_xor_b32 s80, s79, 0x80
  s_lshl_b32 s80, s80, 2
  s_add_u32 s80, s80, s76
  v_mfma_f32_16x16x32_bf16 v[100:103], a[36:39], a[148:151], v[100:103]
  s_add_u32 s85, s5, 7168
  s_mul_i32 s91, s80, 2816
  s_lshl_b32 s90, s80, 13
  v_mfma_f32_16x16x32_bf16 v[104:107], a[32:35], a[136:139], v[104:107]
  s_sub_u32 s91, s91, 512
  ds_read_b64_tr_b16 a[28:29], v22 offset:4096
  ds_read_b64_tr_b16 a[30:31], v22 offset:6144
  v_mfma_f32_16x16x32_bf16 v[104:107], a[36:39], a[152:155], v[104:107]
  buffer_load_dwordx4 a[184:187], v12, s[68:71], s85 offen sc1
  v_mfma_f32_16x16x32_bf16 v[108:111], a[32:35], a[140:143], v[108:111]
  s_sub_u32 s90, s90, 1408
  v_mfma_f32_16x16x32_bf16 v[108:111], a[36:39], a[156:159], v[108:111]
  v_mfma_f32_16x16x32_bf16 v[112:115], a[0:3], a[128:131], v[112:115]
  ds_read_b64_tr_b16 a[32:33], v23 offset:0
  ds_read_b64_tr_b16 a[34:35], v23 offset:2048
  v_mfma_f32_16x16x32_bf16 v[112:115], a[4:7], a[144:147], v[112:115]
  buffer_store_dwordx4 a[48:51], v24, s[68:71], s11 offen offset:0 sc1
  v_mfma_f32_16x16x32_bf16 v[116:119], a[0:3], a[132:135], v[116:119]
  s_add_u32 s85, s5, 72704
  v_mfma_f32_16x16x32_bf16 v[116:119], a[4:7], a[148:151], v[116:119]
  v_mfma_f32_16x16x32_bf16 v[120:123], a[0:3], a[136:139], v[120:123]
  ds_read_b64_tr_b16 a[36:37], v23 offset:4096
  ds_read_b64_tr_b16 a[38:39], v23 offset:6144
  v_mfma_f32_16x16x32_bf16 v[120:123], a[4:7], a[152:155], v[120:123]
  buffer_load_dwordx4 a[188:191], v12, s[68:71], s85 offen sc1
  v_mfma_f32_16x16x32_bf16 v[124:127], a[0:3], a[140:143], v[124:127]
  s_add_u32 m0, s89, 66560
  s_add_u32 s85, s87, 1703936
  v_mfma_f32_16x16x32_bf16 v[124:127], a[4:7], a[156:159], v[124:127]
  s_waitcnt lgkmcnt(8)
  v_mfma_f32_16x16x32_bf16 v[192:195], a[8:11], a[192:195], v[192:195]
  ds_read_b64_tr_b16 a[0:1], v20 offset:8192
  ds_read_b64_tr_b16 a[2:3], v20 offset:10240
  v_mfma_f32_16x16x32_bf16 v[192:195], a[12:15], a[208:211], v[192:195]
  buffer_load_dwordx4 v15, s[40:43], s85 offen lds
  v_mfma_f32_16x16x32_bf16 v[196:199], a[8:11], a[196:199], v[196:199]
  s_add_u32 m0, s89, 67584
  s_add_u32 s85, s87, 1605632
  v_mfma_f32_16x16x32_bf16 v[196:199], a[12:15], a[212:215], v[196:199]
  v_mfma_f32_16x16x32_bf16 v[128:131], a[8:11], a[200:203], v[128:131]
  ds_read_b64_tr_b16 a[4:5], v20 offset:12288
  ds_read_b64_tr_b16 a[6:7], v20 offset:14336
  v_mfma_f32_16x16x32_bf16 v[128:131], a[12:15], a[216:219], v[128:131]
  buffer_load_dwordx4 v15, s[40:43], s85 offen lds
  v_mfma_f32_16x16x32_bf16 v[132:135], a[8:11], a[204:207], v[132:135]
  s_add_u32 m0, s89, 68608
  s_add_u32 s85, s87, 1736704
  v_mfma_f32_16x16x32_bf16 v[132:135], a[12:15], a[220:223], v[132:135]
  v_mfma_f32_16x16x32_bf16 v[200:203], a[16:19], a[192:195], v[200:203]
  ds_read_b64_tr_b16 a[8:9], v21 offset:8192
  ds_read_b64_tr_b16 a[10:11], v21 offset:10240
  v_mfma_f32_16x16x32_bf16 v[200:203], a[20:23], a[208:211], v[200:203]
  buffer_load_dwordx4 v15, s[40:43], s85 offen lds
  v_mfma_f32_16x16x32_bf16 v[204:207], a[16:19], a[196:199], v[204:207]
  v_mfma_f32_16x16x32_bf16 v[204:207], a[20:23], a[212:215], v[204:207]
  v_mfma_f32_16x16x32_bf16 v[136:139], a[16:19], a[200:203], v[136:139]
  ds_read_b64_tr_b16 a[12:13], v21 offset:12288
  ds_read_b64_tr_b16 a[14:15], v21 offset:14336
  v_mfma_f32_16x16x32_bf16 v[136:139], a[20:23], a[216:219], v[136:139]
  v_mfma_f32_16x16x32_bf16 v[140:143], a[16:19], a[204:207], v[140:143]
  v_mfma_f32_16x16x32_bf16 v[140:143], a[20:23], a[220:223], v[140:143]
  s_waitcnt lgkmcnt(8)
  v_mfma_f32_16x16x32_bf16 v[208:211], a[24:27], a[192:195], v[208:211]
  ds_read_b64_tr_b16 a[16:17], v22 offset:8192
  ds_read_b64_tr_b16 a[18:19], v22 offset:10240
  v_mfma_f32_16x16x32_bf16 v[208:211], a[28:31], a[208:211], v[208:211]
  v_mfma_f32_16x16x32_bf16 v[212:215], a[24:27], a[196:199], v[212:215]
  v_mfma_f32_16x16x32_bf16 v[212:215], a[28:31], a[212:215], v[212:215]
  v_mfma_f32_16x16x32_bf16 v[144:147], a[24:27], a[200:203], v[144:147]
  ds_read_b64_tr_b16 a[20:21], v22 offset:12288
  ds_read_b64_tr_b16 a[22:23], v22 offset:14336
  v_mfma_f32_16x16x32_bf16 v[144:147], a[28:31], a[216:219], v[144:147]
  buffer_store_dwordx4 a[64:67], v12, s[68:71], s10 offen offset:1024 sc1
  v_mfma_f32_16x16x32_bf16 v[148:151], a[24:27], a[204:207], v[148:151]
  v_mfma_f32_16x16x32_bf16 v[148:151], a[28:31], a[220:223], v[148:151]
  v_mfma_f32_16x16x32_bf16 v[216:219], a[32:35], a[192:195], v[216:219]
  ds_read_b64_tr_b16 a[24:25], v23 offset:8192
  ds_read_b64_tr_b16 a[26:27], v23 offset:10240
  v_mfma_f32_16x16x32_bf16 v[216:219], a[36:39], a[208:211], v[216:219]
  v_mfma_f32_16x16x32_bf16 v[220:223], a[32:35], a[196:199], v[220:223]
  v_mfma_f32_16x16x32_bf16 v[220:223], a[36:39], a[212:215], v[220:223]
  v_mfma_f32_16x16x32_bf16 v[152:155], a[32:35], a[200:203], v[152:155]
  ds_read_b64_tr_b16 a[28:29], v23 offset:12288
  ds_read_b64_tr_b16 a[30:31], v23 offset:14336
  v_mfma_f32_16x16x32_bf16 v[152:155], a[36:39], a[216:219], v[152:155]
  v_mfma_f32_16x16x32_bf16 v[156:159], a[32:35], a[204:207], v[156:159]
  v_mfma_f32_16x16x32_bf16 v[156:159], a[36:39], a[220:223], v[156:159]
  s_waitcnt vmcnt(20)
  v_add_u32 v1, 32768, v1
  s_barrier
  s_waitcnt lgkmcnt(8)
  v_mfma_f32_16x16x32_bf16 v[224:227], a[0:3], a[192:195], v[224:227]
  s_add_u32 m0, s8, 32768
  ds_read_b64_tr_b16 a[32:33], v1 offset:0
  ds_read_b64_tr_b16 a[34:35], v1 offset:1536
  v_mfma_f32_16x16x32_bf16 v[224:227], a[4:7], a[208:211], v[224:227]
  s_add_u32 s85, s7, 880640
  v_add_u32 v20, 32768, v20
  v_mfma_f32_16x16x32_bf16 v[228:231], a[0:3], a[196:199], v[228:231]
  buffer_load_dwordx4 v26, s[56:59], s85 offen lds
  v_mfma_f32_16x16x32_bf16 v[228:231], a[4:7], a[212:215], v[228:231]
  v_add_u32 v21, 32768, v21
  v_mfma_f32_16x16x32_bf16 v[160:163], a[0:3], a[200:203], v[160:163]
  ds_read_b64_tr_b16 a[36:37], v1 offset:3072
  ds_read_b64_tr_b16 a[38:39], v1 offset:4608
  v_mfma_f32_16x16x32_bf16 v[160:163], a[4:7], a[216:219], v[160:163]
  v_add_u32 v22, 32768, v22
  v_mfma_f32_16x16x32_bf16 v[164:167], a[0:3], a[204:207], v[164:167]
  v_mfma_f32_16x16x32_bf16 v[164:167], a[4:7], a[220:223], v[164:167]
  v_add_u32 v23, 32768, v23
  v_mfma_f32_16x16x32_bf16 v[232:235], a[8:11], a[192:195], v[232:235]
  ds_read_b64_tr_b16 a[0:1], v1 offset:6144
  ds_read_b64_tr_b16 a[2:3], v1 offset:7680
  v_mfma_f32_16x16x32_bf16 v[232:235], a[12:15], a[208:211], v[232:235]
  v_mfma_f32_16x16x32_bf16 v[236:239], a[8:11], a[196:199], v[236:239]
  v_mfma_f32_16x16x32_bf16 v[236:239], a[12:15], a[212:215], v[236:239]
  v_mfma_f32_16x16x32_bf16 v[168:171], a[8:11], a[200:203], v[168:171]
  ds_read_b64_tr_b16 a[4:5], v1 offset:9216
  ds_read_b64_tr_b16 a[6:7], v1 offset:10752
  v_mfma_f32_16x16x32_bf16 v[168:171], a[12:15], a[216:219], v[168:171]
  s_add_u32 m0, s8, 33792
  s_add_u32 s85, s7, 880640
  v_mfma_f32_16x16x32_bf16 v[172:175], a[8:11], a[204:207], v[172:175]
  v_mfma_f32_16x16x32_bf16 v[172:175], a[12:15], a[220:223], v[172:175]
  s_waitcnt lgkmcnt(8)
  v_mfma_f32_16x16x32_bf16 v[240:243], a[16:19], a[192:195], v[240:243]
  ds_read_b64_tr_b16 a[8:9], v1 offset:32
  ds_read_b64_tr_b16 a[10:11], v1 offset:1568
  v_mfma_f32_16x16x32_bf16 v[240:243], a[20:23], a[208:211], v[240:243]
  buffer_load_dwordx4 v27, s[56:59], s85 offen lds
  v_mfma_f32_16x16x32_bf16 v[244:247], a[16:19], a[196:199], v[244:247]
  v_mfma_f32_16x16x32_bf16 v[244:247], a[20:23], a[212:215], v[244:247]
  v_mfma_f32_16x16x32_bf16 v[176:179], a[16:19], a[200:203], v[176:179]
  ds_read_b64_tr_b16 a[12:13], v1 offset:3104
  ds_read_b64_tr_b16 a[14:15], v1 offset:4640
  v_mfma_f32_16x16x32_bf16 v[176:179], a[20:23], a[216:219], v[176:179]
  buffer_store_dwordx4 a[68:71], v12, s[68:71], s11 offen offset:1024 sc1
  v_mfma_f32_16x16x32_bf16 v[180:183], a[16:19], a[204:207], v[180:183]
  v_mfma_f32_16x16x32_bf16 v[180:183], a[20:23], a[220:223], v[180:183]
  v_mfma_f32_16x16x32_bf16 v[248:251], a[24:27], a[192:195], v[248:251]
  ds_read_b64_tr_b16 a[16:17], v1 offset:6176
  ds_read_b64_tr_b16 a[18:19], v1 offset:7712
  v_mfma_f32_16x16x32_bf16 v[248:251], a[28:31], a[208:211], v[248:251]
  v_mfma_f32_16x16x32_bf16 v[252:255], a[24:27], a[196:199], v[252:255]
  v_mfma_f32_16x16x32_bf16 v[252:255], a[28:31], a[212:215], v[252:255]
  s_add_u32 m0, s8, 34816
  s_add_u32 s85, s7, 880640
  v_mfma_f32_16x16x32_bf16 v[184:187], a[24:27], a[200:203], v[184:187]
  ds_read_b64_tr_b16 a[20:21], v1 offset:9248
  ds_read_b64_tr_b16 a[22:23], v1 offset:10784
  v_mfma_f32_16x16x32_bf16 v[184:187], a[28:31], a[216:219], v[184:187]
  buffer_load_dwordx4 v28, s[56:59], s85 offen lds
  v_mfma_f32_16x16x32_bf16 v[188:191], a[24:27], a[204:207], v[188:191]
  v_mfma_f32_16x16x32_bf16 v[188:191], a[28:31], a[220:223], v[188:191]
  s_add_u32 s85, s4, 8192
  s_waitcnt vmcnt(8) lgkmcnt(8)
  v_mfma_f32_16x16x32_bf16 v[32:35], a[32:35], a[160:163], v[32:35]
  ds_read_b64_tr_b16 a[24:25], v1 offset:64
  ds_read_b64_tr_b16 a[26:27], v1 offset:1600
  v_mfma_f32_16x16x32_bf16 v[32:35], a[36:39], a[176:179], v[32:35]
  buffer_load_dwordx4 a[192:195], v12, s[68:71], s85 offen sc1
  v_mfma_f32_16x16x32_bf16 v[36:39], a[32:35], a[164:167], v[36:39]
  v_mfma_f32_16x16x32_bf16 v[36:39], a[36:39], a[180:183], v[36:39]
  v_mfma_f32_16x16x32_bf16 v[40:43], a[32:35], a[168:171], v[40:43]
  ds_read_b64_tr_b16 a[28:29], v1 offset:3136
  ds_read_b64_tr_b16 a[30:31], v1 offset:4672
  v_mfma_f32_16x16x32_bf16 v[40:43], a[36:39], a[184:187], v[40:43]
  s_add_u32 s85, s4, 73728
  v_mfma_f32_16x16x32_bf16 v[44:47], a[32:35], a[172:175], v[44:47]
  v_mfma_f32_16x16x32_bf16 v[44:47], a[36:39], a[188:191], v[44:47]
  buffer_load_dwordx4 a[196:199], v12, s[68:71], s85 offen sc1
  v_mfma_f32_16x16x32_bf16 v[48:51], a[0:3], a[160:163], v[48:51]
  ds_read_b64_tr_b16 a[32:33], v1 offset:6208
  ds_read_b64_tr_b16 a[34:35], v1 offset:7744
  v_mfma_f32_16x16x32_bf16 v[48:51], a[4:7], a[176:179], v[48:51]
  s_add_u32 m0, s89, 32768
  s_add_u32 s85, s87, 2097152
  v_mfma_f32_16x16x32_bf16 v[52:55], a[0:3], a[164:167], v[52:55]
  v_mfma_f32_16x16x32_bf16 v[52:55], a[4:7], a[180:183], v[52:55]
  buffer_load_dwordx4 v15, s[40:43], s85 offen lds
  v_mfma_f32_16x16x32_bf16 v[56:59], a[0:3], a[168:171], v[56:59]
L_hop6:
  s_cbranch_execz L_hop10
  ds_read_b64_tr_b16 a[36:37], v1 offset:9280
  ds_read_b64_tr_b16 a[38:39], v1 offset:10816
  v_mfma_f32_16x16x32_bf16 v[56:59], a[4:7], a[184:187], v[56:59]
  v_mfma_f32_16x16x32_bf16 v[60:63], a[0:3], a[172:175], v[60:63]
  v_mfma_f32_16x16x32_bf16 v[60:63], a[4:7], a[188:191], v[60:63]
  s_waitcnt lgkmcnt(8)
  v_mfma_f32_16x16x32_bf16 v[64:67], a[8:11], a[160:163], v[64:67]
  ds_read_b64_tr_b16 a[0:1], v20 offset:0
  ds_read_b64_tr_b16 a[2:3], v20 offset:2048
  v_mfma_f32_16x16x32_bf16 v[64:67], a[12:15], a[176:179], v[64:67]
  buffer_store_dwordx4 a[72:75], v24, s[68:71], s11 offen offset:1024 sc1
  v_mfma_f32_16x16x32_bf16 v[68:71], a[8:11], a[164:167], v[68:71]
  s_add_u32 s85, s5, 8192
  v_mfma_f32_16x16x32_bf16 v[68:71], a[12:15], a[180:183], v[68:71]
  v_mfma_f32_16x16x32_bf16 v[72:75], a[8:11], a[168:171], v[72:75]
  ds_read_b64_tr_b16 a[4:5], v20 offset:4096
  ds_read_b64_tr_b16 a[6:7], v20 offset:6144
  v_mfma_f32_16x16x32_bf16 v[72:75], a[12:15], a[184:187], v[72:75]
  buffer_load_dwordx4 a[200:203], v12, s[68:71], s85 offen sc1
  v_mfma_f32_16x16x32_bf16 v[76:79], a[8:11], a[172:175], v[76:79]
  s_add_u32 s85, s5, 73728
  v_mfma_f32_16x16x32_bf16 v[76:79], a[12:15], a[188:191], v[76:79]
  v_mfma_f32_16x16x32_bf16 v[80:83], a[16:19], a[160:163], v[80:83]
  ds_read_b64_tr_b16 a[8:9], v21 offset:0
  ds_read_b64_tr_b16 a[10:11], v21 offset:2048
  v_mfma_f32_16x16x32_bf16 v[80:83], a[20:23], a[176:179], v[80:83]
  buffer_load_dwordx4 a[204:207], v12, s[68:71], s85 offen sc1
  v_mfma_f32_16x16x32_bf16 v[84:87], a[16:19], a[164:167], v[84:87]
  s_add_u32 s85, s4, 9216
  v_mfma_f32_16x16x32_bf16 v[84:87], a[20:23], a[180:183], v[84:87]
  v_mfma_f32_16x16x32_bf16 v[88:91], a[16:19], a[168:171], v[88:91]
  ds_read_b64_tr_b16 a[12:13], v21 offset:4096
  ds_read_b64_tr_b16 a[14:15], v21 offset:6144
  v_mfma_f32_16x16x32_bf16 v[88:91], a[20:23], a[184:187], v[88:91]
  buffer_load_dwordx4 a[208:211], v12, s[68:71], s85 offen sc1
  v_mfma_f32_16x16x32_bf16 v[92:95], a[16:19], a[172:175], v[92:95]
  s_add_u32 s85, s4, 74752
  v_mfma_f32_16x16x32_bf16 v[92:95], a[20:23], a[188:191], v[92:95]
  s_waitcnt lgkmcnt(8)
  v_mfma_f32_16x16x32_bf16 v[96:99], a[24:27], a[160:163], v[96:99]
  ds_read_b64_tr_b16 a[16:17], v22 offset:0
  ds_read_b64_tr_b16 a[18:19], v22 offset:2048
  v_mfma_f32_16x16x32_bf16 v[96:99], a[28:31], a[176:179], v[96:99]
  buffer_load_dwordx4 a[212:215], v12, s[68:71], s85 offen sc1
  v_mfma_f32_16x16x32_bf16 v[100:103], a[24:27], a[164:167], v[100:103]
  v_mfma_f32_16x16x32_bf16 v[100:103], a[28:31], a[180:183], v[100:103]
  s_add_u32 s85, s5, 9216
  v_mfma_f32_16x16x32_bf16 v[104:107], a[24:27], a[168:171], v[104:107]
  ds_read_b64_tr_b16 a[20:21], v22 offset:4096
  ds_read_b64_tr_b16 a[22:23], v22 offset:6144
  v_mfma_f32_16x16x32_bf16 v[104:107], a[28:31], a[184:187], v[104:107]
  buffer_load_dwordx4 a[216:219], v12, s[68:71], s85 offen sc1
  v_mfma_f32_16x16x32_bf16 v[108:111], a[24:27], a[172:175], v[108:111]
  v_mfma_f32_16x16x32_bf16 v[108:111], a[28:31], a[188:191], v[108:111]
  v_mfma_f32_16x16x32_bf16 v[112:115], a[32:35], a[160:163], v[112:115]
  ds_read_b64_tr_b16 a[24:25], v23 offset:0
  ds_read_b64_tr_b16 a[26:27], v23 offset:2048
  v_mfma_f32_16x16x32_bf16 v[112:115], a[36:39], a[176:179], v[112:115]
  buffer_store_dwordx4 a[88:91], v12, s[68:71], s14 offen offset:0 sc1
  v_mfma_f32_16x16x32_bf16 v[116:119], a[32:35], a[164:167], v[116:119]
  s_add_u32 s85, s5, 74752
  v_mfma_f32_16x16x32_bf16 v[116:119], a[36:39], a[180:183], v[116:119]
  v_mfma_f32_16x16x32_bf16 v[120:123], a[32:35], a[168:171], v[120:123]
  ds_read_b64_tr_b16 a[28:29], v23 offset:4096
  ds_read_b64_tr_b16 a[30:31], v23 offset:6144
  v_mfma_f32_16x16x32_bf16 v[120:123], a[36:39], a[184:187], v[120:123]
  buffer_load_dwordx4 a[220:223], v12, s[68:71], s85 offen sc1
  v_mfma_f32_16x16x32_bf16 v[124:127], a[32:35], a[172:175], v[124:127]
  s_add_u32 m0, s89, 33792
  s_add_u32 s85, s87, 2228224
  v_mfma_f32_16x16x32_bf16 v[124:127], a[36:39], a[188:191], v[124:127]
  s_waitcnt lgkmcnt(8)
  v_mfma_f32_16x16x32_bf16 v[192:195], a[0:3], a[128:131], v[192:195]
  ds_read_b64_tr_b16 a[32:33], v20 offset:8192
  ds_read_b64_tr_b16 a[34:35], v20 offset:10240
  v_mfma_f32_16x16x32_bf16 v[192:195], a[4:7], a[144:147], v[192:195]
  buffer_load_dwordx4 v15, s[40:43], s85 offen lds
  v_mfma_f32_16x16x32_bf16 v[196:199], a[0:3], a[132:135], v[196:199]
  s_add_u32 m0, s89, 34816
  s_add_u32 s85, s87, 2129920
  v_mfma_f32_16x16x32_bf16 v[196:199], a[4:7], a[148:151], v[196:199]
  v_mfma_f32_16x16x32_bf16 v[128:131], a[0:3], a[136:139], v[128:131]
  ds_read_b64_tr_b16 a[36:37], v20 offset:12288
  ds_read_b64_tr_b16 a[38:39], v20 offset:14336
  v_mfma_f32_16x16x32_bf16 v[128:131], a[4:7], a[152:155], v[128:131]
  buffer_load_dwordx4 v15, s[40:43], s85 offen lds
  v_mfma_f32_16x16x32_bf16 v[132:135], a[0:3], a[140:143], v[132:135]
  s_add_u32 m0, s89, 35840
  s_add_u32 s85, s87, 2260992
  v_mfma_f32_16x16x32_bf16 v[132:135], a[4:7], a[156:159], v[132:135]
  v_mfma_f32_16x16x32_bf16 v[200:203], a[8:11], a[128:131], v[200:203]
  ds_read_b64_tr_b16 a[0:1], v21 offset:8192
  ds_read_b64_tr_b16 a[2:3], v21 offset:10240
  v_mfma_f32_16x16x32_bf16 v[200:203], a[12:15], a[144:147], v[200:203]
  buffer_load_dwordx4 v15, s[40:43], s85 offen lds
  v_mfma_f32_16x16x32_bf16 v[204:207], a[8:11], a[132:135], v[204:207]
  v_mfma_f32_16x16x32_bf16 v[204:207], a[12:15], a[148:151], v[204:207]
  v_mfma_f32_16x16x32_bf16 v[136:139], a[8:11], a[136:139], v[136:139]
  ds_read_b64_tr_b16 a[4:5], v21 offset:12288
  ds_read_b64_tr_b16 a[6:7], v21 offset:14336
  v_mfma_f32_16x16x32_bf16 v[136:139], a[12:15], a[152:155], v[136:139]
  v_mfma_f32_16x16x32_bf16 v[140:143], a[8:11], a[140:143], v[140:143]
  v_mfma_f32_16x16x32_bf16 v[140:143], a[12:15], a[156:159], v[140:143]
  s_waitcnt lgkmcnt(8)
  v_mfma_f32_16x16x32_bf16 v[208:211], a[16:19], a[128:131], v[208:211]
  ds_read_b64_tr_b16 a[8:9], v22 offset:8192
  ds_read_b64_tr_b16 a[10:11], v22 offset:10240
  v_mfma_f32_16x16x32_bf16 v[208:211], a[20:23], a[144:147], v[208:211]
  v_mfma_f32_16x16x32_bf16 v[212:215], a[16:19], a[132:135], v[212:215]
  v_mfma_f32_16x16x32_bf16 v[212:215], a[20:23], a[148:151], v[212:215]
  v_mfma_f32_16x16x32_bf16 v[144:147], a[16:19], a[136:139], v[144:147]
  ds_read_b64_tr_b16 a[12:13], v22 offset:12288
  ds_read_b64_tr_b16 a[14:15], v22 offset:14336
  v_mfma_f32_16x16x32_bf16 v[144:147], a[20:23], a[152:155], v[144:147]
  buffer_store_dwordx4 a[92:95], v12, s[68:71], s14 offen offset:1024 sc1
  v_mfma_f32_16x16x32_bf16 v[148:151], a[16:19], a[140:143], v[148:151]
  v_mfma_f32_16x16x32_bf16 v[148:151], a[20:23], a[156:159], v[148:151]
  v_mfma_f32_16x16x32_bf16 v[216:219], a[24:27], a[128:131], v[216:219]
  ds_read_b64_tr_b16 a[16:17], v23 offset:8192
  ds_read_b64_tr_b16 a[18:19], v23 offset:10240
  v_mfma_f32_16x16x32_bf16 v[216:219], a[28:31], a[144:147], v[216:219]
  v_mfma_f32_16x16x32_bf16 v[220:223], a[24:27], a[132:135], v[220:223]
  v_mfma_f32_16x16x32_bf16 v[220:223], a[28:31], a[148:151], v[220:223]
  v_mfma_f32_16x16x32_bf16 v[152:155], a[24:27], a[136:139], v[152:155]
  ds_read_b64_tr_b16 a[20:21], v23 offset:12288
  ds_read_b64_tr_b16 a[22:23], v23 offset:14336
  v_mfma_f32_16x16x32_bf16 v[152:155], a[28:31], a[152:155], v[152:155]
  v_mfma_f32_16x16x32_bf16 v[156:159], a[24:27], a[140:143], v[156:159]
  v_mfma_f32_16x16x32_bf16 v[156:159], a[28:31], a[156:159], v[156:159]
  s_waitcnt vmcnt(20)
  v_subrev_u32 v1, 65536, v1
  s_barrier
  s_waitcnt lgkmcnt(8)
  v_mfma_f32_16x16x32_bf16 v[224:227], a[32:35], a[128:131], v[224:227]
  s_add_u32 m0, s8, 0
  ds_read_b64_tr_b16 a[24:25], v1 offset:0
  ds_read_b64_tr_b16 a[26:27], v1 offset:1536
  v_mfma_f32_16x16x32_bf16 v[224:227], a[36:39], a[144:147], v[224:227]
  s_add_u32 s85, s7, 1056768
  v_subrev_u32 v20, 65536, v20
  v_mfma_f32_16x16x32_bf16 v[228:231], a[32:35], a[132:135], v[228:231]
  buffer_load_dwordx4 v26, s[56:59], s85 offen lds
  v_mfma_f32_16x16x32_bf16 v[228:231], a[36:39], a[148:151], v[228:231]
  v_subrev_u32 v21, 65536, v21
  v_mfma_f32_16x16x32_bf16 v[160:163], a[32:35], a[136:139], v[160:163]
  ds_read_b64_tr_b16 a[28:29], v1 offset:3072
  ds_read_b64_tr_b16 a[30:31], v1 offset:4608
  v_mfma_f32_16x16x32_bf16 v[160:163], a[36:39], a[152:155], v[160:163]
  v_subrev_u32 v22, 65536, v22
  v_mfma_f32_16x16x32_bf16 v[164:167], a[32:35], a[140:143], v[164:167]
  v_mfma_f32_16x16x32_bf16 v[164:167], a[36:39], a[156:159], v[164:167]
  v_subrev_u32 v23, 65536, v23
  v_mfma_f32_16x16x32_bf16 v[232:235], a[0:3], a[128:131], v[232:235]
  ds_read_b64_tr_b16 a[32:33], v1 offset:6144
  ds_read_b64_tr_b16 a[34:35], v1 offset:7680
  v_mfma_f32_16x16x32_bf16 v[232:235], a[4:7], a[144:147], v[232:235]
  v_mfma_f32_16x16x32_bf16 v[236:239], a[0:3], a[132:135], v[236:239]
  v_mfma_f32_16x16x32_bf16 v[236:239], a[4:7], a[148:151], v[236:239]
  v_mfma_f32_16x16x32_bf16 v[168:171], a[0:3], a[136:139], v[168:171]
  ds_read_b64_tr_b16 a[36:37], v1 offset:9216
  ds_read_b64_tr_b16 a[38:39], v1 offset:10752
  v_mfma_f32_16x16x32_bf16 v[168:171], a[4:7], a[152:155], v[168:171]
  s_add_u32 m0, s8, 1024
  s_add_u32 s85, s7, 1056768
  v_mfma_f32_16x16x32_bf16 v[172:175], a[0:3], a[140:143], v[172:175]
  v_mfma_f32_16x16x32_bf16 v[172:175], a[4:7], a[156:159], v[172:175]
  s_waitcnt lgkmcnt(8)
  v_mfma_f32_16x16x32_bf16 v[240:243], a[8:11], a[128:131], v[240:243]
  ds_read_b64_tr_b16 a[0:1], v1 offset:32
  ds_read_b64_tr_b16 a[2:3], v1 offset:1568
  v_mfma_f32_16x16x32_bf16 v[240:243], a[12:15], a[144:147], v[240:243]
  buffer_load_dwordx4 v27, s[56:59], s85 offen lds
  v_mfma_f32_16x16x32_bf16 v[244:247], a[8:11], a[132:135], v[244:247]
  v_mfma_f32_16x16x32_bf16 v[244:247], a[12:15], a[148:151], v[244:247]
  v_mfma_f32_16x16x32_bf16 v[176:179], a[8:11], a[136:139], v[176:179]
  ds_read_b64_tr_b16 a[4:5], v1 offset:3104
  ds_read_b64_tr_b16 a[6:7], v1 offset:4640
  v_mfma_f32_16x16x32_bf16 v[176:179], a[12:15], a[152:155], v[176:179]
  buffer_store_dwordx4 a[96:99], v12, s[68:71], s14 offen offset:3072 sc1
  v_mfma_f32_16x16x32_bf16 v[180:183], a[8:11], a[140:143], v[180:183]
  v_mfma_f32_16x16x32_bf16 v[180:183], a[12:15], a[156:159], v[180:183]
  v_mfma_f32_16x16x32_bf16 v[248:251], a[16:19], a[128:131], v[248:251]
  ds_read_b64_tr_b16 a[8:9], v1 offset:6176
  ds_read_b64_tr_b16 a[10:11], v1 offset:7712
  v_mfma_f32_16x16x32_bf16 v[248:251], a[20:23], a[144:147], v[248:251]
  v_mfma_f32_16x16x32_bf16 v[252:255], a[16:19], a[132:135], v[252:255]
  v_mfma_f32_16x16x32_bf16 v[252:255], a[20:23], a[148:151], v[252:255]
  s_add_u32 m0, s8, 2048
  s_add_u32 s85, s7, 1056768
  v_mfma_f32_16x16x32_bf16 v[184:187], a[16:19], a[136:139], v[184:187]
  ds_read_b64_tr_b16 a[12:13], v1 offset:9248
  ds_read_b64_tr_b16 a[14:15], v1 offset:10784
  v_mfma_f32_16x16x32_bf16 v[184:187], a[20:23], a[152:155], v[184:187]
  buffer_load_dwordx4 v28, s[56:59], s85 offen lds
  v_mfma_f32_16x16x32_bf16 v[188:191], a[16:19], a[140:143], v[188:191]
  v_mfma_f32_16x16x32_bf16 v[188:191], a[20:23], a[156:159], v[188:191]
  s_add_u32 s85, s4, 10240
  s_waitcnt vmcnt(8) lgkmcnt(8)
  v_mfma_f32_16x16x32_bf16 v[32:35], a[24:27], a[192:195], v[32:35]
  ds_read_b64_tr_b16 a[16:17], v1 offset:64
  ds_read_b64_tr_b16 a[18:19], v1 offset:1600
  v_mfma_f32_16x16x32_bf16 v[32:35], a[28:31], a[208:211], v[32:35]
  buffer_load_dwordx4 a[128:131], v12, s[68:71], s85 offen sc1
  v_mfma_f32_16x16x32_bf16 v[36:39], a[24:27], a[196:199], v[36:39]
  v_mfma_f32_16x16x32_bf16 v[36:39], a[28:31], a[212:215], v[36:39]
  v_mfma_f32_16x16x32_bf16 v[40:43], a[24:27], a[200:203], v[40:43]
  ds_read_b64_tr_b16 a[20:21], v1 offset:3136
  ds_read_b64_tr_b16 a[22:23], v1 offset:4672
  v_mfma_f32_16x16x32_bf16 v[40:43], a[28:31], a[216:219], v[40:43]
  s_add_u32 s85, s4, 75776
  v_mfma_f32_16x16x32_bf16 v[44:47], a[24:27], a[204:207], v[44:47]
  v_mfma_f32_16x16x32_bf16 v[44:47], a[28:31], a[220:223], v[44:47]
  buffer_load_dwordx4 a[132:135], v12, s[68:71], s85 offen sc1
  v_mfma_f32_16x16x32_bf16 v[48:51], a[32:35], a[192:195], v[48:51]
  ds_read_b64_tr_b16 a[24:25], v1 offset:6208
  ds_read_b64_tr_b16 a[26:27], v1 offset:7744
  v_mfma_f32_16x16x32_bf16 v[48:51], a[36:39], a[208:211], v[48:51]
  s_add_u32 m0, s89, 0
  s_add_u32 s85, s87, 2621440
  v_mfma_f32_16x16x32_bf16 v[52:55], a[32:35], a[196:199], v[52:55]
  v_mfma_f32_16x16x32_bf16 v[52:55], a[36:39], a[212:215], v[52:55]
  buffer_load_dwordx4 v15, s[40:43], s85 offen lds
  v_mfma_f32_16x16x32_bf16 v[56:59], a[32:35], a[200:203], v[56:59]
  ds_read_b64_tr_b16 a[28:29], v1 offset:9280
  ds_read_b64_tr_b16 a[30:31], v1 offset:10816
  v_mfma_f32_16x16x32_bf16 v[56:59], a[36:39], a[216:219], v[56:59]
  v_mfma_f32_16x16x32_bf16 v[60:63], a[32:35], a[204:207], v[60:63]
  v_mfma_f32_16x16x32_bf16 v[60:63], a[36:39], a[220:223], v[60:63]
  s_waitcnt lgkmcnt(8)
  v_mfma_f32_16x16x32_bf16 v[64:67], a[0:3], a[192:195], v[64:67]
  ds_read_b64_tr_b16 a[32:33], v20 offset:0
  ds_read_b64_tr_b16 a[34:35], v20 offset:2048
  v_mfma_f32_16x16x32_bf16 v[64:67], a[4:7], a[208:211], v[64:67]
  buffer_store_dwordx4 a[100:103], v12, s[68:71], s15 offen offset:0 sc1
  v_mfma_f32_16x16x32_bf16 v[68:71], a[0:3], a[196:199], v[68:71]
  s_add_u32 s85, s5, 10240
  v_mfma_f32_16x16x32_bf16 v[68:71], a[4:7], a[212:215], v[68:71]
  v_mfma_f32_16x16x32_bf16 v[72:75], a[0:3], a[200:203], v[72:75]
  ds_read_b64_tr_b16 a[36:37], v20 offset:4096
  ds_read_b64_tr_b16 a[38:39], v20 offset:6144
  v_mfma_f32_16x16x32_bf16 v[72:75], a[4:7], a[216:219], v[72:75]
  buffer_load_dwordx4 a[136:139], v12, s[68:71], s85 offen sc1
  v_mfma_f32_16x16x32_bf16 v[76:79], a[0:3], a[204:207], v[76:79]
  s_add_u32 s85, s5, 75776
  v_mfma_f32_16x16x32_bf16 v[76:79], a[4:7], a[220:223], v[76:79]
  v_mfma_f32_16x16x32_bf16 v[80:83], a[8:11], a[192:195], v[80:83]
  ds_read_b64_tr_b16 a[0:1], v21 offset:0
  ds_read_b64_tr_b16 a[2:3], v21 offset:2048
  v_mfma_f32_16x16x32_bf16 v[80:83], a[12:15], a[208:211], v[80:83]
  buffer_load_dwordx4 a[140:143], v12, s[68:71], s85 offen sc1
  v_mfma_f32_16x16x32_bf16 v[84:87], a[8:11], a[196:199], v[84:87]
  s_add_u32 s85, s4, 11264
  v_mfma_f32_16x16x32_bf16 v[84:87], a[12:15], a[212:215], v[84:87]
  v_mfma_f32_16x16x32_bf16 v[88:91], a[8:11], a[200:203], v[88:91]
  ds_read_b64_tr_b16 a[4:5], v21 offset:4096
  ds_read_b64_tr_b16 a[6:7], v21 offset:6144
  v_mfma_f32_16x16x32_bf16 v[88:91], a[12:15], a[216:219], v[88:91]
  buffer_load_dwordx4 a[144:147], v12, s[68:71], s85 offen sc1
  v_mfma_f32_16x16x32_bf16 v[92:95], a[8:11], a[204:207], v[92:95]
  s_add_u32 s85, s4, 76800
  v_mfma_f32_16x16x32_bf16 v[92:95], a[12:15], a[220:223], v[92:95]
  s_waitcnt lgkmcnt(8)
  v_mfma_f32_16x16x32_bf16 v[96:99], a[16:19], a[192:195], v[96:99]
  ds_read_b64_tr_b16 a[8:9], v22 offset:0
  ds_read_b64_tr_b16 a[10:11], v22 offset:2048
  v_mfma_f32_16x16x32_bf16 v[96:99], a[20:23], a[208:211], v[96:99]
  buffer_load_dwordx4 a[148:151], v12, s[68:71], s85 offen sc1
  v_mfma_f32_16x16x32_bf16 v[100:103], a[16:19], a[196:199], v[100:103]
  v_mfma_f32_16x16x32_bf16 v[100:103], a[20:23], a[212:215], v[100:103]
  s_add_u32 s85, s5, 11264
  v_mfma_f32_16x16x32_bf16 v[104:107], a[16:19], a[200:203], v[104:107]
  ds_read_b64_tr_b16 a[12:13], v22 offset:4096
  ds_read_b64_tr_b16 a[14:15], v22 offset:6144
  v_mfma_f32_16x16x32_bf16 v[104:107], a[20:23], a[216:219], v[104:107]
  buffer_load_dwordx4 a[152:155], v12, s[68:71], s85 offen sc1
  v_mfma_f32_16x16x32_bf16 v[108:111], a[16:19], a[204:207], v[108:111]
  v_mfma_f32_16x16x32_bf16 v[108:111], a[20:23], a[220:223], v[108:111]
  v_mfma_f32_16x16x32_bf16 v[112:115], a[24:27], a[192:195], v[112:115]
  ds_read_b64_tr_b16 a[16:17], v23 offset:0
  ds_read_b64_tr_b16 a[18:19], v23 offset:2048
  v_mfma_f32_16x16x32_bf16 v[112:115], a[28:31], a[208:211], v[112:115]
  buffer_store_dwordx4 a[104:107], v12, s[68:71], s15 offen offset:1024 sc1
  v_mfma_f32_16x16x32_bf16 v[116:119], a[24:27], a[196:199], v[116:119]
  s_add_u32 s85, s5, 76800
  v_mfma_f32_16x16x32_bf16 v[116:119], a[28:31], a[212:215], v[116:119]
  v_mfma_f32_16x16x32_bf16 v[120:123], a[24:27], a[200:203], v[120:123]
  ds_read_b64_tr_b16 a[20:21], v23 offset:4096
  ds_read_b64_tr_b16 a[22:23], v23 offset:6144
  v_mfma_f32_16x16x32_bf16 v[120:123], a[28:31], a[216:219], v[120:123]
  buffer_load_dwordx4 a[156:159], v12, s[68:71], s85 offen sc1
  v_mfma_f32_16x16x32_bf16 v[124:127], a[24:27], a[204:207], v[124:127]
  s_add_u32 m0, s89, 1024
  s_add_u32 s85, s87, 2752512
  v_mfma_f32_16x16x32_bf16 v[124:127], a[28:31], a[220:223], v[124:127]
  s_waitcnt lgkmcnt(8)
  v_mfma_f32_16x16x32_bf16 v[192:195], a[32:35], a[160:163], v[192:195]
  ds_read_b64_tr_b16 a[24:25], v20 offset:8192
  ds_read_b64_tr_b16 a[26:27], v20 offset:10240
  v_mfma_f32_16x16x32_bf16 v[192:195], a[36:39], a[176:179], v[192:195]
  buffer_load_dwordx4 v15, s[40:43], s85 offen lds
  v_mfma_f32_16x16x32_bf16 v[196:199], a[32:35], a[164:167], v[196:199]
  s_add_u32 m0, s89, 2048
  s_add_u32 s85, s87, 2654208
  v_mfma_f32_16x16x32_bf16 v[196:199], a[36:39], a[180:183], v[196:199]
  v_mfma_f32_16x16x32_bf16 v[128:131], a[32:35], a[168:171], v[128:131]
  ds_read_b64_tr_b16 a[28:29], v20 offset:12288
  ds_read_b64_tr_b16 a[30:31], v20 offset:14336
  v_mfma_f32_16x16x32_bf16 v[128:131], a[36:39], a[184:187], v[128:131]
  buffer_load_dwordx4 v15, s[40:43], s85 offen lds
  v_mfma_f32_16x16x32_bf16 v[132:135], a[32:35], a[172:175], v[132:135]
  s_add_u32 m0, s89, 3072
  s_add_u32 s85, s87, 2785280
  v_mfma_f32_16x16x32_bf16 v[132:135], a[36:39], a[188:191], v[132:135]
  v_mfma_f32_16x16x32_bf16 v[200:203], a[0:3], a[160:163], v[200:203]
  ds_read_b64_tr_b16 a[32:33], v21 offset:8192
  ds_read_b64_tr_b16 a[34:35], v21 offset:10240
  v_mfma_f32_16x16x32_bf16 v[200:203], a[4:7], a[176:179], v[200:203]
  buffer_load_dwordx4 v15, s[40:43], s85 offen lds
  v_mfma_f32_16x16x32_bf16 v[204:207], a[0:3], a[164:167], v[204:207]
  v_mfma_f32_16x16x32_bf16 v[204:207], a[4:7], a[180:183], v[204:207]
  v_mfma_f32_16x16x32_bf16 v[136:139], a[0:3], a[168:171], v[136:139]
  ds_read_b64_tr_b16 a[36:37], v21 offset:12288
  ds_read_b64_tr_b16 a[38:39], v21 offset:14336
  v_mfma_f32_16x16x32_bf16 v[136:139], a[4:7], a[184:187], v[136:139]
  v_mfma_f32_16x16x32_bf16 v[140:143], a[0:3], a[172:175], v[140:143]
  v_mfma_f32_16x16x32_bf16 v[140:143], a[4:7], a[188:191], v[140:143]
  s_waitcnt lgkmcnt(8)
  v_mfma_f32_16x16x32_bf16 v[208:211], a[8:11], a[160:163], v[208:211]
  ds_read_b64_tr_b16 a[0:1], v22 offset:8192
  ds_read_b64_tr_b16 a[2:3], v22 offset:10240
  v_mfma_f32_16x16x32_bf16 v[208:211], a[12:15], a[176:179], v[208:211]
  v_mfma_f32_16x16x32_bf16 v[212:215], a[8:11], a[164:167], v[212:215]
  v_mfma_f32_16x16x32_bf16 v[212:215], a[12:15], a[180:183], v[212:215]
  v_mfma_f32_16x16x32_bf16 v[144:147], a[8:11], a[168:171], v[144:147]
  ds_read_b64_tr_b16 a[4:5], v22 offset:12288
  ds_read_b64_tr_b16 a[6:7], v22 offset:14336
  v_mfma_f32_16x16x32_bf16 v[144:147], a[12:15], a[184:187], v[144:147]
  buffer_store_dwordx4 a[108:111], v12, s[68:71], s15 offen offset:3072 sc1
  v_mfma_f32_16x16x32_bf16 v[148:151], a[8:11], a[172:175], v[148:151]
  v_mfma_f32_16x16x32_bf16 v[148:151], a[12:15], a[188:191], v[148:151]
  v_mfma_f32_16x16x32_bf16 v[216:219], a[16:19], a[160:163], v[216:219]
  ds_read_b64_tr_b16 a[8:9], v23 offset:8192
  ds_read_b64_tr_b16 a[10:11], v23 offset:10240
  v_mfma_f32_16x16x32_bf16 v[216:219], a[20:23], a[176:179], v[216:219]
  v_mfma_f32_16x16x32_bf16 v[220:223], a[16:19], a[164:167], v[220:223]
  v_mfma_f32_16x16x32_bf16 v[220:223], a[20:23], a[180:183], v[220:223]
  v_mfma_f32_16x16x32_bf16 v[152:155], a[16:19], a[168:171], v[152:155]
  ds_read_b64_tr_b16 a[12:13], v23 offset:12288
  ds_read_b64_tr_b16 a[14:15], v23 offset:14336
  v_mfma_f32_16x16x32_bf16 v[152:155], a[20:23], a[184:187], v[152:155]
  v_mfma_f32_16x16x32_bf16 v[156:159], a[16:19], a[172:175], v[156:159]
  v_mfma_f32_16x16x32_bf16 v[156:159], a[20:23], a[188:191], v[156:159]
  s_waitcnt vmcnt(20)
  v_subrev_u32 v1, 32768, v1
  s_barrier
  s_waitcnt lgkmcnt(8)
  v_mfma_f32_16x16x32_bf16 v[224:227], a[24:27], a[160:163], v[224:227]
  s_add_u32 m0, s8, 131072
  ds_read_b64_tr_b16 a[16:17], v1 offset:0
  ds_read_b64_tr_b16 a[18:19], v1 offset:1536
  v_mfma_f32_16x16x32_bf16 v[224:227], a[28:31], a[176:179], v[224:227]
  s_add_u32 s85, s7, 1232896
  v_subrev_u32 v20, 32768, v20
  v_accvgpr_read_b32 v2, a224
  v_mfma_f32_16x16x32_bf16 v[228:231], a[24:27], a[164:167], v[228:231]
  buffer_load_dwordx4 v26, s[56:59], s85 offen lds
  v_mfma_f32_16x16x32_bf16 v[228:231], a[28:31], a[180:183], v[228:231]
  v_subrev_u32 v21, 32768, v21
  v_accvgpr_read_b32 v3, a225
  v_mfma_f32_16x16x32_bf16 v[160:163], a[24:27], a[168:171], v[160:163]
  ds_read_b64_tr_b16 a[20:21], v1 offset:3072
  ds_read_b64_tr_b16 a[22:23], v1 offset:4608
  v_mfma_f32_16x16x32_bf16 v[160:163], a[28:31], a[184:187], v[160:163]
  v_subrev_u32 v22, 32768, v22
  v_cvt_pk_bf16_f32 v4, v2, v3
  v_mfma_f32_16x16x32_bf16 v[164:167], a[24:27], a[172:175], v[164:167]
  v_accvgpr_read_b32 v2, a226
  v_accvgpr_read_b32 v3, a227
  v_mfma_f32_16x16x32_bf16 v[164:167], a[28:31], a[188:191], v[164:167]
  v_subrev_u32 v23, 32768, v23
  v_cvt_pk_bf16_f32 v5, v2, v3
  v_mfma_f32_16x16x32_bf16 v[232:235], a[32:35], a[160:163], v[232:235]
  ds_read_b64_tr_b16 a[24:25], v1 offset:6144
  ds_read_b64_tr_b16 a[26:27], v1 offset:7680
  v_mfma_f32_16x16x32_bf16 v[232:235], a[36:39], a[176:179], v[232:235]
  v_accvgpr_read_b32 v2, a228
  v_accvgpr_read_b32 v3, a229
  v_mfma_f32_16x16x32_bf16 v[236:239], a[32:35], a[164:167], v[236:239]
  v_cvt_pk_bf16_f32 v6, v2, v3
  v_accvgpr_read_b32 v2, a230
  v_mfma_f32_16x16x32_bf16 v[236:239], a[36:39], a[180:183], v[236:239]
  v_accvgpr_read_b32 v3, a231
  v_cvt_pk_bf16_f32 v7, v2, v3
  v_mfma_f32_16x16x32_bf16 v[168:171], a[32:35], a[168:171], v[168:171]
  ds_read_b64_tr_b16 a[28:29], v1 offset:9216
  ds_read_b64_tr_b16 a[30:31], v1 offset:10752
  v_mfma_f32_16x16x32_bf16 v[168:171], a[36:39], a[184:187], v[168:171]
  s_add_u32 m0, s8, 132096
  s_add_u32 s85, s7, 1232896
  v_mfma_f32_16x16x32_bf16 v[172:175], a[32:35], a[172:175], v[172:175]
  v_mfma_f32_16x16x32_bf16 v[172:175], a[36:39], a[188:191], v[172:175]
  s_waitcnt lgkmcnt(8)
  v_mfma_f32_16x16x32_bf16 v[240:243], a[0:3], a[160:163], v[240:243]
  ds_read_b64_tr_b16 a[32:33], v1 offset:32
  ds_read_b64_tr_b16 a[34:35], v1 offset:1568
  v_mfma_f32_16x16x32_bf16 v[240:243], a[4:7], a[176:179], v[240:243]
  buffer_load_dwordx4 v27, s[56:59], s85 offen lds
  v_mfma_f32_16x16x32_bf16 v[244:247], a[0:3], a[164:167], v[244:247]
  v_mfma_f32_16x16x32_bf16 v[244:247], a[4:7], a[180:183], v[244:247]
  v_mfma_f32_16x16x32_bf16 v[176:179], a[0:3], a[168:171], v[176:179]
  ds_read_b64_tr_b16 a[36:37], v1 offset:3104
  ds_read_b64_tr_b16 a[38:39], v1 offset:4640
  v_mfma_f32_16x16x32_bf16 v[176:179], a[4:7], a[184:187], v[176:179]
  buffer_store_dwordx4 v[4:7], v12, s[68:71], s17 offen offset:0 sc1
  v_mfma_f32_16x16x32_bf16 v[180:183], a[0:3], a[172:175], v[180:183]
  v_mfma_f32_16x16x32_bf16 v[180:183], a[4:7], a[188:191], v[180:183]
  v_mfma_f32_16x16x32_bf16 v[248:251], a[8:11], a[160:163], v[248:251]
  ds_read_b64_tr_b16 a[0:1], v1 offset:6176
  ds_read_b64_tr_b16 a[2:3], v1 offset:7712
  v_mfma_f32_16x16x32_bf16 v[248:251], a[12:15], a[176:179], v[248:251]
  v_mfma_f32_16x16x32_bf16 v[252:255], a[8:11], a[164:167], v[252:255]
  v_mfma_f32_16x16x32_bf16 v[252:255], a[12:15], a[180:183], v[252:255]
  s_add_u32 m0, s8, 133120
  s_add_u32 s85, s7, 1232896
  v_mfma_f32_16x16x32_bf16 v[184:187], a[8:11], a[168:171], v[184:187]
  ds_read_b64_tr_b16 a[4:5], v1 offset:9248
  ds_read_b64_tr_b16 a[6:7], v1 offset:10784
  v_mfma_f32_16x16x32_bf16 v[184:187], a[12:15], a[184:187], v[184:187]
  buffer_load_dwordx4 v28, s[56:59], s85 offen lds
  v_mfma_f32_16x16x32_bf16 v[188:191], a[8:11], a[172:175], v[188:191]
  v_accvgpr_read_b32 v2, a232
  v_accvgpr_read_b32 v3, a233
  v_mfma_f32_16x16x32_bf16 v[188:191], a[12:15], a[188:191], v[188:191]
  s_add_u32 s85, s4, 12288
  v_cvt_pk_bf16_f32 v8, v2, v3
  s_waitcnt vmcnt(8) lgkmcnt(8)
  v_mfma_f32_16x16x32_bf16 v[32:35], a[16:19], a[128:131], v[32:35]
  ds_read_b64_tr_b16 a[8:9], v1 offset:64
  ds_read_b64_tr_b16 a[10:11], v1 offset:1600
  v_mfma_f32_16x16x32_bf16 v[32:35], a[20:23], a[144:147], v[32:35]
  buffer_load_dwordx4 a[160:163], v12, s[68:71], s85 offen sc1
  v_mfma_f32_16x16x32_bf16 v[36:39], a[16:19], a[132:135], v[36:39]
  v_accvgpr_read_b32 v2, a234
  v_accvgpr_read_b32 v3, a235
  v_mfma_f32_16x16x32_bf16 v[36:39], a[20:23], a[148:151], v[36:39]
  v_cvt_pk_bf16_f32 v9, v2, v3
  v_accvgpr_read_b32 v2, a236
  v_mfma_f32_16x16x32_bf16 v[40:43], a[16:19], a[136:139], v[40:43]
  ds_read_b64_tr_b16 a[12:13], v1 offset:3136
  ds_read_b64_tr_b16 a[14:15], v1 offset:4672
  v_mfma_f32_16x16x32_bf16 v[40:43], a[20:23], a[152:155], v[40:43]
  s_add_u32 s85, s4, 77824
  v_accvgpr_read_b32 v3, a237
  v_cvt_pk_bf16_f32 v10, v2, v3
  v_mfma_f32_16x16x32_bf16 v[44:47], a[16:19], a[140:143], v[44:47]
  v_accvgpr_read_b32 v2, a238
  v_accvgpr_read_b32 v3, a239
  v_mfma_f32_16x16x32_bf16 v[44:47], a[20:23], a[156:159], v[44:47]
  buffer_load_dwordx4 a[164:167], v12, s[68:71], s85 offen sc1
  v_mfma_f32_16x16x32_bf16 v[48:51], a[24:27], a[128:131], v[48:51]
  ds_read_b64_tr_b16 a[16:17], v1 offset:6208
  ds_read_b64_tr_b16 a[18:19], v1 offset:7744
  v_mfma_f32_16x16x32_bf16 v[48:51], a[28:31], a[144:147], v[48:51]
  s_add_u32 m0, s89, 131072
  s_add_u32 s85, s87, 3145728
  v_cvt_pk_bf16_f32 v11, v2, v3
  v_mfma_f32_16x16x32_bf16 v[52:55], a[24:27], a[132:135], v[52:55]
  v_mfma_f32_16x16x32_bf16 v[52:55], a[28:31], a[148:151], v[52:55]
  buffer_load_dwordx4 v15, s[40:43], s85 offen lds
  v_mfma_f32_16x16x32_bf16 v[56:59], a[24:27], a[136:139], v[56:59]
  ds_read_b64_tr_b16 a[20:21], v1 offset:9280
  ds_read_b64_tr_b16 a[22:23], v1 offset:10816
  v_mfma_f32_16x16x32_bf16 v[56:59], a[28:31], a[152:155], v[56:59]
  v_mfma_f32_16x16x32_bf16 v[60:63], a[24:27], a[140:143], v[60:63]
  v_mfma_f32_16x16x32_bf16 v[60:63], a[28:31], a[156:159], v[60:63]
  s_waitcnt lgkmcnt(8)
  v_mfma_f32_16x16x32_bf16 v[64:67], a[32:35], a[128:131], v[64:67]
  ds_read_b64_tr_b16 a[24:25], v20 offset:0
  ds_read_b64_tr_b16 a[26:27], v20 offset:2048
  v_mfma_f32_16x16x32_bf16 v[64:67], a[36:39], a[144:147], v[64:67]
  buffer_store_dwordx4 v[8:11], v12, s[68:71], s17 offen offset:1024 sc1
  v_mfma_f32_16x16x32_bf16 v[68:71], a[32:35], a[132:135], v[68:71]
  s_add_u32 s85, s5, 12288
  v_mfma_f32_16x16x32_bf16 v[68:71], a[36:39], a[148:151], v[68:71]
  v_mfma_f32_16x16x32_bf16 v[72:75], a[32:35], a[136:139], v[72:75]
  ds_read_b64_tr_b16 a[28:29], v20 offset:4096
  ds_read_b64_tr_b16 a[30:31], v20 offset:6144
  v_mfma_f32_16x16x32_bf16 v[72:75], a[36:39], a[152:155], v[72:75]
  buffer_load_dwordx4 a[168:171], v12, s[68:71], s85 offen sc1
  v_mfma_f32_16x16x32_bf16 v[76:79], a[32:35], a[140:143], v[76:79]
  s_add_u32 s85, s5, 77824
  v_accvgpr_read_b32 v2, a240
  v_accvgpr_read_b32 v3, a241
  v_mfma_f32_16x16x32_bf16 v[76:79], a[36:39], a[156:159], v[76:79]
  v_cvt_pk_bf16_f32 v4, v2, v3
  v_accvgpr_read_b32 v2, a242
  v_mfma_f32_16x16x32_bf16 v[80:83], a[0:3], a[128:131], v[80:83]
  ds_read_b64_tr_b16 a[32:33], v21 offset:0
  ds_read_b64_tr_b16 a[34:35], v21 offset:2048
  v_mfma_f32_16x16x32_bf16 v[80:83], a[4:7], a[144:147], v[80:83]
  buffer_load_dwordx4 a[172:175], v12, s[68:71], s85 offen sc1
  v_mfma_f32_16x16x32_bf16 v[84:87], a[0:3], a[132:135], v[84:87]
  s_add_u32 s85, s4, 13312
  v_accvgpr_read_b32 v3, a243
  v_cvt_pk_bf16_f32 v5, v2, v3
  v_mfma_f32_16x16x32_bf16 v[84:87], a[4:7], a[148:151], v[84:87]
  v_accvgpr_read_b32 v2, a244
  v_accvgpr_read_b32 v3, a245
  v_mfma_f32_16x16x32_bf16 v[88:91], a[0:3], a[136:139], v[88:91]
  ds_read_b64_tr_b16 a[36:37], v21 offset:4096
  ds_read_b64_tr_b16 a[38:39], v21 offset:6144
  v_mfma_f32_16x16x32_bf16 v[88:91], a[4:7], a[152:155], v[88:91]
  buffer_load_dwordx4 a[176:179], v12, s[68:71], s85 offen sc1
  v_mfma_f32_16x16x32_bf16 v[92:95], a[0:3], a[140:143], v[92:95]
  s_add_u32 s85, s4, 78848
  v_cvt_pk_bf16_f32 v6, v2, v3
  v_accvgpr_read_b32 v2, a246
  v_mfma_f32_16x16x32_bf16 v[92:95], a[4:7], a[156:159], v[92:95]
  s_waitcnt lgkmcnt(8)
  v_accvgpr_read_b32 v3, a247
  v_cvt_pk_bf16_f32 v7, v2, v3
  v_mfma_f32_16x16x32_bf16 v[96:99], a[8:11], a[128:131], v[96:99]
L_hop7:
  s_cbranch_execz L_hop11
  ds_read_b64_tr_b16 a[0:1], v22 offset:0
  ds_read_b64_tr_b16 a[2:3], v22 offset:2048
  v_mfma_f32_16x16x32_bf16 v[96:99], a[12:15], a[144:147], v[96:99]
  buffer_load_dwordx4 a[180:183], v12, s[68:71], s85 offen sc1
  v_mfma_f32_16x16x32_bf16 v[100:103], a[8:11], a[132:135], v[100:103]
  v_mfma_f32_16x16x32_bf16 v[100:103], a[12:15], a[148:151], v[100:103]
  s_add_u32 s85, s5, 13312
  v_mfma_f32_16x16x32_bf16 v[104:107], a[8:11], a[136:139], v[104:107]
  ds_read_b64_tr_b16 a[4:5], v22 offset:4096
  ds_read_b64_tr_b16 a[6:7], v22 offset:6144
  v_mfma_f32_16x16x32_bf16 v[104:107], a[12:15], a[152:155], v[104:107]
  buffer_load_dwordx4 a[184:187], v12, s[68:71], s85 offen sc1
  v_mfma_f32_16x16x32_bf16 v[108:111], a[8:11], a[140:143], v[108:111]
  v_mfma_f32_16x16x32_bf16 v[108:111], a[12:15], a[156:159], v[108:111]
  v_mfma_f32_16x16x32_bf16 v[112:115], a[16:19], a[128:131], v[112:115]
  ds_read_b64_tr_b16 a[8:9], v23 offset:0
  ds_read_b64_tr_b16 a[10:11], v23 offset:2048
  v_mfma_f32_16x16x32_bf16 v[112:115], a[20:23], a[144:147], v[112:115]
  buffer_store_dwordx4 v[4:7], v12, s[68:71], s17 offen offset:2048 sc1
  v_mfma_f32_16x16x32_bf16 v[116:119], a[16:19], a[132:135], v[116:119]
  s_add_u32 s85, s5, 78848
  v_mfma_f32_16x16x32_bf16 v[116:119], a[20:23], a[148:151], v[116:119]
  v_mfma_f32_16x16x32_bf16 v[120:123], a[16:19], a[136:139], v[120:123]
  ds_read_b64_tr_b16 a[12:13], v23 offset:4096
  ds_read_b64_tr_b16 a[14:15], v23 offset:6144
  v_mfma_f32_16x16x32_bf16 v[120:123], a[20:23], a[152:155], v[120:123]
  buffer_load_dwordx4 a[188:191], v12, s[68:71], s85 offen sc1
  v_mfma_f32_16x16x32_bf16 v[124:127], a[16:19], a[140:143], v[124:127]
  s_add_u32 m0, s89, 132096
  s_add_u32 s85, s87, 3276800
  v_mfma_f32_16x16x32_bf16 v[124:127], a[20:23], a[156:159], v[124:127]
  s_waitcnt lgkmcnt(8)
  v_mfma_f32_16x16x32_bf16 v[192:195], a[24:27], a[192:195], v[192:195]
  ds_read_b64_tr_b16 a[16:17], v20 offset:8192
  ds_read_b64_tr_b16 a[18:19], v20 offset:10240
  v_mfma_f32_16x16x32_bf16 v[192:195], a[28:31], a[208:211], v[192:195]
  buffer_load_dwordx4 v15, s[40:43], s85 offen lds
  v_mfma_f32_16x16x32_bf16 v[196:199], a[24:27], a[196:199], v[196:199]
  s_add_u32 m0, s89, 133120
  s_add_u32 s85, s87, 3178496
  v_accvgpr_read_b32 v2, a248
  v_mfma_f32_16x16x32_bf16 v[196:199], a[28:31], a[212:215], v[196:199]
  v_accvgpr_read_b32 v3, a249
  v_cvt_pk_bf16_f32 v8, v2, v3
  v_mfma_f32_16x16x32_bf16 v[128:131], a[24:27], a[200:203], v[128:131]
  ds_read_b64_tr_b16 a[20:21], v20 offset:12288
  ds_read_b64_tr_b16 a[22:23], v20 offset:14336
  v_mfma_f32_16x16x32_bf16 v[128:131], a[28:31], a[216:219], v[128:131]
  buffer_load_dwordx4 v15, s[40:43], s85 offen lds
  v_mfma_f32_16x16x32_bf16 v[132:135], a[24:27], a[204:207], v[132:135]
  s_add_u32 m0, s89, 134144
  s_add_u32 s85, s87, 3309568
  v_accvgpr_read_b32 v2, a250
  v_mfma_f32_16x16x32_bf16 v[132:135], a[28:31], a[220:223], v[132:135]
  v_accvgpr_read_b32 v3, a251
  v_cvt_pk_bf16_f32 v9, v2, v3
  v_mfma_f32_16x16x32_bf16 v[200:203], a[32:35], a[192:195], v[200:203]
  ds_read_b64_tr_b16 a[24:25], v21 offset:8192
  ds_read_b64_tr_b16 a[26:27], v21 offset:10240
  v_mfma_f32_16x16x32_bf16 v[200:203], a[36:39], a[208:211], v[200:203]
  buffer_load_dwordx4 v15, s[40:43], s85 offen lds
  v_mfma_f32_16x16x32_bf16 v[204:207], a[32:35], a[196:199], v[204:207]
  v_accvgpr_read_b32 v2, a252
  v_accvgpr_read_b32 v3, a253
  v_mfma_f32_16x16x32_bf16 v[204:207], a[36:39], a[212:215], v[204:207]
  v_cvt_pk_bf16_f32 v10, v2, v3
  v_accvgpr_read_b32 v2, a254
  v_mfma_f32_16x16x32_bf16 v[136:139], a[32:35], a[200:203], v[136:139]
  ds_read_b64_tr_b16 a[28:29], v21 offset:12288
  ds_read_b64_tr_b16 a[30:31], v21 offset:14336
  v_mfma_f32_16x16x32_bf16 v[136:139], a[36:39], a[216:219], v[136:139]
  v_accvgpr_read_b32 v3, a255
  v_cvt_pk_bf16_f32 v11, v2, v3
  v_mfma_f32_16x16x32_bf16 v[140:143], a[32:35], a[204:207], v[140:143]
  v_mfma_f32_16x16x32_bf16 v[140:143], a[36:39], a[220:223], v[140:143]
  s_waitcnt lgkmcnt(8)
  v_mfma_f32_16x16x32_bf16 v[208:211], a[0:3], a[192:195], v[208:211]
  ds_read_b64_tr_b16 a[32:33], v22 offset:8192
  ds_read_b64_tr_b16 a[34:35], v22 offset:10240
  v_mfma_f32_16x16x32_bf16 v[208:211], a[4:7], a[208:211], v[208:211]
  v_mfma_f32_16x16x32_bf16 v[212:215], a[0:3], a[196:199], v[212:215]
  v_mfma_f32_16x16x32_bf16 v[212:215], a[4:7], a[212:215], v[212:215]
  v_mfma_f32_16x16x32_bf16 v[144:147], a[0:3], a[200:203], v[144:147]
  ds_read_b64_tr_b16 a[36:37], v22 offset:12288
  ds_read_b64_tr_b16 a[38:39], v22 offset:14336
  v_mfma_f32_16x16x32_bf16 v[144:147], a[4:7], a[216:219], v[144:147]
  buffer_store_dwordx4 v[8:11], v12, s[68:71], s17 offen offset:3072 sc1
  v_mfma_f32_16x16x32_bf16 v[148:151], a[0:3], a[204:207], v[148:151]
  s_nop 0
  v_mov_b32 v11, 0xf149f2ca
  v_lshrrev_b32 v2, 4, v0
  v_mfma_f32_16x16x32_bf16 v[148:151], a[4:7], a[220:223], v[148:151]
  v_lshlrev_b32 v2, 2, v2
  v_and_b32 v8, 15, v0
  v_mfma_f32_16x16x32_bf16 v[216:219], a[8:11], a[192:195], v[216:219]
  ds_read_b64_tr_b16 a[0:1], v23 offset:8192
  ds_read_b64_tr_b16 a[2:3], v23 offset:10240
  v_mfma_f32_16x16x32_bf16 v[216:219], a[12:15], a[208:211], v[216:219]
  v_sub_u32 v8, v8, v2
  v_lshl_add_u32 v8, s76, 4, v8
  v_mfma_f32_16x16x32_bf16 v[220:223], a[8:11], a[196:199], v[220:223]
  v_and_b32 v2, 3, v0
  v_mov_b32 v3, 0x3f803f80
  v_mfma_f32_16x16x32_bf16 v[220:223], a[12:15], a[212:215], v[220:223]
  v_xor_b32 v4, 0, v2
  v_min_u32 v4, 1, v4
  v_mfma_f32_16x16x32_bf16 v[152:155], a[8:11], a[200:203], v[152:155]
  ds_read_b64_tr_b16 a[4:5], v23 offset:12288
  ds_read_b64_tr_b16 a[6:7], v23 offset:14336
  v_mfma_f32_16x16x32_bf16 v[152:155], a[12:15], a[216:219], v[152:155]
  v_subrev_u32 v4, 1, v4
  v_and_b32 v4, v3, v4
  v_mfma_f32_16x16x32_bf16 v[156:159], a[8:11], a[204:207], v[156:159]
  v_xor_b32 v5, 1, v2
  v_min_u32 v5, 1, v5
  v_mfma_f32_16x16x32_bf16 v[156:159], a[12:15], a[220:223], v[156:159]
  s_waitcnt vmcnt(20)
  v_subrev_u32 v1, 32768, v1
  s_barrier
  s_waitcnt lgkmcnt(8)
  v_mfma_f32_16x16x32_bf16 v[224:227], a[16:19], a[192:195], v[224:227]
  s_add_u32 m0, s89, 98304
  ds_read_b64_tr_b16 a[8:9], v1 offset:0
  ds_read_b64_tr_b16 a[10:11], v1 offset:1536
  v_mfma_f32_16x16x32_bf16 v[224:227], a[20:23], a[208:211], v[224:227]
  s_add_u32 s85, s87, 3670016
  v_subrev_u32 v20, 32768, v20
  v_subrev_u32 v5, 1, v5
  v_mfma_f32_16x16x32_bf16 v[228:231], a[16:19], a[196:199], v[228:231]
  buffer_load_dwordx4 v15, s[40:43], s85 offen lds
  v_mfma_f32_16x16x32_bf16 v[228:231], a[20:23], a[212:215], v[228:231]
  v_subrev_u32 v21, 32768, v21
  v_and_b32 v5, v3, v5
  v_mfma_f32_16x16x32_bf16 v[160:163], a[16:19], a[200:203], v[160:163]
  ds_read_b64_tr_b16 a[12:13], v1 offset:3072
  ds_read_b64_tr_b16 a[14:15], v1 offset:4608
  v_mfma_f32_16x16x32_bf16 v[160:163], a[20:23], a[216:219], v[160:163]
  v_subrev_u32 v22, 32768, v22
  v_xor_b32 v6, 2, v2
  v_mfma_f32_16x16x32_bf16 v[164:167], a[16:19], a[204:207], v[164:167]
  v_min_u32 v6, 1, v6
  v_subrev_u32 v6, 1, v6
  v_mfma_f32_16x16x32_bf16 v[164:167], a[20:23], a[220:223], v[164:167]
  v_subrev_u32 v23, 32768, v23
  v_and_b32 v6, v3, v6
  v_mfma_f32_16x16x32_bf16 v[232:235], a[24:27], a[192:195], v[232:235]
  ds_read_b64_tr_b16 a[16:17], v1 offset:6144
  ds_read_b64_tr_b16 a[18:19], v1 offset:7680
  v_mfma_f32_16x16x32_bf16 v[232:235], a[28:31], a[208:211], v[232:235]
  v_xor_b32 v7, 3, v2
  v_min_u32 v7, 1, v7
  v_mfma_f32_16x16x32_bf16 v[236:239], a[24:27], a[196:199], v[236:239]
  v_subrev_u32 v7, 1, v7
  v_and_b32 v7, v3, v7
  v_mfma_f32_16x16x32_bf16 v[236:239], a[28:31], a[212:215], v[236:239]
  v_cmp_le_i32 s[0:1], 0, v8
  v_cmp_le_i32 s[2:3], 1, v8
  v_mfma_f32_16x16x32_bf16 v[168:171], a[24:27], a[200:203], v[168:171]
  ds_read_b64_tr_b16 a[20:21], v1 offset:9216
  ds_read_b64_tr_b16 a[22:23], v1 offset:10752
  v_mfma_f32_16x16x32_bf16 v[168:171], a[28:31], a[216:219], v[168:171]
  s_add_u32 m0, s89, 99328
  s_add_u32 s85, s87, 3801088
  v_cmp_le_i32 s[6:7], 3, v8
  v_mfma_f32_16x16x32_bf16 v[172:175], a[24:27], a[204:207], v[172:175]
  v_cmp_le_i32 s[8:9], 16, v8
  v_cmp_le_i32 s[18:19], 33, v8
  v_mfma_f32_16x16x32_bf16 v[172:175], a[28:31], a[220:223], v[172:175]
  s_waitcnt lgkmcnt(8)
  v_cmp_le_i32 s[20:21], 34, v8
  v_cmp_le_i32 s[22:23], 35, v8
  v_mfma_f32_16x16x32_bf16 v[240:243], a[32:35], a[192:195], v[240:243]
  ds_read_b64_tr_b16 a[24:25], v1 offset:32
  ds_read_b64_tr_b16 a[26:27], v1 offset:1568
  v_mfma_f32_16x16x32_bf16 v[240:243], a[36:39], a[208:211], v[240:243]
  buffer_load_dwordx4 v15, s[40:43], s85 offen lds
  v_mfma_f32_16x16x32_bf16 v[244:247], a[32:35], a[196:199], v[244:247]
  v_cmp_le_i32 s[24:25], 48, v8
  v_cmp_le_i32 s[26:27], 49, v8
  v_mfma_f32_16x16x32_bf16 v[244:247], a[36:39], a[212:215], v[244:247]
  v_cmp_le_i32 s[28:29], 50, v8
  v_cmp_le_i32 s[30:31], 51, v8
  v_mfma_f32_16x16x32_bf16 v[176:179], a[32:35], a[200:203], v[176:179]
  ds_read_b64_tr_b16 a[28:29], v1 offset:3104
  ds_read_b64_tr_b16 a[30:31], v1 offset:4640
  v_mfma_f32_16x16x32_bf16 v[176:179], a[36:39], a[216:219], v[176:179]
  buffer_store_dwordx4 a[52:55], v24, s[68:71], s12 offen offset:0 sc1
  v_mfma_f32_16x16x32_bf16 v[180:183], a[32:35], a[204:207], v[180:183]
  v_mfma_f32_16x16x32_bf16 v[180:183], a[36:39], a[220:223], v[180:183]
  v_mfma_f32_16x16x32_bf16 v[248:251], a[0:3], a[192:195], v[248:251]
  ds_read_b64_tr_b16 a[32:33], v1 offset:6176
  ds_read_b64_tr_b16 a[34:35], v1 offset:7712
  v_mfma_f32_16x16x32_bf16 v[248:251], a[4:7], a[208:211], v[248:251]
  v_mfma_f32_16x16x32_bf16 v[252:255], a[0:3], a[196:199], v[252:255]
  v_mfma_f32_16x16x32_bf16 v[252:255], a[4:7], a[212:215], v[252:255]
  s_add_u32 m0, s89, 100352
  s_add_u32 s85, s87, 3702784
  v_mfma_f32_16x16x32_bf16 v[184:187], a[0:3], a[200:203], v[184:187]
  ds_read_b64_tr_b16 a[36:37], v1 offset:9248
  ds_read_b64_tr_b16 a[38:39], v1 offset:10784
  v_mfma_f32_16x16x32_bf16 v[184:187], a[4:7], a[216:219], v[184:187]
  buffer_load_dwordx4 v15, s[40:43], s85 offen lds
  v_mfma_f32_16x16x32_bf16 v[188:191], a[0:3], a[204:207], v[188:191]
  v_mfma_f32_16x16x32_bf16 v[188:191], a[4:7], a[220:223], v[188:191]
  s_add_u32 s85, s4, 14336
  s_waitcnt vmcnt(8) lgkmcnt(8)
  v_mfma_f32_16x16x32_bf16 v[32:35], a[8:11], a[160:163], v[32:35]
  ds_read_b64_tr_b16 a[0:1], v1 offset:64
  ds_read_b64_tr_b16 a[2:3], v1 offset:1600
  v_mfma_f32_16x16x32_bf16 v[32:35], a[12:15], a[176:179], v[32:35]
  buffer_load_dwordx4 a[192:195], v12, s[68:71], s85 offen sc1
  v_mfma_f32_16x16x32_bf16 v[36:39], a[8:11], a[164:167], v[36:39]
  v_mfma_f32_16x16x32_bf16 v[36:39], a[12:15], a[180:183], v[36:39]
  v_mfma_f32_16x16x32_bf16 v[40:43], a[8:11], a[168:171], v[40:43]
  ds_read_b64_tr_b16 a[4:5], v1 offset:3136
  ds_read_b64_tr_b16 a[6:7], v1 offset:4672
  v_mfma_f32_16x16x32_bf16 v[40:43], a[12:15], a[184:187], v[40:43]
  s_add_u32 s85, s4, 79872
  v_mfma_f32_16x16x32_bf16 v[44:47], a[8:11], a[172:175], v[44:47]
  v_mfma_f32_16x16x32_bf16 v[44:47], a[12:15], a[188:191], v[44:47]
  buffer_load_dwordx4 a[196:199], v12, s[68:71], s85 offen sc1
  v_mfma_f32_16x16x32_bf16 v[48:51], a[16:19], a[160:163], v[48:51]
  ds_read_b64_tr_b16 a[8:9], v1 offset:6208
  ds_read_b64_tr_b16 a[10:11], v1 offset:7744
  v_mfma_f32_16x16x32_bf16 v[48:51], a[20:23], a[176:179], v[48:51]
  s_add_u32 m0, s89, 101376
  s_add_u32 s85, s87, 3833856
  v_mfma_f32_16x16x32_bf16 v[52:55], a[16:19], a[164:167], v[52:55]
  v_mfma_f32_16x16x32_bf16 v[52:55], a[20:23], a[180:183], v[52:55]
  buffer_load_dwordx4 v15, s[40:43], s85 offen lds
  v_mfma_f32_16x16x32_bf16 v[56:59], a[16:19], a[168:171], v[56:59]
  s_bfe_u32 s40, s79, 0x20001
  ds_read_b64_tr_b16 a[12:13], v1 offset:9280
  ds_read_b64_tr_b16 a[14:15], v1 offset:10816
  v_mfma_f32_16x16x32_bf16 v[56:59], a[20:23], a[184:187], v[56:59]
  s_and_b32 s80, s79, 1
  s_lshl_b32 s80, s80, 3
  s_mov_b32 s81, s78
  v_mfma_f32_16x16x32_bf16 v[60:63], a[16:19], a[172:175], v[60:63]
  s_add_u32 s80, s80, s81
  s_sub_u32 s81, 15, s80
  s_min_u32 s81, s80, s81
  v_mfma_f32_16x16x32_bf16 v[60:63], a[20:23], a[188:191], v[60:63]
  s_lshl_b32 s81, s81, 7
  s_add_u32 s89, s81, 67112960
  s_waitcnt lgkmcnt(8)
  v_mfma_f32_16x16x32_bf16 v[64:67], a[24:27], a[160:163], v[64:67]
  ds_read_b64_tr_b16 a[16:17], v20 offset:0
  ds_read_b64_tr_b16 a[18:19], v20 offset:2048
  v_mfma_f32_16x16x32_bf16 v[64:67], a[28:31], a[176:179], v[64:67]
  buffer_store_dwordx4 a[56:59], v12, s[68:71], s13 offen offset:0 sc1
  v_mfma_f32_16x16x32_bf16 v[68:71], a[24:27], a[164:167], v[68:71]
  s_add_u32 s85, s5, 14336
  v_and_b32 v27, 31, v0
  v_lshlrev_b32 v27, 2, v27
  v_mfma_f32_16x16x32_bf16 v[68:71], a[28:31], a[180:183], v[68:71]
  s_add_u32 s81, s40, 1
  v_add_u32 v28, s81, v0
  v_and_b32 v28, 3, v28
  v_mfma_f32_16x16x32_bf16 v[72:75], a[24:27], a[168:171], v[72:75]
  ds_read_b64_tr_b16 a[20:21], v20 offset:4096
  ds_read_b64_tr_b16 a[22:23], v20 offset:6144
  v_mfma_f32_16x16x32_bf16 v[72:75], a[28:31], a[184:187], v[72:75]
  buffer_load_dwordx4 a[200:203], v12, s[68:71], s85 offen sc1
  v_mfma_f32_16x16x32_bf16 v[76:79], a[24:27], a[172:175], v[76:79]
  s_add_u32 s85, s5, 79872
  v_lshlrev_b32 v28, 3, v28
  v_and_b32 v26, 4, v0
  v_mfma_f32_16x16x32_bf16 v[76:79], a[28:31], a[188:191], v[76:79]
  v_add_u32 v28, v28, v26
  v_add_u32 v28, s40, v28
  v_mfma_f32_16x16x32_bf16 v[80:83], a[32:35], a[160:163], v[80:83]
  ds_read_b64_tr_b16 a[24:25], v21 offset:0
  ds_read_b64_tr_b16 a[26:27], v21 offset:2048
  v_mfma_f32_16x16x32_bf16 v[80:83], a[36:39], a[176:179], v[80:83]
  buffer_load_dwordx4 a[204:207], v12, s[68:71], s85 offen sc1
  v_mfma_f32_16x16x32_bf16 v[84:87], a[32:35], a[164:167], v[84:87]
  s_add_u32 s85, s4, 15360
  v_lshlrev_b32 v28, 2, v28
  s_lshl_b32 s41, s80, 3
  v_mfma_f32_16x16x32_bf16 v[84:87], a[36:39], a[180:183], v[84:87]
  s_lshr_b32 s81, s76, 1
  s_lshl_b32 s81, s81, 2
  s_add_u32 s80, s41, s81
  v_mfma_f32_16x16x32_bf16 v[88:91], a[32:35], a[168:171], v[88:91]
  s_mul_i32 s80, s80, 176128
  ds_read_b64_tr_b16 a[28:29], v21 offset:4096
  ds_read_b64_tr_b16 a[30:31], v21 offset:6144
  v_mfma_f32_16x16x32_bf16 v[88:91], a[36:39], a[184:187], v[88:91]
  buffer_load_dwordx4 a[208:211], v12, s[68:71], s85 offen sc1
  v_mfma_f32_16x16x32_bf16 v[92:95], a[32:35], a[172:175], v[92:95]
  s_add_u32 s85, s4, 80896
  s_add_u32 s58, s80, 2094080
  s_mul_i32 s81, s40, 11264
  v_mfma_f32_16x16x32_bf16 v[92:95], a[36:39], a[188:191], v[92:95]
  s_add_u32 s86, s58, s81
  s_add_u32 s86, s86, 131072
  s_waitcnt lgkmcnt(8)
  v_mfma_f32_16x16x32_bf16 v[96:99], a[0:3], a[160:163], v[96:99]
  s_andn2_b32 s80, 3, s77
  ds_read_b64_tr_b16 a[32:33], v22 offset:0
  ds_read_b64_tr_b16 a[34:35], v22 offset:2048
  v_mfma_f32_16x16x32_bf16 v[96:99], a[4:7], a[176:179], v[96:99]
  buffer_load_dwordx4 a[212:215], v12, s[68:71], s85 offen sc1
  v_mfma_f32_16x16x32_bf16 v[100:103], a[0:3], a[164:167], v[100:103]
  s_lshl_b32 s80, s80, 8
  s_lshr_b32 s81, s76, 1
  s_lshl_b32 s81, s81, 7
  v_mfma_f32_16x16x32_bf16 v[100:103], a[4:7], a[180:183], v[100:103]
  s_add_u32 s85, s5, 15360
  s_add_u32 s80, s80, s81
  s_and_b32 s81, s76, 1
  v_mfma_f32_16x16x32_bf16 v[104:107], a[0:3], a[168:171], v[104:107]
  s_lshl_b32 s81, s81, 13
  ds_read_b64_tr_b16 a[36:37], v22 offset:4096
  ds_read_b64_tr_b16 a[38:39], v22 offset:6144
  v_mfma_f32_16x16x32_bf16 v[104:107], a[4:7], a[184:187], v[104:107]
  buffer_load_dwordx4 a[216:219], v12, s[68:71], s85 offen sc1
  v_mfma_f32_16x16x32_bf16 v[108:111], a[0:3], a[172:175], v[108:111]
  s_add_u32 s57, s80, s81
  s_mul_i32 s81, s40, 360448
  s_add_u32 s87, s57, s81
  v_mfma_f32_16x16x32_bf16 v[108:111], a[4:7], a[188:191], v[108:111]
  s_and_b32 s81, s76, 1
  s_lshl_b32 s81, s81, 13
  s_add_u32 s57, s57, s81
  v_mfma_f32_16x16x32_bf16 v[112:115], a[8:11], a[160:163], v[112:115]
  ds_read_b64_tr_b16 a[0:1], v23 offset:0
  ds_read_b64_tr_b16 a[2:3], v23 offset:2048
  v_mfma_f32_16x16x32_bf16 v[112:115], a[12:15], a[176:179], v[112:115]
  buffer_store_dwordx4 a[60:63], v24, s[68:71], s13 offen offset:0 sc1
  v_mfma_f32_16x16x32_bf16 v[116:119], a[8:11], a[164:167], v[116:119]
  s_add_u32 s85, s5, 80896
  v_add_u32 v15, 7168, v16
  v_add_u32 v26, 15360, v16
  v_mfma_f32_16x16x32_bf16 v[116:119], a[12:15], a[180:183], v[116:119]
  s_lshl_b32 s88, s76, 12
  s_lshr_b32 s80, s76, 1
  s_lshl_b32 s80, s80, 13
  v_mfma_f32_16x16x32_bf16 v[120:123], a[8:11], a[168:171], v[120:123]
  s_sub_u32 s43, s80, 98304
  ds_read_b64_tr_b16 a[4:5], v23 offset:4096
  ds_read_b64_tr_b16 a[6:7], v23 offset:6144
  v_mfma_f32_16x16x32_bf16 v[120:123], a[12:15], a[184:187], v[120:123]
  buffer_load_dwordx4 a[220:223], v12, s[68:71], s85 offen sc1
  v_mfma_f32_16x16x32_bf16 v[124:127], a[8:11], a[172:175], v[124:127]
  s_and_b32 s80, s76, 1
  s_lshl_b32 s80, s80, 13
  s_add_u32 s59, s80, 2048
  v_mfma_f32_16x16x32_bf16 v[124:127], a[12:15], a[188:191], v[124:127]
  s_cmp_eq_u32 s40, 3
  s_cselect_b32 s56, 1073741824, 0
  s_waitcnt lgkmcnt(8)
  v_mfma_f32_16x16x32_bf16 v[192:195], a[16:19], a[128:131], v[192:195]
  s_and_b32 s80, s79, 1
  ds_read_b64_tr_b16 a[8:9], v20 offset:8192
  ds_read_b64_tr_b16 a[10:11], v20 offset:10240
  v_mfma_f32_16x16x32_bf16 v[192:195], a[20:23], a[144:147], v[192:195]
  s_lshl_b32 s80, s80, 5
  s_lshr_b32 s81, s79, 3
  s_add_u32 s80, s80, s81
  v_mfma_f32_16x16x32_bf16 v[196:199], a[16:19], a[132:135], v[196:199]
  s_lshl_b32 s81, s80, 7
  s_add_u32 s75, s81, 67117056
  s_mul_i32 s80, s80, 98304
  v_mfma_f32_16x16x32_bf16 v[196:199], a[20:23], a[148:151], v[196:199]
  s_lshl_b32 s81, s76, 11
  s_add_u32 s80, s80, s81
  s_add_u32 s80, s80, 25165824
  v_mfma_f32_16x16x32_bf16 v[128:131], a[16:19], a[136:139], v[128:131]
  s_add_u32 s81, s40, 1
  ds_read_b64_tr_b16 a[12:13], v20 offset:12288
  ds_read_b64_tr_b16 a[14:15], v20 offset:14336
  v_mfma_f32_16x16x32_bf16 v[128:131], a[20:23], a[152:155], v[128:131]
  s_and_b32 s81, s81, 3
  s_mul_i32 s81, s81, 24576
  s_add_u32 s81, s81, 0
  v_mfma_f32_16x16x32_bf16 v[132:135], a[16:19], a[140:143], v[132:135]
  s_add_u32 s72, s80, s81
  s_add_u32 s81, s40, 2
  s_and_b32 s81, s81, 3
  v_mfma_f32_16x16x32_bf16 v[132:135], a[20:23], a[156:159], v[132:135]
  s_mul_i32 s81, s81, 24576
  s_add_u32 s81, s81, 8192
  s_add_u32 s73, s80, s81
  v_mfma_f32_16x16x32_bf16 v[200:203], a[24:27], a[128:131], v[200:203]
  s_add_u32 s81, s40, 3
  ds_read_b64_tr_b16 a[16:17], v21 offset:8192
  ds_read_b64_tr_b16 a[18:19], v21 offset:10240
  v_mfma_f32_16x16x32_bf16 v[200:203], a[28:31], a[144:147], v[200:203]
  s_and_b32 s81, s81, 3
  s_mul_i32 s81, s81, 24576
  s_add_u32 s81, s81, 16384
  v_mfma_f32_16x16x32_bf16 v[204:207], a[24:27], a[132:135], v[204:207]
  s_add_u32 s74, s80, s81
  v_cmp_le_i32 s[4:5], 2, v8
  v_mfma_f32_16x16x32_bf16 v[204:207], a[28:31], a[148:151], v[204:207]
  v_mfma_f32_16x16x32_bf16 v[136:139], a[24:27], a[136:139], v[136:139]
  ds_read_b64_tr_b16 a[20:21], v21 offset:12288
  ds_read_b64_tr_b16 a[22:23], v21 offset:14336
  v_mfma_f32_16x16x32_bf16 v[136:139], a[28:31], a[152:155], v[136:139]
  v_mfma_f32_16x16x32_bf16 v[140:143], a[24:27], a[140:143], v[140:143]
  v_mfma_f32_16x16x32_bf16 v[140:143], a[28:31], a[156:159], v[140:143]
  s_waitcnt lgkmcnt(8)
  v_mfma_f32_16x16x32_bf16 v[208:211], a[32:35], a[128:131], v[208:211]
  ds_read_b64_tr_b16 a[24:25], v22 offset:8192
  ds_read_b64_tr_b16 a[26:27], v22 offset:10240
  v_mfma_f32_16x16x32_bf16 v[208:211], a[36:39], a[144:147], v[208:211]
  v_mfma_f32_16x16x32_bf16 v[212:215], a[32:35], a[132:135], v[212:215]
  v_mfma_f32_16x16x32_bf16 v[212:215], a[36:39], a[148:151], v[212:215]
  v_mfma_f32_16x16x32_bf16 v[144:147], a[32:35], a[136:139], v[144:147]
  ds_read_b64_tr_b16 a[28:29], v22 offset:12288
  ds_read_b64_tr_b16 a[30:31], v22 offset:14336
  v_mfma_f32_16x16x32_bf16 v[144:147], a[36:39], a[152:155], v[144:147]
  buffer_store_dwordx4 a[76:79], v12, s[68:71], s12 offen offset:1024 sc1
  v_mfma_f32_16x16x32_bf16 v[148:151], a[32:35], a[140:143], v[148:151]
  v_mfma_f32_16x16x32_bf16 v[148:151], a[36:39], a[156:159], v[148:151]
  v_mfma_f32_16x16x32_bf16 v[216:219], a[0:3], a[128:131], v[216:219]
  ds_read_b64_tr_b16 a[32:33], v23 offset:8192
  ds_read_b64_tr_b16 a[34:35], v23 offset:10240
  v_mfma_f32_16x16x32_bf16 v[216:219], a[4:7], a[144:147], v[216:219]
  v_mfma_f32_16x16x32_bf16 v[220:223], a[0:3], a[132:135], v[220:223]
  v_mfma_f32_16x16x32_bf16 v[220:223], a[4:7], a[148:151], v[220:223]
  v_mfma_f32_16x16x32_bf16 v[152:155], a[0:3], a[136:139], v[152:155]
  ds_read_b64_tr_b16 a[36:37], v23 offset:12288
  ds_read_b64_tr_b16 a[38:39], v23 offset:14336
  v_mfma_f32_16x16x32_bf16 v[152:155], a[4:7], a[152:155], v[152:155]
  v_mfma_f32_16x16x32_bf16 v[156:159], a[0:3], a[140:143], v[156:159]
  v_mfma_f32_16x16x32_bf16 v[156:159], a[4:7], a[156:159], v[156:159]
  s_waitcnt vmcnt(17)
  v_add_u32 v1, 131072, v1
  s_barrier
  s_waitcnt lgkmcnt(8)
  v_mfma_f32_16x16x32_bf16 v[224:227], a[8:11], a[128:131], v[224:227]
  ds_read_b64_tr_b16 a[0:1], v1 offset:64
  ds_read_b64_tr_b16 a[2:3], v1 offset:1600
  v_mfma_f32_16x16x32_bf16 v[224:227], a[12:15], a[144:147], v[224:227]
  v_add_u32 v20, 131072, v20
  v_mov_b32 v13, 1
  v_mfma_f32_16x16x32_bf16 v[228:231], a[8:11], a[132:135], v[228:231]
  buffer_store_dword v13, v17, s[68:71], s47 offen sc1
  v_mfma_f32_16x16x32_bf16 v[228:231], a[12:15], a[148:151], v[228:231]
  v_add_u32 v21, 131072, v21
  v_mfma_f32_16x16x32_bf16 v[160:163], a[8:11], a[136:139], v[160:163]
  ds_read_b64_tr_b16 a[4:5], v1 offset:3136
  ds_read_b64_tr_b16 a[6:7], v1 offset:4672
  v_mfma_f32_16x16x32_bf16 v[160:163], a[12:15], a[152:155], v[160:163]
  v_add_u32 v22, 131072, v22
  v_mfma_f32_16x16x32_bf16 v[164:167], a[8:11], a[140:143], v[164:167]
  v_mfma_f32_16x16x32_bf16 v[164:167], a[12:15], a[156:159], v[164:167]
  v_add_u32 v23, 131072, v23
  v_mfma_f32_16x16x32_bf16 v[232:235], a[16:19], a[128:131], v[232:235]
  ds_read_b64_tr_b16 a[8:9], v1 offset:6208
  ds_read_b64_tr_b16 a[10:11], v1 offset:7744
  v_mfma_f32_16x16x32_bf16 v[232:235], a[20:23], a[144:147], v[232:235]
  v_mfma_f32_16x16x32_bf16 v[236:239], a[16:19], a[132:135], v[236:239]
  v_mfma_f32_16x16x32_bf16 v[236:239], a[20:23], a[148:151], v[236:239]
  v_mfma_f32_16x16x32_bf16 v[168:171], a[16:19], a[136:139], v[168:171]
  ds_read_b64_tr_b16 a[12:13], v1 offset:9280
  ds_read_b64_tr_b16 a[14:15], v1 offset:10816
  v_mfma_f32_16x16x32_bf16 v[168:171], a[20:23], a[152:155], v[168:171]
  v_mfma_f32_16x16x32_bf16 v[172:175], a[16:19], a[140:143], v[172:175]
  v_mfma_f32_16x16x32_bf16 v[172:175], a[20:23], a[156:159], v[172:175]
  s_waitcnt lgkmcnt(8)
  v_mfma_f32_16x16x32_bf16 v[240:243], a[24:27], a[128:131], v[240:243]
  ds_read_b64_tr_b16 a[16:17], v1 offset:0
  ds_read_b64_tr_b16 a[18:19], v1 offset:1536
  v_mfma_f32_16x16x32_bf16 v[240:243], a[28:31], a[144:147], v[240:243]
  buffer_store_dwordx4 a[80:83], v24, s[68:71], s12 offen offset:1024 sc1
  v_mfma_f32_16x16x32_bf16 v[244:247], a[24:27], a[132:135], v[244:247]
  v_mfma_f32_16x16x32_bf16 v[244:247], a[28:31], a[148:151], v[244:247]
  v_mfma_f32_16x16x32_bf16 v[176:179], a[24:27], a[136:139], v[176:179]
  ds_read_b64_tr_b16 a[20:21], v1 offset:3072
  ds_read_b64_tr_b16 a[22:23], v1 offset:4608
  v_mfma_f32_16x16x32_bf16 v[176:179], a[28:31], a[152:155], v[176:179]
  v_mfma_f32_16x16x32_bf16 v[180:183], a[24:27], a[140:143], v[180:183]
  v_mfma_f32_16x16x32_bf16 v[180:183], a[28:31], a[156:159], v[180:183]
  v_mfma_f32_16x16x32_bf16 v[248:251], a[32:35], a[128:131], v[248:251]
  ds_read_b64_tr_b16 a[24:25], v1 offset:6144
  ds_read_b64_tr_b16 a[26:27], v1 offset:7680
  v_mfma_f32_16x16x32_bf16 v[248:251], a[36:39], a[144:147], v[248:251]
  v_mfma_f32_16x16x32_bf16 v[252:255], a[32:35], a[132:135], v[252:255]
  v_mfma_f32_16x16x32_bf16 v[252:255], a[36:39], a[148:151], v[252:255]
  v_mfma_f32_16x16x32_bf16 v[184:187], a[32:35], a[136:139], v[184:187]
  ds_read_b64_tr_b16 a[28:29], v1 offset:9216
  ds_read_b64_tr_b16 a[30:31], v1 offset:10752
  v_mfma_f32_16x16x32_bf16 v[184:187], a[36:39], a[152:155], v[184:187]
  v_mfma_f32_16x16x32_bf16 v[188:191], a[32:35], a[140:143], v[188:191]
  v_mfma_f32_16x16x32_bf16 v[188:191], a[36:39], a[156:159], v[188:191]
  s_waitcnt vmcnt(3) lgkmcnt(8)
  v_mfma_f32_16x16x32_bf16 v[96:99], a[0:3], a[192:195], v[96:99]
  ds_read_b64_tr_b16 a[32:33], v1 offset:32
  ds_read_b64_tr_b16 a[34:35], v1 offset:1568
  v_mfma_f32_16x16x32_bf16 v[96:99], a[4:7], a[208:211], v[96:99]
  v_mfma_f32_16x16x32_bf16 v[100:103], a[0:3], a[196:199], v[100:103]
  v_mfma_f32_16x16x32_bf16 v[100:103], a[4:7], a[212:215], v[100:103]
  v_mfma_f32_16x16x32_bf16 v[104:107], a[0:3], a[200:203], v[104:107]
  ds_read_b64_tr_b16 a[36:37], v1 offset:3104
  ds_read_b64_tr_b16 a[38:39], v1 offset:4640
  v_mfma_f32_16x16x32_bf16 v[104:107], a[4:7], a[216:219], v[104:107]
  v_mfma_f32_16x16x32_bf16 v[108:111], a[0:3], a[204:207], v[108:111]
  v_mfma_f32_16x16x32_bf16 v[108:111], a[4:7], a[220:223], v[108:111]
  v_mfma_f32_16x16x32_bf16 v[112:115], a[8:11], a[192:195], v[112:115]
  ds_read_b64_tr_b16 a[0:1], v1 offset:6176
  ds_read_b64_tr_b16 a[2:3], v1 offset:7712
  v_mfma_f32_16x16x32_bf16 v[112:115], a[12:15], a[208:211], v[112:115]
  v_mfma_f32_16x16x32_bf16 v[116:119], a[8:11], a[196:199], v[116:119]
  v_mfma_f32_16x16x32_bf16 v[116:119], a[12:15], a[212:215], v[116:119]
  v_mfma_f32_16x16x32_bf16 v[120:123], a[8:11], a[200:203], v[120:123]
  ds_read_b64_tr_b16 a[4:5], v1 offset:9248
  ds_read_b64_tr_b16 a[6:7], v1 offset:10784
  v_mfma_f32_16x16x32_bf16 v[120:123], a[12:15], a[216:219], v[120:123]
  buffer_store_dwordx4 a[84:87], v24, s[68:71], s13 offen offset:1024 sc1
  v_mfma_f32_16x16x32_bf16 v[124:127], a[8:11], a[204:207], v[124:127]
  v_mfma_f32_16x16x32_bf16 v[124:127], a[12:15], a[220:223], v[124:127]
  s_waitcnt lgkmcnt(8)
  v_mfma_f32_16x16x32_bf16 v[32:35], a[16:19], a[192:195], v[32:35]
  ds_read_b64_tr_b16 a[8:9], v20 offset:0
  ds_read_b64_tr_b16 a[10:11], v20 offset:2048
  v_mfma_f32_16x16x32_bf16 v[32:35], a[20:23], a[208:211], v[32:35]
  v_mfma_f32_16x16x32_bf16 v[36:39], a[16:19], a[196:199], v[36:39]
  v_mfma_f32_16x16x32_bf16 v[36:39], a[20:23], a[212:215], v[36:39]
  v_mul_f32 v96, s83, v96
  v_mul_f32 v97, s83, v97
  v_mfma_f32_16x16x32_bf16 v[40:43], a[16:19], a[200:203], v[40:43]
  ds_read_b64_tr_b16 a[12:13], v20 offset:4096
  ds_read_b64_tr_b16 a[14:15], v20 offset:6144
  v_mfma_f32_16x16x32_bf16 v[40:43], a[20:23], a[216:219], v[40:43]
  v_mul_f32 v98, s83, v98
  v_mul_f32 v99, s83, v99
  v_mfma_f32_16x16x32_bf16 v[44:47], a[16:19], a[204:207], v[44:47]
  v_mul_f32 v100, s83, v100
  v_mul_f32 v101, s83, v101
  v_mfma_f32_16x16x32_bf16 v[44:47], a[20:23], a[220:223], v[44:47]
  v_mul_f32 v102, s83, v102
  v_mul_f32 v103, s83, v103
  v_mfma_f32_16x16x32_bf16 v[48:51], a[24:27], a[192:195], v[48:51]
  ds_read_b64_tr_b16 a[16:17], v21 offset:0
  ds_read_b64_tr_b16 a[18:19], v21 offset:2048
  v_mfma_f32_16x16x32_bf16 v[48:51], a[28:31], a[208:211], v[48:51]
  v_exp_f32 v96, v96
  v_mfma_f32_16x16x32_bf16 v[52:55], a[24:27], a[196:199], v[52:55]
  v_exp_f32 v97, v97
  v_mfma_f32_16x16x32_bf16 v[52:55], a[28:31], a[212:215], v[52:55]
  v_exp_f32 v98, v98
  v_mfma_f32_16x16x32_bf16 v[56:59], a[24:27], a[200:203], v[56:59]
  ds_read_b64_tr_b16 a[20:21], v21 offset:4096
  ds_read_b64_tr_b16 a[22:23], v21 offset:6144
  v_mfma_f32_16x16x32_bf16 v[56:59], a[28:31], a[216:219], v[56:59]
  v_exp_f32 v99, v99
  v_mfma_f32_16x16x32_bf16 v[60:63], a[24:27], a[204:207], v[60:63]
  v_exp_f32 v100, v100
  v_mfma_f32_16x16x32_bf16 v[60:63], a[28:31], a[220:223], v[60:63]
  s_waitcnt lgkmcnt(8)
  v_exp_f32 v101, v101
  v_mfma_f32_16x16x32_bf16 v[64:67], a[32:35], a[192:195], v[64:67]
  ds_read_b64_tr_b16 a[24:25], v22 offset:0
  ds_read_b64_tr_b16 a[26:27], v22 offset:2048
  v_mfma_f32_16x16x32_bf16 v[64:67], a[36:39], a[208:211], v[64:67]
  v_exp_f32 v102, v102
  v_mfma_f32_16x16x32_bf16 v[68:71], a[32:35], a[196:199], v[68:71]
  v_exp_f32 v103, v103
  v_mfma_f32_16x16x32_bf16 v[68:71], a[36:39], a[212:215], v[68:71]
  v_add_f32 v96, 1.0, v96
  v_add_f32 v97, 1.0, v97
  v_mfma_f32_16x16x32_bf16 v[72:75], a[32:35], a[200:203], v[72:75]
  ds_read_b64_tr_b16 a[28:29], v22 offset:4096
  ds_read_b64_tr_b16 a[30:31], v22 offset:6144
  v_mfma_f32_16x16x32_bf16 v[72:75], a[36:39], a[216:219], v[72:75]
  v_add_f32 v98, 1.0, v98
  v_add_f32 v99, 1.0, v99
  v_mfma_f32_16x16x32_bf16 v[76:79], a[32:35], a[204:207], v[76:79]
L_hop8:
  s_cbranch_execz L_hop12
  v_add_f32 v100, 1.0, v100
  v_add_f32 v101, 1.0, v101
  v_mfma_f32_16x16x32_bf16 v[76:79], a[36:39], a[220:223], v[76:79]
  v_add_f32 v102, 1.0, v102
  v_add_f32 v103, 1.0, v103
  v_mfma_f32_16x16x32_bf16 v[80:83], a[0:3], a[192:195], v[80:83]
  ds_read_b64_tr_b16 a[32:33], v23 offset:0
  ds_read_b64_tr_b16 a[34:35], v23 offset:2048
  v_mfma_f32_16x16x32_bf16 v[80:83], a[4:7], a[208:211], v[80:83]
  buffer_store_dwordx4 a[112:115], v12, s[68:71], s16 offen offset:0 sc1
  v_mfma_f32_16x16x32_bf16 v[84:87], a[0:3], a[196:199], v[84:87]
  v_rcp_f32 v96, v96
  v_mfma_f32_16x16x32_bf16 v[84:87], a[4:7], a[212:215], v[84:87]
  v_rcp_f32 v97, v97
  v_mfma_f32_16x16x32_bf16 v[88:91], a[0:3], a[200:203], v[88:91]
  ds_read_b64_tr_b16 a[36:37], v23 offset:4096
  ds_read_b64_tr_b16 a[38:39], v23 offset:6144
  v_mfma_f32_16x16x32_bf16 v[88:91], a[4:7], a[216:219], v[88:91]
  v_rcp_f32 v98, v98
  v_mfma_f32_16x16x32_bf16 v[92:95], a[0:3], a[204:207], v[92:95]
  v_rcp_f32 v99, v99
  v_mfma_f32_16x16x32_bf16 v[92:95], a[4:7], a[220:223], v[92:95]
  s_waitcnt lgkmcnt(8)
  v_rcp_f32 v100, v100
  v_mfma_f32_16x16x32_bf16 v[192:195], a[8:11], a[160:163], v[192:195]
  ds_read_b64_tr_b16 a[0:1], v20 offset:8192
  ds_read_b64_tr_b16 a[2:3], v20 offset:10240
  v_mfma_f32_16x16x32_bf16 v[192:195], a[12:15], a[176:179], v[192:195]
  v_rcp_f32 v101, v101
  v_mfma_f32_16x16x32_bf16 v[196:199], a[8:11], a[164:167], v[196:199]
  v_rcp_f32 v102, v102
  v_mfma_f32_16x16x32_bf16 v[196:199], a[12:15], a[180:183], v[196:199]
  v_rcp_f32 v103, v103
  v_mfma_f32_16x16x32_bf16 v[128:131], a[8:11], a[168:171], v[128:131]
  ds_read_b64_tr_b16 a[4:5], v20 offset:12288
  ds_read_b64_tr_b16 a[6:7], v20 offset:14336
  v_mfma_f32_16x16x32_bf16 v[128:131], a[12:15], a[184:187], v[128:131]
  v_mul_f32 v96, v96, v112
  v_mul_f32 v97, v97, v113
  v_mfma_f32_16x16x32_bf16 v[132:135], a[8:11], a[172:175], v[132:135]
  v_mul_f32 v98, v98, v114
  v_mul_f32 v99, v99, v115
  v_mfma_f32_16x16x32_bf16 v[132:135], a[12:15], a[188:191], v[132:135]
  v_mul_f32 v100, v100, v116
  v_mul_f32 v101, v101, v117
  v_mfma_f32_16x16x32_bf16 v[200:203], a[16:19], a[160:163], v[200:203]
  ds_read_b64_tr_b16 a[8:9], v21 offset:8192
  ds_read_b64_tr_b16 a[10:11], v21 offset:10240
  v_mfma_f32_16x16x32_bf16 v[200:203], a[20:23], a[176:179], v[200:203]
  v_mul_f32 v102, v102, v118
  v_mul_f32 v103, v103, v119
  v_mfma_f32_16x16x32_bf16 v[204:207], a[16:19], a[164:167], v[204:207]
  v_cvt_pk_bf16_f32 v112, v96, v97
  v_cvt_pk_bf16_f32 v113, v98, v99
  v_mfma_f32_16x16x32_bf16 v[204:207], a[20:23], a[180:183], v[204:207]
  v_cvt_pk_bf16_f32 v114, v100, v101
  v_cvt_pk_bf16_f32 v115, v102, v103
  v_mfma_f32_16x16x32_bf16 v[136:139], a[16:19], a[168:171], v[136:139]
  ds_read_b64_tr_b16 a[12:13], v21 offset:12288
  ds_read_b64_tr_b16 a[14:15], v21 offset:14336
  v_mfma_f32_16x16x32_bf16 v[136:139], a[20:23], a[184:187], v[136:139]
  v_permlane32_swap_b32 v112, v114
  v_mfma_f32_16x16x32_bf16 v[140:143], a[16:19], a[172:175], v[140:143]
  v_permlane32_swap_b32 v113, v115
  v_mfma_f32_16x16x32_bf16 v[140:143], a[20:23], a[188:191], v[140:143]
  s_waitcnt lgkmcnt(8)
  v_mul_f32 v104, s83, v104
  v_mul_f32 v105, s83, v105
  v_mfma_f32_16x16x32_bf16 v[208:211], a[24:27], a[160:163], v[208:211]
  ds_read_b64_tr_b16 a[16:17], v22 offset:8192
  ds_read_b64_tr_b16 a[18:19], v22 offset:10240
  v_mfma_f32_16x16x32_bf16 v[208:211], a[28:31], a[176:179], v[208:211]
  v_mul_f32 v106, s83, v106
  v_mul_f32 v107, s83, v107
  v_mfma_f32_16x16x32_bf16 v[212:215], a[24:27], a[164:167], v[212:215]
  v_mul_f32 v108, s83, v108
  v_mul_f32 v109, s83, v109
  v_mfma_f32_16x16x32_bf16 v[212:215], a[28:31], a[180:183], v[212:215]
  v_mul_f32 v110, s83, v110
  v_mul_f32 v111, s83, v111
  v_mfma_f32_16x16x32_bf16 v[144:147], a[24:27], a[168:171], v[144:147]
  ds_read_b64_tr_b16 a[20:21], v22 offset:12288
  ds_read_b64_tr_b16 a[22:23], v22 offset:14336
  v_mfma_f32_16x16x32_bf16 v[144:147], a[28:31], a[184:187], v[144:147]
  buffer_store_dwordx4 a[116:119], v12, s[68:71], s16 offen offset:1024 sc1
  v_mfma_f32_16x16x32_bf16 v[148:151], a[24:27], a[172:175], v[148:151]
  v_exp_f32 v104, v104
  v_mfma_f32_16x16x32_bf16 v[148:151], a[28:31], a[188:191], v[148:151]
  v_exp_f32 v105, v105
  v_mfma_f32_16x16x32_bf16 v[216:219], a[32:35], a[160:163], v[216:219]
  ds_read_b64_tr_b16 a[24:25], v23 offset:8192
  ds_read_b64_tr_b16 a[26:27], v23 offset:10240
  v_mfma_f32_16x16x32_bf16 v[216:219], a[36:39], a[176:179], v[216:219]
  v_exp_f32 v106, v106
  v_mfma_f32_16x16x32_bf16 v[220:223], a[32:35], a[164:167], v[220:223]
  v_exp_f32 v107, v107
  v_mfma_f32_16x16x32_bf16 v[220:223], a[36:39], a[180:183], v[220:223]
  v_exp_f32 v108, v108
  v_mfma_f32_16x16x32_bf16 v[152:155], a[32:35], a[168:171], v[152:155]
  ds_read_b64_tr_b16 a[28:29], v23 offset:12288
  ds_read_b64_tr_b16 a[30:31], v23 offset:14336
  v_mfma_f32_16x16x32_bf16 v[152:155], a[36:39], a[184:187], v[152:155]
  v_exp_f32 v109, v109
  v_mfma_f32_16x16x32_bf16 v[156:159], a[32:35], a[172:175], v[156:159]
  v_exp_f32 v110, v110
  v_mfma_f32_16x16x32_bf16 v[156:159], a[36:39], a[188:191], v[156:159]
  s_waitcnt vmcnt(63)
  v_subrev_u32 v20, 32768, v20
  v_subrev_u32 v21, 32768, v21
  v_subrev_u32 v22, 32768, v22
  v_subrev_u32 v23, 32768, v23
  s_barrier
  s_waitcnt lgkmcnt(8)
  v_mfma_f32_16x16x32_bf16 v[224:227], a[0:3], a[160:163], v[224:227]
  ds_read_b64_tr_b16 a[32:33], v20 offset:0
  ds_read_b64_tr_b16 a[34:35], v20 offset:2048
  v_mfma_f32_16x16x32_bf16 v[224:227], a[4:7], a[176:179], v[224:227]
  v_exp_f32 v111, v111
  v_mfma_f32_16x16x32_bf16 v[228:231], a[0:3], a[164:167], v[228:231]
  v_add_f32 v104, 1.0, v104
  v_add_f32 v105, 1.0, v105
  v_mfma_f32_16x16x32_bf16 v[228:231], a[4:7], a[180:183], v[228:231]
  v_add_f32 v106, 1.0, v106
  v_add_f32 v107, 1.0, v107
  v_mfma_f32_16x16x32_bf16 v[160:163], a[0:3], a[168:171], v[160:163]
  ds_read_b64_tr_b16 a[36:37], v20 offset:4096
  ds_read_b64_tr_b16 a[38:39], v20 offset:6144
  v_mfma_f32_16x16x32_bf16 v[160:163], a[4:7], a[184:187], v[160:163]
  v_add_f32 v108, 1.0, v108
  v_add_f32 v109, 1.0, v109
  v_mfma_f32_16x16x32_bf16 v[164:167], a[0:3], a[172:175], v[164:167]
  v_add_f32 v110, 1.0, v110
  v_add_f32 v111, 1.0, v111
  v_mfma_f32_16x16x32_bf16 v[164:167], a[4:7], a[188:191], v[164:167]
  v_rcp_f32 v104, v104
  v_mfma_f32_16x16x32_bf16 v[232:235], a[8:11], a[160:163], v[232:235]
  ds_read_b64_tr_b16 a[0:1], v21 offset:0
  ds_read_b64_tr_b16 a[2:3], v21 offset:2048
  v_mfma_f32_16x16x32_bf16 v[232:235], a[12:15], a[176:179], v[232:235]
  v_rcp_f32 v105, v105
  v_mfma_f32_16x16x32_bf16 v[236:239], a[8:11], a[164:167], v[236:239]
  v_rcp_f32 v106, v106
  v_mfma_f32_16x16x32_bf16 v[236:239], a[12:15], a[180:183], v[236:239]
  v_rcp_f32 v107, v107
  v_mfma_f32_16x16x32_bf16 v[168:171], a[8:11], a[168:171], v[168:171]
  ds_read_b64_tr_b16 a[4:5], v21 offset:4096
  ds_read_b64_tr_b16 a[6:7], v21 offset:6144
  v_mfma_f32_16x16x32_bf16 v[168:171], a[12:15], a[184:187], v[168:171]
  v_rcp_f32 v108, v108
  v_mfma_f32_16x16x32_bf16 v[172:175], a[8:11], a[172:175], v[172:175]
  v_rcp_f32 v109, v109
  v_mfma_f32_16x16x32_bf16 v[172:175], a[12:15], a[188:191], v[172:175]
  s_waitcnt lgkmcnt(8)
  v_rcp_f32 v110, v110
  v_mfma_f32_16x16x32_bf16 v[240:243], a[16:19], a[160:163], v[240:243]
  ds_read_b64_tr_b16 a[8:9], v22 offset:0
  ds_read_b64_tr_b16 a[10:11], v22 offset:2048
  v_mfma_f32_16x16x32_bf16 v[240:243], a[20:23], a[176:179], v[240:243]
  buffer_load_dword v13, v18, s[68:71], s82 offen sc1
  v_mfma_f32_16x16x32_bf16 v[244:247], a[16:19], a[164:167], v[244:247]
  v_rcp_f32 v111, v111
  v_mfma_f32_16x16x32_bf16 v[244:247], a[20:23], a[180:183], v[244:247]
  v_mul_f32 v104, v104, v120
  v_mul_f32 v105, v105, v121
  v_mfma_f32_16x16x32_bf16 v[176:179], a[16:19], a[168:171], v[176:179]
  ds_read_b64_tr_b16 a[12:13], v22 offset:4096
  ds_read_b64_tr_b16 a[14:15], v22 offset:6144
  v_mfma_f32_16x16x32_bf16 v[176:179], a[20:23], a[184:187], v[176:179]
  buffer_store_dwordx4 a[120:123], v12, s[68:71], s16 offen offset:2048 sc1
  v_mfma_f32_16x16x32_bf16 v[180:183], a[16:19], a[172:175], v[180:183]
  v_mul_f32 v106, v106, v122
  v_mul_f32 v107, v107, v123
  v_mfma_f32_16x16x32_bf16 v[180:183], a[20:23], a[188:191], v[180:183]
  v_mul_f32 v108, v108, v124
  v_mul_f32 v109, v109, v125
  v_mfma_f32_16x16x32_bf16 v[248:251], a[24:27], a[160:163], v[248:251]
  ds_read_b64_tr_b16 a[16:17], v23 offset:0
  ds_read_b64_tr_b16 a[18:19], v23 offset:2048
  v_mfma_f32_16x16x32_bf16 v[248:251], a[28:31], a[176:179], v[248:251]
  v_mul_f32 v110, v110, v126
  v_mul_f32 v111, v111, v127
  v_mfma_f32_16x16x32_bf16 v[252:255], a[24:27], a[164:167], v[252:255]
  v_cvt_pk_bf16_f32 v120, v104, v105
  v_cvt_pk_bf16_f32 v121, v106, v107
  v_mfma_f32_16x16x32_bf16 v[252:255], a[28:31], a[180:183], v[252:255]
  v_cvt_pk_bf16_f32 v122, v108, v109
  v_cvt_pk_bf16_f32 v123, v110, v111
  v_mfma_f32_16x16x32_bf16 v[184:187], a[24:27], a[168:171], v[184:187]
  ds_read_b64_tr_b16 a[20:21], v23 offset:4096
  ds_read_b64_tr_b16 a[22:23], v23 offset:6144
  v_mfma_f32_16x16x32_bf16 v[184:187], a[28:31], a[184:187], v[184:187]
  v_permlane32_swap_b32 v120, v122
  v_mfma_f32_16x16x32_bf16 v[188:191], a[24:27], a[172:175], v[188:191]
  v_permlane32_swap_b32 v121, v123
  v_mfma_f32_16x16x32_bf16 v[188:191], a[28:31], a[188:191], v[188:191]
  s_waitcnt lgkmcnt(8)
  v_mul_f32 v32, s83, v32
  v_mul_f32 v33, s83, v33
  v_mfma_f32_16x16x32_bf16 v[192:195], a[32:35], a[192:195], v[192:195]
  ds_read_b64_tr_b16 a[24:25], v20 offset:8192
  ds_read_b64_tr_b16 a[26:27], v20 offset:10240
  v_mfma_f32_16x16x32_bf16 v[192:195], a[36:39], a[208:211], v[192:195]
  v_mul_f32 v34, s83, v34
  v_mul_f32 v35, s83, v35
  v_mfma_f32_16x16x32_bf16 v[196:199], a[32:35], a[196:199], v[196:199]
  v_mul_f32 v36, s83, v36
  v_mul_f32 v37, s83, v37
  v_mfma_f32_16x16x32_bf16 v[196:199], a[36:39], a[212:215], v[196:199]
  v_mul_f32 v38, s83, v38
  v_mul_f32 v39, s83, v39
  v_mfma_f32_16x16x32_bf16 v[128:131], a[32:35], a[200:203], v[128:131]
  ds_read_b64_tr_b16 a[28:29], v20 offset:12288
  ds_read_b64_tr_b16 a[30:31], v20 offset:14336
  v_mfma_f32_16x16x32_bf16 v[128:131], a[36:39], a[216:219], v[128:131]
  v_exp_f32 v32, v32
  v_mfma_f32_16x16x32_bf16 v[132:135], a[32:35], a[204:207], v[132:135]
  v_exp_f32 v33, v33
  v_mfma_f32_16x16x32_bf16 v[132:135], a[36:39], a[220:223], v[132:135]
  v_exp_f32 v34, v34
  v_mfma_f32_16x16x32_bf16 v[200:203], a[0:3], a[192:195], v[200:203]
  ds_read_b64_tr_b16 a[32:33], v21 offset:8192
  ds_read_b64_tr_b16 a[34:35], v21 offset:10240
  v_mfma_f32_16x16x32_bf16 v[200:203], a[4:7], a[208:211], v[200:203]
  v_exp_f32 v35, v35
  v_mfma_f32_16x16x32_bf16 v[204:207], a[0:3], a[196:199], v[204:207]
  v_exp_f32 v36, v36
  v_mfma_f32_16x16x32_bf16 v[204:207], a[4:7], a[212:215], v[204:207]
  v_exp_f32 v37, v37
  v_mfma_f32_16x16x32_bf16 v[136:139], a[0:3], a[200:203], v[136:139]
  ds_read_b64_tr_b16 a[36:37], v21 offset:12288
  ds_read_b64_tr_b16 a[38:39], v21 offset:14336
  v_mfma_f32_16x16x32_bf16 v[136:139], a[4:7], a[216:219], v[136:139]
  v_exp_f32 v38, v38
  v_mfma_f32_16x16x32_bf16 v[140:143], a[0:3], a[204:207], v[140:143]
  buffer_store_dwordx4 a[124:127], v12, s[68:71], s16 offen offset:3072 sc1
  v_mfma_f32_16x16x32_bf16 v[140:143], a[4:7], a[220:223], v[140:143]
  s_waitcnt lgkmcnt(8)
  v_exp_f32 v39, v39
  v_mfma_f32_16x16x32_bf16 v[208:211], a[8:11], a[192:195], v[208:211]
  ds_read_b64_tr_b16 a[0:1], v22 offset:8192
  ds_read_b64_tr_b16 a[2:3], v22 offset:10240
  v_mfma_f32_16x16x32_bf16 v[208:211], a[12:15], a[208:211], v[208:211]
  v_add_f32 v32, 1.0, v32
  v_add_f32 v33, 1.0, v33
  v_mfma_f32_16x16x32_bf16 v[212:215], a[8:11], a[196:199], v[212:215]
  v_add_f32 v34, 1.0, v34
  v_add_f32 v35, 1.0, v35
  v_mfma_f32_16x16x32_bf16 v[212:215], a[12:15], a[212:215], v[212:215]
  v_add_f32 v36, 1.0, v36
  v_add_f32 v37, 1.0, v37
  v_mfma_f32_16x16x32_bf16 v[144:147], a[8:11], a[200:203], v[144:147]
  ds_read_b64_tr_b16 a[4:5], v22 offset:12288
  ds_read_b64_tr_b16 a[6:7], v22 offset:14336
  v_mfma_f32_16x16x32_bf16 v[144:147], a[12:15], a[216:219], v[144:147]
  v_add_f32 v38, 1.0, v38
  v_add_f32 v39, 1.0, v39
  v_mfma_f32_16x16x32_bf16 v[148:151], a[8:11], a[204:207], v[148:151]
  s_waitcnt vmcnt(2)
  v_cmp_le_u32 vcc, 1, v13
  s_nop 0
  s_and_b32 s80, vcc_lo, 257
  s_cmp_eq_u32 s80, 257
  s_cbranch_scc0 L_kv_spin
L_kv_ok:
  v_mfma_f32_16x16x32_bf16 v[148:151], a[12:15], a[220:223], v[148:151]
  s_xor_b32 m0, s49, 0
  v_rcp_f32 v32, v32
  v_mfma_f32_16x16x32_bf16 v[216:219], a[16:19], a[192:195], v[216:219]
  ds_read_b64_tr_b16 a[8:9], v23 offset:8192
  ds_read_b64_tr_b16 a[10:11], v23 offset:10240
  v_mfma_f32_16x16x32_bf16 v[216:219], a[20:23], a[208:211], v[216:219]
  buffer_load_dwordx4 v12, s[68:71], s38 offen offset:0 sc1 lds
  v_mfma_f32_16x16x32_bf16 v[220:223], a[16:19], a[196:199], v[220:223]
  v_rcp_f32 v33, v33
  v_mfma_f32_16x16x32_bf16 v[220:223], a[20:23], a[212:215], v[220:223]
  v_rcp_f32 v34, v34
  v_mfma_f32_16x16x32_bf16 v[152:155], a[16:19], a[200:203], v[152:155]
  ds_read_b64_tr_b16 a[12:13], v23 offset:12288
  ds_read_b64_tr_b16 a[14:15], v23 offset:14336
  v_mfma_f32_16x16x32_bf16 v[152:155], a[20:23], a[216:219], v[152:155]
  buffer_load_dwordx4 v12, s[68:71], s38 offen offset:1024 sc1 lds
  v_mfma_f32_16x16x32_bf16 v[156:159], a[16:19], a[204:207], v[156:159]
  v_rcp_f32 v35, v35
  v_mfma_f32_16x16x32_bf16 v[156:159], a[20:23], a[220:223], v[156:159]
  s_waitcnt lgkmcnt(8)
  v_rcp_f32 v36, v36
  v_mfma_f32_16x16x32_bf16 v[224:227], a[24:27], a[192:195], v[224:227]
  buffer_load_dwordx4 v12, s[68:71], s38 offen offset:2048 sc1 lds
  v_mfma_f32_16x16x32_bf16 v[224:227], a[28:31], a[208:211], v[224:227]
  v_rcp_f32 v37, v37
  v_mfma_f32_16x16x32_bf16 v[228:231], a[24:27], a[196:199], v[228:231]
  v_rcp_f32 v38, v38
  v_mfma_f32_16x16x32_bf16 v[228:231], a[28:31], a[212:215], v[228:231]
  buffer_load_dwordx4 v12, s[68:71], s38 offen offset:3072 sc1 lds
  v_mfma_f32_16x16x32_bf16 v[160:163], a[24:27], a[200:203], v[160:163]
  s_xor_b32 m0, s49, 16384
  v_rcp_f32 v39, v39
  v_mfma_f32_16x16x32_bf16 v[160:163], a[28:31], a[216:219], v[160:163]
  v_mul_f32 v32, v32, v48
  v_mul_f32 v33, v33, v49
  v_mfma_f32_16x16x32_bf16 v[164:167], a[24:27], a[204:207], v[164:167]
  buffer_load_dwordx4 v12, s[68:71], s48 offen offset:0 sc1 lds
  v_mfma_f32_16x16x32_bf16 v[164:167], a[28:31], a[220:223], v[164:167]
  v_mul_f32 v34, v34, v50
  v_mul_f32 v35, v35, v51
  v_mfma_f32_16x16x32_bf16 v[232:235], a[32:35], a[192:195], v[232:235]
  v_mul_f32 v36, v36, v52
  v_mul_f32 v37, v37, v53
  v_mfma_f32_16x16x32_bf16 v[232:235], a[36:39], a[208:211], v[232:235]
  buffer_load_dwordx4 v12, s[68:71], s48 offen offset:1024 sc1 lds
  v_mfma_f32_16x16x32_bf16 v[236:239], a[32:35], a[196:199], v[236:239]
  v_mul_f32 v38, v38, v54
  v_mul_f32 v39, v39, v55
  v_mfma_f32_16x16x32_bf16 v[236:239], a[36:39], a[212:215], v[236:239]
  v_cvt_pk_bf16_f32 v96, v32, v33
  v_cvt_pk_bf16_f32 v97, v34, v35
  v_mfma_f32_16x16x32_bf16 v[168:171], a[32:35], a[200:203], v[168:171]
  buffer_load_dwordx4 v12, s[68:71], s48 offen offset:2048 sc1 lds
  v_mfma_f32_16x16x32_bf16 v[168:171], a[36:39], a[216:219], v[168:171]
  v_cvt_pk_bf16_f32 v98, v36, v37
  v_cvt_pk_bf16_f32 v99, v38, v39
  v_mfma_f32_16x16x32_bf16 v[172:175], a[32:35], a[204:207], v[172:175]
  v_permlane32_swap_b32 v96, v98
  v_mfma_f32_16x16x32_bf16 v[172:175], a[36:39], a[220:223], v[172:175]
  s_waitcnt lgkmcnt(0)
  v_permlane32_swap_b32 v97, v99
  v_mfma_f32_16x16x32_bf16 v[240:243], a[0:3], a[192:195], v[240:243]
  buffer_load_dwordx4 v12, s[68:71], s48 offen offset:3072 sc1 lds
  v_mfma_f32_16x16x32_bf16 v[240:243], a[4:7], a[208:211], v[240:243]
  v_mul_f32 v40, s83, v40
  v_mul_f32 v41, s83, v41
  v_mfma_f32_16x16x32_bf16 v[244:247], a[0:3], a[196:199], v[244:247]
  v_mul_f32 v42, s83, v42
  v_mul_f32 v43, s83, v43
  v_mfma_f32_16x16x32_bf16 v[244:247], a[4:7], a[212:215], v[244:247]
  v_mul_f32 v44, s83, v44
  v_mul_f32 v45, s83, v45
  v_mfma_f32_16x16x32_bf16 v[176:179], a[0:3], a[200:203], v[176:179]
  v_mul_f32 v46, s83, v46
  v_mul_f32 v47, s83, v47
  v_mfma_f32_16x16x32_bf16 v[176:179], a[4:7], a[216:219], v[176:179]
  v_exp_f32 v40, v40
  v_mfma_f32_16x16x32_bf16 v[180:183], a[0:3], a[204:207], v[180:183]
  v_exp_f32 v41, v41
  v_mfma_f32_16x16x32_bf16 v[180:183], a[4:7], a[220:223], v[180:183]
  v_exp_f32 v42, v42
  v_mfma_f32_16x16x32_bf16 v[248:251], a[8:11], a[192:195], v[248:251]
  v_exp_f32 v43, v43
  v_mfma_f32_16x16x32_bf16 v[248:251], a[12:15], a[208:211], v[248:251]
  v_exp_f32 v44, v44
  v_mfma_f32_16x16x32_bf16 v[252:255], a[8:11], a[196:199], v[252:255]
  v_exp_f32 v45, v45
  v_mfma_f32_16x16x32_bf16 v[252:255], a[12:15], a[212:215], v[252:255]
  v_exp_f32 v46, v46
  v_mfma_f32_16x16x32_bf16 v[184:187], a[8:11], a[200:203], v[184:187]
  v_exp_f32 v47, v47
  v_mfma_f32_16x16x32_bf16 v[184:187], a[12:15], a[216:219], v[184:187]
  v_add_f32 v40, 1.0, v40
  v_add_f32 v41, 1.0, v41
  v_mfma_f32_16x16x32_bf16 v[188:191], a[8:11], a[204:207], v[188:191]
  v_add_f32 v42, 1.0, v42
  v_add_f32 v43, 1.0, v43
  v_mfma_f32_16x16x32_bf16 v[188:191], a[12:15], a[220:223], v[188:191]
  v_add_f32 v44, 1.0, v44
  v_add_f32 v45, 1.0, v45
  v_mov_b32 v13, 2
  s_waitcnt vmcnt(8)
  s_barrier
  buffer_store_dword v13, v17, s[68:71], s47 offen sc1
  v_cvt_pk_bf16_f32 v192, v192, v193
  v_cvt_pk_bf16_f32 v193, v194, v195
  v_cvt_pk_bf16_f32 v194, v196, v197
  v_cvt_pk_bf16_f32 v195, v198, v199
  v_accvgpr_write_b32 a160, v192
  v_accvgpr_write_b32 a161, v193
  v_accvgpr_write_b32 a176, v194
  v_accvgpr_write_b32 a177, v195
  v_cvt_pk_bf16_f32 v200, v200, v201
  v_cvt_pk_bf16_f32 v201, v202, v203
  v_cvt_pk_bf16_f32 v202, v204, v205
  v_cvt_pk_bf16_f32 v203, v206, v207
  v_accvgpr_write_b32 a162, v200
  v_accvgpr_write_b32 a163, v201
  v_accvgpr_write_b32 a178, v202
  v_accvgpr_write_b32 a179, v203
  v_cvt_pk_bf16_f32 v208, v208, v209
  v_cvt_pk_bf16_f32 v209, v210, v211
  v_cvt_pk_bf16_f32 v210, v212, v213
  v_cvt_pk_bf16_f32 v211, v214, v215
  v_accvgpr_write_b32 a164, v208
  v_accvgpr_write_b32 a165, v209
  v_accvgpr_write_b32 a180, v210
  v_accvgpr_write_b32 a181, v211
  v_cvt_pk_bf16_f32 v216, v216, v217
  v_cvt_pk_bf16_f32 v217, v218, v219
  v_cvt_pk_bf16_f32 v218, v220, v221
  v_cvt_pk_bf16_f32 v219, v222, v223
  v_accvgpr_write_b32 a166, v216
  v_accvgpr_write_b32 a167, v217
  v_accvgpr_write_b32 a182, v218
  v_accvgpr_write_b32 a183, v219
  v_cvt_pk_bf16_f32 v224, v224, v225
  v_cvt_pk_bf16_f32 v225, v226, v227
  v_cvt_pk_bf16_f32 v226, v228, v229
  v_cvt_pk_bf16_f32 v227, v230, v231
  v_accvgpr_write_b32 a168, v224
  v_accvgpr_write_b32 a169, v225
  v_accvgpr_write_b32 a184, v226
  v_accvgpr_write_b32 a185, v227
  v_cvt_pk_bf16_f32 v232, v232, v233
  v_cvt_pk_bf16_f32 v233, v234, v235
  v_cvt_pk_bf16_f32 v234, v236, v237
  v_cvt_pk_bf16_f32 v235, v238, v239
  v_accvgpr_write_b32 a170, v232
  v_accvgpr_write_b32 a171, v233
  v_accvgpr_write_b32 a186, v234
  v_accvgpr_write_b32 a187, v235
  v_cvt_pk_bf16_f32 v240, v240, v241
  v_cvt_pk_bf16_f32 v241, v242, v243
  v_cvt_pk_bf16_f32 v242, v244, v245
  v_cvt_pk_bf16_f32 v243, v246, v247
  v_accvgpr_write_b32 a172, v240
  v_accvgpr_write_b32 a173, v241
  v_accvgpr_write_b32 a188, v242
  v_accvgpr_write_b32 a189, v243
  v_cvt_pk_bf16_f32 v248, v248, v249
  v_cvt_pk_bf16_f32 v249, v250, v251
  v_cvt_pk_bf16_f32 v250, v252, v253
  v_cvt_pk_bf16_f32 v251, v254, v255
  v_accvgpr_write_b32 a174, v248
  v_accvgpr_write_b32 a175, v249
  v_accvgpr_write_b32 a190, v250
  v_accvgpr_write_b32 a191, v251
  s_and_b32 s80, s49, 0x10000
  v_add_u32 v249, s80, v12
  v_xor_b32 v248, 0x10000, v249
  v_min_u32 v1, 0x180, v19
  v_cmp_le_i32 s[10:11], 17, v8
  v_cmp_le_i32 s[12:13], 18, v8
  v_cmp_le_i32 s[14:15], 19, v8
  v_cmp_le_i32 s[16:17], 32, v8
  v_cvt_pk_bf16_f32 v128, v128, v129
  v_cvt_pk_bf16_f32 v129, v130, v131
  v_cvt_pk_bf16_f32 v130, v132, v133
  v_cvt_pk_bf16_f32 v131, v134, v135
  v_accvgpr_write_b32 a128, v128
  v_accvgpr_write_b32 a129, v129
  v_accvgpr_write_b32 a144, v130
  v_accvgpr_write_b32 a145, v131
  v_cvt_pk_bf16_f32 v136, v136, v137
  v_cvt_pk_bf16_f32 v137, v138, v139
  v_cvt_pk_bf16_f32 v138, v140, v141
  v_cvt_pk_bf16_f32 v139, v142, v143
  v_accvgpr_write_b32 a130, v136
  v_accvgpr_write_b32 a131, v137
  v_accvgpr_write_b32 a146, v138
  v_accvgpr_write_b32 a147, v139
  v_cvt_pk_bf16_f32 v144, v144, v145
  v_cvt_pk_bf16_f32 v145, v146, v147
  v_cvt_pk_bf16_f32 v146, v148, v149
  v_cvt_pk_bf16_f32 v147, v150, v151
  v_accvgpr_write_b32 a132, v144
  v_accvgpr_write_b32 a133, v145
  v_accvgpr_write_b32 a148, v146
  v_accvgpr_write_b32 a149, v147
  v_cvt_pk_bf16_f32 v152, v152, v153
  v_cvt_pk_bf16_f32 v153, v154, v155
  v_cvt_pk_bf16_f32 v154, v156, v157
  v_cvt_pk_bf16_f32 v155, v158, v159
  v_accvgpr_write_b32 a134, v152
  v_accvgpr_write_b32 a135, v153
  v_accvgpr_write_b32 a150, v154
  v_accvgpr_write_b32 a151, v155
  v_cvt_pk_bf16_f32 v160, v160, v161
  v_cvt_pk_bf16_f32 v161, v162, v163
  v_cvt_pk_bf16_f32 v162, v164, v165
  v_cvt_pk_bf16_f32 v163, v166, v167
  v_accvgpr_write_b32 a136, v160
  v_accvgpr_write_b32 a137, v161
  v_accvgpr_write_b32 a152, v162
  v_accvgpr_write_b32 a153, v163
  s_waitcnt vmcnt(5)
  s_barrier
  ds_read_b128 a[32:35], v249 offset:0
  ds_read_b128 a[36:39], v249 offset:1024
  ds_read_b128 a[40:43], v249 offset:2048
  ds_read_b128 a[44:47], v249 offset:3072
  ds_read_b128 a[48:51], v249 offset:4096
  ds_read_b128 a[52:55], v249 offset:5120
  ds_read_b128 a[56:59], v249 offset:6144
  ds_read_b128 a[60:63], v249 offset:7168
  v_cvt_pk_bf16_f32 v168, v168, v169
  v_cvt_pk_bf16_f32 v169, v170, v171
  v_cvt_pk_bf16_f32 v170, v172, v173
  v_cvt_pk_bf16_f32 v171, v174, v175
  v_accvgpr_write_b32 a138, v168
  v_accvgpr_write_b32 a139, v169
  v_accvgpr_write_b32 a154, v170
  v_accvgpr_write_b32 a155, v171
  v_cvt_pk_bf16_f32 v176, v176, v177
  v_cvt_pk_bf16_f32 v177, v178, v179
  v_cvt_pk_bf16_f32 v178, v180, v181
  v_cvt_pk_bf16_f32 v179, v182, v183
  v_accvgpr_write_b32 a140, v176
  v_accvgpr_write_b32 a141, v177
  v_accvgpr_write_b32 a156, v178
  v_accvgpr_write_b32 a157, v179
  v_cvt_pk_bf16_f32 v184, v184, v185
  v_cvt_pk_bf16_f32 v185, v186, v187
  v_cvt_pk_bf16_f32 v186, v188, v189
  v_cvt_pk_bf16_f32 v187, v190, v191
  v_accvgpr_write_b32 a142, v184
  v_accvgpr_write_b32 a143, v185
  v_accvgpr_write_b32 a158, v186
  v_accvgpr_write_b32 a159, v187
  s_waitcnt lgkmcnt(0)
  v_mfma_f32_16x16x32_bf16 v[192:195], a[32:35], a[160:163], 0
  v_cndmask_b32 v254, 0, v11, s[96:97]
  v_cndmask_b32 v208, v254, 0, s[0:1]
  v_cndmask_b32 v209, v254, 0, s[2:3]
  v_cndmask_b32 v210, v254, 0, s[4:5]
  v_cndmask_b32 v211, v254, 0, s[6:7]
  v_mfma_f32_16x16x32_bf16 v[192:195], a[36:39], a[164:167], v[192:195]
  ds_read_b128 a[0:3], v249 offset:8192
  ds_read_b128 a[4:7], v249 offset:9216
  v_cndmask_b32 v212, v254, 0, s[8:9]
  v_cndmask_b32 v213, v254, 0, s[10:11]
  v_cndmask_b32 v214, v254, 0, s[12:13]
  v_mfma_f32_16x16x32_bf16 v[192:195], a[40:43], a[168:171], v[192:195]
  v_cndmask_b32 v215, v254, 0, s[14:15]
  v_mov_b32 v244, 0
  v_mov_b32 v245, 0
  v_mov_b32 v246, 0
  v_mov_b32 v247, 0
  v_mfma_f32_16x16x32_bf16 v[192:195], a[44:47], a[172:175], v[192:195]
  ds_read_b128 a[8:11], v249 offset:10240
  ds_read_b128 a[12:15], v249 offset:11264
  v_accvgpr_write_b32 a68, v4
  v_accvgpr_write_b32 a69, v4
  v_accvgpr_write_b32 a70, v4
  v_mfma_f32_16x16x32_bf16 v[196:199], a[48:51], a[160:163], 0
  v_accvgpr_write_b32 a71, v4
  v_accvgpr_write_b32 a72, v5
  v_accvgpr_write_b32 a73, v5
  v_accvgpr_write_b32 a74, v5
  v_accvgpr_write_b32 a75, v5
  v_mfma_f32_16x16x32_bf16 v[196:199], a[52:55], a[164:167], v[196:199]
  ds_read_b128 a[16:19], v249 offset:12288
  ds_read_b128 a[20:23], v249 offset:13312
  v_accvgpr_write_b32 a76, v6
  v_accvgpr_write_b32 a77, v6
  v_accvgpr_write_b32 a78, v6
  v_mfma_f32_16x16x32_bf16 v[196:199], a[56:59], a[168:171], v[196:199]
  v_accvgpr_write_b32 a79, v6
  v_accvgpr_write_b32 a80, v7
  v_accvgpr_write_b32 a81, v7
  v_accvgpr_write_b32 a82, v7
  v_accvgpr_write_b32 a83, v7
  v_mfma_f32_16x16x32_bf16 v[196:199], a[60:63], a[172:175], v[196:199]
  ds_read_b128 a[24:27], v249 offset:14336
  ds_read_b128 a[28:31], v249 offset:15360
  v_add_f32 v46, 1.0, v46
  v_add_f32 v47, 1.0, v47
  v_mfma_f32_16x16x32_bf16 v[200:203], a[32:35], a[176:179], 0
  v_rcp_f32 v40, v40
  v_rcp_f32 v41, v41
  v_mfma_f32_16x16x32_bf16 v[200:203], a[36:39], a[180:183], v[200:203]
  v_rcp_f32 v42, v42
  v_rcp_f32 v43, v43
  v_mfma_f32_16x16x32_bf16 v[200:203], a[40:43], a[184:187], v[200:203]
  v_rcp_f32 v44, v44
  v_rcp_f32 v45, v45
  v_mfma_f32_16x16x32_bf16 v[200:203], a[44:47], a[188:191], v[200:203]
  v_rcp_f32 v46, v46
  v_rcp_f32 v47, v47
  v_mul_f32 v40, v40, v56
  v_mfma_f32_16x16x32_bf16 v[204:207], a[48:51], a[176:179], 0
  v_mul_f32 v41, v41, v57
  v_mul_f32 v42, v42, v58
  v_mul_f32 v43, v43, v59
  v_mul_f32 v44, v44, v60
  v_mul_f32 v45, v45, v61
  v_mfma_f32_16x16x32_bf16 v[204:207], a[52:55], a[180:183], v[204:207]
  v_mul_f32 v46, v46, v62
  v_mul_f32 v47, v47, v63
  v_cvt_pk_bf16_f32 v100, v40, v41
  v_cvt_pk_bf16_f32 v101, v42, v43
  v_cvt_pk_bf16_f32 v102, v44, v45
  v_mfma_f32_16x16x32_bf16 v[204:207], a[56:59], a[184:187], v[204:207]
  v_cvt_pk_bf16_f32 v103, v46, v47
  v_permlane32_swap_b32 v100, v102
  s_nop 0
  v_permlane32_swap_b32 v101, v103
  v_mfma_f32_16x16x32_bf16 v[204:207], a[60:63], a[188:191], v[204:207]
  v_mul_f32 v64, s83, v64
  v_mul_f32 v65, s83, v65
  v_mul_f32 v66, s83, v66
  v_mul_f32 v67, s83, v67
  v_mul_f32 v68, s83, v68
  v_mfma_f32_16x16x32_bf16 v[208:211], a[32:35], a[128:131], v[208:211]
  v_mul_f32 v69, s83, v69
  v_mul_f32 v70, s83, v70
  v_mul_f32 v71, s83, v71
  v_exp_f32 v64, v64
  v_mfma_f32_16x16x32_bf16 v[208:211], a[36:39], a[132:135], v[208:211]
L_hop9:
  s_cbranch_execz L_hop13
  v_exp_f32 v65, v65
  v_exp_f32 v66, v66
  v_mfma_f32_16x16x32_bf16 v[208:211], a[40:43], a[136:139], v[208:211]
  v_exp_f32 v67, v67
  v_exp_f32 v68, v68
  v_mfma_f32_16x16x32_bf16 v[208:211], a[44:47], a[140:143], v[208:211]
  v_exp_f32 v69, v69
  v_exp_f32 v70, v70
  v_mfma_f32_16x16x32_bf16 v[212:215], a[48:51], a[128:131], v[212:215]
  v_exp_f32 v71, v71
  v_add_f32 v64, 1.0, v64
  v_add_f32 v65, 1.0, v65
  v_add_f32 v66, 1.0, v66
  v_mfma_f32_16x16x32_bf16 v[212:215], a[52:55], a[132:135], v[212:215]
  v_add_f32 v67, 1.0, v67
  v_add_f32 v68, 1.0, v68
  v_add_f32 v69, 1.0, v69
  v_add_f32 v70, 1.0, v70
  v_add_f32 v71, 1.0, v71
  v_mfma_f32_16x16x32_bf16 v[212:215], a[56:59], a[136:139], v[212:215]
  v_rcp_f32 v64, v64
  v_rcp_f32 v65, v65
  v_mfma_f32_16x16x32_bf16 v[212:215], a[60:63], a[140:143], v[212:215]
  v_rcp_f32 v66, v66
  v_rcp_f32 v67, v67
  v_mfma_f32_16x16x32_bf16 v[216:219], a[32:35], a[144:147], 0
  buffer_load_dword v13, v18, s[68:71], s82 offen sc1
  v_rcp_f32 v68, v68
  v_rcp_f32 v69, v69
  v_mfma_f32_16x16x32_bf16 v[216:219], a[36:39], a[148:151], v[216:219]
  v_rcp_f32 v70, v70
  v_rcp_f32 v71, v71
  v_mul_f32 v64, v64, v80
  v_mfma_f32_16x16x32_bf16 v[216:219], a[40:43], a[152:155], v[216:219]
  v_mul_f32 v65, v65, v81
  v_mul_f32 v66, v66, v82
  v_mul_f32 v67, v67, v83
  v_mul_f32 v68, v68, v84
  v_mul_f32 v69, v69, v85
  v_mfma_f32_16x16x32_bf16 v[216:219], a[44:47], a[156:159], v[216:219]
  v_mul_f32 v70, v70, v86
  v_mul_f32 v71, v71, v87
  v_cvt_pk_bf16_f32 v104, v64, v65
  v_cvt_pk_bf16_f32 v105, v66, v67
  v_cvt_pk_bf16_f32 v106, v68, v69
  v_mfma_f32_16x16x32_bf16 v[220:223], a[48:51], a[144:147], 0
  v_cvt_pk_bf16_f32 v107, v70, v71
  v_permlane32_swap_b32 v104, v106
  s_nop 0
  v_permlane32_swap_b32 v105, v107
  v_mfma_f32_16x16x32_bf16 v[220:223], a[52:55], a[148:151], v[220:223]
  v_mul_f32 v72, s83, v72
  v_mul_f32 v73, s83, v73
  v_mul_f32 v74, s83, v74
  v_mul_f32 v75, s83, v75
  v_mul_f32 v76, s83, v76
  v_mfma_f32_16x16x32_bf16 v[220:223], a[56:59], a[152:155], v[220:223]
  v_mul_f32 v77, s83, v77
  v_mul_f32 v78, s83, v78
  v_mul_f32 v79, s83, v79
  v_exp_f32 v72, v72
  v_mfma_f32_16x16x32_bf16 v[220:223], a[60:63], a[156:159], v[220:223]
  v_exp_f32 v73, v73
  v_exp_f32 v74, v74
  v_exp_f32 v75, v75
  v_exp_f32 v76, v76
  v_exp_f32 v77, v77
  v_exp_f32 v78, v78
  v_exp_f32 v79, v79
  v_add_f32 v72, 1.0, v72
  v_max3_f32 v2, v192, v193, v194
  v_max3_f32 v4, v200, v201, v202
  v_max3_f32 v6, v208, v209, v210
  v_max3_f32 v8, v216, v217, v218
  v_max3_f32 v2, v2, v195, v196
  v_max3_f32 v4, v4, v203, v204
  v_max3_f32 v6, v6, v211, v212
  v_max3_f32 v8, v8, v219, v220
  v_max3_f32 v2, v2, v197, v198
  v_max3_f32 v4, v4, v205, v206
  v_max3_f32 v6, v6, v213, v214
  v_max3_f32 v8, v8, v221, v222
  v_max_f32 v2, v2, v199
  v_max_f32 v4, v4, v207
  v_max_f32 v6, v6, v215
  v_max_f32 v8, v8, v223
  v_permlane32_swap_b32 v2, v4
  s_nop 0
  v_permlane32_swap_b32 v6, v8
  v_max_f32 v2, v2, v4
  v_max_f32 v6, v6, v8
  s_nop 1
  v_permlane16_swap_b32 v2, v6
  v_max_f32 v2, v2, v6
  v_mov_b32 v6, v2
  s_nop 1
  v_permlane16_swap_b32 v2, v6
  v_mov_b32 v4, v2
  v_mov_b32 v8, v6
  s_nop 0
  v_permlane32_swap_b32 v2, v4
  v_permlane32_swap_b32 v6, v8
  v_pk_mul_f32 v[224:225], v[2:3], -1.0 op_sel_hi:[0,0]
  v_pk_mul_f32 v[226:227], v[2:3], -1.0 op_sel_hi:[0,0]
  v_pk_mul_f32 v[228:229], v[4:5], -1.0 op_sel_hi:[0,0]
  v_pk_mul_f32 v[230:231], v[4:5], -1.0 op_sel_hi:[0,0]
  v_pk_mul_f32 v[232:233], v[6:7], -1.0 op_sel_hi:[0,0]
  v_pk_mul_f32 v[234:235], v[6:7], -1.0 op_sel_hi:[0,0]
  v_pk_mul_f32 v[236:237], v[8:9], -1.0 op_sel_hi:[0,0]
  v_pk_mul_f32 v[238:239], v[8:9], -1.0 op_sel_hi:[0,0]
  v_pk_add_f32 v[192:193], v[192:193], v[224:225]
  v_pk_add_f32 v[194:195], v[194:195], v[224:225]
  v_pk_add_f32 v[196:197], v[196:197], v[224:225]
  v_pk_add_f32 v[198:199], v[198:199], v[224:225]
  v_pk_add_f32 v[200:201], v[200:201], v[228:229]
  v_pk_add_f32 v[202:203], v[202:203], v[228:229]
  v_pk_add_f32 v[204:205], v[204:205], v[228:229]
  v_pk_add_f32 v[206:207], v[206:207], v[228:229]
  v_pk_add_f32 v[208:209], v[208:209], v[232:233]
  v_pk_add_f32 v[210:211], v[210:211], v[232:233]
  v_pk_add_f32 v[212:213], v[212:213], v[232:233]
  v_pk_add_f32 v[214:215], v[214:215], v[232:233]
  v_pk_add_f32 v[216:217], v[216:217], v[236:237]
  v_pk_add_f32 v[218:219], v[218:219], v[236:237]
  v_pk_add_f32 v[220:221], v[220:221], v[236:237]
  v_pk_add_f32 v[222:223], v[222:223], v[236:237]
  s_waitcnt vmcnt(0)
  v_cmp_le_u32 vcc, 2, v13
  s_nop 0
  s_and_b32 s80, vcc_lo, 257
  s_cmp_eq_u32 s80, 257
  s_cbranch_scc0 L_kv2_spin
L_kv2_ok:
  s_xor_b32 m0, s49, 32768
  s_waitcnt vmcnt(63)
  s_barrier
  s_waitcnt lgkmcnt(0)
  v_mfma_f32_16x16x32_bf16 v[128:131], a[0:3], a[160:163], v[224:227]
  buffer_load_dwordx4 v12, s[68:71], s39 offen offset:0 sc1 lds
  v_cndmask_b32 v254, v232, v11, s[96:97]
  v_cndmask_b32 v144, v254, v232, s[16:17]
  v_cndmask_b32 v145, v254, v232, s[18:19]
  v_cndmask_b32 v146, v254, v232, s[20:21]
  v_mfma_f32_16x16x32_bf16 v[128:131], a[4:7], a[164:167], v[128:131]
  v_cndmask_b32 v147, v254, v232, s[22:23]
  v_cndmask_b32 v148, v254, v232, s[24:25]
  v_cndmask_b32 v149, v254, v232, s[26:27]
  v_cndmask_b32 v150, v254, v232, s[28:29]
  v_cndmask_b32 v151, v254, v232, s[30:31]
  v_mfma_f32_16x16x32_bf16 v[128:131], a[8:11], a[168:171], v[128:131]
  buffer_load_dwordx4 v12, s[68:71], s39 offen offset:1024 sc1 lds
  v_add_f32 v73, 1.0, v73
  v_add_f32 v74, 1.0, v74
  v_add_f32 v75, 1.0, v75
  v_add_f32 v76, 1.0, v76
  v_mfma_f32_16x16x32_bf16 v[128:131], a[12:15], a[172:175], v[128:131]
  v_add_f32 v77, 1.0, v77
  v_add_f32 v78, 1.0, v78
  v_add_f32 v79, 1.0, v79
  v_rcp_f32 v72, v72
  v_mfma_f32_16x16x32_bf16 v[132:135], a[16:19], a[160:163], v[224:227]
  buffer_load_dwordx4 v12, s[68:71], s39 offen offset:2048 sc1 lds
  v_rcp_f32 v73, v73
  v_rcp_f32 v74, v74
  v_mfma_f32_16x16x32_bf16 v[132:135], a[20:23], a[164:167], v[132:135]
  v_rcp_f32 v75, v75
  v_rcp_f32 v76, v76
  v_mfma_f32_16x16x32_bf16 v[132:135], a[24:27], a[168:171], v[132:135]
  v_rcp_f32 v77, v77
  v_rcp_f32 v78, v78
  v_mfma_f32_16x16x32_bf16 v[132:135], a[28:31], a[172:175], v[132:135]
  v_rcp_f32 v79, v79
  v_mul_f32 v72, v72, v88
  v_mul_f32 v73, v73, v89
  v_mul_f32 v74, v74, v90
  v_mfma_f32_16x16x32_bf16 v[136:139], a[0:3], a[176:179], v[228:231]
  buffer_load_dwordx4 v12, s[68:71], s39 offen offset:3072 sc1 lds
  v_mul_f32 v75, v75, v91
  v_mul_f32 v76, v76, v92
  v_mul_f32 v77, v77, v93
  v_mul_f32 v78, v78, v94
  v_mfma_f32_16x16x32_bf16 v[136:139], a[4:7], a[180:183], v[136:139]
  v_mul_f32 v79, v79, v95
  s_xor_b32 s49, s49, 0x10000
  s_add_u32 s48, s39, 16384
  s_add_u32 s39, s39, 32768
  s_xor_b32 m0, s49, 114688
  v_mfma_f32_16x16x32_bf16 v[136:139], a[8:11], a[184:187], v[136:139]
  buffer_load_dwordx4 v12, s[68:71], s48 offen offset:0 sc1 lds
  v_cvt_pk_bf16_f32 v108, v72, v73
  v_cvt_pk_bf16_f32 v109, v74, v75
  v_cvt_pk_bf16_f32 v110, v76, v77
  v_cvt_pk_bf16_f32 v111, v78, v79
  v_mfma_f32_16x16x32_bf16 v[136:139], a[12:15], a[188:191], v[136:139]
  v_permlane32_swap_b32 v108, v110
  v_permlane32_swap_b32 v109, v111
  v_mfma_f32_16x16x32_bf16 v[140:143], a[16:19], a[176:179], v[228:231]
  buffer_load_dwordx4 v12, s[68:71], s48 offen offset:1024 sc1 lds
  v_exp_f32 v2, v192
  v_exp_f32 v3, v193
  v_mfma_f32_16x16x32_bf16 v[140:143], a[20:23], a[180:183], v[140:143]
  v_exp_f32 v4, v194
  v_exp_f32 v5, v195
  v_cvt_pk_bf16_f32 v160, v2, v3
  v_mfma_f32_16x16x32_bf16 v[140:143], a[24:27], a[184:187], v[140:143]
  v_exp_f32 v6, v196
  v_exp_f32 v7, v197
  v_cvt_pk_bf16_f32 v161, v4, v5
  v_mfma_f32_16x16x32_bf16 v[140:143], a[28:31], a[188:191], v[140:143]
  v_exp_f32 v8, v198
  v_exp_f32 v9, v199
  v_cvt_pk_bf16_f32 v162, v6, v7
  v_mfma_f32_16x16x32_bf16 v[144:147], a[0:3], a[128:131], v[144:147]
  buffer_load_dwordx4 v12, s[68:71], s48 offen offset:2048 sc1 lds
  v_exp_f32 v2, v200
  v_exp_f32 v3, v201
  v_mfma_f32_16x16x32_bf16 v[144:147], a[4:7], a[132:135], v[144:147]
  v_cvt_pk_bf16_f32 v163, v8, v9
  v_exp_f32 v4, v202
  v_exp_f32 v5, v203
  v_mfma_f32_16x16x32_bf16 v[144:147], a[8:11], a[136:139], v[144:147]
  buffer_load_dwordx4 v12, s[68:71], s48 offen offset:3072 sc1 lds
  v_cvt_pk_bf16_f32 v164, v2, v3
  v_mfma_f32_16x16x32_bf16 v[240:243], a[68:71], v[160:163], v[244:247]
  v_exp_f32 v6, v204
  v_mfma_f32_16x16x32_bf16 v[144:147], a[12:15], a[140:143], v[144:147]
  v_exp_f32 v7, v205
  v_cvt_pk_bf16_f32 v165, v4, v5
  s_xor_b32 m0, s49, 0
  v_mfma_f32_16x16x32_bf16 v[148:151], a[16:19], a[128:131], v[148:151]
  buffer_load_dwordx4 v12, s[68:71], s39 offen offset:0 sc1 lds
  v_exp_f32 v8, v206
  v_exp_f32 v9, v207
  v_mfma_f32_16x16x32_bf16 v[148:151], a[20:23], a[132:135], v[148:151]
  v_cvt_pk_bf16_f32 v166, v6, v7
  v_exp_f32 v2, v208
  v_exp_f32 v3, v209
  v_mfma_f32_16x16x32_bf16 v[148:151], a[24:27], a[136:139], v[148:151]
  v_cvt_pk_bf16_f32 v167, v8, v9
  v_exp_f32 v4, v210
  v_exp_f32 v5, v211
  v_mfma_f32_16x16x32_bf16 v[148:151], a[28:31], a[140:143], v[148:151]
  v_cvt_pk_bf16_f32 v168, v2, v3
  v_mfma_f32_16x16x32_bf16 v[240:243], a[72:75], v[164:167], v[240:243]
  v_exp_f32 v6, v212
  v_mfma_f32_16x16x32_bf16 v[152:155], a[0:3], a[144:147], v[236:239]
  buffer_load_dwordx4 v12, s[68:71], s39 offen offset:1024 sc1 lds
  v_exp_f32 v7, v213
  v_cvt_pk_bf16_f32 v169, v4, v5
  v_mfma_f32_16x16x32_bf16 v[152:155], a[4:7], a[148:151], v[152:155]
  v_exp_f32 v8, v214
  v_exp_f32 v9, v215
  v_cvt_pk_bf16_f32 v170, v6, v7
  v_mfma_f32_16x16x32_bf16 v[152:155], a[8:11], a[152:155], v[152:155]
  buffer_load_dwordx4 v12, s[68:71], s39 offen offset:2048 sc1 lds
  v_exp_f32 v2, v216
  v_exp_f32 v3, v217
  v_mfma_f32_16x16x32_bf16 v[152:155], a[12:15], a[156:159], v[152:155]
  v_cvt_pk_bf16_f32 v171, v8, v9
  v_exp_f32 v4, v218
  v_exp_f32 v5, v219
  v_mfma_f32_16x16x32_bf16 v[156:159], a[16:19], a[144:147], v[236:239]
  buffer_load_dwordx4 v12, s[68:71], s39 offen offset:3072 sc1 lds
  v_cvt_pk_bf16_f32 v172, v2, v3
  v_mfma_f32_16x16x32_bf16 v[240:243], a[76:79], v[168:171], v[240:243]
  v_exp_f32 v6, v220
  v_mfma_f32_16x16x32_bf16 v[156:159], a[20:23], a[148:151], v[156:159]
  v_exp_f32 v7, v221
  v_cvt_pk_bf16_f32 v173, v4, v5
  v_exp_f32 v8, v222
  v_mfma_f32_16x16x32_bf16 v[156:159], a[24:27], a[152:155], v[156:159]
  v_exp_f32 v9, v223
  v_cvt_pk_bf16_f32 v174, v6, v7
  v_cvt_pk_bf16_f32 v175, v8, v9
  s_nop 1
  v_mfma_f32_16x16x32_bf16 v[240:243], a[80:83], v[172:175], v[240:243]
  v_mfma_f32_16x16x32_bf16 v[156:159], a[28:31], a[156:159], v[156:159]
  ds_read_b128 a[0:3], v249 offset:16384
  ds_read_b128 a[4:7], v249 offset:17408
  ds_read_b128 a[8:11], v249 offset:18432
  ds_read_b128 a[12:15], v249 offset:19456
  ds_read_b128 a[16:19], v249 offset:20480
  ds_read_b128 a[20:23], v249 offset:21504
  ds_read_b128 a[24:27], v249 offset:22528
  ds_read_b128 a[28:31], v249 offset:23552
  s_waitcnt lgkmcnt(4)

  v_mfma_f32_16x16x32_bf16 v[32:35], a[0:3], v[160:163], 0
  s_add_u32 s48, s39, 16384
  v_exp_f32 v2, v128
  v_mfma_f32_16x16x32_bf16 v[40:43], a[0:3], v[164:167], 0
  s_waitcnt vmcnt(8)
  s_barrier
  v_mfma_f32_16x16x32_bf16 a[192:195], a[0:3], v[168:171], 0
  ds_read_b128 a[32:35], v249 offset:32768
  v_cndmask_b32 v254, v236, v11, s[96:97]
  v_mfma_f32_16x16x32_bf16 a[200:203], a[0:3], v[172:175], 0
  s_add_u32 s39, s39, 32768
  v_exp_f32 v3, v129
  v_mfma_f32_16x16x32_bf16 v[36:39], a[4:7], v[160:163], 0
  ds_read_b128 a[36:39], v249 offset:33792
  v_cvt_pk_bf16_f32 v176, v2, v3
  v_mfma_f32_16x16x32_bf16 v[44:47], a[4:7], v[164:167], 0
  v_exp_f32 v4, v130
  v_mfma_f32_16x16x32_bf16 a[196:199], a[4:7], v[168:171], 0
  v_exp_f32 v5, v131
  v_mfma_f32_16x16x32_bf16 a[204:207], a[4:7], v[172:175], 0
  ds_read_b128 a[40:43], v249 offset:34816
  v_cvt_pk_bf16_f32 v177, v4, v5
  v_mfma_f32_16x16x32_bf16 v[48:51], a[8:11], v[160:163], 0
  s_xor_b32 m0, s49, 16384
  v_exp_f32 v6, v132
  v_mfma_f32_16x16x32_bf16 v[56:59], a[8:11], v[164:167], 0
  buffer_load_dwordx4 v12, s[68:71], s48 offen offset:0 sc1 lds
  v_mfma_f32_16x16x32_bf16 a[208:211], a[8:11], v[168:171], 0
  v_exp_f32 v7, v133
  v_mfma_f32_16x16x32_bf16 a[216:219], a[8:11], v[172:175], 0
  ds_read_b128 a[44:47], v249 offset:35840
  v_cvt_pk_bf16_f32 v178, v6, v7
  v_mfma_f32_16x16x32_bf16 v[52:55], a[12:15], v[160:163], 0
  v_exp_f32 v8, v134
  v_mfma_f32_16x16x32_bf16 v[60:63], a[12:15], v[164:167], 0
  ds_read_b128 a[48:51], v249 offset:36864
  ds_read_b128 a[52:55], v249 offset:37888
  v_mfma_f32_16x16x32_bf16 a[212:215], a[12:15], v[168:171], 0
  v_exp_f32 v9, v135
  v_mfma_f32_16x16x32_bf16 a[220:223], a[12:15], v[172:175], 0
  s_waitcnt lgkmcnt(6)
  v_exp_f32 v2, v136
  v_mfma_f32_16x16x32_bf16 v[64:67], a[16:19], v[160:163], 0
  ds_read_b128 a[56:59], v249 offset:38912
  v_cvt_pk_bf16_f32 v179, v8, v9
  v_mfma_f32_16x16x32_bf16 v[72:75], a[16:19], v[164:167], 0
  v_exp_f32 v3, v137
  v_mfma_f32_16x16x32_bf16 a[224:227], a[16:19], v[168:171], 0
  ds_read_b128 a[60:63], v249 offset:39936
  v_cvt_pk_bf16_f32 v180, v2, v3
  v_mfma_f32_16x16x32_bf16 a[232:235], a[16:19], v[172:175], 0
  v_exp_f32 v4, v138
  v_mfma_f32_16x16x32_bf16 v[244:247], a[68:71], v[176:179], v[240:243]
  buffer_load_dwordx4 v12, s[68:71], s48 offen offset:1024 sc1 lds
  v_mfma_f32_16x16x32_bf16 v[68:71], a[20:23], v[160:163], 0
  v_exp_f32 v5, v139
  v_mfma_f32_16x16x32_bf16 v[76:79], a[20:23], v[164:167], 0
  v_cvt_pk_bf16_f32 v181, v4, v5
  v_xor_b32 v248, 0x10000, v248
  v_mfma_f32_16x16x32_bf16 a[228:231], a[20:23], v[168:171], 0
  v_exp_f32 v6, v140
  v_mfma_f32_16x16x32_bf16 a[236:239], a[20:23], v[172:175], 0
  v_exp_f32 v7, v141
  v_mfma_f32_16x16x32_bf16 v[80:83], a[24:27], v[160:163], 0
  v_cvt_pk_bf16_f32 v182, v6, v7
  v_cndmask_b32 v212, v232, v11, s[96:97]
  v_mfma_f32_16x16x32_bf16 v[88:91], a[24:27], v[164:167], 0
  v_exp_f32 v8, v142
  v_mfma_f32_16x16x32_bf16 a[240:243], a[24:27], v[168:171], 0
  v_cndmask_b32 v213, v232, v11, s[96:97]
  v_cndmask_b32 v214, v232, v11, s[96:97]
  v_mfma_f32_16x16x32_bf16 a[248:251], a[24:27], v[172:175], 0
  v_exp_f32 v9, v143
  v_mfma_f32_16x16x32_bf16 v[84:87], a[28:31], v[160:163], 0
  v_cvt_pk_bf16_f32 v183, v8, v9
  v_cndmask_b32 v215, v232, v11, s[96:97]
  v_mfma_f32_16x16x32_bf16 v[92:95], a[28:31], v[164:167], 0
  v_exp_f32 v2, v144
  v_mfma_f32_16x16x32_bf16 a[244:247], a[28:31], v[168:171], 0
  v_cndmask_b32 v216, v254, v236, s[0:1]
  v_cndmask_b32 v217, v254, v236, s[2:3]
  v_mfma_f32_16x16x32_bf16 a[252:255], a[28:31], v[172:175], 0
  s_waitcnt lgkmcnt(0)
  v_exp_f32 v3, v145
  v_mfma_f32_16x16x32_bf16 v[244:247], a[72:75], v[180:183], v[244:247]
  buffer_load_dwordx4 v12, s[68:71], s48 offen offset:2048 sc1 lds
  v_mfma_f32_16x16x32_bf16 v[192:195], a[32:35], a[160:163], v[224:227]
  s_lshl_b32 s81, s46, 30
  v_exp_f32 v4, v146
  v_mfma_f32_16x16x32_bf16 v[192:195], a[36:39], a[164:167], v[192:195]
  s_add_u32 s81, s81, s46
  v_exp_f32 v5, v147
  v_mfma_f32_16x16x32_bf16 v[192:195], a[40:43], a[168:171], v[192:195]
  v_cvt_pk_bf16_f32 v184, v2, v3
  v_cvt_pk_bf16_f32 v185, v4, v5
  v_mfma_f32_16x16x32_bf16 v[192:195], a[44:47], a[172:175], v[192:195]
  s_add_u32 s81, s81, s36
  v_exp_f32 v6, v148
  v_mfma_f32_16x16x32_bf16 v[196:199], a[48:51], a[160:163], v[224:227]
  buffer_store_dwordx4 v[112:115], v14, s[68:71], s81 offen offset:1024 sc1
  v_mfma_f32_16x16x32_bf16 v[196:199], a[52:55], a[164:167], v[196:199]
  v_exp_f32 v7, v149
  v_mfma_f32_16x16x32_bf16 v[196:199], a[56:59], a[168:171], v[196:199]
  ds_read_b128 a[0:3], v249 offset:24576
  v_cvt_pk_bf16_f32 v186, v6, v7
  v_mfma_f32_16x16x32_bf16 v[196:199], a[60:63], a[172:175], v[196:199]
  v_exp_f32 v8, v150
  v_mfma_f32_16x16x32_bf16 v[200:203], a[32:35], a[176:179], v[228:231]
  ds_read_b128 a[4:7], v249 offset:25600
  ds_read_b128 a[8:11], v249 offset:26624
  v_mfma_f32_16x16x32_bf16 v[200:203], a[36:39], a[180:183], v[200:203]
  v_exp_f32 v9, v151
  v_mfma_f32_16x16x32_bf16 v[200:203], a[40:43], a[184:187], v[200:203]
  v_exp_f32 v2, v152
  v_cvt_pk_bf16_f32 v187, v8, v9
  v_mfma_f32_16x16x32_bf16 v[200:203], a[44:47], a[188:191], v[200:203]
  buffer_load_dwordx4 v12, s[68:71], s48 offen offset:3072 sc1 lds
  v_mfma_f32_16x16x32_bf16 v[204:207], a[48:51], a[176:179], v[228:231]
  s_lshl_b32 s81, s46, 30
  v_exp_f32 v3, v153
  s_add_u32 s81, s81, s46
  s_add_u32 s81, s81, s37
  v_mfma_f32_16x16x32_bf16 v[204:207], a[52:55], a[180:183], v[204:207]
  buffer_store_dwordx4 v[120:123], v14, s[68:71], s81 offen offset:1024 sc1
  v_mfma_f32_16x16x32_bf16 v[204:207], a[56:59], a[184:187], v[204:207]
  v_exp_f32 v4, v154
  v_mfma_f32_16x16x32_bf16 v[204:207], a[60:63], a[188:191], v[204:207]
  v_cvt_pk_bf16_f32 v188, v2, v3
  v_cndmask_b32 v218, v254, v236, s[4:5]
  v_mfma_f32_16x16x32_bf16 v[244:247], a[76:79], v[184:187], v[244:247]
  v_exp_f32 v5, v155
  v_mfma_f32_16x16x32_bf16 v[208:211], a[32:35], a[128:131], v[212:215]
  v_cvt_pk_bf16_f32 v189, v4, v5
  v_cndmask_b32 v219, v254, v236, s[6:7]
  v_mfma_f32_16x16x32_bf16 v[208:211], a[36:39], a[132:135], v[208:211]
  s_andn2_b32 s81, s46, 1
  v_exp_f32 v6, v156
  v_mfma_f32_16x16x32_bf16 v[208:211], a[40:43], a[136:139], v[208:211]
  s_add_u32 s81, s81, s36
  v_exp_f32 v7, v157
  v_mfma_f32_16x16x32_bf16 v[208:211], a[44:47], a[140:143], v[208:211]
  buffer_store_dwordx4 v[96:99], v14, s[68:71], s81 offen offset:0 sc1
  v_mfma_f32_16x16x32_bf16 v[212:215], a[48:51], a[128:131], v[212:215]
  v_exp_f32 v8, v158
  v_mfma_f32_16x16x32_bf16 v[212:215], a[52:55], a[132:135], v[212:215]
  v_cvt_pk_bf16_f32 v190, v6, v7
  v_cndmask_b32 v220, v254, v236, s[8:9]
  v_mfma_f32_16x16x32_bf16 v[212:215], a[56:59], a[136:139], v[212:215]
  v_exp_f32 v9, v159
  v_mfma_f32_16x16x32_bf16 v[212:215], a[60:63], a[140:143], v[212:215]
  v_cvt_pk_bf16_f32 v191, v8, v9
  v_cndmask_b32 v221, v254, v236, s[10:11]
  v_mfma_f32_16x16x32_bf16 v[216:219], a[32:35], a[144:147], v[216:219]
  ds_read_b128 a[12:15], v249 offset:27648
  v_cndmask_b32 v222, v254, v236, s[12:13]
  v_mfma_f32_16x16x32_bf16 v[244:247], a[80:83], v[188:191], v[244:247]
  ds_read_b128 a[16:19], v249 offset:28672
  v_cndmask_b32 v223, v254, v236, s[14:15]
  v_mfma_f32_16x16x32_bf16 v[216:219], a[36:39], a[148:151], v[216:219]
  ds_read_b128 a[20:23], v249 offset:29696
  v_accvgpr_write_b32 a84, -1
  v_mfma_f32_16x16x32_bf16 v[216:219], a[40:43], a[152:155], v[216:219]
  ds_read_b128 a[24:27], v249 offset:30720
  v_accvgpr_write_b32 a85, -1
  v_mfma_f32_16x16x32_bf16 v[216:219], a[44:47], a[156:159], v[216:219]
  ds_read_b128 a[28:31], v249 offset:31744
  v_accvgpr_write_b32 a86, -1
  v_mfma_f32_16x16x32_bf16 v[220:223], a[48:51], a[144:147], v[220:223]
  s_lshr_b32 s84, s78, 2
  v_accvgpr_write_b32 a87, -1
  v_max3_f32 v250, v244, v245, v246
  v_mfma_f32_16x16x32_bf16 v[220:223], a[52:55], a[148:151], v[220:223]
  s_waitcnt lgkmcnt(4)
  v_max_f32 v250, v250, v247
  v_cmp_nge_f32 vcc, s44, v250
  v_mfma_f32_16x16x32_bf16 v[220:223], a[56:59], a[152:155], v[220:223]
  s_xor_b32 s84, s84, 1
  s_lshl_b32 s84, s84, 30
  v_add_u32 v255, s84, v12
  v_mfma_f32_16x16x32_bf16 v[220:223], a[60:63], a[156:159], v[220:223]
  s_cbranch_vccnz L_g1_rare
L_g1_back:
  v_mfma_f32_16x16x32_bf16 v[32:35], a[0:3], v[176:179], v[32:35]
  s_lshl_b32 s84, s78, 7
  v_exp_f32 v2, v192
  v_mfma_f32_16x16x32_bf16 v[40:43], a[0:3], v[180:183], v[40:43]
  s_waitcnt vmcnt(11)
  s_barrier
  v_mfma_f32_16x16x32_bf16 a[192:195], a[0:3], v[184:187], a[192:195]
  s_lshl_b32 s85, s77, 2
  ds_read_b128 a[32:35], v249 offset:40960
  v_cndmask_b32 v254, v236, v11, s[96:97]
  v_mfma_f32_16x16x32_bf16 a[200:203], a[0:3], v[188:191], a[200:203]
  s_add_u32 s84, s84, s85
  v_exp_f32 v3, v193
  v_mfma_f32_16x16x32_bf16 v[36:39], a[4:7], v[176:179], v[36:39]
  s_add_u32 s38, s84, 67112960
  ds_read_b128 a[36:39], v249 offset:41984
  v_cvt_pk_bf16_f32 v160, v2, v3
  v_mfma_f32_16x16x32_bf16 v[44:47], a[4:7], v[180:183], v[44:47]
  s_lshl_b32 s84, s76, 1
  v_exp_f32 v4, v194
  v_mfma_f32_16x16x32_bf16 a[196:199], a[4:7], v[184:187], a[196:199]
  s_add_u32 s84, s84, s40
  v_exp_f32 v5, v195
  v_mfma_f32_16x16x32_bf16 a[204:207], a[4:7], v[188:191], a[204:207]
  s_and_b32 s85, s84, 3
  ds_read_b128 a[40:43], v249 offset:43008
  v_cvt_pk_bf16_f32 v161, v4, v5
  v_mfma_f32_16x16x32_bf16 v[48:51], a[8:11], v[176:179], v[48:51]
  s_mul_i32 s85, s85, 176128
  v_exp_f32 v6, v196
  v_mfma_f32_16x16x32_bf16 v[56:59], a[8:11], v[180:183], v[56:59]
  buffer_load_dword v13, v18, s[68:71], s82 offen sc1
  v_mfma_f32_16x16x32_bf16 a[208:211], a[8:11], v[184:187], a[208:211]
  s_xor_b32 m0, s49, 32768
  v_exp_f32 v7, v197
  v_mfma_f32_16x16x32_bf16 a[216:219], a[8:11], v[188:191], a[216:219]
  buffer_load_dwordx4 v12, s[68:71], s39 offen offset:0 sc1 lds
  v_mfma_f32_16x16x32_bf16 v[52:55], a[12:15], v[176:179], v[52:55]
  s_add_u32 s85, s85, 1024
  v_exp_f32 v8, v198
  v_mfma_f32_16x16x32_bf16 v[60:63], a[12:15], v[180:183], v[60:63]
  ds_read_b128 a[44:47], v249 offset:44032
  v_cvt_pk_bf16_f32 v162, v6, v7
  v_mfma_f32_16x16x32_bf16 a[212:215], a[12:15], v[184:187], a[212:215]
  v_exp_f32 v9, v199
  v_mfma_f32_16x16x32_bf16 a[220:223], a[12:15], v[188:191], a[220:223]
  s_waitcnt lgkmcnt(4)
  v_exp_f32 v2, v200
  v_mfma_f32_16x16x32_bf16 v[64:67], a[16:19], v[176:179], v[64:67]
  ds_read_b128 a[48:51], v249 offset:45056
  v_cvt_pk_bf16_f32 v163, v8, v9
  v_mfma_f32_16x16x32_bf16 v[72:75], a[16:19], v[180:183], v[72:75]
  v_exp_f32 v3, v201
  v_mfma_f32_16x16x32_bf16 a[224:227], a[16:19], v[184:187], a[224:227]
  ds_read_b128 a[52:55], v249 offset:46080
  ds_read_b128 a[56:59], v249 offset:47104
  v_mfma_f32_16x16x32_bf16 a[232:235], a[16:19], v[188:191], a[232:235]
  v_exp_f32 v4, v202
  v_mfma_f32_16x16x32_bf16 v[240:243], a[68:71], v[160:163], v[244:247]
  buffer_load_dwordx4 v12, s[68:71], s39 offen offset:1024 sc1 lds
  v_mfma_f32_16x16x32_bf16 v[68:71], a[20:23], v[176:179], v[68:71]
  s_andn2_b32 s81, s46, 1
  v_exp_f32 v5, v203
  s_add_u32 s81, s81, s37
  v_mfma_f32_16x16x32_bf16 v[76:79], a[20:23], v[180:183], v[76:79]
  buffer_store_dwordx4 v[100:103], v14, s[68:71], s81 offen offset:0 sc1
  v_mfma_f32_16x16x32_bf16 a[228:231], a[20:23], v[184:187], a[228:231]
  v_exp_f32 v6, v204
  v_mfma_f32_16x16x32_bf16 a[236:239], a[20:23], v[188:191], a[236:239]
  v_exp_f32 v7, v205
  v_mfma_f32_16x16x32_bf16 v[80:83], a[24:27], v[176:179], v[80:83]
  ds_read_b128 a[60:63], v249 offset:48128
  v_cvt_pk_bf16_f32 v164, v2, v3
  v_mfma_f32_16x16x32_bf16 v[88:91], a[24:27], v[180:183], v[88:91]
  v_exp_f32 v8, v206
  v_mfma_f32_16x16x32_bf16 a[240:243], a[24:27], v[184:187], a[240:243]
  v_cvt_pk_bf16_f32 v165, v4, v5
  v_cvt_pk_bf16_f32 v166, v6, v7
  v_mfma_f32_16x16x32_bf16 a[248:251], a[24:27], v[188:191], a[248:251]
  v_exp_f32 v9, v207
  v_mfma_f32_16x16x32_bf16 v[84:87], a[28:31], v[176:179], v[84:87]
  v_cvt_pk_bf16_f32 v167, v8, v9
  v_cndmask_b32 v148, v232, v11, s[96:97]
  v_mfma_f32_16x16x32_bf16 v[92:95], a[28:31], v[180:183], v[92:95]
  v_exp_f32 v2, v208
  v_mfma_f32_16x16x32_bf16 a[244:247], a[28:31], v[184:187], a[244:247]
  v_cndmask_b32 v149, v232, v11, s[96:97]
  v_cndmask_b32 v150, v232, v11, s[96:97]
  v_mfma_f32_16x16x32_bf16 a[252:255], a[28:31], v[188:191], a[252:255]
  s_waitcnt lgkmcnt(0)
  v_exp_f32 v3, v209
  v_mfma_f32_16x16x32_bf16 v[240:243], a[72:75], v[164:167], v[240:243]
  buffer_load_dwordx4 v12, s[68:71], s39 offen offset:2048 sc1 lds
  v_mfma_f32_16x16x32_bf16 v[128:131], a[32:35], a[160:163], v[224:227]
  v_exp_f32 v4, v210
  v_mfma_f32_16x16x32_bf16 v[128:131], a[36:39], a[164:167], v[128:131]
  s_andn2_b32 s81, s46, 1
  v_exp_f32 v5, v211
  v_mfma_f32_16x16x32_bf16 v[128:131], a[40:43], a[168:171], v[128:131]
  v_cvt_pk_bf16_f32 v168, v2, v3
  v_cvt_pk_bf16_f32 v169, v4, v5
  v_mfma_f32_16x16x32_bf16 v[128:131], a[44:47], a[172:175], v[128:131]
  s_add_u32 s81, s81, s36
  v_exp_f32 v6, v212
  v_mfma_f32_16x16x32_bf16 v[132:135], a[48:51], a[160:163], v[224:227]
  buffer_store_dwordx4 v[104:107], v14, s[68:71], s81 offen offset:512 sc1
  v_mfma_f32_16x16x32_bf16 v[132:135], a[52:55], a[164:167], v[132:135]
  v_exp_f32 v7, v213
  v_mfma_f32_16x16x32_bf16 v[132:135], a[56:59], a[168:171], v[132:135]
  ds_read_b128 a[0:3], v249 offset:49152
  v_cvt_pk_bf16_f32 v170, v6, v7
  v_mfma_f32_16x16x32_bf16 v[132:135], a[60:63], a[172:175], v[132:135]
  v_exp_f32 v8, v214
  v_mfma_f32_16x16x32_bf16 v[136:139], a[32:35], a[176:179], v[228:231]
  ds_read_b128 a[4:7], v249 offset:50176
  ds_read_b128 a[8:11], v249 offset:51200
  v_mfma_f32_16x16x32_bf16 v[136:139], a[36:39], a[180:183], v[136:139]
  v_exp_f32 v9, v215
  v_mfma_f32_16x16x32_bf16 v[136:139], a[40:43], a[184:187], v[136:139]
  v_exp_f32 v2, v216
  v_mfma_f32_16x16x32_bf16 v[136:139], a[44:47], a[188:191], v[136:139]
  buffer_load_dwordx4 v12, s[68:71], s39 offen offset:3072 sc1 lds
  v_mfma_f32_16x16x32_bf16 v[140:143], a[48:51], a[176:179], v[228:231]
  v_exp_f32 v3, v217
  v_mfma_f32_16x16x32_bf16 v[140:143], a[52:55], a[180:183], v[140:143]
  v_cvt_pk_bf16_f32 v171, v8, v9
  v_cvt_pk_bf16_f32 v172, v2, v3
  v_mfma_f32_16x16x32_bf16 v[140:143], a[56:59], a[184:187], v[140:143]
  s_andn2_b32 s81, s46, 1
  v_exp_f32 v4, v218
  v_cndmask_b32 v151, v232, v11, s[96:97]
  v_mfma_f32_16x16x32_bf16 v[140:143], a[60:63], a[188:191], v[140:143]
  v_cndmask_b32 v152, v254, v236, s[16:17]
  v_cndmask_b32 v153, v254, v236, s[18:19]
  v_mfma_f32_16x16x32_bf16 v[240:243], a[76:79], v[168:171], v[240:243]
  s_add_u32 s81, s81, s37
  v_exp_f32 v5, v219
  v_mfma_f32_16x16x32_bf16 v[144:147], a[32:35], a[128:131], v[148:151]
  buffer_store_dwordx4 v[108:111], v14, s[68:71], s81 offen offset:512 sc1
  v_mfma_f32_16x16x32_bf16 v[144:147], a[36:39], a[132:135], v[144:147]
  v_exp_f32 v6, v220
  v_mfma_f32_16x16x32_bf16 v[144:147], a[40:43], a[136:139], v[144:147]
  v_exp_f32 v7, v221
  v_mfma_f32_16x16x32_bf16 v[144:147], a[44:47], a[140:143], v[144:147]
  v_cvt_pk_bf16_f32 v173, v4, v5
  v_cvt_pk_bf16_f32 v174, v6, v7
  v_mfma_f32_16x16x32_bf16 v[148:151], a[48:51], a[128:131], v[148:151]
  v_exp_f32 v8, v222
  v_mfma_f32_16x16x32_bf16 v[148:151], a[52:55], a[132:135], v[148:151]
  v_cndmask_b32 v154, v254, v236, s[20:21]
  v_cndmask_b32 v155, v254, v236, s[22:23]
  v_mfma_f32_16x16x32_bf16 v[148:151], a[56:59], a[136:139], v[148:151]
  v_exp_f32 v9, v223
  v_mfma_f32_16x16x32_bf16 v[148:151], a[60:63], a[140:143], v[148:151]
  v_cvt_pk_bf16_f32 v175, v8, v9
  v_cndmask_b32 v156, v254, v236, s[24:25]
  v_mfma_f32_16x16x32_bf16 v[152:155], a[32:35], a[144:147], v[152:155]
  ds_read_b128 a[12:15], v249 offset:52224
  v_cndmask_b32 v157, v254, v236, s[26:27]
  v_mfma_f32_16x16x32_bf16 v[240:243], a[80:83], v[172:175], v[240:243]
  ds_read_b128 a[16:19], v249 offset:53248
  v_cndmask_b32 v158, v254, v236, s[28:29]
  v_mfma_f32_16x16x32_bf16 v[152:155], a[36:39], a[148:151], v[152:155]
L_hop10:
  s_cbranch_execz L_hop14
  ds_read_b128 a[20:23], v249 offset:54272
  v_cndmask_b32 v159, v254, v236, s[30:31]
  v_mfma_f32_16x16x32_bf16 v[152:155], a[40:43], a[152:155], v[152:155]
  s_add_u32 s84, s84, 1
  ds_read_b128 a[24:27], v249 offset:55296
  v_add_u32 v24, s85, v12
  v_mfma_f32_16x16x32_bf16 v[152:155], a[44:47], a[156:159], v[152:155]
  s_and_b32 s85, s84, 3
  ds_read_b128 a[28:31], v249 offset:56320
  s_mul_i32 s85, s85, 176128
  v_mfma_f32_16x16x32_bf16 v[156:159], a[48:51], a[144:147], v[156:159]
  v_add_u32 v25, s85, v12
  v_max3_f32 v250, v240, v241, v242
  v_mfma_f32_16x16x32_bf16 v[156:159], a[52:55], a[148:151], v[156:159]
  s_waitcnt lgkmcnt(4)
  v_max_f32 v250, v250, v243
  v_cmp_nge_f32 vcc, s44, v250
  v_mfma_f32_16x16x32_bf16 v[156:159], a[56:59], a[152:155], v[156:159]
  v_mfma_f32_16x16x32_bf16 v[156:159], a[60:63], a[156:159], v[156:159]
  s_cbranch_vccnz L_g2_rare
L_g2_back:
  s_waitcnt vmcnt(7)
  v_cmp_le_u32 vcc, 2, v13
  s_nop 0
  s_and_b32 s80, vcc_lo, 65535
  s_cmp_eq_u32 s80, 65535
  s_cbranch_scc0 L_kv3_spin
L_kv3_ok:
  s_cmp_eq_u32 s78, 0
  s_cbranch_scc1 L_dx
  s_cmp_eq_u32 s78, 1
  s_cbranch_scc1 L_dm
L_dl:
  v_mfma_f32_16x16x32_bf16 v[32:35], a[0:3], v[160:163], v[32:35]
  v_exp_f32 v2, v128
  v_xor_b32 v249, 0x10000, v249
  v_mfma_f32_16x16x32_bf16 v[40:43], a[0:3], v[164:167], v[40:43]
  s_waitcnt vmcnt(6)
  s_barrier
  v_mfma_f32_16x16x32_bf16 a[192:195], a[0:3], v[168:171], a[192:195]
  s_xor_b32 s49, s49, 0x10000
  ds_read_b128 a[32:35], v249 offset:0
  v_mfma_f32_16x16x32_bf16 a[200:203], a[0:3], v[172:175], a[200:203]
  s_add_u32 s48, s39, 16384
  v_exp_f32 v3, v129
  v_mfma_f32_16x16x32_bf16 v[36:39], a[4:7], v[160:163], v[36:39]
  s_add_u32 s39, s39, 32768
  ds_read_b128 a[36:39], v249 offset:1024
  v_cvt_pk_bf16_f32 v176, v2, v3
  v_mfma_f32_16x16x32_bf16 v[44:47], a[4:7], v[164:167], v[44:47]
  v_exp_f32 v4, v130
  v_mfma_f32_16x16x32_bf16 a[196:199], a[4:7], v[168:171], a[196:199]
  v_exp_f32 v5, v131
  v_mfma_f32_16x16x32_bf16 a[204:207], a[4:7], v[172:175], a[204:207]
  ds_read_b128 a[40:43], v249 offset:2048
  v_cvt_pk_bf16_f32 v177, v4, v5
  v_mfma_f32_16x16x32_bf16 v[48:51], a[8:11], v[160:163], v[48:51]
  s_xor_b32 m0, s49, 114688
  v_exp_f32 v6, v132
  v_mfma_f32_16x16x32_bf16 v[56:59], a[8:11], v[164:167], v[56:59]
  buffer_load_dwordx4 v12, s[68:71], s48 offen offset:0 sc1 lds
  v_mfma_f32_16x16x32_bf16 a[208:211], a[8:11], v[168:171], a[208:211]
  v_exp_f32 v7, v133
  v_mfma_f32_16x16x32_bf16 a[216:219], a[8:11], v[172:175], a[216:219]
  ds_read_b128 a[44:47], v249 offset:3072
  v_cvt_pk_bf16_f32 v178, v6, v7
  v_mfma_f32_16x16x32_bf16 v[52:55], a[12:15], v[160:163], v[52:55]
  v_exp_f32 v8, v134
  v_mfma_f32_16x16x32_bf16 v[60:63], a[12:15], v[164:167], v[60:63]
  ds_read_b128 a[48:51], v249 offset:4096
  ds_read_b128 a[52:55], v249 offset:5120
  v_mfma_f32_16x16x32_bf16 a[212:215], a[12:15], v[168:171], a[212:215]
  v_exp_f32 v9, v135
  v_mfma_f32_16x16x32_bf16 a[220:223], a[12:15], v[172:175], a[220:223]
  s_waitcnt lgkmcnt(6)
  v_exp_f32 v2, v136
  v_mfma_f32_16x16x32_bf16 v[64:67], a[16:19], v[160:163], v[64:67]
  buffer_load_dwordx4 v12, s[68:71], s48 offen offset:1024 sc1 lds
  v_mfma_f32_16x16x32_bf16 v[72:75], a[16:19], v[164:167], v[72:75]
  v_exp_f32 v3, v137
  v_mfma_f32_16x16x32_bf16 a[224:227], a[16:19], v[168:171], a[224:227]
  ds_read_b128 a[56:59], v249 offset:6144
  v_cvt_pk_bf16_f32 v179, v8, v9
  v_mfma_f32_16x16x32_bf16 a[232:235], a[16:19], v[172:175], a[232:235]
  v_exp_f32 v4, v138
  v_mfma_f32_16x16x32_bf16 v[244:247], a[68:71], v[176:179], v[240:243]
  ds_read_b128 a[60:63], v249 offset:7168
  v_cvt_pk_bf16_f32 v180, v2, v3
  v_mfma_f32_16x16x32_bf16 v[68:71], a[20:23], v[160:163], v[68:71]
  v_exp_f32 v5, v139
  v_mfma_f32_16x16x32_bf16 v[76:79], a[20:23], v[164:167], v[76:79]
  v_cvt_pk_bf16_f32 v181, v4, v5
  v_mfma_f32_16x16x32_bf16 a[228:231], a[20:23], v[168:171], a[228:231]
  v_exp_f32 v6, v140
  v_mfma_f32_16x16x32_bf16 a[236:239], a[20:23], v[172:175], a[236:239]
  v_exp_f32 v7, v141
  v_mfma_f32_16x16x32_bf16 v[80:83], a[24:27], v[160:163], v[80:83]
  buffer_load_dwordx4 v12, s[68:71], s48 offen offset:2048 sc1 lds
  v_mfma_f32_16x16x32_bf16 v[88:91], a[24:27], v[164:167], v[88:91]
  v_exp_f32 v8, v142
  v_mfma_f32_16x16x32_bf16 a[240:243], a[24:27], v[168:171], a[240:243]
  v_cvt_pk_bf16_f32 v182, v6, v7
  v_mfma_f32_16x16x32_bf16 a[248:251], a[24:27], v[172:175], a[248:251]
  v_exp_f32 v9, v143
  v_mfma_f32_16x16x32_bf16 v[84:87], a[28:31], v[160:163], v[84:87]
  v_cvt_pk_bf16_f32 v183, v8, v9
  v_mfma_f32_16x16x32_bf16 v[92:95], a[28:31], v[164:167], v[92:95]
  v_exp_f32 v2, v144
  v_mfma_f32_16x16x32_bf16 a[244:247], a[28:31], v[168:171], a[244:247]
  v_mfma_f32_16x16x32_bf16 a[252:255], a[28:31], v[172:175], a[252:255]
  s_waitcnt lgkmcnt(0)
  v_exp_f32 v3, v145
  v_mfma_f32_16x16x32_bf16 v[244:247], a[72:75], v[180:183], v[244:247]
  buffer_load_dwordx4 v12, s[68:71], s48 offen offset:3072 sc1 lds
  v_mfma_f32_16x16x32_bf16 v[192:195], a[32:35], a[160:163], v[224:227]
  v_exp_f32 v4, v146
  v_mfma_f32_16x16x32_bf16 v[192:195], a[36:39], a[164:167], v[192:195]
  s_add_u32 s90, s90, 1408
  v_exp_f32 v5, v147
  v_mfma_f32_16x16x32_bf16 v[192:195], a[40:43], a[168:171], v[192:195]
  buffer_load_dword a65, v19, s[52:55], s90 offen
  v_mfma_f32_16x16x32_bf16 v[192:195], a[44:47], a[172:175], v[192:195]
  v_exp_f32 v6, v148
  v_mfma_f32_16x16x32_bf16 v[196:199], a[48:51], a[160:163], v[224:227]
  v_cvt_pk_bf16_f32 v184, v2, v3
  v_cvt_pk_bf16_f32 v185, v4, v5
  v_mfma_f32_16x16x32_bf16 v[196:199], a[52:55], a[164:167], v[196:199]
  v_exp_f32 v7, v149
  v_mfma_f32_16x16x32_bf16 v[196:199], a[56:59], a[168:171], v[196:199]
  ds_read_b128 a[0:3], v248 offset:57344
  v_cvt_pk_bf16_f32 v186, v6, v7
  v_mfma_f32_16x16x32_bf16 v[196:199], a[60:63], a[172:175], v[196:199]
  v_exp_f32 v8, v150
  v_mfma_f32_16x16x32_bf16 v[200:203], a[32:35], a[176:179], v[228:231]
  ds_read_b128 a[4:7], v248 offset:58368
  ds_read_b128 a[8:11], v248 offset:59392
  v_mfma_f32_16x16x32_bf16 v[200:203], a[36:39], a[180:183], v[200:203]
  v_exp_f32 v9, v151
  v_mfma_f32_16x16x32_bf16 v[200:203], a[40:43], a[184:187], v[200:203]
  v_exp_f32 v2, v152
  v_mfma_f32_16x16x32_bf16 v[200:203], a[44:47], a[188:191], v[200:203]
  v_cvt_pk_bf16_f32 v187, v8, v9
  v_mfma_f32_16x16x32_bf16 v[204:207], a[48:51], a[176:179], v[228:231]
  v_exp_f32 v3, v153
  v_mfma_f32_16x16x32_bf16 v[204:207], a[52:55], a[180:183], v[204:207]
  v_cvt_pk_bf16_f32 v188, v2, v3
  v_mfma_f32_16x16x32_bf16 v[204:207], a[56:59], a[184:187], v[204:207]
  v_exp_f32 v4, v154
  v_mfma_f32_16x16x32_bf16 v[204:207], a[60:63], a[188:191], v[204:207]
  v_mfma_f32_16x16x32_bf16 v[244:247], a[76:79], v[184:187], v[244:247]
  v_exp_f32 v5, v155
  v_mfma_f32_16x16x32_bf16 v[208:211], a[32:35], a[128:131], v[232:235]
  v_cvt_pk_bf16_f32 v189, v4, v5
  v_mfma_f32_16x16x32_bf16 v[208:211], a[36:39], a[132:135], v[208:211]
  v_exp_f32 v6, v156
  v_mfma_f32_16x16x32_bf16 v[208:211], a[40:43], a[136:139], v[208:211]
  v_exp_f32 v7, v157
  v_mfma_f32_16x16x32_bf16 v[208:211], a[44:47], a[140:143], v[208:211]
  v_cvt_pk_bf16_f32 v190, v6, v7
  v_mfma_f32_16x16x32_bf16 v[212:215], a[48:51], a[128:131], v[232:235]
  v_exp_f32 v8, v158
  v_mfma_f32_16x16x32_bf16 v[212:215], a[52:55], a[132:135], v[212:215]
  v_mfma_f32_16x16x32_bf16 v[212:215], a[56:59], a[136:139], v[212:215]
  v_exp_f32 v9, v159
  v_mfma_f32_16x16x32_bf16 v[212:215], a[60:63], a[140:143], v[212:215]
  v_cvt_pk_bf16_f32 v191, v8, v9
  v_mfma_f32_16x16x32_bf16 v[216:219], a[32:35], a[144:147], v[236:239]
  ds_read_b128 a[12:15], v248 offset:60416
  v_mfma_f32_16x16x32_bf16 v[244:247], a[80:83], v[188:191], v[244:247]
  ds_read_b128 a[16:19], v248 offset:61440
  v_mfma_f32_16x16x32_bf16 v[216:219], a[36:39], a[148:151], v[216:219]
  ds_read_b128 a[20:23], v248 offset:62464
  v_mfma_f32_16x16x32_bf16 v[216:219], a[40:43], a[152:155], v[216:219]
  ds_read_b128 a[24:27], v248 offset:63488
  v_mfma_f32_16x16x32_bf16 v[216:219], a[44:47], a[156:159], v[216:219]
  ds_read_b128 a[28:31], v248 offset:64512
  v_mfma_f32_16x16x32_bf16 v[220:223], a[48:51], a[144:147], v[236:239]
  v_max3_f32 v250, v244, v245, v246
  v_mfma_f32_16x16x32_bf16 v[220:223], a[52:55], a[148:151], v[220:223]
  s_waitcnt lgkmcnt(4)
  v_max_f32 v250, v250, v247
  v_cmp_nge_f32 vcc, s44, v250
  v_mfma_f32_16x16x32_bf16 v[220:223], a[56:59], a[152:155], v[220:223]
  v_mfma_f32_16x16x32_bf16 v[220:223], a[60:63], a[156:159], v[220:223]
  s_cbranch_vccnz L_dl0_rare
L_dl0_back:
  v_mfma_f32_16x16x32_bf16 v[32:35], a[0:3], v[176:179], v[32:35]
  v_exp_f32 v2, v192
  v_mfma_f32_16x16x32_bf16 v[40:43], a[0:3], v[180:183], v[40:43]
  ds_read_b128 a[32:35], v249 offset:8192
  v_mfma_f32_16x16x32_bf16 a[192:195], a[0:3], v[184:187], a[192:195]
  v_exp_f32 v3, v193
  v_mfma_f32_16x16x32_bf16 a[200:203], a[0:3], v[188:191], a[200:203]
  ds_read_b128 a[36:39], v249 offset:9216
  v_cvt_pk_bf16_f32 v160, v2, v3
  v_mfma_f32_16x16x32_bf16 v[36:39], a[4:7], v[176:179], v[36:39]
  v_exp_f32 v4, v194
  v_mfma_f32_16x16x32_bf16 v[44:47], a[4:7], v[180:183], v[44:47]
  ds_read_b128 a[40:43], v249 offset:10240
  v_mfma_f32_16x16x32_bf16 a[196:199], a[4:7], v[184:187], a[196:199]
  v_exp_f32 v5, v195
  v_mfma_f32_16x16x32_bf16 a[204:207], a[4:7], v[188:191], a[204:207]
  s_xor_b32 m0, s49, 0
  v_exp_f32 v6, v196
  v_mfma_f32_16x16x32_bf16 v[48:51], a[8:11], v[176:179], v[48:51]
  buffer_load_dwordx4 v12, s[68:71], s39 offen offset:0 sc1 lds
  v_mfma_f32_16x16x32_bf16 v[56:59], a[8:11], v[180:183], v[56:59]
  v_exp_f32 v7, v197
  v_mfma_f32_16x16x32_bf16 a[208:211], a[8:11], v[184:187], a[208:211]
  v_cvt_pk_bf16_f32 v161, v4, v5
  v_cvt_pk_bf16_f32 v162, v6, v7
  v_mfma_f32_16x16x32_bf16 a[216:219], a[8:11], v[188:191], a[216:219]
  v_exp_f32 v8, v198
  v_mfma_f32_16x16x32_bf16 v[52:55], a[12:15], v[176:179], v[52:55]
  ds_read_b128 a[44:47], v249 offset:11264
  ds_read_b128 a[48:51], v249 offset:12288
  v_mfma_f32_16x16x32_bf16 v[60:63], a[12:15], v[180:183], v[60:63]
  v_exp_f32 v9, v199
  v_mfma_f32_16x16x32_bf16 a[212:215], a[12:15], v[184:187], a[212:215]
  ds_read_b128 a[52:55], v249 offset:13312
  v_cvt_pk_bf16_f32 v163, v8, v9
  v_mfma_f32_16x16x32_bf16 a[220:223], a[12:15], v[188:191], a[220:223]
  s_waitcnt lgkmcnt(6)
  v_exp_f32 v2, v200
  v_mfma_f32_16x16x32_bf16 v[64:67], a[16:19], v[176:179], v[64:67]
  buffer_load_dwordx4 v12, s[68:71], s39 offen offset:1024 sc1 lds
  v_mfma_f32_16x16x32_bf16 v[72:75], a[16:19], v[180:183], v[72:75]
  v_exp_f32 v3, v201
  v_mfma_f32_16x16x32_bf16 a[224:227], a[16:19], v[184:187], a[224:227]
  v_exp_f32 v4, v202
  v_mfma_f32_16x16x32_bf16 a[232:235], a[16:19], v[188:191], a[232:235]
  ds_read_b128 a[56:59], v249 offset:14336
  ds_read_b128 a[60:63], v249 offset:15360
  v_mfma_f32_16x16x32_bf16 v[240:243], a[68:71], v[160:163], v[244:247]
  v_exp_f32 v5, v203
  v_mfma_f32_16x16x32_bf16 v[68:71], a[20:23], v[176:179], v[68:71]
  v_cvt_pk_bf16_f32 v164, v2, v3
  v_cvt_pk_bf16_f32 v165, v4, v5
  v_mfma_f32_16x16x32_bf16 v[76:79], a[20:23], v[180:183], v[76:79]
  v_exp_f32 v6, v204
  v_mfma_f32_16x16x32_bf16 a[228:231], a[20:23], v[184:187], a[228:231]
  v_mfma_f32_16x16x32_bf16 a[236:239], a[20:23], v[188:191], a[236:239]
  v_exp_f32 v7, v205
  v_mfma_f32_16x16x32_bf16 v[80:83], a[24:27], v[176:179], v[80:83]
  buffer_load_dwordx4 v12, s[68:71], s39 offen offset:2048 sc1 lds
  v_mfma_f32_16x16x32_bf16 v[88:91], a[24:27], v[180:183], v[88:91]
  v_exp_f32 v8, v206
  v_mfma_f32_16x16x32_bf16 a[240:243], a[24:27], v[184:187], a[240:243]
  v_cvt_pk_bf16_f32 v166, v6, v7
  v_mfma_f32_16x16x32_bf16 a[248:251], a[24:27], v[188:191], a[248:251]
  v_exp_f32 v9, v207
  v_mfma_f32_16x16x32_bf16 v[84:87], a[28:31], v[176:179], v[84:87]
  v_exp_f32 v2, v208
  v_mfma_f32_16x16x32_bf16 v[92:95], a[28:31], v[180:183], v[92:95]
  v_cvt_pk_bf16_f32 v167, v8, v9
  v_mfma_f32_16x16x32_bf16 a[244:247], a[28:31], v[184:187], a[244:247]
  v_exp_f32 v3, v209
  v_mfma_f32_16x16x32_bf16 a[252:255], a[28:31], v[188:191], a[252:255]
  buffer_load_dwordx4 v12, s[68:71], s39 offen offset:3072 sc1 lds
  v_mfma_f32_16x16x32_bf16 v[240:243], a[72:75], v[164:167], v[240:243]
  s_waitcnt lgkmcnt(0)
  v_exp_f32 v4, v210
  v_mfma_f32_16x16x32_bf16 v[128:131], a[32:35], a[160:163], v[224:227]
  ds_read_b128 a[0:3], v249 offset:16384
  v_cvt_pk_bf16_f32 v168, v2, v3
  v_mfma_f32_16x16x32_bf16 v[128:131], a[36:39], a[164:167], v[128:131]
  s_add_u32 s91, s91, 512
  v_exp_f32 v5, v211
  v_mfma_f32_16x16x32_bf16 v[128:131], a[40:43], a[168:171], v[128:131]
  buffer_load_dword a64, v1, s[60:63], s91 offen
  v_mfma_f32_16x16x32_bf16 v[128:131], a[44:47], a[172:175], v[128:131]
  v_exp_f32 v6, v212
  v_mfma_f32_16x16x32_bf16 v[132:135], a[48:51], a[160:163], v[224:227]
  ds_read_b128 a[4:7], v249 offset:17408
  v_cvt_pk_bf16_f32 v169, v4, v5
  v_mfma_f32_16x16x32_bf16 v[132:135], a[52:55], a[164:167], v[132:135]
  v_exp_f32 v7, v213
  v_mfma_f32_16x16x32_bf16 v[132:135], a[56:59], a[168:171], v[132:135]
  v_exp_f32 v8, v214
  v_mfma_f32_16x16x32_bf16 v[132:135], a[60:63], a[172:175], v[132:135]
  ds_read_b128 a[8:11], v249 offset:18432
  v_cvt_pk_bf16_f32 v170, v6, v7
  v_mfma_f32_16x16x32_bf16 v[136:139], a[32:35], a[176:179], v[228:231]
  v_exp_f32 v9, v215
  v_mfma_f32_16x16x32_bf16 v[136:139], a[36:39], a[180:183], v[136:139]
  v_cvt_pk_bf16_f32 v171, v8, v9
  v_mfma_f32_16x16x32_bf16 v[136:139], a[40:43], a[184:187], v[136:139]
  v_exp_f32 v2, v216
  v_mfma_f32_16x16x32_bf16 v[136:139], a[44:47], a[188:191], v[136:139]
  v_mfma_f32_16x16x32_bf16 v[140:143], a[48:51], a[176:179], v[228:231]
  v_exp_f32 v3, v217
  v_mfma_f32_16x16x32_bf16 v[140:143], a[52:55], a[180:183], v[140:143]
  v_cvt_pk_bf16_f32 v172, v2, v3
  v_mfma_f32_16x16x32_bf16 v[140:143], a[56:59], a[184:187], v[140:143]
  v_exp_f32 v4, v218
  v_mfma_f32_16x16x32_bf16 v[140:143], a[60:63], a[188:191], v[140:143]
  v_mfma_f32_16x16x32_bf16 v[240:243], a[76:79], v[168:171], v[240:243]
  v_exp_f32 v5, v219
  v_mfma_f32_16x16x32_bf16 v[144:147], a[32:35], a[128:131], v[232:235]
  v_exp_f32 v6, v220
  v_mfma_f32_16x16x32_bf16 v[144:147], a[36:39], a[132:135], v[144:147]
  v_cvt_pk_bf16_f32 v173, v4, v5
  v_mfma_f32_16x16x32_bf16 v[144:147], a[40:43], a[136:139], v[144:147]
  v_exp_f32 v7, v221
  v_mfma_f32_16x16x32_bf16 v[144:147], a[44:47], a[140:143], v[144:147]
  v_cvt_pk_bf16_f32 v174, v6, v7
  v_mfma_f32_16x16x32_bf16 v[148:151], a[48:51], a[128:131], v[232:235]
  v_exp_f32 v8, v222
  v_mfma_f32_16x16x32_bf16 v[148:151], a[52:55], a[132:135], v[148:151]
  v_mfma_f32_16x16x32_bf16 v[148:151], a[56:59], a[136:139], v[148:151]
  v_exp_f32 v9, v223
  v_mfma_f32_16x16x32_bf16 v[148:151], a[60:63], a[140:143], v[148:151]
  v_cvt_pk_bf16_f32 v175, v8, v9
  v_mfma_f32_16x16x32_bf16 v[152:155], a[32:35], a[144:147], v[236:239]
  ds_read_b128 a[12:15], v249 offset:19456
  v_mfma_f32_16x16x32_bf16 v[240:243], a[80:83], v[172:175], v[240:243]
  ds_read_b128 a[16:19], v249 offset:20480
  v_mfma_f32_16x16x32_bf16 v[152:155], a[36:39], a[148:151], v[152:155]
  ds_read_b128 a[20:23], v249 offset:21504
  v_mfma_f32_16x16x32_bf16 v[152:155], a[40:43], a[152:155], v[152:155]
  ds_read_b128 a[24:27], v249 offset:22528
  v_mfma_f32_16x16x32_bf16 v[152:155], a[44:47], a[156:159], v[152:155]
  ds_read_b128 a[28:31], v249 offset:23552
  v_mfma_f32_16x16x32_bf16 v[156:159], a[48:51], a[144:147], v[236:239]
  v_max3_f32 v250, v240, v241, v242
  v_mfma_f32_16x16x32_bf16 v[156:159], a[52:55], a[148:151], v[156:159]
  s_waitcnt lgkmcnt(4)
  v_max_f32 v250, v250, v243
  v_cmp_nge_f32 vcc, s44, v250
  v_mfma_f32_16x16x32_bf16 v[156:159], a[56:59], a[152:155], v[156:159]
  v_mfma_f32_16x16x32_bf16 v[156:159], a[60:63], a[156:159], v[156:159]
  s_cbranch_vccnz L_dl1_rare
L_dl1_back:
  v_mfma_f32_16x16x32_bf16 v[32:35], a[0:3], v[160:163], v[32:35]
  s_add_u32 s48, s39, 16384
  v_exp_f32 v2, v128
  v_mfma_f32_16x16x32_bf16 v[40:43], a[0:3], v[164:167], v[40:43]
  s_waitcnt vmcnt(6)
  s_barrier
  v_mfma_f32_16x16x32_bf16 a[192:195], a[0:3], v[168:171], a[192:195]
  ds_read_b128 a[32:35], v249 offset:32768
  v_mfma_f32_16x16x32_bf16 a[200:203], a[0:3], v[172:175], a[200:203]
  s_add_u32 s39, s39, 32768
  v_exp_f32 v3, v129
  v_mfma_f32_16x16x32_bf16 v[36:39], a[4:7], v[160:163], v[36:39]
  ds_read_b128 a[36:39], v249 offset:33792
  v_cvt_pk_bf16_f32 v176, v2, v3
  v_mfma_f32_16x16x32_bf16 v[44:47], a[4:7], v[164:167], v[44:47]
  v_exp_f32 v4, v130
  v_mfma_f32_16x16x32_bf16 a[196:199], a[4:7], v[168:171], a[196:199]
  v_exp_f32 v5, v131
  v_mfma_f32_16x16x32_bf16 a[204:207], a[4:7], v[172:175], a[204:207]
  ds_read_b128 a[40:43], v249 offset:34816
  v_cvt_pk_bf16_f32 v177, v4, v5
  v_mfma_f32_16x16x32_bf16 v[48:51], a[8:11], v[160:163], v[48:51]
  v_exp_f32 v6, v132
  v_mov_b32 v10, 1
  v_mfma_f32_16x16x32_bf16 v[56:59], a[8:11], v[164:167], v[56:59]
  buffer_store_dword v10, v17, s[68:71], s38 offen sc1
  v_mfma_f32_16x16x32_bf16 a[208:211], a[8:11], v[168:171], a[208:211]
  s_xor_b32 m0, s49, 16384
  v_exp_f32 v7, v133
  v_mfma_f32_16x16x32_bf16 a[216:219], a[8:11], v[172:175], a[216:219]
  buffer_load_dwordx4 v12, s[68:71], s48 offen offset:0 sc1 lds
  v_mfma_f32_16x16x32_bf16 v[52:55], a[12:15], v[160:163], v[52:55]
  v_exp_f32 v8, v134
  v_mfma_f32_16x16x32_bf16 v[60:63], a[12:15], v[164:167], v[60:63]
  ds_read_b128 a[44:47], v249 offset:35840
  v_cvt_pk_bf16_f32 v178, v6, v7
  v_mfma_f32_16x16x32_bf16 a[212:215], a[12:15], v[168:171], a[212:215]
  v_exp_f32 v9, v135
  v_mfma_f32_16x16x32_bf16 a[220:223], a[12:15], v[172:175], a[220:223]
  s_waitcnt lgkmcnt(4)
  v_exp_f32 v2, v136
  v_mfma_f32_16x16x32_bf16 v[64:67], a[16:19], v[160:163], v[64:67]
  buffer_load_dwordx4 v12, s[68:71], s48 offen offset:1024 sc1 lds
  v_mfma_f32_16x16x32_bf16 v[72:75], a[16:19], v[164:167], v[72:75]
  v_exp_f32 v3, v137
  v_mfma_f32_16x16x32_bf16 a[224:227], a[16:19], v[168:171], a[224:227]
  ds_read_b128 a[48:51], v249 offset:36864
  v_cvt_pk_bf16_f32 v179, v8, v9
  v_mfma_f32_16x16x32_bf16 a[232:235], a[16:19], v[172:175], a[232:235]
  v_exp_f32 v4, v138
  v_mfma_f32_16x16x32_bf16 v[244:247], a[68:71], v[176:179], v[240:243]
  ds_read_b128 a[52:55], v249 offset:37888
  ds_read_b128 a[56:59], v249 offset:38912
  v_mfma_f32_16x16x32_bf16 v[68:71], a[20:23], v[160:163], v[68:71]
  v_exp_f32 v5, v139
  v_mfma_f32_16x16x32_bf16 v[76:79], a[20:23], v[164:167], v[76:79]
  ds_read_b128 a[60:63], v249 offset:39936
  v_cvt_pk_bf16_f32 v180, v2, v3
  v_mfma_f32_16x16x32_bf16 a[228:231], a[20:23], v[168:171], a[228:231]
  v_exp_f32 v6, v140
  v_mfma_f32_16x16x32_bf16 a[236:239], a[20:23], v[172:175], a[236:239]
  v_exp_f32 v7, v141
  v_mfma_f32_16x16x32_bf16 v[80:83], a[24:27], v[160:163], v[80:83]
  buffer_load_dwordx4 v12, s[68:71], s48 offen offset:2048 sc1 lds
  v_mfma_f32_16x16x32_bf16 v[88:91], a[24:27], v[164:167], v[88:91]
  v_exp_f32 v8, v142
  v_mfma_f32_16x16x32_bf16 a[240:243], a[24:27], v[168:171], a[240:243]
  v_cvt_pk_bf16_f32 v181, v4, v5
  v_cvt_pk_bf16_f32 v182, v6, v7
  v_mfma_f32_16x16x32_bf16 a[248:251], a[24:27], v[172:175], a[248:251]
  v_exp_f32 v9, v143
  v_mfma_f32_16x16x32_bf16 v[84:87], a[28:31], v[160:163], v[84:87]
  v_cvt_pk_bf16_f32 v183, v8, v9
  v_xor_b32 v248, 0x10000, v248
  v_mfma_f32_16x16x32_bf16 v[92:95], a[28:31], v[164:167], v[92:95]
  v_exp_f32 v2, v144
  v_mfma_f32_16x16x32_bf16 a[244:247], a[28:31], v[168:171], a[244:247]
  v_mfma_f32_16x16x32_bf16 a[252:255], a[28:31], v[172:175], a[252:255]
  s_waitcnt lgkmcnt(0)
  v_exp_f32 v3, v145
  v_mfma_f32_16x16x32_bf16 v[244:247], a[72:75], v[180:183], v[244:247]
  buffer_load_dwordx4 v12, s[68:71], s48 offen offset:3072 sc1 lds
  v_mfma_f32_16x16x32_bf16 v[192:195], a[32:35], a[160:163], v[224:227]
  v_exp_f32 v4, v146
  v_mfma_f32_16x16x32_bf16 v[192:195], a[36:39], a[164:167], v[192:195]
  s_add_u32 s90, s90, 1408
  v_exp_f32 v5, v147
  v_mfma_f32_16x16x32_bf16 v[192:195], a[40:43], a[168:171], v[192:195]
  buffer_load_dword a65, v19, s[52:55], s90 offen
  v_mfma_f32_16x16x32_bf16 v[192:195], a[44:47], a[172:175], v[192:195]
  v_exp_f32 v6, v148
  v_mfma_f32_16x16x32_bf16 v[196:199], a[48:51], a[160:163], v[224:227]
  v_cvt_pk_bf16_f32 v184, v2, v3
  v_cvt_pk_bf16_f32 v185, v4, v5
  v_mfma_f32_16x16x32_bf16 v[196:199], a[52:55], a[164:167], v[196:199]
  v_exp_f32 v7, v149
  v_mfma_f32_16x16x32_bf16 v[196:199], a[56:59], a[168:171], v[196:199]
  ds_read_b128 a[0:3], v249 offset:24576
  v_cvt_pk_bf16_f32 v186, v6, v7
  v_mfma_f32_16x16x32_bf16 v[196:199], a[60:63], a[172:175], v[196:199]
  v_exp_f32 v8, v150
  v_mfma_f32_16x16x32_bf16 v[200:203], a[32:35], a[176:179], v[228:231]
  ds_read_b128 a[4:7], v249 offset:25600
  ds_read_b128 a[8:11], v249 offset:26624
  v_mfma_f32_16x16x32_bf16 v[200:203], a[36:39], a[180:183], v[200:203]
  v_exp_f32 v9, v151
  v_mfma_f32_16x16x32_bf16 v[200:203], a[40:43], a[184:187], v[200:203]
  v_exp_f32 v2, v152
  v_mfma_f32_16x16x32_bf16 v[200:203], a[44:47], a[188:191], v[200:203]
  v_cvt_pk_bf16_f32 v187, v8, v9
  v_mfma_f32_16x16x32_bf16 v[204:207], a[48:51], a[176:179], v[228:231]
  v_exp_f32 v3, v153
  v_mfma_f32_16x16x32_bf16 v[204:207], a[52:55], a[180:183], v[204:207]
  v_cvt_pk_bf16_f32 v188, v2, v3
  v_mfma_f32_16x16x32_bf16 v[204:207], a[56:59], a[184:187], v[204:207]
  v_exp_f32 v4, v154
  v_mfma_f32_16x16x32_bf16 v[204:207], a[60:63], a[188:191], v[204:207]
  v_mfma_f32_16x16x32_bf16 v[244:247], a[76:79], v[184:187], v[244:247]
  v_exp_f32 v5, v155
  v_mfma_f32_16x16x32_bf16 v[208:211], a[32:35], a[128:131], v[232:235]
  v_cvt_pk_bf16_f32 v189, v4, v5
  v_mfma_f32_16x16x32_bf16 v[208:211], a[36:39], a[132:135], v[208:211]
  v_exp_f32 v6, v156
  v_mfma_f32_16x16x32_bf16 v[208:211], a[40:43], a[136:139], v[208:211]
  v_exp_f32 v7, v157
  v_mfma_f32_16x16x32_bf16 v[208:211], a[44:47], a[140:143], v[208:211]
  v_cvt_pk_bf16_f32 v190, v6, v7
  v_mfma_f32_16x16x32_bf16 v[212:215], a[48:51], a[128:131], v[232:235]
  v_exp_f32 v8, v158
  v_mfma_f32_16x16x32_bf16 v[212:215], a[52:55], a[132:135], v[212:215]
  v_mfma_f32_16x16x32_bf16 v[212:215], a[56:59], a[136:139], v[212:215]
  v_exp_f32 v9, v159
  v_mfma_f32_16x16x32_bf16 v[212:215], a[60:63], a[140:143], v[212:215]
  v_cvt_pk_bf16_f32 v191, v8, v9
  v_mfma_f32_16x16x32_bf16 v[216:219], a[32:35], a[144:147], v[236:239]
  ds_read_b128 a[12:15], v249 offset:27648
  v_mfma_f32_16x16x32_bf16 v[244:247], a[80:83], v[188:191], v[244:247]
  ds_read_b128 a[16:19], v249 offset:28672
  v_mfma_f32_16x16x32_bf16 v[216:219], a[36:39], a[148:151], v[216:219]
  ds_read_b128 a[20:23], v249 offset:29696
  v_mfma_f32_16x16x32_bf16 v[216:219], a[40:43], a[152:155], v[216:219]
  ds_read_b128 a[24:27], v249 offset:30720
  v_mfma_f32_16x16x32_bf16 v[216:219], a[44:47], a[156:159], v[216:219]
  ds_read_b128 a[28:31], v249 offset:31744
  v_mfma_f32_16x16x32_bf16 v[220:223], a[48:51], a[144:147], v[236:239]
  v_max3_f32 v250, v244, v245, v246
  v_mfma_f32_16x16x32_bf16 v[220:223], a[52:55], a[148:151], v[220:223]
  s_waitcnt lgkmcnt(4)
  v_max_f32 v250, v250, v247
  v_cmp_nge_f32 vcc, s44, v250
  v_mfma_f32_16x16x32_bf16 v[220:223], a[56:59], a[152:155], v[220:223]
  v_mfma_f32_16x16x32_bf16 v[220:223], a[60:63], a[156:159], v[220:223]
  s_cbranch_vccnz L_dl2_rare
L_dl2_back:
  v_mfma_f32_16x16x32_bf16 v[32:35], a[0:3], v[176:179], v[32:35]
  v_exp_f32 v2, v192
  v_mfma_f32_16x16x32_bf16 v[40:43], a[0:3], v[180:183], v[40:43]
  ds_read_b128 a[32:35], v249 offset:40960
  v_mfma_f32_16x16x32_bf16 a[192:195], a[0:3], v[184:187], a[192:195]
  v_exp_f32 v3, v193
  v_mfma_f32_16x16x32_bf16 a[200:203], a[0:3], v[188:191], a[200:203]
  ds_read_b128 a[36:39], v249 offset:41984
  v_cvt_pk_bf16_f32 v160, v2, v3
  v_mfma_f32_16x16x32_bf16 v[36:39], a[4:7], v[176:179], v[36:39]
  v_exp_f32 v4, v194
  v_mfma_f32_16x16x32_bf16 v[44:47], a[4:7], v[180:183], v[44:47]
  ds_read_b128 a[40:43], v249 offset:43008
  v_mfma_f32_16x16x32_bf16 a[196:199], a[4:7], v[184:187], a[196:199]
  v_exp_f32 v5, v195
  v_mfma_f32_16x16x32_bf16 a[204:207], a[4:7], v[188:191], a[204:207]
  s_xor_b32 m0, s49, 32768
  v_exp_f32 v6, v196
  v_mfma_f32_16x16x32_bf16 v[48:51], a[8:11], v[176:179], v[48:51]
  buffer_load_dwordx4 v12, s[68:71], s39 offen offset:0 sc1 lds
  v_mfma_f32_16x16x32_bf16 v[56:59], a[8:11], v[180:183], v[56:59]
  v_exp_f32 v7, v197
  v_mfma_f32_16x16x32_bf16 a[208:211], a[8:11], v[184:187], a[208:211]
  v_cvt_pk_bf16_f32 v161, v4, v5
  v_cvt_pk_bf16_f32 v162, v6, v7
  v_mfma_f32_16x16x32_bf16 a[216:219], a[8:11], v[188:191], a[216:219]
  v_exp_f32 v8, v198
  v_mfma_f32_16x16x32_bf16 v[52:55], a[12:15], v[176:179], v[52:55]
  ds_read_b128 a[44:47], v249 offset:44032
  ds_read_b128 a[48:51], v249 offset:45056
  v_mfma_f32_16x16x32_bf16 v[60:63], a[12:15], v[180:183], v[60:63]
  v_exp_f32 v9, v199
  v_mfma_f32_16x16x32_bf16 a[212:215], a[12:15], v[184:187], a[212:215]
  ds_read_b128 a[52:55], v249 offset:46080
  v_cvt_pk_bf16_f32 v163, v8, v9
  v_mfma_f32_16x16x32_bf16 a[220:223], a[12:15], v[188:191], a[220:223]
  s_waitcnt lgkmcnt(6)
  v_exp_f32 v2, v200
  v_mfma_f32_16x16x32_bf16 v[64:67], a[16:19], v[176:179], v[64:67]
  buffer_load_dwordx4 v12, s[68:71], s39 offen offset:1024 sc1 lds
  v_mfma_f32_16x16x32_bf16 v[72:75], a[16:19], v[180:183], v[72:75]
  v_exp_f32 v3, v201
  v_mfma_f32_16x16x32_bf16 a[224:227], a[16:19], v[184:187], a[224:227]
  v_exp_f32 v4, v202
  v_mfma_f32_16x16x32_bf16 a[232:235], a[16:19], v[188:191], a[232:235]
  ds_read_b128 a[56:59], v249 offset:47104
  ds_read_b128 a[60:63], v249 offset:48128
  v_mfma_f32_16x16x32_bf16 v[240:243], a[68:71], v[160:163], v[244:247]
  v_exp_f32 v5, v203
  v_mfma_f32_16x16x32_bf16 v[68:71], a[20:23], v[176:179], v[68:71]
  v_cvt_pk_bf16_f32 v164, v2, v3
  v_cvt_pk_bf16_f32 v165, v4, v5
  v_mfma_f32_16x16x32_bf16 v[76:79], a[20:23], v[180:183], v[76:79]
  v_exp_f32 v6, v204
  v_mfma_f32_16x16x32_bf16 a[228:231], a[20:23], v[184:187], a[228:231]
  v_mfma_f32_16x16x32_bf16 a[236:239], a[20:23], v[188:191], a[236:239]
  v_exp_f32 v7, v205
  v_mfma_f32_16x16x32_bf16 v[80:83], a[24:27], v[176:179], v[80:83]
  buffer_load_dwordx4 v12, s[68:71], s39 offen offset:2048 sc1 lds
  v_mfma_f32_16x16x32_bf16 v[88:91], a[24:27], v[180:183], v[88:91]
  v_exp_f32 v8, v206
  v_mfma_f32_16x16x32_bf16 a[240:243], a[24:27], v[184:187], a[240:243]
  v_cvt_pk_bf16_f32 v166, v6, v7
  v_mfma_f32_16x16x32_bf16 a[248:251], a[24:27], v[188:191], a[248:251]
  v_exp_f32 v9, v207
  v_mfma_f32_16x16x32_bf16 v[84:87], a[28:31], v[176:179], v[84:87]
  v_exp_f32 v2, v208
  v_mfma_f32_16x16x32_bf16 v[92:95], a[28:31], v[180:183], v[92:95]
  v_cvt_pk_bf16_f32 v167, v8, v9
  v_mfma_f32_16x16x32_bf16 a[244:247], a[28:31], v[184:187], a[244:247]
  v_exp_f32 v3, v209
  v_mfma_f32_16x16x32_bf16 a[252:255], a[28:31], v[188:191], a[252:255]
  buffer_load_dwordx4 v12, s[68:71], s39 offen offset:3072 sc1 lds
  v_mfma_f32_16x16x32_bf16 v[240:243], a[72:75], v[164:167], v[240:243]
  s_waitcnt lgkmcnt(0)
  v_exp_f32 v4, v210
  v_mfma_f32_16x16x32_bf16 v[128:131], a[32:35], a[160:163], v[224:227]
  ds_read_b128 a[0:3], v249 offset:49152
  v_cvt_pk_bf16_f32 v168, v2, v3
  v_mfma_f32_16x16x32_bf16 v[128:131], a[36:39], a[164:167], v[128:131]
  s_add_u32 s91, s91, 512
  v_exp_f32 v5, v211
  v_mfma_f32_16x16x32_bf16 v[128:131], a[40:43], a[168:171], v[128:131]
  buffer_load_dword a64, v1, s[60:63], s91 offen
  v_mfma_f32_16x16x32_bf16 v[128:131], a[44:47], a[172:175], v[128:131]
  v_exp_f32 v6, v212
  v_mfma_f32_16x16x32_bf16 v[132:135], a[48:51], a[160:163], v[224:227]
  ds_read_b128 a[4:7], v249 offset:50176
  v_cvt_pk_bf16_f32 v169, v4, v5
  v_mfma_f32_16x16x32_bf16 v[132:135], a[52:55], a[164:167], v[132:135]
  v_exp_f32 v7, v213
  v_mfma_f32_16x16x32_bf16 v[132:135], a[56:59], a[168:171], v[132:135]
  v_exp_f32 v8, v214
  v_mfma_f32_16x16x32_bf16 v[132:135], a[60:63], a[172:175], v[132:135]
  ds_read_b128 a[8:11], v249 offset:51200
  v_cvt_pk_bf16_f32 v170, v6, v7
  v_mfma_f32_16x16x32_bf16 v[136:139], a[32:35], a[176:179], v[228:231]
  v_exp_f32 v9, v215
  v_mfma_f32_16x16x32_bf16 v[136:139], a[36:39], a[180:183], v[136:139]
  v_cvt_pk_bf16_f32 v171, v8, v9
  v_mfma_f32_16x16x32_bf16 v[136:139], a[40:43], a[184:187], v[136:139]
  v_exp_f32 v2, v216
  v_mfma_f32_16x16x32_bf16 v[136:139], a[44:47], a[188:191], v[136:139]
  v_mfma_f32_16x16x32_bf16 v[140:143], a[48:51], a[176:179], v[228:231]
  v_exp_f32 v3, v217
  v_mfma_f32_16x16x32_bf16 v[140:143], a[52:55], a[180:183], v[140:143]
  v_cvt_pk_bf16_f32 v172, v2, v3
  v_mfma_f32_16x16x32_bf16 v[140:143], a[56:59], a[184:187], v[140:143]
  v_exp_f32 v4, v218
  v_mfma_f32_16x16x32_bf16 v[140:143], a[60:63], a[188:191], v[140:143]
  v_mfma_f32_16x16x32_bf16 v[240:243], a[76:79], v[168:171], v[240:243]
  v_exp_f32 v5, v219
  v_mfma_f32_16x16x32_bf16 v[144:147], a[32:35], a[128:131], v[232:235]
  v_exp_f32 v6, v220
  v_mfma_f32_16x16x32_bf16 v[144:147], a[36:39], a[132:135], v[144:147]
L_hop11:
  s_cbranch_execz L_hop15
  v_cvt_pk_bf16_f32 v173, v4, v5
  v_mfma_f32_16x16x32_bf16 v[144:147], a[40:43], a[136:139], v[144:147]
  v_exp_f32 v7, v221
  v_mfma_f32_16x16x32_bf16 v[144:147], a[44:47], a[140:143], v[144:147]
  v_cvt_pk_bf16_f32 v174, v6, v7
  v_mfma_f32_16x16x32_bf16 v[148:151], a[48:51], a[128:131], v[232:235]
  v_exp_f32 v8, v222
  v_mfma_f32_16x16x32_bf16 v[148:151], a[52:55], a[132:135], v[148:151]
  v_mfma_f32_16x16x32_bf16 v[148:151], a[56:59], a[136:139], v[148:151]
  v_exp_f32 v9, v223
  v_mfma_f32_16x16x32_bf16 v[148:151], a[60:63], a[140:143], v[148:151]
  v_cvt_pk_bf16_f32 v175, v8, v9
  v_mfma_f32_16x16x32_bf16 v[152:155], a[32:35], a[144:147], v[236:239]
  ds_read_b128 a[12:15], v249 offset:52224
  v_mfma_f32_16x16x32_bf16 v[240:243], a[80:83], v[172:175], v[240:243]
  ds_read_b128 a[16:19], v249 offset:53248
  v_mfma_f32_16x16x32_bf16 v[152:155], a[36:39], a[148:151], v[152:155]
  ds_read_b128 a[20:23], v249 offset:54272
  v_mfma_f32_16x16x32_bf16 v[152:155], a[40:43], a[152:155], v[152:155]
  ds_read_b128 a[24:27], v249 offset:55296
  v_mfma_f32_16x16x32_bf16 v[152:155], a[44:47], a[156:159], v[152:155]
  ds_read_b128 a[28:31], v249 offset:56320
  v_mfma_f32_16x16x32_bf16 v[156:159], a[48:51], a[144:147], v[236:239]
  v_max3_f32 v250, v240, v241, v242
  v_mfma_f32_16x16x32_bf16 v[156:159], a[52:55], a[148:151], v[156:159]
  s_waitcnt lgkmcnt(4)
  v_max_f32 v250, v250, v243
  v_cmp_nge_f32 vcc, s44, v250
  v_mfma_f32_16x16x32_bf16 v[156:159], a[56:59], a[152:155], v[156:159]
  v_mfma_f32_16x16x32_bf16 v[156:159], a[60:63], a[156:159], v[156:159]
  s_cbranch_vccnz L_dl3_rare
L_dl3_back:
  s_sub_u32 s45, s45, 1
  s_cbranch_scc0 L_dl
L_dm:
  s_cbranch_execz L_main
  v_mfma_f32_16x16x32_bf16 v[32:35], a[0:3], v[160:163], v[32:35]
  v_exp_f32 v2, v128
  v_xor_b32 v249, 0x10000, v249
  v_mfma_f32_16x16x32_bf16 v[40:43], a[0:3], v[164:167], v[40:43]
  s_waitcnt vmcnt(6)
  s_barrier
  v_mfma_f32_16x16x32_bf16 a[192:195], a[0:3], v[168:171], a[192:195]
  s_xor_b32 s49, s49, 0x10000
  ds_read_b128 a[32:35], v249 offset:0
  v_cndmask_b32 v208, v11, v232, s[0:1]
  v_mfma_f32_16x16x32_bf16 a[200:203], a[0:3], v[172:175], a[200:203]
  s_add_u32 s48, s39, 16384
  v_exp_f32 v3, v129
  v_mfma_f32_16x16x32_bf16 v[36:39], a[4:7], v[160:163], v[36:39]
  s_add_u32 s39, s39, 32768
  ds_read_b128 a[36:39], v249 offset:1024
  v_cvt_pk_bf16_f32 v176, v2, v3
  v_mfma_f32_16x16x32_bf16 v[44:47], a[4:7], v[164:167], v[44:47]
  v_exp_f32 v4, v130
  v_mfma_f32_16x16x32_bf16 a[196:199], a[4:7], v[168:171], a[196:199]
  v_exp_f32 v5, v131
  v_mfma_f32_16x16x32_bf16 a[204:207], a[4:7], v[172:175], a[204:207]
  ds_read_b128 a[40:43], v249 offset:2048
  v_cvt_pk_bf16_f32 v177, v4, v5
  v_mfma_f32_16x16x32_bf16 v[48:51], a[8:11], v[160:163], v[48:51]
  s_xor_b32 m0, s49, 114688
  v_exp_f32 v6, v132
  v_mfma_f32_16x16x32_bf16 v[56:59], a[8:11], v[164:167], v[56:59]
  buffer_load_dwordx4 v12, s[68:71], s48 offen offset:0 sc1 lds
  v_mfma_f32_16x16x32_bf16 a[208:211], a[8:11], v[168:171], a[208:211]
  v_exp_f32 v7, v133
  v_mfma_f32_16x16x32_bf16 a[216:219], a[8:11], v[172:175], a[216:219]
  ds_read_b128 a[44:47], v249 offset:3072
  v_cvt_pk_bf16_f32 v178, v6, v7
  v_mfma_f32_16x16x32_bf16 v[52:55], a[12:15], v[160:163], v[52:55]
  v_exp_f32 v8, v134
  v_mfma_f32_16x16x32_bf16 v[60:63], a[12:15], v[164:167], v[60:63]
  ds_read_b128 a[48:51], v249 offset:4096
  ds_read_b128 a[52:55], v249 offset:5120
  v_mfma_f32_16x16x32_bf16 a[212:215], a[12:15], v[168:171], a[212:215]
  v_exp_f32 v9, v135
  v_mfma_f32_16x16x32_bf16 a[220:223], a[12:15], v[172:175], a[220:223]
  s_waitcnt lgkmcnt(6)
  v_exp_f32 v2, v136
  v_mfma_f32_16x16x32_bf16 v[64:67], a[16:19], v[160:163], v[64:67]
  ds_read_b128 a[56:59], v249 offset:6144
  v_cvt_pk_bf16_f32 v179, v8, v9
  v_mfma_f32_16x16x32_bf16 v[72:75], a[16:19], v[164:167], v[72:75]
  v_exp_f32 v3, v137
  v_mfma_f32_16x16x32_bf16 a[224:227], a[16:19], v[168:171], a[224:227]
  ds_read_b128 a[60:63], v249 offset:7168
  v_cvt_pk_bf16_f32 v180, v2, v3
  v_mfma_f32_16x16x32_bf16 a[232:235], a[16:19], v[172:175], a[232:235]
  v_exp_f32 v4, v138
  v_mfma_f32_16x16x32_bf16 v[244:247], a[68:71], v[176:179], v[240:243]
  buffer_load_dwordx4 v12, s[68:71], s48 offen offset:1024 sc1 lds
  v_mfma_f32_16x16x32_bf16 v[68:71], a[20:23], v[160:163], v[68:71]
  v_exp_f32 v5, v139
  v_mfma_f32_16x16x32_bf16 v[76:79], a[20:23], v[164:167], v[76:79]
  v_cvt_pk_bf16_f32 v181, v4, v5
  v_cndmask_b32 v209, v11, v232, s[2:3]
  v_mfma_f32_16x16x32_bf16 a[228:231], a[20:23], v[168:171], a[228:231]
  v_exp_f32 v6, v140
  v_mfma_f32_16x16x32_bf16 a[236:239], a[20:23], v[172:175], a[236:239]
  v_exp_f32 v7, v141
  v_mfma_f32_16x16x32_bf16 v[80:83], a[24:27], v[160:163], v[80:83]
  v_cvt_pk_bf16_f32 v182, v6, v7
  v_cndmask_b32 v210, v11, v232, s[4:5]
  v_mfma_f32_16x16x32_bf16 v[88:91], a[24:27], v[164:167], v[88:91]
  s_sub_u32 s85, s72, 0
  v_exp_f32 v8, v142
  v_mfma_f32_16x16x32_bf16 a[240:243], a[24:27], v[168:171], a[240:243]
  buffer_store_dwordx4 a[84:87], v255, s[68:71], s85 offen offset:0 sc1
  v_mfma_f32_16x16x32_bf16 a[248:251], a[24:27], v[172:175], a[248:251]
  v_exp_f32 v9, v143
  v_mfma_f32_16x16x32_bf16 v[84:87], a[28:31], v[160:163], v[84:87]
  v_cvt_pk_bf16_f32 v183, v8, v9
  v_cndmask_b32 v211, v11, v232, s[6:7]
  v_mfma_f32_16x16x32_bf16 v[92:95], a[28:31], v[164:167], v[92:95]
  v_exp_f32 v2, v144
  v_mfma_f32_16x16x32_bf16 a[244:247], a[28:31], v[168:171], a[244:247]
  v_cndmask_b32 v212, v11, v232, s[8:9]
  v_cndmask_b32 v213, v11, v232, s[10:11]
  v_mfma_f32_16x16x32_bf16 a[252:255], a[28:31], v[172:175], a[252:255]
  s_waitcnt lgkmcnt(0)
  v_exp_f32 v3, v145
  v_mfma_f32_16x16x32_bf16 v[244:247], a[72:75], v[180:183], v[244:247]
  buffer_load_dwordx4 v12, s[68:71], s48 offen offset:2048 sc1 lds
  v_mfma_f32_16x16x32_bf16 v[192:195], a[32:35], a[160:163], v[224:227]
  v_exp_f32 v4, v146
  v_mfma_f32_16x16x32_bf16 v[192:195], a[36:39], a[164:167], v[192:195]
  v_exp_f32 v5, v147
  v_mfma_f32_16x16x32_bf16 v[192:195], a[40:43], a[168:171], v[192:195]
  v_cvt_pk_bf16_f32 v184, v2, v3
  v_cvt_pk_bf16_f32 v185, v4, v5
  v_mfma_f32_16x16x32_bf16 v[192:195], a[44:47], a[172:175], v[192:195]
  v_exp_f32 v6, v148
  v_mfma_f32_16x16x32_bf16 v[196:199], a[48:51], a[160:163], v[224:227]
  buffer_store_dwordx4 a[84:87], v255, s[68:71], s85 offen offset:1024 sc1
  v_mfma_f32_16x16x32_bf16 v[196:199], a[52:55], a[164:167], v[196:199]
  v_exp_f32 v7, v149
  v_mfma_f32_16x16x32_bf16 v[196:199], a[56:59], a[168:171], v[196:199]
  ds_read_b128 a[0:3], v248 offset:57344
  v_cvt_pk_bf16_f32 v186, v6, v7
  v_mfma_f32_16x16x32_bf16 v[196:199], a[60:63], a[172:175], v[196:199]
  v_exp_f32 v8, v150
  v_mfma_f32_16x16x32_bf16 v[200:203], a[32:35], a[176:179], v[228:231]
  ds_read_b128 a[4:7], v248 offset:58368
  ds_read_b128 a[8:11], v248 offset:59392
  v_mfma_f32_16x16x32_bf16 v[200:203], a[36:39], a[180:183], v[200:203]
  v_exp_f32 v9, v151
  v_mfma_f32_16x16x32_bf16 v[200:203], a[40:43], a[184:187], v[200:203]
  v_exp_f32 v2, v152
  v_mfma_f32_16x16x32_bf16 v[200:203], a[44:47], a[188:191], v[200:203]
  buffer_load_dwordx4 v12, s[68:71], s48 offen offset:3072 sc1 lds
  v_mfma_f32_16x16x32_bf16 v[204:207], a[48:51], a[176:179], v[228:231]
  v_exp_f32 v3, v153
  v_mfma_f32_16x16x32_bf16 v[204:207], a[52:55], a[180:183], v[204:207]
  v_cvt_pk_bf16_f32 v187, v8, v9
  v_cvt_pk_bf16_f32 v188, v2, v3
  v_mfma_f32_16x16x32_bf16 v[204:207], a[56:59], a[184:187], v[204:207]
  v_exp_f32 v4, v154
  v_mfma_f32_16x16x32_bf16 v[204:207], a[60:63], a[188:191], v[204:207]
  v_cndmask_b32 v214, v11, v232, s[12:13]
  v_cndmask_b32 v215, v11, v232, s[14:15]
  v_mfma_f32_16x16x32_bf16 v[244:247], a[76:79], v[184:187], v[244:247]
  s_sub_u32 s85, s73, 0
  v_exp_f32 v5, v155
  v_mfma_f32_16x16x32_bf16 v[208:211], a[32:35], a[128:131], v[208:211]
  buffer_store_dwordx4 a[84:87], v255, s[68:71], s85 offen offset:0 sc1
  v_mfma_f32_16x16x32_bf16 v[208:211], a[36:39], a[132:135], v[208:211]
  v_exp_f32 v6, v156
  v_mfma_f32_16x16x32_bf16 v[208:211], a[40:43], a[136:139], v[208:211]
  v_exp_f32 v7, v157
  v_mfma_f32_16x16x32_bf16 v[208:211], a[44:47], a[140:143], v[208:211]
  v_cvt_pk_bf16_f32 v189, v4, v5
  v_cvt_pk_bf16_f32 v190, v6, v7
  v_mfma_f32_16x16x32_bf16 v[212:215], a[48:51], a[128:131], v[212:215]
  v_exp_f32 v8, v158
  v_mfma_f32_16x16x32_bf16 v[212:215], a[52:55], a[132:135], v[212:215]
  buffer_store_dwordx4 a[84:87], v255, s[68:71], s85 offen offset:1024 sc1
  v_mfma_f32_16x16x32_bf16 v[212:215], a[56:59], a[136:139], v[212:215]
  v_exp_f32 v9, v159
  v_mfma_f32_16x16x32_bf16 v[212:215], a[60:63], a[140:143], v[212:215]
  v_cvt_pk_bf16_f32 v191, v8, v9
  v_mfma_f32_16x16x32_bf16 v[216:219], a[32:35], a[144:147], v[236:239]
  ds_read_b128 a[12:15], v248 offset:60416
  v_mfma_f32_16x16x32_bf16 v[244:247], a[80:83], v[188:191], v[244:247]
  ds_read_b128 a[16:19], v248 offset:61440
  v_mfma_f32_16x16x32_bf16 v[216:219], a[36:39], a[148:151], v[216:219]
  ds_read_b128 a[20:23], v248 offset:62464
  v_mfma_f32_16x16x32_bf16 v[216:219], a[40:43], a[152:155], v[216:219]
  ds_read_b128 a[24:27], v248 offset:63488
  v_mfma_f32_16x16x32_bf16 v[216:219], a[44:47], a[156:159], v[216:219]
  ds_read_b128 a[28:31], v248 offset:64512
  v_mfma_f32_16x16x32_bf16 v[220:223], a[48:51], a[144:147], v[236:239]
  v_max3_f32 v250, v244, v245, v246
  v_mfma_f32_16x16x32_bf16 v[220:223], a[52:55], a[148:151], v[220:223]
  s_waitcnt lgkmcnt(4)
  v_max_f32 v250, v250, v247
  v_cmp_nge_f32 vcc, s44, v250
  v_mfma_f32_16x16x32_bf16 v[220:223], a[56:59], a[152:155], v[220:223]
  v_mfma_f32_16x16x32_bf16 v[220:223], a[60:63], a[156:159], v[220:223]
  s_cbranch_vccnz L_dm0_rare
L_dm0_back:
  v_mfma_f32_16x16x32_bf16 v[32:35], a[0:3], v[176:179], v[32:35]
  v_exp_f32 v2, v192
  v_mfma_f32_16x16x32_bf16 v[40:43], a[0:3], v[180:183], v[40:43]
  ds_read_b128 a[32:35], v249 offset:8192
  v_cndmask_b32 v144, v11, v232, s[16:17]
  v_mfma_f32_16x16x32_bf16 a[192:195], a[0:3], v[184:187], a[192:195]
  v_exp_f32 v3, v193
  v_mfma_f32_16x16x32_bf16 a[200:203], a[0:3], v[188:191], a[200:203]
  ds_read_b128 a[36:39], v249 offset:9216
  v_cvt_pk_bf16_f32 v160, v2, v3
  v_mfma_f32_16x16x32_bf16 v[36:39], a[4:7], v[176:179], v[36:39]
  v_exp_f32 v4, v194
  v_mfma_f32_16x16x32_bf16 v[44:47], a[4:7], v[180:183], v[44:47]
  ds_read_b128 a[40:43], v249 offset:10240
  v_cndmask_b32 v145, v11, v232, s[18:19]
  v_mfma_f32_16x16x32_bf16 a[196:199], a[4:7], v[184:187], a[196:199]
  v_exp_f32 v5, v195
  v_mfma_f32_16x16x32_bf16 a[204:207], a[4:7], v[188:191], a[204:207]
  s_xor_b32 m0, s49, 0
  v_exp_f32 v6, v196
  v_mfma_f32_16x16x32_bf16 v[48:51], a[8:11], v[176:179], v[48:51]
  buffer_load_dwordx4 v12, s[68:71], s39 offen offset:0 sc1 lds
  v_mfma_f32_16x16x32_bf16 v[56:59], a[8:11], v[180:183], v[56:59]
  v_exp_f32 v7, v197
  v_mfma_f32_16x16x32_bf16 a[208:211], a[8:11], v[184:187], a[208:211]
  v_cvt_pk_bf16_f32 v161, v4, v5
  v_cvt_pk_bf16_f32 v162, v6, v7
  v_mfma_f32_16x16x32_bf16 a[216:219], a[8:11], v[188:191], a[216:219]
  v_exp_f32 v8, v198
  v_mfma_f32_16x16x32_bf16 v[52:55], a[12:15], v[176:179], v[52:55]
  ds_read_b128 a[44:47], v249 offset:11264
  ds_read_b128 a[48:51], v249 offset:12288
  v_mfma_f32_16x16x32_bf16 v[60:63], a[12:15], v[180:183], v[60:63]
  v_exp_f32 v9, v199
  v_mfma_f32_16x16x32_bf16 a[212:215], a[12:15], v[184:187], a[212:215]
  ds_read_b128 a[52:55], v249 offset:13312
  v_cvt_pk_bf16_f32 v163, v8, v9
  v_mfma_f32_16x16x32_bf16 a[220:223], a[12:15], v[188:191], a[220:223]
  s_waitcnt lgkmcnt(6)
  v_exp_f32 v2, v200
  v_mfma_f32_16x16x32_bf16 v[64:67], a[16:19], v[176:179], v[64:67]
  ds_read_b128 a[56:59], v249 offset:14336
  ds_read_b128 a[60:63], v249 offset:15360
  v_mfma_f32_16x16x32_bf16 v[72:75], a[16:19], v[180:183], v[72:75]
  v_exp_f32 v3, v201
  v_mfma_f32_16x16x32_bf16 a[224:227], a[16:19], v[184:187], a[224:227]
  v_exp_f32 v4, v202
  v_mfma_f32_16x16x32_bf16 a[232:235], a[16:19], v[188:191], a[232:235]
  v_cvt_pk_bf16_f32 v164, v2, v3
  v_cndmask_b32 v146, v11, v232, s[20:21]
  v_mfma_f32_16x16x32_bf16 v[240:243], a[68:71], v[160:163], v[244:247]
  v_exp_f32 v5, v203
  v_mfma_f32_16x16x32_bf16 v[68:71], a[20:23], v[176:179], v[68:71]
  buffer_load_dwordx4 v12, s[68:71], s39 offen offset:1024 sc1 lds
  v_mfma_f32_16x16x32_bf16 v[76:79], a[20:23], v[180:183], v[76:79]
  v_exp_f32 v6, v204
  v_mfma_f32_16x16x32_bf16 a[228:231], a[20:23], v[184:187], a[228:231]
  v_cvt_pk_bf16_f32 v165, v4, v5
  v_cndmask_b32 v147, v11, v232, s[22:23]
  v_mfma_f32_16x16x32_bf16 a[236:239], a[20:23], v[188:191], a[236:239]
  v_exp_f32 v7, v205
  v_mfma_f32_16x16x32_bf16 v[80:83], a[24:27], v[176:179], v[80:83]
  v_cvt_pk_bf16_f32 v166, v6, v7
  v_cndmask_b32 v148, v11, v232, s[24:25]
  v_mfma_f32_16x16x32_bf16 v[88:91], a[24:27], v[180:183], v[88:91]
  s_sub_u32 s85, s74, 0
  v_exp_f32 v8, v206
  v_mfma_f32_16x16x32_bf16 a[240:243], a[24:27], v[184:187], a[240:243]
  buffer_store_dwordx4 a[84:87], v255, s[68:71], s85 offen offset:0 sc1
  v_mfma_f32_16x16x32_bf16 a[248:251], a[24:27], v[188:191], a[248:251]
  v_exp_f32 v9, v207
  v_mfma_f32_16x16x32_bf16 v[84:87], a[28:31], v[176:179], v[84:87]
  v_exp_f32 v2, v208
  v_mfma_f32_16x16x32_bf16 v[92:95], a[28:31], v[180:183], v[92:95]
  v_cvt_pk_bf16_f32 v167, v8, v9
  v_cndmask_b32 v149, v11, v232, s[26:27]
  v_mfma_f32_16x16x32_bf16 a[244:247], a[28:31], v[184:187], a[244:247]
  v_exp_f32 v3, v209
  v_mfma_f32_16x16x32_bf16 a[252:255], a[28:31], v[188:191], a[252:255]
  buffer_load_dwordx4 v12, s[68:71], s39 offen offset:2048 sc1 lds
  v_mfma_f32_16x16x32_bf16 v[240:243], a[72:75], v[164:167], v[240:243]
  s_waitcnt lgkmcnt(0)
  v_exp_f32 v4, v210
  v_mfma_f32_16x16x32_bf16 v[128:131], a[32:35], a[160:163], v[224:227]
  ds_read_b128 a[0:3], v249 offset:16384
  v_cvt_pk_bf16_f32 v168, v2, v3
  v_mfma_f32_16x16x32_bf16 v[128:131], a[36:39], a[164:167], v[128:131]
  v_exp_f32 v5, v211
  v_mfma_f32_16x16x32_bf16 v[128:131], a[40:43], a[168:171], v[128:131]
  ds_read_b128 a[4:7], v249 offset:17408
  v_cvt_pk_bf16_f32 v169, v4, v5
  v_mfma_f32_16x16x32_bf16 v[128:131], a[44:47], a[172:175], v[128:131]
  v_exp_f32 v6, v212
  v_mfma_f32_16x16x32_bf16 v[132:135], a[48:51], a[160:163], v[224:227]
  buffer_store_dwordx4 a[84:87], v255, s[68:71], s85 offen offset:1024 sc1
  v_mfma_f32_16x16x32_bf16 v[132:135], a[52:55], a[164:167], v[132:135]
  v_exp_f32 v7, v213
  v_mfma_f32_16x16x32_bf16 v[132:135], a[56:59], a[168:171], v[132:135]
  v_exp_f32 v8, v214
  v_mfma_f32_16x16x32_bf16 v[132:135], a[60:63], a[172:175], v[132:135]
  ds_read_b128 a[8:11], v249 offset:18432
  v_cvt_pk_bf16_f32 v170, v6, v7
  v_mfma_f32_16x16x32_bf16 v[136:139], a[32:35], a[176:179], v[228:231]
  v_exp_f32 v9, v215
  v_mfma_f32_16x16x32_bf16 v[136:139], a[36:39], a[180:183], v[136:139]
  v_cvt_pk_bf16_f32 v171, v8, v9
  v_cndmask_b32 v150, v11, v232, s[28:29]
  v_mfma_f32_16x16x32_bf16 v[136:139], a[40:43], a[184:187], v[136:139]
  v_exp_f32 v2, v216
  v_mfma_f32_16x16x32_bf16 v[136:139], a[44:47], a[188:191], v[136:139]
  buffer_load_dwordx4 v12, s[68:71], s39 offen offset:3072 sc1 lds
  v_mfma_f32_16x16x32_bf16 v[140:143], a[48:51], a[176:179], v[228:231]
  v_exp_f32 v3, v217
  v_mfma_f32_16x16x32_bf16 v[140:143], a[52:55], a[180:183], v[140:143]
  v_cvt_pk_bf16_f32 v172, v2, v3
  v_cndmask_b32 v151, v11, v232, s[30:31]
  v_mfma_f32_16x16x32_bf16 v[140:143], a[56:59], a[184:187], v[140:143]
  v_exp_f32 v4, v218
  v_mfma_f32_16x16x32_bf16 v[140:143], a[60:63], a[188:191], v[140:143]
  v_mfma_f32_16x16x32_bf16 v[240:243], a[76:79], v[168:171], v[240:243]
  v_exp_f32 v5, v219
  v_mfma_f32_16x16x32_bf16 v[144:147], a[32:35], a[128:131], v[144:147]
  s_sub_u32 s85, s72, 1572864
  v_exp_f32 v6, v220
  v_mfma_f32_16x16x32_bf16 v[144:147], a[36:39], a[132:135], v[144:147]
  buffer_store_dwordx4 a[84:87], v255, s[68:71], s85 offen offset:0 sc1
  v_mfma_f32_16x16x32_bf16 v[144:147], a[40:43], a[136:139], v[144:147]
  v_exp_f32 v7, v221
  v_mfma_f32_16x16x32_bf16 v[144:147], a[44:47], a[140:143], v[144:147]
  v_cvt_pk_bf16_f32 v173, v4, v5
  v_cvt_pk_bf16_f32 v174, v6, v7
  v_mfma_f32_16x16x32_bf16 v[148:151], a[48:51], a[128:131], v[148:151]
  v_exp_f32 v8, v222
  v_mfma_f32_16x16x32_bf16 v[148:151], a[52:55], a[132:135], v[148:151]
  buffer_store_dwordx4 a[84:87], v255, s[68:71], s85 offen offset:1024 sc1
  v_mfma_f32_16x16x32_bf16 v[148:151], a[56:59], a[136:139], v[148:151]
  v_exp_f32 v9, v223
  v_mfma_f32_16x16x32_bf16 v[148:151], a[60:63], a[140:143], v[148:151]
  v_cvt_pk_bf16_f32 v175, v8, v9
  v_mfma_f32_16x16x32_bf16 v[152:155], a[32:35], a[144:147], v[236:239]
  ds_read_b128 a[12:15], v249 offset:19456
  v_mfma_f32_16x16x32_bf16 v[240:243], a[80:83], v[172:175], v[240:243]
  ds_read_b128 a[16:19], v249 offset:20480
  v_mfma_f32_16x16x32_bf16 v[152:155], a[36:39], a[148:151], v[152:155]
  ds_read_b128 a[20:23], v249 offset:21504
  v_mfma_f32_16x16x32_bf16 v[152:155], a[40:43], a[152:155], v[152:155]
  ds_read_b128 a[24:27], v249 offset:22528
  v_mfma_f32_16x16x32_bf16 v[152:155], a[44:47], a[156:159], v[152:155]
  ds_read_b128 a[28:31], v249 offset:23552
  v_mfma_f32_16x16x32_bf16 v[156:159], a[48:51], a[144:147], v[236:239]
  v_max3_f32 v250, v240, v241, v242
  v_mfma_f32_16x16x32_bf16 v[156:159], a[52:55], a[148:151], v[156:159]
  s_waitcnt lgkmcnt(4)
  v_max_f32 v250, v250, v243
  v_cmp_nge_f32 vcc, s44, v250
  v_mfma_f32_16x16x32_bf16 v[156:159], a[56:59], a[152:155], v[156:159]
  v_mfma_f32_16x16x32_bf16 v[156:159], a[60:63], a[156:159], v[156:159]
  s_cbranch_vccnz L_dm1_rare
L_dm1_back:
  v_mfma_f32_16x16x32_bf16 v[32:35], a[0:3], v[160:163], v[32:35]
  v_exp_f32 v2, v128
  v_mfma_f32_16x16x32_bf16 v[40:43], a[0:3], v[164:167], v[40:43]
  s_waitcnt vmcnt(10)
  s_barrier
  v_mfma_f32_16x16x32_bf16 a[192:195], a[0:3], v[168:171], a[192:195]
  ds_read_b128 a[32:35], v249 offset:32768
  v_cndmask_b32 v216, v11, v236, s[0:1]
  v_mfma_f32_16x16x32_bf16 a[200:203], a[0:3], v[172:175], a[200:203]
  s_add_u32 s48, s39, 16384
  v_exp_f32 v3, v129
  v_mfma_f32_16x16x32_bf16 v[36:39], a[4:7], v[160:163], v[36:39]
  s_add_u32 s39, s39, 32768
  v_exp_f32 v4, v130
  v_cvt_pk_bf16_f32 v176, v2, v3
  v_mfma_f32_16x16x32_bf16 v[44:47], a[4:7], v[164:167], v[44:47]
  ds_read_b128 a[36:39], v249 offset:33792
  v_cndmask_b32 v217, v11, v236, s[2:3]
  v_mfma_f32_16x16x32_bf16 a[196:199], a[4:7], v[168:171], a[196:199]
  ds_read_b128 a[40:43], v249 offset:34816
  v_exp_f32 v5, v131
  v_mfma_f32_16x16x32_bf16 a[204:207], a[4:7], v[172:175], a[204:207]
  v_exp_f32 v6, v132
  v_mov_b32 v10, 1
  v_mfma_f32_16x16x32_bf16 v[48:51], a[8:11], v[160:163], v[48:51]
  buffer_store_dword v10, v17, s[68:71], s38 offen sc1
  v_mfma_f32_16x16x32_bf16 v[56:59], a[8:11], v[164:167], v[56:59]
  v_exp_f32 v7, v133
  v_cvt_pk_bf16_f32 v177, v4, v5
  v_mfma_f32_16x16x32_bf16 a[208:211], a[8:11], v[168:171], a[208:211]
  s_xor_b32 m0, s49, 16384
  v_exp_f32 v8, v134
  v_cvt_pk_bf16_f32 v178, v6, v7
  v_mfma_f32_16x16x32_bf16 a[216:219], a[8:11], v[172:175], a[216:219]
  buffer_load_dwordx4 v12, s[68:71], s48 offen offset:0 sc1 lds
  v_mfma_f32_16x16x32_bf16 v[52:55], a[12:15], v[160:163], v[52:55]
  ds_read_b128 a[44:47], v249 offset:35840
  v_exp_f32 v9, v135
  v_mfma_f32_16x16x32_bf16 v[60:63], a[12:15], v[164:167], v[60:63]
  v_exp_f32 v2, v136
  v_cvt_pk_bf16_f32 v179, v8, v9
  v_mfma_f32_16x16x32_bf16 a[212:215], a[12:15], v[168:171], a[212:215]
  ds_read_b128 a[48:51], v249 offset:36864
  ds_read_b128 a[52:55], v249 offset:37888
  v_mfma_f32_16x16x32_bf16 a[220:223], a[12:15], v[172:175], a[220:223]
  s_waitcnt lgkmcnt(6)
  v_exp_f32 v3, v137
  v_mfma_f32_16x16x32_bf16 v[64:67], a[16:19], v[160:163], v[64:67]
  v_exp_f32 v4, v138
  v_mfma_f32_16x16x32_bf16 v[72:75], a[16:19], v[164:167], v[72:75]
  buffer_load_dwordx4 v12, s[68:71], s48 offen offset:1024 sc1 lds
  v_mfma_f32_16x16x32_bf16 a[224:227], a[16:19], v[168:171], a[224:227]
  v_exp_f32 v5, v139
  v_mfma_f32_16x16x32_bf16 a[232:235], a[16:19], v[172:175], a[232:235]
  ds_read_b128 a[56:59], v249 offset:38912
  ds_read_b128 a[60:63], v249 offset:39936
  v_mfma_f32_16x16x32_bf16 v[244:247], a[68:71], v[176:179], v[240:243]
  v_exp_f32 v6, v140
  v_mfma_f32_16x16x32_bf16 v[68:71], a[20:23], v[160:163], v[68:71]
  v_exp_f32 v7, v141
  v_mfma_f32_16x16x32_bf16 v[76:79], a[20:23], v[164:167], v[76:79]
  v_cvt_pk_bf16_f32 v180, v2, v3
  v_cvt_pk_bf16_f32 v181, v4, v5
  v_mfma_f32_16x16x32_bf16 a[228:231], a[20:23], v[168:171], a[228:231]
  v_exp_f32 v8, v142
  v_mfma_f32_16x16x32_bf16 a[236:239], a[20:23], v[172:175], a[236:239]
  v_exp_f32 v9, v143
  v_mfma_f32_16x16x32_bf16 v[80:83], a[24:27], v[160:163], v[80:83]
  v_cvt_pk_bf16_f32 v182, v6, v7
  v_cvt_pk_bf16_f32 v183, v8, v9
  v_mfma_f32_16x16x32_bf16 v[88:91], a[24:27], v[164:167], v[88:91]
  v_exp_f32 v2, v144
  v_mfma_f32_16x16x32_bf16 a[240:243], a[24:27], v[168:171], a[240:243]
  v_exp_f32 v3, v145
  v_mfma_f32_16x16x32_bf16 a[248:251], a[24:27], v[172:175], a[248:251]
  buffer_load_dwordx4 v12, s[68:71], s48 offen offset:2048 sc1 lds
  v_mfma_f32_16x16x32_bf16 v[244:247], a[72:75], v[180:183], v[244:247]
  v_exp_f32 v4, v146
  v_mfma_f32_16x16x32_bf16 v[84:87], a[28:31], v[160:163], v[84:87]
  v_exp_f32 v5, v147
  v_mfma_f32_16x16x32_bf16 v[92:95], a[28:31], v[164:167], v[92:95]
  v_cvt_pk_bf16_f32 v184, v2, v3
  v_cvt_pk_bf16_f32 v185, v4, v5
  v_mfma_f32_16x16x32_bf16 a[244:247], a[28:31], v[168:171], a[244:247]
  s_waitcnt lgkmcnt(0)
  v_exp_f32 v6, v148
  v_mfma_f32_16x16x32_bf16 a[252:255], a[28:31], v[172:175], a[252:255]
  ds_read_b128 a[0:3], v249 offset:24576
  v_xor_b32 v248, 0x10000, v248
  v_mfma_f32_16x16x32_bf16 v[192:195], a[32:35], a[160:163], v[224:227]
  v_exp_f32 v7, v149
  v_mfma_f32_16x16x32_bf16 v[192:195], a[36:39], a[164:167], v[192:195]
  v_exp_f32 v8, v150
  v_mfma_f32_16x16x32_bf16 v[192:195], a[40:43], a[168:171], v[192:195]
  ds_read_b128 a[4:7], v249 offset:25600
  v_cvt_pk_bf16_f32 v186, v6, v7
  v_mfma_f32_16x16x32_bf16 v[192:195], a[44:47], a[172:175], v[192:195]
  v_exp_f32 v9, v151
  v_mfma_f32_16x16x32_bf16 v[196:199], a[48:51], a[160:163], v[224:227]
  v_exp_f32 v2, v152
  v_cvt_pk_bf16_f32 v187, v8, v9
  v_mfma_f32_16x16x32_bf16 v[196:199], a[52:55], a[164:167], v[196:199]
  buffer_load_dwordx4 v12, s[68:71], s48 offen offset:3072 sc1 lds
  v_mfma_f32_16x16x32_bf16 v[196:199], a[56:59], a[168:171], v[196:199]
  v_exp_f32 v3, v153
  v_mfma_f32_16x16x32_bf16 v[196:199], a[60:63], a[172:175], v[196:199]
  v_exp_f32 v4, v154
  v_mfma_f32_16x16x32_bf16 v[244:247], a[76:79], v[184:187], v[244:247]
  ds_read_b128 a[8:11], v249 offset:26624
  v_cvt_pk_bf16_f32 v188, v2, v3
  v_mfma_f32_16x16x32_bf16 v[200:203], a[32:35], a[176:179], v[228:231]
  v_exp_f32 v5, v155
  v_mfma_f32_16x16x32_bf16 v[200:203], a[36:39], a[180:183], v[200:203]
  s_sub_u32 s85, s73, 1572864
  v_exp_f32 v6, v156
  v_mfma_f32_16x16x32_bf16 v[200:203], a[40:43], a[184:187], v[200:203]
  buffer_store_dwordx4 a[84:87], v255, s[68:71], s85 offen offset:0 sc1
  v_mfma_f32_16x16x32_bf16 v[200:203], a[44:47], a[188:191], v[200:203]
  v_exp_f32 v7, v157
  v_mfma_f32_16x16x32_bf16 v[204:207], a[48:51], a[176:179], v[228:231]
  v_exp_f32 v8, v158
  v_mfma_f32_16x16x32_bf16 v[204:207], a[52:55], a[180:183], v[204:207]
  v_cvt_pk_bf16_f32 v189, v4, v5
  v_cvt_pk_bf16_f32 v190, v6, v7
  v_cndmask_b32 v218, v11, v236, s[4:5]
  v_cndmask_b32 v219, v11, v236, s[6:7]
  v_mfma_f32_16x16x32_bf16 v[204:207], a[56:59], a[184:187], v[204:207]
  v_exp_f32 v9, v159
  v_mfma_f32_16x16x32_bf16 v[204:207], a[60:63], a[188:191], v[204:207]
  v_cvt_pk_bf16_f32 v191, v8, v9
  v_cndmask_b32 v220, v11, v236, s[8:9]
  v_mfma_f32_16x16x32_bf16 v[216:219], a[32:35], a[144:147], v[216:219]
  ds_read_b128 a[12:15], v249 offset:27648
  v_cndmask_b32 v221, v11, v236, s[10:11]
  v_mfma_f32_16x16x32_bf16 v[244:247], a[80:83], v[188:191], v[244:247]
  ds_read_b128 a[16:19], v249 offset:28672
  v_cndmask_b32 v222, v11, v236, s[12:13]
  v_mfma_f32_16x16x32_bf16 v[216:219], a[36:39], a[148:151], v[216:219]
  ds_read_b128 a[20:23], v249 offset:29696
  v_cndmask_b32 v223, v11, v236, s[14:15]
  v_mfma_f32_16x16x32_bf16 v[216:219], a[40:43], a[152:155], v[216:219]
  ds_read_b128 a[24:27], v249 offset:30720
  v_mfma_f32_16x16x32_bf16 v[216:219], a[44:47], a[156:159], v[216:219]
  ds_read_b128 a[28:31], v249 offset:31744
  v_mfma_f32_16x16x32_bf16 v[220:223], a[48:51], a[144:147], v[220:223]
  v_max3_f32 v250, v244, v245, v246
  v_mfma_f32_16x16x32_bf16 v[220:223], a[52:55], a[148:151], v[220:223]
  s_waitcnt lgkmcnt(4)
  v_max_f32 v250, v250, v247
  v_cmp_nge_f32 vcc, s44, v250
  v_mfma_f32_16x16x32_bf16 v[220:223], a[56:59], a[152:155], v[220:223]
  v_mfma_f32_16x16x32_bf16 v[220:223], a[60:63], a[156:159], v[220:223]
  s_cbranch_vccnz L_dm2_rare
L_dm2_back:
  v_mfma_f32_16x16x32_bf16 v[32:35], a[0:3], v[176:179], v[32:35]
  v_exp_f32 v2, v192
  v_mfma_f32_16x16x32_bf16 v[40:43], a[0:3], v[180:183], v[40:43]
  ds_read_b128 a[32:35], v249 offset:40960
  v_cndmask_b32 v152, v11, v236, s[16:17]
  v_mfma_f32_16x16x32_bf16 a[192:195], a[0:3], v[184:187], a[192:195]
  v_exp_f32 v3, v193
  v_mfma_f32_16x16x32_bf16 a[200:203], a[0:3], v[188:191], a[200:203]
  ds_read_b128 a[36:39], v249 offset:41984
  v_cvt_pk_bf16_f32 v160, v2, v3
  v_mfma_f32_16x16x32_bf16 v[36:39], a[4:7], v[176:179], v[36:39]
  v_exp_f32 v4, v194
  v_mfma_f32_16x16x32_bf16 v[44:47], a[4:7], v[180:183], v[44:47]
  ds_read_b128 a[40:43], v249 offset:43008
  v_cndmask_b32 v153, v11, v236, s[18:19]
  v_mfma_f32_16x16x32_bf16 a[196:199], a[4:7], v[184:187], a[196:199]
  v_exp_f32 v5, v195
  v_mfma_f32_16x16x32_bf16 a[204:207], a[4:7], v[188:191], a[204:207]
  ds_read_b128 a[44:47], v249 offset:44032
  v_cvt_pk_bf16_f32 v161, v4, v5
  v_mfma_f32_16x16x32_bf16 v[48:51], a[8:11], v[176:179], v[48:51]
  s_xor_b32 m0, s49, 32768
  v_exp_f32 v6, v196
  v_mfma_f32_16x16x32_bf16 v[56:59], a[8:11], v[180:183], v[56:59]
  buffer_load_dwordx4 v12, s[68:71], s39 offen offset:0 sc1 lds
  v_mfma_f32_16x16x32_bf16 a[208:211], a[8:11], v[184:187], a[208:211]
  v_exp_f32 v7, v197
  v_mfma_f32_16x16x32_bf16 a[216:219], a[8:11], v[188:191], a[216:219]
  ds_read_b128 a[48:51], v249 offset:45056
  v_cvt_pk_bf16_f32 v162, v6, v7
  v_mfma_f32_16x16x32_bf16 v[52:55], a[12:15], v[176:179], v[52:55]
  ds_read_b128 a[52:55], v249 offset:46080
  ds_read_b128 a[56:59], v249 offset:47104
  v_mfma_f32_16x16x32_bf16 v[60:63], a[12:15], v[180:183], v[60:63]
  v_exp_f32 v8, v198
  v_mfma_f32_16x16x32_bf16 a[212:215], a[12:15], v[184:187], a[212:215]
  ds_read_b128 a[60:63], v249 offset:48128
  v_cndmask_b32 v154, v11, v236, s[20:21]
  v_mfma_f32_16x16x32_bf16 a[220:223], a[12:15], v[188:191], a[220:223]
  s_waitcnt lgkmcnt(8)
  v_exp_f32 v9, v199
  v_mfma_f32_16x16x32_bf16 v[64:67], a[16:19], v[176:179], v[64:67]
  v_cvt_pk_bf16_f32 v163, v8, v9
  v_cndmask_b32 v155, v11, v236, s[22:23]
  v_mfma_f32_16x16x32_bf16 v[72:75], a[16:19], v[180:183], v[72:75]
  v_exp_f32 v2, v200
  v_mfma_f32_16x16x32_bf16 a[224:227], a[16:19], v[184:187], a[224:227]
  buffer_load_dwordx4 v12, s[68:71], s39 offen offset:1024 sc1 lds
  v_mfma_f32_16x16x32_bf16 a[232:235], a[16:19], v[188:191], a[232:235]
  v_exp_f32 v3, v201
  v_mfma_f32_16x16x32_bf16 v[240:243], a[68:71], v[160:163], v[244:247]
  v_cvt_pk_bf16_f32 v164, v2, v3
  v_cndmask_b32 v156, v11, v236, s[24:25]
  v_mfma_f32_16x16x32_bf16 v[68:71], a[20:23], v[176:179], v[68:71]
  v_exp_f32 v4, v202
  v_mfma_f32_16x16x32_bf16 v[76:79], a[20:23], v[180:183], v[76:79]
  buffer_store_dwordx4 a[84:87], v255, s[68:71], s85 offen offset:1024 sc1
  v_mfma_f32_16x16x32_bf16 a[228:231], a[20:23], v[184:187], a[228:231]
  v_exp_f32 v5, v203
  v_mfma_f32_16x16x32_bf16 a[236:239], a[20:23], v[188:191], a[236:239]
  v_cvt_pk_bf16_f32 v165, v4, v5
  v_cndmask_b32 v157, v11, v236, s[26:27]
  v_mfma_f32_16x16x32_bf16 v[80:83], a[24:27], v[176:179], v[80:83]
  v_exp_f32 v6, v204
  v_mfma_f32_16x16x32_bf16 v[88:91], a[24:27], v[180:183], v[88:91]
  v_cndmask_b32 v158, v11, v236, s[28:29]
  v_cndmask_b32 v159, v11, v236, s[30:31]
  v_mfma_f32_16x16x32_bf16 a[240:243], a[24:27], v[184:187], a[240:243]
  v_exp_f32 v7, v205
  v_mfma_f32_16x16x32_bf16 a[248:251], a[24:27], v[188:191], a[248:251]
  buffer_load_dwordx4 v12, s[68:71], s39 offen offset:2048 sc1 lds
  v_mfma_f32_16x16x32_bf16 v[84:87], a[28:31], v[176:179], v[84:87]
  s_waitcnt lgkmcnt(0)
  v_exp_f32 v8, v206
  v_mfma_f32_16x16x32_bf16 v[92:95], a[28:31], v[180:183], v[92:95]
  v_cvt_pk_bf16_f32 v166, v6, v7
  v_mfma_f32_16x16x32_bf16 a[244:247], a[28:31], v[184:187], a[244:247]
  s_sub_u32 s85, s74, 1572864
  v_exp_f32 v9, v207
  v_mfma_f32_16x16x32_bf16 a[252:255], a[28:31], v[188:191], a[252:255]
  buffer_store_dwordx4 a[84:87], v255, s[68:71], s85 offen offset:0 sc1
  v_mfma_f32_16x16x32_bf16 v[128:131], a[32:35], a[160:163], v[224:227]
L_hop12:
  s_cbranch_execz L_dxm
  v_exp_f32 v2, v216
  v_mfma_f32_16x16x32_bf16 v[128:131], a[36:39], a[164:167], v[128:131]
  ds_read_b128 a[0:3], v249 offset:49152
  v_cvt_pk_bf16_f32 v167, v8, v9
  v_mfma_f32_16x16x32_bf16 v[128:131], a[40:43], a[168:171], v[128:131]
  v_exp_f32 v3, v217
  v_mfma_f32_16x16x32_bf16 v[128:131], a[44:47], a[172:175], v[128:131]
  ds_read_b128 a[4:7], v249 offset:50176
  v_cvt_pk_bf16_f32 v172, v2, v3
  v_mfma_f32_16x16x32_bf16 v[240:243], a[72:75], v[164:167], v[240:243]
  v_mfma_f32_16x16x32_bf16 v[132:135], a[48:51], a[160:163], v[224:227]
  v_exp_f32 v4, v218
  v_mfma_f32_16x16x32_bf16 v[132:135], a[52:55], a[164:167], v[132:135]
  buffer_load_dwordx4 v12, s[68:71], s39 offen offset:3072 sc1 lds
  v_mfma_f32_16x16x32_bf16 v[132:135], a[56:59], a[168:171], v[132:135]
  v_exp_f32 v5, v219
  v_mfma_f32_16x16x32_bf16 v[132:135], a[60:63], a[172:175], v[132:135]
  ds_read_b128 a[8:11], v249 offset:51200
  v_cvt_pk_bf16_f32 v173, v4, v5
  v_mfma_f32_16x16x32_bf16 v[136:139], a[32:35], a[176:179], v[228:231]
  v_exp_f32 v6, v220
  v_mfma_f32_16x16x32_bf16 v[136:139], a[36:39], a[180:183], v[136:139]
  buffer_store_dwordx4 a[84:87], v255, s[68:71], s85 offen offset:1024 sc1
  v_mfma_f32_16x16x32_bf16 v[136:139], a[40:43], a[184:187], v[136:139]
  v_exp_f32 v7, v221
  v_mfma_f32_16x16x32_bf16 v[136:139], a[44:47], a[188:191], v[136:139]
  v_cvt_pk_bf16_f32 v174, v6, v7
  v_mfma_f32_16x16x32_bf16 v[140:143], a[48:51], a[176:179], v[228:231]
  v_exp_f32 v8, v222
  v_mfma_f32_16x16x32_bf16 v[140:143], a[52:55], a[180:183], v[140:143]
  v_mfma_f32_16x16x32_bf16 v[140:143], a[56:59], a[184:187], v[140:143]
  v_exp_f32 v9, v223
  v_mfma_f32_16x16x32_bf16 v[140:143], a[60:63], a[188:191], v[140:143]
  v_cvt_pk_bf16_f32 v175, v8, v9
  v_mfma_f32_16x16x32_bf16 v[152:155], a[32:35], a[144:147], v[152:155]
  ds_read_b128 a[12:15], v249 offset:52224
  v_mfma_f32_16x16x32_bf16 v[240:243], a[80:83], v[172:175], v[240:243]
  ds_read_b128 a[16:19], v249 offset:53248
  v_mfma_f32_16x16x32_bf16 v[152:155], a[36:39], a[148:151], v[152:155]
  ds_read_b128 a[20:23], v249 offset:54272
  v_mfma_f32_16x16x32_bf16 v[152:155], a[40:43], a[152:155], v[152:155]
  ds_read_b128 a[24:27], v249 offset:55296
  v_mfma_f32_16x16x32_bf16 v[152:155], a[44:47], a[156:159], v[152:155]
  ds_read_b128 a[28:31], v249 offset:56320
  v_mfma_f32_16x16x32_bf16 v[156:159], a[48:51], a[144:147], v[156:159]
  v_max3_f32 v250, v240, v241, v242
  v_mfma_f32_16x16x32_bf16 v[156:159], a[52:55], a[148:151], v[156:159]
  s_waitcnt lgkmcnt(4)
  v_max_f32 v250, v250, v243
  v_cmp_nge_f32 vcc, s44, v250
  v_mfma_f32_16x16x32_bf16 v[156:159], a[56:59], a[152:155], v[156:159]
  v_mfma_f32_16x16x32_bf16 v[156:159], a[60:63], a[156:159], v[156:159]
  s_cbranch_vccnz L_dm3_rare
L_dm3_back:
  s_cmp_eq_u32 s78, 7
  s_cbranch_scc1 L_dxm
L_dx:
  s_cbranch_execz L_main
  v_mfma_f32_16x16x32_bf16 v[32:35], a[0:3], v[160:163], v[32:35]
  v_exp_f32 v2, v128
  v_xor_b32 v249, 0x10000, v249
  v_mfma_f32_16x16x32_bf16 v[40:43], a[0:3], v[164:167], v[40:43]
  s_waitcnt vmcnt(15)
  s_barrier
  v_mfma_f32_16x16x32_bf16 a[200:203], a[0:3], v[172:175], a[200:203]
  s_xor_b32 s49, s49, 0x10000
  ds_read_b128 a[32:35], v249 offset:0
  ds_read_b128 a[36:39], v249 offset:1024
  v_mfma_f32_16x16x32_bf16 v[36:39], a[4:7], v[160:163], v[36:39]
  s_add_u32 s48, s39, 16384
  v_exp_f32 v3, v129
  v_mfma_f32_16x16x32_bf16 v[44:47], a[4:7], v[164:167], v[44:47]
  s_add_u32 s39, s39, 32768
  ds_read_b128 a[40:43], v249 offset:2048
  ds_read_b128 a[44:47], v249 offset:3072
  v_mfma_f32_16x16x32_bf16 a[204:207], a[4:7], v[172:175], a[204:207]
  v_exp_f32 v4, v130
  v_mfma_f32_16x16x32_bf16 v[48:51], a[8:11], v[160:163], v[48:51]
  ds_read_b128 a[48:51], v249 offset:4096
  v_cvt_pk_bf16_f32 v176, v2, v3
  v_mfma_f32_16x16x32_bf16 v[56:59], a[8:11], v[164:167], v[56:59]
  v_exp_f32 v5, v131
  v_mfma_f32_16x16x32_bf16 a[216:219], a[8:11], v[172:175], a[216:219]
  ds_read_b128 a[52:55], v249 offset:5120
  v_cvt_pk_bf16_f32 v177, v4, v5
  v_mfma_f32_16x16x32_bf16 v[52:55], a[12:15], v[160:163], v[52:55]
  s_xor_b32 m0, s49, 0
  v_exp_f32 v6, v132
  v_mfma_f32_16x16x32_bf16 v[60:63], a[12:15], v[164:167], v[60:63]
  buffer_load_dwordx4 v12, s[68:71], s39 offen offset:0 sc1 lds
  v_mfma_f32_16x16x32_bf16 a[220:223], a[12:15], v[172:175], a[220:223]
  s_waitcnt lgkmcnt(6)
  v_exp_f32 v7, v133
  v_mfma_f32_16x16x32_bf16 v[64:67], a[16:19], v[160:163], v[64:67]
  ds_read_b128 a[56:59], v249 offset:6144
  v_cvt_pk_bf16_f32 v178, v6, v7
  v_mfma_f32_16x16x32_bf16 v[72:75], a[16:19], v[164:167], v[72:75]
  v_exp_f32 v8, v134
  v_mfma_f32_16x16x32_bf16 a[232:235], a[16:19], v[172:175], a[232:235]
  ds_read_b128 a[60:63], v249 offset:7168
  ds_read_b128 a[0:3], v249 offset:8192
  v_mfma_f32_16x16x32_bf16 v[68:71], a[20:23], v[160:163], v[68:71]
  v_exp_f32 v9, v135
  v_mfma_f32_16x16x32_bf16 v[76:79], a[20:23], v[164:167], v[76:79]
  ds_read_b128 a[4:7], v249 offset:9216
  v_cvt_pk_bf16_f32 v179, v8, v9
  v_mfma_f32_16x16x32_bf16 a[236:239], a[20:23], v[172:175], a[236:239]
  v_exp_f32 v2, v136
  v_mfma_f32_16x16x32_bf16 v[80:83], a[24:27], v[160:163], v[80:83]
  ds_read_b128 a[8:11], v249 offset:10240
  ds_read_b128 a[12:15], v249 offset:11264
  v_mfma_f32_16x16x32_bf16 v[88:91], a[24:27], v[164:167], v[88:91]
  v_exp_f32 v3, v137
  v_mfma_f32_16x16x32_bf16 v[244:247], a[68:71], v[176:179], v[240:243]
  buffer_load_dwordx4 v12, s[68:71], s39 offen offset:1024 sc1 lds
  v_mfma_f32_16x16x32_bf16 a[248:251], a[24:27], v[172:175], a[248:251]
  v_exp_f32 v4, v138
  v_mfma_f32_16x16x32_bf16 v[84:87], a[28:31], v[160:163], v[84:87]
  ds_read_b128 a[16:19], v249 offset:12288
  v_cvt_pk_bf16_f32 v180, v2, v3
  v_mfma_f32_16x16x32_bf16 v[92:95], a[28:31], v[164:167], v[92:95]
  s_waitcnt lgkmcnt(9)
  v_exp_f32 v5, v139
  v_mfma_f32_16x16x32_bf16 a[252:255], a[28:31], v[172:175], a[252:255]
  ds_read_b128 a[20:23], v249 offset:13312
  v_cvt_pk_bf16_f32 v181, v4, v5
  v_mfma_f32_16x16x32_bf16 v[192:195], a[32:35], a[160:163], v[224:227]
  ds_read_b128 a[24:27], v249 offset:14336
  ds_read_b128 a[28:31], v249 offset:15360
  v_mfma_f32_16x16x32_bf16 v[192:195], a[36:39], a[164:167], v[192:195]
  v_exp_f32 v6, v140
  v_mfma_f32_16x16x32_bf16 v[192:195], a[40:43], a[168:171], v[192:195]
  buffer_load_dwordx4 v12, s[68:71], s39 offen offset:2048 sc1 lds
  v_mfma_f32_16x16x32_bf16 v[192:195], a[44:47], a[172:175], v[192:195]
  v_exp_f32 v7, v141
  v_mfma_f32_16x16x32_bf16 v[200:203], a[32:35], a[176:179], v[228:231]
  ds_read_b128 a[32:35], v248 offset:57344
  v_cvt_pk_bf16_f32 v182, v6, v7
  v_mfma_f32_16x16x32_bf16 v[200:203], a[36:39], a[180:183], v[200:203]
  v_exp_f32 v8, v142
  v_mfma_f32_16x16x32_bf16 v[200:203], a[40:43], a[184:187], v[200:203]
  ds_read_b128 a[36:39], v248 offset:58368
  ds_read_b128 a[40:43], v248 offset:59392
  v_mfma_f32_16x16x32_bf16 v[200:203], a[44:47], a[188:191], v[200:203]
  s_waitcnt lgkmcnt(11)
  v_exp_f32 v9, v143
  v_mfma_f32_16x16x32_bf16 v[196:199], a[48:51], a[160:163], v[224:227]
  ds_read_b128 a[44:47], v248 offset:60416
  v_cvt_pk_bf16_f32 v183, v8, v9
  v_mfma_f32_16x16x32_bf16 v[196:199], a[52:55], a[164:167], v[196:199]
  v_exp_f32 v2, v152
  v_mfma_f32_16x16x32_bf16 v[196:199], a[56:59], a[168:171], v[196:199]
  v_mfma_f32_16x16x32_bf16 v[196:199], a[60:63], a[172:175], v[196:199]
  v_exp_f32 v3, v153
  v_mfma_f32_16x16x32_bf16 v[244:247], a[72:75], v[180:183], v[244:247]
  buffer_load_dwordx4 v12, s[68:71], s39 offen offset:3072 sc1 lds
  v_mfma_f32_16x16x32_bf16 v[204:207], a[48:51], a[176:179], v[228:231]
  v_exp_f32 v4, v154
  v_mfma_f32_16x16x32_bf16 v[204:207], a[52:55], a[180:183], v[204:207]
  ds_read_b128 a[48:51], v248 offset:61440
  v_cvt_pk_bf16_f32 v188, v2, v3
  v_mfma_f32_16x16x32_bf16 v[204:207], a[56:59], a[184:187], v[204:207]
  s_waitcnt lgkmcnt(9)
  v_exp_f32 v5, v155
  v_mfma_f32_16x16x32_bf16 v[204:207], a[60:63], a[188:191], v[204:207]
  ds_read_b128 a[52:55], v248 offset:62464
  v_cvt_pk_bf16_f32 v189, v4, v5
  v_mfma_f32_16x16x32_bf16 v[208:211], a[0:3], a[160:163], v[224:227]
  v_exp_f32 v6, v156
  v_mfma_f32_16x16x32_bf16 v[208:211], a[4:7], a[164:167], v[208:211]
  ds_read_b128 a[56:59], v248 offset:63488
  ds_read_b128 a[60:63], v248 offset:64512
  v_mfma_f32_16x16x32_bf16 v[208:211], a[8:11], a[168:171], v[208:211]
  s_xor_b32 m0, s49, 114688
  v_exp_f32 v7, v157
  v_mfma_f32_16x16x32_bf16 v[208:211], a[12:15], a[172:175], v[208:211]
  buffer_load_dwordx4 v12, s[68:71], s48 offen offset:0 sc1 lds
  v_mfma_f32_16x16x32_bf16 v[216:219], a[0:3], a[176:179], v[228:231]
  v_exp_f32 v8, v158
  v_mfma_f32_16x16x32_bf16 v[216:219], a[4:7], a[180:183], v[216:219]
  v_cvt_pk_bf16_f32 v190, v6, v7
  v_mfma_f32_16x16x32_bf16 v[216:219], a[8:11], a[184:187], v[216:219]
  s_waitcnt lgkmcnt(8)
  v_exp_f32 v9, v159
  v_mfma_f32_16x16x32_bf16 v[216:219], a[12:15], a[188:191], v[216:219]
  v_cvt_pk_bf16_f32 v191, v8, v9
  v_mfma_f32_16x16x32_bf16 v[212:215], a[16:19], a[160:163], v[224:227]
  s_nop 0
  v_mfma_f32_16x16x32_bf16 v[244:247], a[80:83], v[188:191], v[244:247]
  v_mfma_f32_16x16x32_bf16 v[212:215], a[20:23], a[164:167], v[212:215]
  buffer_load_dwordx4 v12, s[68:71], s48 offen offset:1024 sc1 lds
  v_mfma_f32_16x16x32_bf16 v[212:215], a[24:27], a[168:171], v[212:215]
  buffer_load_dwordx4 v12, s[68:71], s48 offen offset:2048 sc1 lds
  v_mfma_f32_16x16x32_bf16 v[212:215], a[28:31], a[172:175], v[212:215]
  v_mfma_f32_16x16x32_bf16 v[220:223], a[16:19], a[176:179], v[228:231]
  buffer_load_dwordx4 v12, s[68:71], s48 offen offset:3072 sc1 lds
  s_nop 0
  v_max3_f32 v250, v244, v245, v246
  v_mfma_f32_16x16x32_bf16 v[220:223], a[20:23], a[180:183], v[220:223]
  s_waitcnt lgkmcnt(4)
  v_max_f32 v250, v250, v247
  v_cmp_nge_f32 vcc, s44, v250
  v_mfma_f32_16x16x32_bf16 v[220:223], a[24:27], a[184:187], v[220:223]
  v_mfma_f32_16x16x32_bf16 v[220:223], a[28:31], a[188:191], v[220:223]
  s_cbranch_vccnz L_dx1_rare
L_dx1_back:
  v_mfma_f32_16x16x32_bf16 v[32:35], a[32:35], v[176:179], v[32:35]
  v_exp_f32 v2, v192
  v_mfma_f32_16x16x32_bf16 v[40:43], a[32:35], v[180:183], v[40:43]
  s_waitcnt vmcnt(8)
  s_barrier
  v_mfma_f32_16x16x32_bf16 a[200:203], a[32:35], v[188:191], a[200:203]
  ds_read_b128 a[0:3], v249 offset:32768
  ds_read_b128 a[4:7], v249 offset:33792
  ds_read_b128 a[8:11], v249 offset:34816
  v_mfma_f32_16x16x32_bf16 v[36:39], a[36:39], v[176:179], v[36:39]
  s_add_u32 s48, s39, 16384
  ds_read_b128 a[12:15], v249 offset:35840
  v_exp_f32 v3, v193
  v_mfma_f32_16x16x32_bf16 v[44:47], a[36:39], v[180:183], v[44:47]
  s_add_u32 s39, s39, 32768
  v_exp_f32 v4, v194
  v_cvt_pk_bf16_f32 v160, v2, v3
  v_mfma_f32_16x16x32_bf16 a[204:207], a[36:39], v[188:191], a[204:207]
  ds_read_b128 a[16:19], v249 offset:36864
  ds_read_b128 a[20:23], v249 offset:37888
  ds_read_b128 a[24:27], v249 offset:38912
  v_mfma_f32_16x16x32_bf16 v[48:51], a[40:43], v[176:179], v[48:51]
  ds_read_b128 a[28:31], v249 offset:39936
  v_exp_f32 v5, v195
  v_mfma_f32_16x16x32_bf16 v[56:59], a[40:43], v[180:183], v[56:59]
  v_exp_f32 v6, v196
  v_mov_b32 v10, 1
  v_mfma_f32_16x16x32_bf16 a[216:219], a[40:43], v[188:191], a[216:219]
  buffer_store_dword v10, v17, s[68:71], s38 offen sc1
  v_rcp_f32 v252, v246
  v_rcp_f32 v253, v247
  s_lshl_b32 s80, s77, 12
  s_add_u32 s80, s80, s37
  s_add_u32 s82, s80, 704512
  v_mfma_f32_16x16x32_bf16 v[52:55], a[44:47], v[176:179], v[52:55]
  s_waitcnt lgkmcnt(8)
  v_exp_f32 v7, v197
  v_cvt_pk_bf16_f32 v161, v4, v5
  v_mfma_f32_16x16x32_bf16 v[60:63], a[44:47], v[180:183], v[60:63]
  s_xor_b32 m0, s49, 32768
  v_exp_f32 v8, v198
  v_cvt_pk_bf16_f32 v162, v6, v7
  v_mfma_f32_16x16x32_bf16 a[220:223], a[44:47], v[188:191], a[220:223]
  buffer_load_dwordx4 v12, s[68:71], s39 offen offset:0 sc1 lds
  s_lshl_b32 s45, s78, 1
  v_mfma_f32_16x16x32_bf16 v[64:67], a[48:51], v[176:179], v[64:67]
  s_sub_u32 s45, 12, s45
  ds_read_b128 a[32:35], v249 offset:40960
  v_exp_f32 v9, v199
  v_mfma_f32_16x16x32_bf16 v[72:75], a[48:51], v[180:183], v[72:75]
  ds_read_b128 a[36:39], v249 offset:41984
  ds_read_b128 a[40:43], v249 offset:43008
  v_cvt_pk_bf16_f32 v163, v8, v9
  v_mfma_f32_16x16x32_bf16 a[232:235], a[48:51], v[188:191], a[232:235]
  ds_read_b128 a[44:47], v249 offset:44032
  v_exp_f32 v2, v200
  v_mfma_f32_16x16x32_bf16 v[68:71], a[52:55], v[176:179], v[68:71]
  ds_read_b128 a[48:51], v249 offset:45056
  v_exp_f32 v3, v201
  v_mfma_f32_16x16x32_bf16 v[76:79], a[52:55], v[180:183], v[76:79]
  v_cvt_pk_bf16_f32 v164, v2, v3
  v_xor_b32 v248, 0x10000, v248
  v_mfma_f32_16x16x32_bf16 a[236:239], a[52:55], v[188:191], a[236:239]
  v_exp_f32 v4, v202
  v_mfma_f32_16x16x32_bf16 v[80:83], a[56:59], v[176:179], v[80:83]
  v_exp_f32 v5, v203
  v_mfma_f32_16x16x32_bf16 v[88:91], a[56:59], v[180:183], v[88:91]
  buffer_load_dwordx4 v12, s[68:71], s39 offen offset:1024 sc1 lds
  v_mfma_f32_16x16x32_bf16 v[240:243], a[68:71], v[160:163], v[244:247]
  v_exp_f32 v6, v204
  v_mfma_f32_16x16x32_bf16 a[248:251], a[56:59], v[188:191], a[248:251]
  ds_read_b128 a[52:55], v249 offset:46080
  v_cvt_pk_bf16_f32 v165, v4, v5
  v_mfma_f32_16x16x32_bf16 v[84:87], a[60:63], v[176:179], v[84:87]
  v_exp_f32 v7, v205
  v_mfma_f32_16x16x32_bf16 v[92:95], a[60:63], v[180:183], v[92:95]
  s_waitcnt lgkmcnt(10)
  v_exp_f32 v8, v206
  v_mfma_f32_16x16x32_bf16 a[252:255], a[60:63], v[188:191], a[252:255]
  ds_read_b128 a[56:59], v249 offset:47104
  v_cvt_pk_bf16_f32 v166, v6, v7
  v_mfma_f32_16x16x32_bf16 v[128:131], a[0:3], a[160:163], v[224:227]
  v_exp_f32 v9, v207
  v_mfma_f32_16x16x32_bf16 v[128:131], a[4:7], a[164:167], v[128:131]
  v_exp_f32 v2, v208
  v_mfma_f32_16x16x32_bf16 v[128:131], a[8:11], a[168:171], v[128:131]
  ds_read_b128 a[60:63], v249 offset:48128
  v_cvt_pk_bf16_f32 v167, v8, v9
  v_mfma_f32_16x16x32_bf16 v[128:131], a[12:15], a[172:175], v[128:131]
  v_exp_f32 v3, v209
  v_mfma_f32_16x16x32_bf16 v[136:139], a[0:3], a[176:179], v[228:231]
  v_exp_f32 v4, v210
  v_mfma_f32_16x16x32_bf16 v[136:139], a[4:7], a[180:183], v[136:139]
  buffer_load_dwordx4 v12, s[68:71], s39 offen offset:2048 sc1 lds
  v_mfma_f32_16x16x32_bf16 v[136:139], a[8:11], a[184:187], v[136:139]
  v_exp_f32 v5, v211
  v_mfma_f32_16x16x32_bf16 v[136:139], a[12:15], a[188:191], v[136:139]
  v_cvt_pk_bf16_f32 v168, v2, v3
  v_cvt_pk_bf16_f32 v169, v4, v5
  v_mfma_f32_16x16x32_bf16 v[240:243], a[72:75], v[164:167], v[240:243]
  s_waitcnt lgkmcnt(8)
  v_exp_f32 v6, v212
  v_mfma_f32_16x16x32_bf16 v[132:135], a[16:19], a[160:163], v[224:227]
  v_exp_f32 v7, v213
  v_mfma_f32_16x16x32_bf16 v[132:135], a[20:23], a[164:167], v[132:135]
  ds_read_b128 a[0:3], v249 offset:16384
  v_cvt_pk_bf16_f32 v170, v6, v7
  v_mfma_f32_16x16x32_bf16 v[132:135], a[24:27], a[168:171], v[132:135]
  v_exp_f32 v8, v214
  v_mfma_f32_16x16x32_bf16 v[132:135], a[28:31], a[172:175], v[132:135]
  v_exp_f32 v9, v215
  v_mfma_f32_16x16x32_bf16 v[140:143], a[16:19], a[176:179], v[228:231]
  buffer_load_dwordx4 v12, s[68:71], s39 offen offset:3072 sc1 lds
  v_mfma_f32_16x16x32_bf16 v[140:143], a[20:23], a[180:183], v[140:143]
  v_exp_f32 v2, v216
  v_mfma_f32_16x16x32_bf16 v[140:143], a[24:27], a[184:187], v[140:143]
  ds_read_b128 a[4:7], v249 offset:24576
  v_cvt_pk_bf16_f32 v171, v8, v9
  v_mfma_f32_16x16x32_bf16 v[140:143], a[28:31], a[188:191], v[140:143]
  v_exp_f32 v3, v217
  v_mfma_f32_16x16x32_bf16 v[240:243], a[68:71], v[168:171], v[240:243]
  s_waitcnt lgkmcnt(6)
  v_exp_f32 v4, v218
  v_mfma_f32_16x16x32_bf16 v[144:147], a[32:35], a[160:163], v[224:227]
  ds_read_b128 a[8:11], v249 offset:17408
  ds_read_b128 a[12:15], v249 offset:25600
  v_mfma_f32_16x16x32_bf16 v[144:147], a[36:39], a[164:167], v[144:147]
  v_exp_f32 v5, v219
  v_mfma_f32_16x16x32_bf16 v[144:147], a[40:43], a[168:171], v[144:147]
  s_xor_b32 m0, s49, 16384
  v_exp_f32 v6, v220
  v_mfma_f32_16x16x32_bf16 v[144:147], a[44:47], a[172:175], v[144:147]
  buffer_load_dwordx4 v12, s[68:71], s48 offen offset:0 sc1 lds
  v_mfma_f32_16x16x32_bf16 v[152:155], a[32:35], a[176:179], v[228:231]
  v_exp_f32 v7, v221
  v_mfma_f32_16x16x32_bf16 v[152:155], a[36:39], a[180:183], v[152:155]
  v_exp_f32 v8, v222
  v_mfma_f32_16x16x32_bf16 v[152:155], a[40:43], a[184:187], v[152:155]
  v_cvt_pk_bf16_f32 v172, v2, v3
  v_cvt_pk_bf16_f32 v173, v4, v5
  v_mfma_f32_16x16x32_bf16 v[152:155], a[44:47], a[188:191], v[152:155]
  s_waitcnt lgkmcnt(4)
  v_exp_f32 v9, v223
  v_mfma_f32_16x16x32_bf16 v[148:151], a[48:51], a[160:163], v[224:227]
  v_cvt_pk_bf16_f32 v174, v6, v7
  v_cvt_pk_bf16_f32 v175, v8, v9
  v_mfma_f32_16x16x32_bf16 v[148:151], a[52:55], a[164:167], v[148:151]
  buffer_load_dwordx4 v12, s[68:71], s48 offen offset:1024 sc1 lds
  v_mfma_f32_16x16x32_bf16 v[240:243], a[72:75], v[172:175], v[240:243]
  ds_read_b128 a[16:19], v249 offset:18432
  ds_read_b128 a[20:23], v249 offset:26624
  v_mfma_f32_16x16x32_bf16 v[148:151], a[56:59], a[168:171], v[148:151]
  buffer_load_dwordx4 v12, s[68:71], s48 offen offset:2048 sc1 lds
  v_mfma_f32_16x16x32_bf16 v[148:151], a[60:63], a[172:175], v[148:151]
  ds_read_b128 a[24:27], v249 offset:19456
  ds_read_b128 a[28:31], v249 offset:27648
  v_mfma_f32_16x16x32_bf16 v[156:159], a[48:51], a[176:179], v[228:231]
  buffer_load_dwordx4 v12, s[68:71], s48 offen offset:3072 sc1 lds
  v_mfma_f32_16x16x32_bf16 v[156:159], a[52:55], a[180:183], v[156:159]
  s_waitcnt lgkmcnt(4)
  v_max_f32 v250, v240, v241
  v_cmp_nge_f32 vcc, s44, v250
  v_mfma_f32_16x16x32_bf16 v[156:159], a[56:59], a[184:187], v[156:159]
  ds_read_b128 a[32:35], v249 offset:20480
  ds_read_b128 a[36:39], v249 offset:28672
  v_mfma_f32_16x16x32_bf16 v[156:159], a[60:63], a[188:191], v[156:159]
  s_cbranch_vccnz L_dx2_rare
L_dx2_back:
  ds_read_b128 a[40:43], v249 offset:21504
  ds_read_b128 a[44:47], v249 offset:29696
  v_accvgpr_read_b32 v112, a192
  v_accvgpr_read_b32 v113, a193
  v_accvgpr_read_b32 v114, a194
  v_accvgpr_read_b32 v115, a195
  v_accvgpr_read_b32 v116, a196
  v_accvgpr_read_b32 v117, a197
  v_accvgpr_read_b32 v118, a198
  v_accvgpr_read_b32 v119, a199
  v_pk_mul_f32 v[112:113], v[112:113], v[252:253] op_sel:[0,0] op_sel_hi:[1,0]
  v_pk_mul_f32 v[114:115], v[114:115], v[252:253] op_sel:[0,0] op_sel_hi:[1,0]
  v_pk_mul_f32 v[116:117], v[116:117], v[252:253] op_sel:[0,0] op_sel_hi:[1,0]
  v_pk_mul_f32 v[118:119], v[118:119], v[252:253] op_sel:[0,0] op_sel_hi:[1,0]
  v_cvt_pk_bf16_f32 v96, v112, v113
  v_cvt_pk_bf16_f32 v97, v114, v115
  v_cvt_pk_bf16_f32 v98, v116, v117
  v_cvt_pk_bf16_f32 v99, v118, v119
  buffer_store_dwordx4 v[96:99], v12, s[68:71], s80 offen offset:0 sc1
  v_accvgpr_read_b32 v120, a200
  v_accvgpr_read_b32 v121, a201
  v_accvgpr_read_b32 v122, a202
  v_accvgpr_read_b32 v123, a203
  v_accvgpr_read_b32 v124, a204
  v_accvgpr_read_b32 v125, a205
  v_accvgpr_read_b32 v126, a206
  v_accvgpr_read_b32 v127, a207
  v_pk_mul_f32 v[120:121], v[120:121], v[252:253] op_sel:[0,1] op_sel_hi:[1,1]
  v_pk_mul_f32 v[122:123], v[122:123], v[252:253] op_sel:[0,1] op_sel_hi:[1,1]
  v_pk_mul_f32 v[124:125], v[124:125], v[252:253] op_sel:[0,1] op_sel_hi:[1,1]
  v_pk_mul_f32 v[126:127], v[126:127], v[252:253] op_sel:[0,1] op_sel_hi:[1,1]
  v_cvt_pk_bf16_f32 v100, v120, v121
  v_cvt_pk_bf16_f32 v101, v122, v123
  v_cvt_pk_bf16_f32 v102, v124, v125
  v_cvt_pk_bf16_f32 v103, v126, v127
  buffer_store_dwordx4 v[100:103], v12, s[68:71], s82 offen offset:0 sc1
  v_accvgpr_read_b32 v112, a208
  v_accvgpr_read_b32 v113, a209
  v_accvgpr_read_b32 v114, a210
  v_accvgpr_read_b32 v115, a211
  v_accvgpr_read_b32 v116, a212
  v_accvgpr_read_b32 v117, a213
  v_accvgpr_read_b32 v118, a214
  v_accvgpr_read_b32 v119, a215
  v_pk_mul_f32 v[112:113], v[112:113], v[252:253] op_sel:[0,0] op_sel_hi:[1,0]
  v_pk_mul_f32 v[114:115], v[114:115], v[252:253] op_sel:[0,0] op_sel_hi:[1,0]
  v_pk_mul_f32 v[116:117], v[116:117], v[252:253] op_sel:[0,0] op_sel_hi:[1,0]
  v_pk_mul_f32 v[118:119], v[118:119], v[252:253] op_sel:[0,0] op_sel_hi:[1,0]
  v_cvt_pk_bf16_f32 v104, v112, v113
  v_cvt_pk_bf16_f32 v105, v114, v115
  v_cvt_pk_bf16_f32 v106, v116, v117
  v_cvt_pk_bf16_f32 v107, v118, v119
  buffer_store_dwordx4 v[104:107], v12, s[68:71], s80 offen offset:1024 sc1
  v_accvgpr_read_b32 v120, a216
  v_accvgpr_read_b32 v121, a217
  v_accvgpr_read_b32 v122, a218
  v_accvgpr_read_b32 v123, a219
  v_accvgpr_read_b32 v124, a220
  v_accvgpr_read_b32 v125, a221
  v_accvgpr_read_b32 v126, a222
  v_accvgpr_read_b32 v127, a223
  v_pk_mul_f32 v[120:121], v[120:121], v[252:253] op_sel:[0,1] op_sel_hi:[1,1]
  v_pk_mul_f32 v[122:123], v[122:123], v[252:253] op_sel:[0,1] op_sel_hi:[1,1]
  v_pk_mul_f32 v[124:125], v[124:125], v[252:253] op_sel:[0,1] op_sel_hi:[1,1]
  v_pk_mul_f32 v[126:127], v[126:127], v[252:253] op_sel:[0,1] op_sel_hi:[1,1]
  v_cvt_pk_bf16_f32 v108, v120, v121
  v_cvt_pk_bf16_f32 v109, v122, v123
  v_cvt_pk_bf16_f32 v110, v124, v125
  v_cvt_pk_bf16_f32 v111, v126, v127
  buffer_store_dwordx4 v[108:111], v12, s[68:71], s82 offen offset:1024 sc1
  v_accvgpr_read_b32 v112, a224
  v_accvgpr_read_b32 v113, a225
  v_accvgpr_read_b32 v114, a226
  v_accvgpr_read_b32 v115, a227
  v_accvgpr_read_b32 v116, a228
  v_accvgpr_read_b32 v117, a229
  v_accvgpr_read_b32 v118, a230
  v_accvgpr_read_b32 v119, a231
  v_pk_mul_f32 v[112:113], v[112:113], v[252:253] op_sel:[0,0] op_sel_hi:[1,0]
  v_pk_mul_f32 v[114:115], v[114:115], v[252:253] op_sel:[0,0] op_sel_hi:[1,0]
  v_pk_mul_f32 v[116:117], v[116:117], v[252:253] op_sel:[0,0] op_sel_hi:[1,0]
  v_pk_mul_f32 v[118:119], v[118:119], v[252:253] op_sel:[0,0] op_sel_hi:[1,0]
  v_cvt_pk_bf16_f32 v96, v112, v113
  v_cvt_pk_bf16_f32 v97, v114, v115
  v_cvt_pk_bf16_f32 v98, v116, v117
  v_cvt_pk_bf16_f32 v99, v118, v119
  buffer_store_dwordx4 v[96:99], v12, s[68:71], s80 offen offset:2048 sc1
  v_accvgpr_read_b32 v120, a232
  v_accvgpr_read_b32 v121, a233
  v_accvgpr_read_b32 v122, a234
  v_accvgpr_read_b32 v123, a235
  v_accvgpr_read_b32 v124, a236
  v_accvgpr_read_b32 v125, a237
  v_accvgpr_read_b32 v126, a238
  v_accvgpr_read_b32 v127, a239
  v_pk_mul_f32 v[120:121], v[120:121], v[252:253] op_sel:[0,1] op_sel_hi:[1,1]
  v_pk_mul_f32 v[122:123], v[122:123], v[252:253] op_sel:[0,1] op_sel_hi:[1,1]
  v_pk_mul_f32 v[124:125], v[124:125], v[252:253] op_sel:[0,1] op_sel_hi:[1,1]
  v_pk_mul_f32 v[126:127], v[126:127], v[252:253] op_sel:[0,1] op_sel_hi:[1,1]
  v_cvt_pk_bf16_f32 v100, v120, v121
  v_cvt_pk_bf16_f32 v101, v122, v123
  v_cvt_pk_bf16_f32 v102, v124, v125
  v_cvt_pk_bf16_f32 v103, v126, v127
  buffer_store_dwordx4 v[100:103], v12, s[68:71], s82 offen offset:2048 sc1
  v_accvgpr_read_b32 v112, a240
  v_accvgpr_read_b32 v113, a241
  v_accvgpr_read_b32 v114, a242
  v_accvgpr_read_b32 v115, a243
  v_accvgpr_read_b32 v116, a244
  v_accvgpr_read_b32 v117, a245
  v_accvgpr_read_b32 v118, a246
  v_accvgpr_read_b32 v119, a247
  v_pk_mul_f32 v[112:113], v[112:113], v[252:253] op_sel:[0,0] op_sel_hi:[1,0]
  v_pk_mul_f32 v[114:115], v[114:115], v[252:253] op_sel:[0,0] op_sel_hi:[1,0]
  v_pk_mul_f32 v[116:117], v[116:117], v[252:253] op_sel:[0,0] op_sel_hi:[1,0]
  v_pk_mul_f32 v[118:119], v[118:119], v[252:253] op_sel:[0,0] op_sel_hi:[1,0]
  v_cvt_pk_bf16_f32 v104, v112, v113
  v_cvt_pk_bf16_f32 v105, v114, v115
  v_cvt_pk_bf16_f32 v106, v116, v117
  v_cvt_pk_bf16_f32 v107, v118, v119
  buffer_store_dwordx4 v[104:107], v12, s[68:71], s80 offen offset:3072 sc1
  v_accvgpr_read_b32 v120, a248
  v_accvgpr_read_b32 v121, a249
  v_accvgpr_read_b32 v122, a250
  v_accvgpr_read_b32 v123, a251
  v_accvgpr_read_b32 v124, a252
  v_accvgpr_read_b32 v125, a253
  v_accvgpr_read_b32 v126, a254
  v_accvgpr_read_b32 v127, a255
  v_pk_mul_f32 v[120:121], v[120:121], v[252:253] op_sel:[0,1] op_sel_hi:[1,1]
  v_pk_mul_f32 v[122:123], v[122:123], v[252:253] op_sel:[0,1] op_sel_hi:[1,1]
  v_pk_mul_f32 v[124:125], v[124:125], v[252:253] op_sel:[0,1] op_sel_hi:[1,1]
  v_pk_mul_f32 v[126:127], v[126:127], v[252:253] op_sel:[0,1] op_sel_hi:[1,1]
  v_cvt_pk_bf16_f32 v108, v120, v121
  v_cvt_pk_bf16_f32 v109, v122, v123
  v_cvt_pk_bf16_f32 v110, v124, v125
  v_cvt_pk_bf16_f32 v111, v126, v127
  buffer_store_dwordx4 v[108:111], v12, s[68:71], s82 offen offset:3072 sc1
.p2align 6
L_sl:
  v_mfma_f32_16x16x32_bf16 v[32:35], a[0:3], v[160:163], v[32:35]
  s_xor_b32 s49, s49, 0x10000
  v_exp_f32 v2, v128
  v_mfma_f32_16x16x32_bf16 v[32:35], a[4:7], v[168:171], v[32:35]
  ds_read_b128 a[48:51], v248 offset:22528
  v_xor_b32 v249, 0x10000, v249
  v_mfma_f32_16x16x32_bf16 v[40:43], a[0:3], v[164:167], v[40:43]
  s_add_u32 s48, s39, 16384
  v_exp_f32 v3, v129
  v_mfma_f32_16x16x32_bf16 v[40:43], a[4:7], v[172:175], v[40:43]
  ds_read_b128 a[52:55], v248 offset:30720
  ds_read_b128 a[56:59], v248 offset:23552
  v_mfma_f32_16x16x32_bf16 v[36:39], a[8:11], v[160:163], v[36:39]
  s_add_u32 s39, s39, 32768
  v_exp_f32 v4, v130
  v_mfma_f32_16x16x32_bf16 v[36:39], a[12:15], v[168:171], v[36:39]
  s_waitcnt vmcnt(8)
  s_barrier
  v_mfma_f32_16x16x32_bf16 v[44:47], a[8:11], v[164:167], v[44:47]
  ds_read_b128 a[60:63], v248 offset:31744
  v_cvt_pk_bf16_f32 v176, v2, v3
  v_mfma_f32_16x16x32_bf16 v[44:47], a[12:15], v[172:175], v[44:47]
  s_waitcnt lgkmcnt(8)
  v_exp_f32 v5, v131
  v_mfma_f32_16x16x32_bf16 v[48:51], a[16:19], v[160:163], v[48:51]
  v_exp_f32 v6, v132
  v_mfma_f32_16x16x32_bf16 v[48:51], a[20:23], v[168:171], v[48:51]
  ds_read_b128 a[0:3], v249 offset:0
  v_cvt_pk_bf16_f32 v177, v4, v5
  v_mfma_f32_16x16x32_bf16 v[56:59], a[16:19], v[164:167], v[56:59]
  v_exp_f32 v7, v133
  v_mfma_f32_16x16x32_bf16 v[56:59], a[20:23], v[172:175], v[56:59]
  ds_read_b128 a[4:7], v249 offset:1024
  v_cvt_pk_bf16_f32 v178, v6, v7
  v_mfma_f32_16x16x32_bf16 v[52:55], a[24:27], v[160:163], v[52:55]
  s_xor_b32 m0, s49, 0
  v_exp_f32 v8, v134
  v_mfma_f32_16x16x32_bf16 v[52:55], a[28:31], v[168:171], v[52:55]
  buffer_load_dwordx4 v12, s[68:71], s39 offen offset:0 sc1 lds
  v_mfma_f32_16x16x32_bf16 v[60:63], a[24:27], v[164:167], v[60:63]
  s_waitcnt lgkmcnt(6)
  v_exp_f32 v9, v135
  v_mfma_f32_16x16x32_bf16 v[60:63], a[28:31], v[172:175], v[60:63]
  ds_read_b128 a[8:11], v249 offset:2048
  v_cvt_pk_bf16_f32 v179, v8, v9
  v_mfma_f32_16x16x32_bf16 v[64:67], a[32:35], v[160:163], v[64:67]
  v_exp_f32 v2, v136
  v_mfma_f32_16x16x32_bf16 v[64:67], a[36:39], v[168:171], v[64:67]
  ds_read_b128 a[12:15], v249 offset:3072
  ds_read_b128 a[16:19], v249 offset:4096
  v_mfma_f32_16x16x32_bf16 v[72:75], a[32:35], v[164:167], v[72:75]
  v_exp_f32 v3, v137
  v_mfma_f32_16x16x32_bf16 v[72:75], a[36:39], v[172:175], v[72:75]
  v_exp_f32 v4, v138
  v_mfma_f32_16x16x32_bf16 v[244:247], a[68:71], v[176:179], v[240:243]
  ds_read_b128 a[20:23], v249 offset:5120
  v_cvt_pk_bf16_f32 v180, v2, v3
  v_mfma_f32_16x16x32_bf16 v[68:71], a[40:43], v[160:163], v[68:71]
L_hop13:
  s_cbranch_execz L_last
  v_exp_f32 v5, v139
  v_mfma_f32_16x16x32_bf16 v[68:71], a[44:47], v[168:171], v[68:71]
  buffer_load_dwordx4 v12, s[68:71], s39 offen offset:1024 sc1 lds
  v_mfma_f32_16x16x32_bf16 v[76:79], a[40:43], v[164:167], v[76:79]
  s_waitcnt lgkmcnt(6)
  v_exp_f32 v6, v140
  v_mfma_f32_16x16x32_bf16 v[76:79], a[44:47], v[172:175], v[76:79]
  ds_read_b128 a[24:27], v249 offset:6144
  ds_read_b128 a[28:31], v249 offset:7168
  v_mfma_f32_16x16x32_bf16 v[80:83], a[48:51], v[160:163], v[80:83]
  v_exp_f32 v7, v141
  v_mfma_f32_16x16x32_bf16 v[80:83], a[52:55], v[168:171], v[80:83]
  v_cvt_pk_bf16_f32 v181, v4, v5
  v_cvt_pk_bf16_f32 v182, v6, v7
  v_mfma_f32_16x16x32_bf16 v[88:91], a[48:51], v[164:167], v[88:91]
  v_exp_f32 v8, v142
  v_mfma_f32_16x16x32_bf16 v[88:91], a[52:55], v[172:175], v[88:91]
  ds_read_b128 a[32:35], v249 offset:8192
  ds_read_b128 a[36:39], v249 offset:9216
  v_mfma_f32_16x16x32_bf16 v[84:87], a[56:59], v[160:163], v[84:87]
  v_exp_f32 v9, v143
  v_mfma_f32_16x16x32_bf16 v[84:87], a[60:63], v[168:171], v[84:87]
  v_exp_f32 v2, v144
  v_mfma_f32_16x16x32_bf16 v[92:95], a[56:59], v[164:167], v[92:95]
  ds_read_b128 a[40:43], v249 offset:10240
  v_cvt_pk_bf16_f32 v183, v8, v9
  v_mfma_f32_16x16x32_bf16 v[92:95], a[60:63], v[172:175], v[92:95]
  s_waitcnt lgkmcnt(7)
  v_exp_f32 v3, v145
  v_mfma_f32_16x16x32_bf16 v[192:195], a[0:3], a[160:163], v[224:227]
  buffer_load_dwordx4 v12, s[68:71], s39 offen offset:2048 sc1 lds
  v_mfma_f32_16x16x32_bf16 v[192:195], a[4:7], a[164:167], v[192:195]
  v_exp_f32 v4, v146
  v_mfma_f32_16x16x32_bf16 v[192:195], a[8:11], a[168:171], v[192:195]
  ds_read_b128 a[44:47], v249 offset:11264
  v_cvt_pk_bf16_f32 v184, v2, v3
  v_mfma_f32_16x16x32_bf16 v[192:195], a[12:15], a[172:175], v[192:195]
  v_exp_f32 v5, v147
  v_mfma_f32_16x16x32_bf16 v[244:247], a[72:75], v[180:183], v[244:247]
  ds_read_b128 a[48:51], v249 offset:12288
  v_cvt_pk_bf16_f32 v185, v4, v5
  v_mfma_f32_16x16x32_bf16 v[200:203], a[0:3], a[176:179], v[228:231]
  v_exp_f32 v6, v148
  v_mfma_f32_16x16x32_bf16 v[200:203], a[4:7], a[180:183], v[200:203]
  ds_read_b128 a[52:55], v249 offset:13312
  ds_read_b128 a[56:59], v249 offset:14336
  v_mfma_f32_16x16x32_bf16 v[200:203], a[8:11], a[184:187], v[200:203]
  v_exp_f32 v7, v149
  v_mfma_f32_16x16x32_bf16 v[200:203], a[12:15], a[188:191], v[200:203]
  s_waitcnt lgkmcnt(7)
  v_exp_f32 v8, v150
  v_mfma_f32_16x16x32_bf16 v[196:199], a[16:19], a[160:163], v[224:227]
  buffer_load_dwordx4 v12, s[68:71], s39 offen offset:3072 sc1 lds
  v_mfma_f32_16x16x32_bf16 v[196:199], a[20:23], a[164:167], v[196:199]
  v_exp_f32 v9, v151
  v_mfma_f32_16x16x32_bf16 v[196:199], a[24:27], a[168:171], v[196:199]
  v_cvt_pk_bf16_f32 v186, v6, v7
  v_cvt_pk_bf16_f32 v187, v8, v9
  v_mfma_f32_16x16x32_bf16 v[196:199], a[28:31], a[172:175], v[196:199]
  v_exp_f32 v2, v152
  v_mfma_f32_16x16x32_bf16 v[204:207], a[16:19], a[176:179], v[228:231]
  ds_read_b128 a[60:63], v249 offset:15360
  ds_read_b128 a[0:3], v248 offset:49152
  v_mfma_f32_16x16x32_bf16 v[204:207], a[20:23], a[180:183], v[204:207]
  v_exp_f32 v3, v153
  v_mfma_f32_16x16x32_bf16 v[204:207], a[24:27], a[184:187], v[204:207]
  ds_read_b128 a[4:7], v248 offset:57344
  ds_read_b128 a[8:11], v248 offset:50176
  v_mfma_f32_16x16x32_bf16 v[204:207], a[28:31], a[188:191], v[204:207]
  s_waitcnt lgkmcnt(7)
  v_exp_f32 v4, v154
  v_mfma_f32_16x16x32_bf16 v[244:247], a[68:71], v[184:187], v[244:247]
  ds_read_b128 a[12:15], v248 offset:58368
  v_cvt_pk_bf16_f32 v188, v2, v3
  v_mfma_f32_16x16x32_bf16 v[208:211], a[32:35], a[160:163], v[224:227]
  v_exp_f32 v5, v155
  v_mfma_f32_16x16x32_bf16 v[208:211], a[36:39], a[164:167], v[208:211]
  s_xor_b32 m0, s49, 114688
  v_exp_f32 v6, v156
  v_mfma_f32_16x16x32_bf16 v[208:211], a[40:43], a[168:171], v[208:211]
  buffer_load_dwordx4 v12, s[68:71], s48 offen offset:0 sc1 lds
  v_mfma_f32_16x16x32_bf16 v[208:211], a[44:47], a[172:175], v[208:211]
  v_exp_f32 v7, v157
  v_mfma_f32_16x16x32_bf16 v[216:219], a[32:35], a[176:179], v[228:231]
  v_cvt_pk_bf16_f32 v189, v4, v5
  v_cvt_pk_bf16_f32 v190, v6, v7
  v_mfma_f32_16x16x32_bf16 v[216:219], a[36:39], a[180:183], v[216:219]
  v_exp_f32 v8, v158
  v_mfma_f32_16x16x32_bf16 v[216:219], a[40:43], a[184:187], v[216:219]
  ds_read_b128 a[16:19], v248 offset:51200
  ds_read_b128 a[20:23], v248 offset:59392
  v_mfma_f32_16x16x32_bf16 v[216:219], a[44:47], a[188:191], v[216:219]
  s_waitcnt lgkmcnt(6)
  v_exp_f32 v9, v159
  v_mfma_f32_16x16x32_bf16 v[212:215], a[48:51], a[160:163], v[224:227]
  ds_read_b128 a[24:27], v248 offset:52224
  v_cvt_pk_bf16_f32 v191, v8, v9
  v_mfma_f32_16x16x32_bf16 v[212:215], a[52:55], a[164:167], v[212:215]
  buffer_load_dwordx4 v12, s[68:71], s48 offen offset:1024 sc1 lds
  v_mfma_f32_16x16x32_bf16 v[244:247], a[72:75], v[188:191], v[244:247]
  ds_read_b128 a[28:31], v248 offset:60416
  ds_read_b128 a[32:35], v248 offset:53248
  v_mfma_f32_16x16x32_bf16 v[212:215], a[56:59], a[168:171], v[212:215]
  buffer_load_dwordx4 v12, s[68:71], s48 offen offset:2048 sc1 lds
  v_mfma_f32_16x16x32_bf16 v[212:215], a[60:63], a[172:175], v[212:215]
  ds_read_b128 a[36:39], v248 offset:61440
  ds_read_b128 a[40:43], v248 offset:54272
  v_mfma_f32_16x16x32_bf16 v[220:223], a[48:51], a[176:179], v[228:231]
  buffer_load_dwordx4 v12, s[68:71], s48 offen offset:3072 sc1 lds
  v_mfma_f32_16x16x32_bf16 v[220:223], a[52:55], a[180:183], v[220:223]
  s_waitcnt lgkmcnt(7)
  v_max_f32 v250, v244, v245
  v_cmp_nge_f32 vcc, s44, v250
  v_mfma_f32_16x16x32_bf16 v[220:223], a[56:59], a[184:187], v[220:223]
  ds_read_b128 a[44:47], v248 offset:62464
  v_mfma_f32_16x16x32_bf16 v[220:223], a[60:63], a[188:191], v[220:223]
  s_cbranch_vccnz L_sl1_rare
L_sl1_back:
  v_mfma_f32_16x16x32_bf16 v[32:35], a[0:3], v[176:179], v[32:35]
  v_exp_f32 v2, v192
  v_mfma_f32_16x16x32_bf16 v[32:35], a[4:7], v[184:187], v[32:35]
  ds_read_b128 a[48:51], v248 offset:55296
  ds_read_b128 a[52:55], v248 offset:63488
  v_mfma_f32_16x16x32_bf16 v[40:43], a[0:3], v[180:183], v[40:43]
  s_add_u32 s48, s39, 16384
  v_exp_f32 v3, v193
  v_mfma_f32_16x16x32_bf16 v[40:43], a[4:7], v[188:191], v[40:43]
  ds_read_b128 a[56:59], v248 offset:56320
  v_cvt_pk_bf16_f32 v160, v2, v3
  v_mfma_f32_16x16x32_bf16 v[36:39], a[8:11], v[176:179], v[36:39]
  s_add_u32 s39, s39, 32768
  v_exp_f32 v4, v194
  v_mfma_f32_16x16x32_bf16 v[36:39], a[12:15], v[184:187], v[36:39]
  s_waitcnt vmcnt(8)
  s_barrier
  v_mfma_f32_16x16x32_bf16 v[44:47], a[8:11], v[180:183], v[44:47]
  ds_read_b128 a[60:63], v248 offset:64512
  v_mfma_f32_16x16x32_bf16 v[44:47], a[12:15], v[188:191], v[44:47]
  s_waitcnt lgkmcnt(8)
  v_exp_f32 v5, v195
  v_mfma_f32_16x16x32_bf16 v[48:51], a[16:19], v[176:179], v[48:51]
  v_exp_f32 v6, v196
  v_mfma_f32_16x16x32_bf16 v[48:51], a[20:23], v[184:187], v[48:51]
  ds_read_b128 a[0:3], v249 offset:32768
  v_cvt_pk_bf16_f32 v161, v4, v5
  v_mfma_f32_16x16x32_bf16 v[56:59], a[16:19], v[180:183], v[56:59]
  v_exp_f32 v7, v197
  v_mfma_f32_16x16x32_bf16 v[56:59], a[20:23], v[188:191], v[56:59]
  ds_read_b128 a[4:7], v249 offset:33792
  v_cvt_pk_bf16_f32 v162, v6, v7
  v_mfma_f32_16x16x32_bf16 v[52:55], a[24:27], v[176:179], v[52:55]
  s_xor_b32 m0, s49, 32768
  v_exp_f32 v8, v198
  v_mfma_f32_16x16x32_bf16 v[52:55], a[28:31], v[184:187], v[52:55]
  buffer_load_dwordx4 v12, s[68:71], s39 offen offset:0 sc1 lds
  v_mfma_f32_16x16x32_bf16 v[60:63], a[24:27], v[180:183], v[60:63]
  s_waitcnt lgkmcnt(6)
  v_exp_f32 v9, v199
  v_mfma_f32_16x16x32_bf16 v[60:63], a[28:31], v[188:191], v[60:63]
  ds_read_b128 a[8:11], v249 offset:34816
  v_cvt_pk_bf16_f32 v163, v8, v9
  v_mfma_f32_16x16x32_bf16 v[64:67], a[32:35], v[176:179], v[64:67]
  v_exp_f32 v2, v200
  v_mfma_f32_16x16x32_bf16 v[64:67], a[36:39], v[184:187], v[64:67]
  ds_read_b128 a[12:15], v249 offset:35840
  ds_read_b128 a[16:19], v249 offset:36864
  v_mfma_f32_16x16x32_bf16 v[72:75], a[32:35], v[180:183], v[72:75]
  v_exp_f32 v3, v201
  v_mfma_f32_16x16x32_bf16 v[72:75], a[36:39], v[188:191], v[72:75]
  v_exp_f32 v4, v202
  v_mfma_f32_16x16x32_bf16 v[240:243], a[68:71], v[160:163], v[244:247]
  ds_read_b128 a[20:23], v249 offset:37888
  v_cvt_pk_bf16_f32 v164, v2, v3
  v_mfma_f32_16x16x32_bf16 v[68:71], a[40:43], v[176:179], v[68:71]
  v_exp_f32 v5, v203
  v_mfma_f32_16x16x32_bf16 v[68:71], a[44:47], v[184:187], v[68:71]
  buffer_load_dwordx4 v12, s[68:71], s39 offen offset:1024 sc1 lds
  v_mfma_f32_16x16x32_bf16 v[76:79], a[40:43], v[180:183], v[76:79]
  s_waitcnt lgkmcnt(6)
  v_exp_f32 v6, v204
  v_mfma_f32_16x16x32_bf16 v[76:79], a[44:47], v[188:191], v[76:79]
  ds_read_b128 a[24:27], v249 offset:38912
  ds_read_b128 a[28:31], v249 offset:39936
  v_mfma_f32_16x16x32_bf16 v[80:83], a[48:51], v[176:179], v[80:83]
  v_exp_f32 v7, v205
  v_mfma_f32_16x16x32_bf16 v[80:83], a[52:55], v[184:187], v[80:83]
  v_cvt_pk_bf16_f32 v165, v4, v5
  v_cvt_pk_bf16_f32 v166, v6, v7
  v_mfma_f32_16x16x32_bf16 v[88:91], a[48:51], v[180:183], v[88:91]
  v_exp_f32 v8, v206
  v_mfma_f32_16x16x32_bf16 v[88:91], a[52:55], v[188:191], v[88:91]
  ds_read_b128 a[32:35], v249 offset:40960
  ds_read_b128 a[36:39], v249 offset:41984
  v_mfma_f32_16x16x32_bf16 v[84:87], a[56:59], v[176:179], v[84:87]
  v_exp_f32 v9, v207
  v_mfma_f32_16x16x32_bf16 v[84:87], a[60:63], v[184:187], v[84:87]
  v_exp_f32 v2, v208
  v_mfma_f32_16x16x32_bf16 v[92:95], a[56:59], v[180:183], v[92:95]
  ds_read_b128 a[40:43], v249 offset:43008
  v_cvt_pk_bf16_f32 v167, v8, v9
  v_mfma_f32_16x16x32_bf16 v[92:95], a[60:63], v[188:191], v[92:95]
  s_waitcnt lgkmcnt(7)
  v_exp_f32 v3, v209
  v_mfma_f32_16x16x32_bf16 v[128:131], a[0:3], a[160:163], v[224:227]
  buffer_load_dwordx4 v12, s[68:71], s39 offen offset:2048 sc1 lds
  v_mfma_f32_16x16x32_bf16 v[128:131], a[4:7], a[164:167], v[128:131]
  v_exp_f32 v4, v210
  v_mfma_f32_16x16x32_bf16 v[128:131], a[8:11], a[168:171], v[128:131]
  ds_read_b128 a[44:47], v249 offset:44032
  v_cvt_pk_bf16_f32 v168, v2, v3
  v_mfma_f32_16x16x32_bf16 v[128:131], a[12:15], a[172:175], v[128:131]
  v_exp_f32 v5, v211
  v_mfma_f32_16x16x32_bf16 v[240:243], a[72:75], v[164:167], v[240:243]
  ds_read_b128 a[48:51], v249 offset:45056
  v_cvt_pk_bf16_f32 v169, v4, v5
  v_mfma_f32_16x16x32_bf16 v[136:139], a[0:3], a[176:179], v[228:231]
  v_exp_f32 v6, v212
  v_mfma_f32_16x16x32_bf16 v[136:139], a[4:7], a[180:183], v[136:139]
  ds_read_b128 a[52:55], v249 offset:46080
  ds_read_b128 a[56:59], v249 offset:47104
  v_mfma_f32_16x16x32_bf16 v[136:139], a[8:11], a[184:187], v[136:139]
  v_exp_f32 v7, v213
  v_mfma_f32_16x16x32_bf16 v[136:139], a[12:15], a[188:191], v[136:139]
  s_waitcnt lgkmcnt(7)
  v_exp_f32 v8, v214
  v_mfma_f32_16x16x32_bf16 v[132:135], a[16:19], a[160:163], v[224:227]
  buffer_load_dwordx4 v12, s[68:71], s39 offen offset:3072 sc1 lds
  v_mfma_f32_16x16x32_bf16 v[132:135], a[20:23], a[164:167], v[132:135]
  v_exp_f32 v9, v215
  v_mfma_f32_16x16x32_bf16 v[132:135], a[24:27], a[168:171], v[132:135]
  v_cvt_pk_bf16_f32 v170, v6, v7
  v_cvt_pk_bf16_f32 v171, v8, v9
  v_mfma_f32_16x16x32_bf16 v[132:135], a[28:31], a[172:175], v[132:135]
  v_exp_f32 v2, v216
  v_mfma_f32_16x16x32_bf16 v[140:143], a[16:19], a[176:179], v[228:231]
  ds_read_b128 a[60:63], v249 offset:48128
  ds_read_b128 a[0:3], v249 offset:16384
  v_mfma_f32_16x16x32_bf16 v[140:143], a[20:23], a[180:183], v[140:143]
  v_exp_f32 v3, v217
  v_mfma_f32_16x16x32_bf16 v[140:143], a[24:27], a[184:187], v[140:143]
  ds_read_b128 a[4:7], v249 offset:24576
  ds_read_b128 a[8:11], v249 offset:17408
  v_mfma_f32_16x16x32_bf16 v[140:143], a[28:31], a[188:191], v[140:143]
  s_waitcnt lgkmcnt(7)
  v_exp_f32 v4, v218
  v_mfma_f32_16x16x32_bf16 v[240:243], a[68:71], v[168:171], v[240:243]
  ds_read_b128 a[12:15], v249 offset:25600
  v_cvt_pk_bf16_f32 v172, v2, v3
  v_mfma_f32_16x16x32_bf16 v[144:147], a[32:35], a[160:163], v[224:227]
  v_exp_f32 v5, v219
  v_mfma_f32_16x16x32_bf16 v[144:147], a[36:39], a[164:167], v[144:147]
  s_xor_b32 m0, s49, 16384
  v_exp_f32 v6, v220
  v_mfma_f32_16x16x32_bf16 v[144:147], a[40:43], a[168:171], v[144:147]
  buffer_load_dwordx4 v12, s[68:71], s48 offen offset:0 sc1 lds
  v_mfma_f32_16x16x32_bf16 v[144:147], a[44:47], a[172:175], v[144:147]
  v_exp_f32 v7, v221
  v_mfma_f32_16x16x32_bf16 v[152:155], a[32:35], a[176:179], v[228:231]
  v_cvt_pk_bf16_f32 v173, v4, v5
  v_cvt_pk_bf16_f32 v174, v6, v7
  v_mfma_f32_16x16x32_bf16 v[152:155], a[36:39], a[180:183], v[152:155]
  v_exp_f32 v8, v222
  v_mfma_f32_16x16x32_bf16 v[152:155], a[40:43], a[184:187], v[152:155]
  ds_read_b128 a[16:19], v249 offset:18432
  v_xor_b32 v248, 0x10000, v248
  v_mfma_f32_16x16x32_bf16 v[152:155], a[44:47], a[188:191], v[152:155]
  s_waitcnt lgkmcnt(5)
  v_exp_f32 v9, v223
  v_mfma_f32_16x16x32_bf16 v[148:151], a[48:51], a[160:163], v[224:227]
  ds_read_b128 a[20:23], v249 offset:26624
  v_cvt_pk_bf16_f32 v175, v8, v9
  v_mfma_f32_16x16x32_bf16 v[148:151], a[52:55], a[164:167], v[148:151]
  buffer_load_dwordx4 v12, s[68:71], s48 offen offset:1024 sc1 lds
  v_mfma_f32_16x16x32_bf16 v[240:243], a[72:75], v[172:175], v[240:243]
  ds_read_b128 a[24:27], v249 offset:19456
  ds_read_b128 a[28:31], v249 offset:27648
  v_mfma_f32_16x16x32_bf16 v[148:151], a[56:59], a[168:171], v[148:151]
  buffer_load_dwordx4 v12, s[68:71], s48 offen offset:2048 sc1 lds
  v_mfma_f32_16x16x32_bf16 v[148:151], a[60:63], a[172:175], v[148:151]
  ds_read_b128 a[32:35], v249 offset:20480
  ds_read_b128 a[36:39], v249 offset:28672
  v_mfma_f32_16x16x32_bf16 v[156:159], a[48:51], a[176:179], v[228:231]
  buffer_load_dwordx4 v12, s[68:71], s48 offen offset:3072 sc1 lds
  v_mfma_f32_16x16x32_bf16 v[156:159], a[52:55], a[180:183], v[156:159]
  s_waitcnt lgkmcnt(6)
  v_max_f32 v250, v240, v241
  v_cmp_nge_f32 vcc, s44, v250
  v_mfma_f32_16x16x32_bf16 v[156:159], a[56:59], a[184:187], v[156:159]
  ds_read_b128 a[40:43], v249 offset:21504
  ds_read_b128 a[44:47], v249 offset:29696
  v_mfma_f32_16x16x32_bf16 v[156:159], a[60:63], a[188:191], v[156:159]
  s_cbranch_vccnz L_sl2_rare
L_sl2_back:
  s_sub_u32 s45, s45, 1
  s_cbranch_scc0 L_sl
L_sm:
  s_cbranch_execz L_main
  buffer_load_dword v13, v27, s[68:71], s89 offen sc1
  v_mfma_f32_16x16x32_bf16 v[32:35], a[0:3], v[160:163], v[32:35]
  v_exp_f32 v2, v128
  v_xor_b32 v249, 0x10000, v249
  v_mfma_f32_16x16x32_bf16 v[32:35], a[4:7], v[168:171], v[32:35]
  ds_read_b128 a[48:51], v248 offset:22528
  ds_read_b128 a[52:55], v248 offset:30720
  v_cndmask_b32 v192, v11, v224, s[0:1]
  v_mfma_f32_16x16x32_bf16 v[40:43], a[0:3], v[164:167], v[40:43]
  s_xor_b32 s49, s49, 0x10000
  v_exp_f32 v3, v129
  v_cndmask_b32 v193, v11, v224, s[2:3]
  v_mfma_f32_16x16x32_bf16 v[40:43], a[4:7], v[172:175], v[40:43]
  ds_read_b128 a[56:59], v248 offset:23552
  v_cvt_pk_bf16_f32 v176, v2, v3
  v_cndmask_b32 v194, v11, v224, s[4:5]
  v_mfma_f32_16x16x32_bf16 v[36:39], a[8:11], v[160:163], v[36:39]
  s_add_u32 s48, s39, 16384
  v_exp_f32 v4, v130
  v_cndmask_b32 v195, v11, v224, s[6:7]
  v_mfma_f32_16x16x32_bf16 v[36:39], a[12:15], v[168:171], v[36:39]
  s_waitcnt vmcnt(9)
  s_barrier
  v_mfma_f32_16x16x32_bf16 v[44:47], a[8:11], v[164:167], v[44:47]
  ds_read_b128 a[60:63], v248 offset:31744
  v_cndmask_b32 v196, v11, v224, s[8:9]
  v_cndmask_b32 v197, v11, v224, s[10:11]
  v_mfma_f32_16x16x32_bf16 v[44:47], a[12:15], v[172:175], v[44:47]
  s_waitcnt lgkmcnt(8)
  ds_read_b128 a[0:3], v249 offset:0
  v_exp_f32 v5, v131
  v_mfma_f32_16x16x32_bf16 v[48:51], a[16:19], v[160:163], v[48:51]
  v_exp_f32 v6, v132
  v_cvt_pk_bf16_f32 v177, v4, v5
  v_mfma_f32_16x16x32_bf16 v[48:51], a[20:23], v[168:171], v[48:51]
  ds_read_b128 a[4:7], v249 offset:1024
  v_cndmask_b32 v198, v11, v224, s[12:13]
  v_cndmask_b32 v199, v11, v224, s[14:15]
  v_mfma_f32_16x16x32_bf16 v[56:59], a[16:19], v[164:167], v[56:59]
  v_exp_f32 v7, v133
  v_cndmask_b32 v208, v11, v224, s[16:17]
  v_mfma_f32_16x16x32_bf16 v[56:59], a[20:23], v[172:175], v[56:59]
  ds_read_b128 a[8:11], v249 offset:2048
  v_cvt_pk_bf16_f32 v178, v6, v7
  v_cndmask_b32 v209, v11, v224, s[18:19]
  v_mfma_f32_16x16x32_bf16 v[52:55], a[24:27], v[160:163], v[52:55]
  s_xor_b32 m0, s49, 114688
  v_exp_f32 v8, v134
  v_cndmask_b32 v210, v11, v224, s[20:21]
  v_mfma_f32_16x16x32_bf16 v[52:55], a[28:31], v[168:171], v[52:55]
  buffer_load_dwordx4 v12, s[68:71], s48 offen offset:0 sc1 lds
  v_cndmask_b32 v211, v11, v224, s[22:23]
  v_mfma_f32_16x16x32_bf16 v[60:63], a[24:27], v[164:167], v[60:63]
  s_waitcnt lgkmcnt(7)
  ds_read_b128 a[12:15], v249 offset:3072
  v_exp_f32 v9, v135
  v_mfma_f32_16x16x32_bf16 v[60:63], a[28:31], v[172:175], v[60:63]
  ds_read_b128 a[16:19], v249 offset:4096
  v_cvt_pk_bf16_f32 v179, v8, v9
  v_cndmask_b32 v212, v11, v224, s[24:25]
  v_mfma_f32_16x16x32_bf16 v[64:67], a[32:35], v[160:163], v[64:67]
  v_exp_f32 v2, v136
  v_cndmask_b32 v213, v11, v224, s[26:27]
  v_mfma_f32_16x16x32_bf16 v[64:67], a[36:39], v[168:171], v[64:67]
  buffer_load_dwordx4 v12, s[68:71], s48 offen offset:1024 sc1 lds
  v_cndmask_b32 v214, v11, v224, s[28:29]
  v_mfma_f32_16x16x32_bf16 v[72:75], a[32:35], v[164:167], v[72:75]
  ds_read_b128 a[20:23], v249 offset:5120
  v_exp_f32 v3, v137
  v_mfma_f32_16x16x32_bf16 v[72:75], a[36:39], v[172:175], v[72:75]
  v_exp_f32 v4, v138
  v_cvt_pk_bf16_f32 v180, v2, v3
  v_mfma_f32_16x16x32_bf16 v[244:247], a[68:71], v[176:179], v[240:243]
  buffer_load_dwordx4 v12, s[68:71], s48 offen offset:2048 sc1 lds
  v_cndmask_b32 v215, v11, v224, s[30:31]
  v_mfma_f32_16x16x32_bf16 v[68:71], a[40:43], v[160:163], v[68:71]
  ds_read_b128 a[24:27], v249 offset:6144
  v_exp_f32 v5, v139
  v_mfma_f32_16x16x32_bf16 v[68:71], a[44:47], v[168:171], v[68:71]
  ds_read_b128 a[28:31], v249 offset:7168
  v_cvt_pk_bf16_f32 v181, v4, v5
  v_mfma_f32_16x16x32_bf16 v[76:79], a[40:43], v[164:167], v[76:79]
  s_waitcnt lgkmcnt(8)
  ds_read_b128 a[32:35], v249 offset:8192
  v_exp_f32 v6, v140
  v_mfma_f32_16x16x32_bf16 v[76:79], a[44:47], v[172:175], v[76:79]
  buffer_load_dwordx4 v12, s[68:71], s48 offen offset:3072 sc1 lds
  v_mfma_f32_16x16x32_bf16 v[80:83], a[48:51], v[160:163], v[80:83]
  ds_read_b128 a[36:39], v249 offset:9216
  v_exp_f32 v7, v141
  v_mfma_f32_16x16x32_bf16 v[80:83], a[52:55], v[168:171], v[80:83]
  v_cvt_pk_bf16_f32 v182, v6, v7
  v_mfma_f32_16x16x32_bf16 v[88:91], a[48:51], v[164:167], v[88:91]
  ds_read_b128 a[40:43], v249 offset:10240
  v_exp_f32 v8, v142
  v_mfma_f32_16x16x32_bf16 v[88:91], a[52:55], v[172:175], v[88:91]
  v_mfma_f32_16x16x32_bf16 v[84:87], a[56:59], v[160:163], v[84:87]
  ds_read_b128 a[44:47], v249 offset:11264
  v_exp_f32 v9, v143
  v_mfma_f32_16x16x32_bf16 v[84:87], a[60:63], v[168:171], v[84:87]
  v_exp_f32 v2, v144
  v_cvt_pk_bf16_f32 v183, v8, v9
  v_mfma_f32_16x16x32_bf16 v[92:95], a[56:59], v[164:167], v[92:95]
  v_mfma_f32_16x16x32_bf16 v[92:95], a[60:63], v[172:175], v[92:95]
  s_waitcnt lgkmcnt(8)
  v_exp_f32 v3, v145
  s_waitcnt vmcnt(4)
  v_cmp_eq_u32 vcc, 1, v13
  s_nop 0
  s_cmp_eq_u32 vcc_lo, -1
  s_cbranch_scc0 L_h_spin
L_h_ok:
  s_add_u32 m0, s88, 131072
  s_add_u32 s84, s87, 0
  v_mfma_f32_16x16x32_bf16 v[192:195], a[0:3], a[160:163], v[192:195]
  buffer_load_dwordx4 v16, s[60:63], s84 offen offset:0 lds
  v_mfma_f32_16x16x32_bf16 v[192:195], a[4:7], a[164:167], v[192:195]
  v_exp_f32 v4, v146
  v_cvt_pk_bf16_f32 v184, v2, v3
  v_mfma_f32_16x16x32_bf16 v[192:195], a[8:11], a[168:171], v[192:195]
  ds_read_b128 a[48:51], v249 offset:12288
  ds_read_b128 a[52:55], v249 offset:13312
  v_mfma_f32_16x16x32_bf16 v[192:195], a[12:15], a[172:175], v[192:195]
  ds_read_b128 a[56:59], v249 offset:14336
  v_exp_f32 v5, v147
  v_mfma_f32_16x16x32_bf16 v[244:247], a[72:75], v[180:183], v[244:247]
  buffer_load_dwordx4 v26, s[60:63], s84 offen offset:1024 lds
  v_mfma_f32_16x16x32_bf16 v[200:203], a[0:3], a[176:179], v[228:231]
  v_exp_f32 v6, v148
  v_cvt_pk_bf16_f32 v185, v4, v5
  v_mfma_f32_16x16x32_bf16 v[200:203], a[4:7], a[180:183], v[200:203]
  ds_read_b128 a[60:63], v249 offset:15360
  v_mfma_f32_16x16x32_bf16 v[200:203], a[8:11], a[184:187], v[200:203]
  s_waitcnt lgkmcnt(8)
  ds_read_b128 a[0:3], v248 offset:49152
  v_exp_f32 v7, v149
  v_mfma_f32_16x16x32_bf16 v[200:203], a[12:15], a[188:191], v[200:203]
  s_add_u32 s85, s86, 0
  v_exp_f32 v8, v150
  v_cvt_pk_bf16_f32 v186, v6, v7
  v_mfma_f32_16x16x32_bf16 v[196:199], a[16:19], a[160:163], v[196:199]
  buffer_load_dwordx4 v24, s[68:71], s85 offen offset:2048 sc1 lds
  v_mfma_f32_16x16x32_bf16 v[196:199], a[20:23], a[164:167], v[196:199]
  v_exp_f32 v9, v151
  v_mfma_f32_16x16x32_bf16 v[196:199], a[24:27], a[168:171], v[196:199]
  buffer_load_dwordx4 v25, s[68:71], s85 offen offset:3072 sc1 lds
  v_mfma_f32_16x16x32_bf16 v[196:199], a[28:31], a[172:175], v[196:199]
  s_add_u32 m0, s88, 147456
  v_exp_f32 v2, v152
  v_mfma_f32_16x16x32_bf16 v[204:207], a[16:19], a[176:179], v[228:231]
  ds_read_b128 a[4:7], v248 offset:57344
  v_cvt_pk_bf16_f32 v187, v8, v9
  v_mfma_f32_16x16x32_bf16 v[204:207], a[20:23], a[180:183], v[204:207]
  s_add_u32 s84, s87, 32768
  v_exp_f32 v3, v153
  v_mfma_f32_16x16x32_bf16 v[204:207], a[24:27], a[184:187], v[204:207]
  buffer_load_dwordx4 v16, s[60:63], s84 offen offset:0 lds
  v_mfma_f32_16x16x32_bf16 v[204:207], a[28:31], a[188:191], v[204:207]
  s_waitcnt lgkmcnt(6)
  v_exp_f32 v4, v154
  v_mfma_f32_16x16x32_bf16 v[244:247], a[68:71], v[184:187], v[244:247]
  ds_read_b128 a[8:11], v248 offset:50176
  ds_read_b128 a[12:15], v248 offset:58368
  v_mfma_f32_16x16x32_bf16 v[208:211], a[32:35], a[160:163], v[208:211]
  v_exp_f32 v5, v155
  v_mfma_f32_16x16x32_bf16 v[208:211], a[36:39], a[164:167], v[208:211]
  v_exp_f32 v6, v156
  v_mfma_f32_16x16x32_bf16 v[208:211], a[40:43], a[168:171], v[208:211]
  buffer_load_dwordx4 v26, s[60:63], s84 offen offset:1024 lds
  v_mfma_f32_16x16x32_bf16 v[208:211], a[44:47], a[172:175], v[208:211]
  v_exp_f32 v7, v157
  v_mfma_f32_16x16x32_bf16 v[216:219], a[32:35], a[176:179], v[228:231]
  v_cvt_pk_bf16_f32 v188, v2, v3
  v_cvt_pk_bf16_f32 v189, v4, v5
  v_mfma_f32_16x16x32_bf16 v[216:219], a[36:39], a[180:183], v[216:219]
  s_add_u32 s85, s86, 1024
  v_exp_f32 v8, v158
  v_mfma_f32_16x16x32_bf16 v[216:219], a[40:43], a[184:187], v[216:219]
  buffer_load_dwordx4 v24, s[68:71], s85 offen offset:2048 sc1 lds
  v_mfma_f32_16x16x32_bf16 v[216:219], a[44:47], a[188:191], v[216:219]
  s_waitcnt lgkmcnt(4)
  v_exp_f32 v9, v159
  v_mfma_f32_16x16x32_bf16 v[212:215], a[48:51], a[160:163], v[212:215]
  v_cvt_pk_bf16_f32 v190, v6, v7
  v_cvt_pk_bf16_f32 v191, v8, v9
  v_mfma_f32_16x16x32_bf16 v[212:215], a[52:55], a[164:167], v[212:215]
  buffer_load_dwordx4 v25, s[68:71], s85 offen offset:3072 sc1 lds
  v_mfma_f32_16x16x32_bf16 v[244:247], a[72:75], v[188:191], v[244:247]
  ds_read_b128 a[16:19], v248 offset:51200
  ds_read_b128 a[20:23], v248 offset:59392
  v_mfma_f32_16x16x32_bf16 v[212:215], a[56:59], a[168:171], v[212:215]
  ds_read_b128 a[24:27], v248 offset:52224
  ds_read_b128 a[28:31], v248 offset:60416
  v_mfma_f32_16x16x32_bf16 v[212:215], a[60:63], a[172:175], v[212:215]
  ds_read_b128 a[32:35], v248 offset:53248
  ds_read_b128 a[36:39], v248 offset:61440
  v_mfma_f32_16x16x32_bf16 v[220:223], a[48:51], a[176:179], v[228:231]
  ds_read_b128 a[40:43], v248 offset:54272
  ds_read_b128 a[44:47], v248 offset:62464
  v_mfma_f32_16x16x32_bf16 v[220:223], a[52:55], a[180:183], v[220:223]
  s_waitcnt lgkmcnt(8)
  v_max_f32 v250, v244, v245
  v_cmp_nge_f32 vcc, s44, v250
  v_mfma_f32_16x16x32_bf16 v[220:223], a[56:59], a[184:187], v[220:223]
  v_mfma_f32_16x16x32_bf16 v[220:223], a[60:63], a[188:191], v[220:223]
  s_cbranch_vccnz L_sm1_rare
L_sm1_back:
  v_mfma_f32_16x16x32_bf16 v[32:35], a[0:3], v[176:179], v[32:35]
  ds_read_b128 a[48:51], v248 offset:55296
  v_exp_f32 v2, v192
  v_mfma_f32_16x16x32_bf16 v[32:35], a[4:7], v[184:187], v[32:35]
  ds_read_b128 a[52:55], v248 offset:63488
  v_exp_f32 v3, v193
  v_mfma_f32_16x16x32_bf16 v[40:43], a[0:3], v[180:183], v[40:43]
  ds_read_b128 a[56:59], v248 offset:56320
  ds_read_b128 a[60:63], v248 offset:64512
  v_cvt_pk_bf16_f32 v160, v2, v3
  v_mfma_f32_16x16x32_bf16 v[40:43], a[4:7], v[188:191], v[40:43]
  v_exp_f32 v4, v194
  v_cndmask_b32 v136, v11, v228, s[0:1]
  v_mfma_f32_16x16x32_bf16 v[36:39], a[8:11], v[176:179], v[36:39]
  v_exp_f32 v5, v195
  v_cndmask_b32 v137, v11, v228, s[2:3]
  v_mfma_f32_16x16x32_bf16 v[36:39], a[12:15], v[184:187], v[36:39]
  s_waitcnt vmcnt(63)
  s_barrier
  v_mfma_f32_16x16x32_bf16 v[44:47], a[8:11], v[180:183], v[44:47]
  s_waitcnt lgkmcnt(8)
  v_exp_f32 v6, v196
  v_cvt_pk_bf16_f32 v161, v4, v5
  v_mfma_f32_16x16x32_bf16 v[44:47], a[12:15], v[188:191], v[44:47]
  ds_read_b128 a[0:3], v249 offset:32768
  ds_read_b128 a[4:7], v249 offset:33792
  ds_read_b128 a[8:11], v249 offset:34816
  v_mfma_f32_16x16x32_bf16 v[48:51], a[16:19], v[176:179], v[48:51]
  ds_read_b128 a[12:15], v249 offset:35840
  v_exp_f32 v7, v197
  v_mfma_f32_16x16x32_bf16 v[48:51], a[20:23], v[184:187], v[48:51]
  s_add_u32 m0, s88, 65536
  v_exp_f32 v8, v198
  v_cvt_pk_bf16_f32 v162, v6, v7
  v_mfma_f32_16x16x32_bf16 v[56:59], a[16:19], v[180:183], v[56:59]
  s_add_u32 s84, s87, 65536
  ds_read_b128 a[16:19], v249 offset:36864
  v_exp_f32 v9, v199
  v_mfma_f32_16x16x32_bf16 v[56:59], a[20:23], v[188:191], v[56:59]
  buffer_load_dwordx4 v16, s[60:63], s84 offen offset:0 lds
  v_cndmask_b32 v138, v11, v228, s[4:5]
  v_mfma_f32_16x16x32_bf16 v[52:55], a[24:27], v[176:179], v[52:55]
  v_exp_f32 v2, v200
  v_cvt_pk_bf16_f32 v163, v8, v9
  v_mfma_f32_16x16x32_bf16 v[52:55], a[28:31], v[184:187], v[52:55]
  ds_read_b128 a[20:23], v249 offset:37888
  v_exp_f32 v3, v201
  v_mfma_f32_16x16x32_bf16 v[60:63], a[24:27], v[180:183], v[60:63]
  v_exp_f32 v4, v202
  v_cvt_pk_bf16_f32 v164, v2, v3
  v_mfma_f32_16x16x32_bf16 v[60:63], a[28:31], v[188:191], v[60:63]
  buffer_load_dwordx4 v26, s[60:63], s84 offen offset:1024 lds
  v_cndmask_b32 v139, v11, v228, s[6:7]
  v_mfma_f32_16x16x32_bf16 v[240:243], a[68:71], v[160:163], v[244:247]
  s_waitcnt lgkmcnt(10)
  ds_read_b128 a[24:27], v249 offset:38912
  v_exp_f32 v5, v203
  v_mfma_f32_16x16x32_bf16 v[64:67], a[32:35], v[176:179], v[64:67]
  v_exp_f32 v6, v204
  v_cvt_pk_bf16_f32 v165, v4, v5
  v_mfma_f32_16x16x32_bf16 v[64:67], a[36:39], v[184:187], v[64:67]
  s_add_u32 s85, s86, 2048
  ds_read_b128 a[28:31], v249 offset:39936
  v_exp_f32 v7, v205
  v_mfma_f32_16x16x32_bf16 v[72:75], a[32:35], v[180:183], v[72:75]
  buffer_load_dwordx4 v24, s[68:71], s85 offen offset:2048 sc1 lds
  v_cndmask_b32 v140, v11, v228, s[8:9]
  v_mfma_f32_16x16x32_bf16 v[72:75], a[36:39], v[188:191], v[72:75]
  v_exp_f32 v8, v206
  v_cvt_pk_bf16_f32 v166, v6, v7
  v_mfma_f32_16x16x32_bf16 v[68:71], a[40:43], v[176:179], v[68:71]
  ds_read_b128 a[32:35], v249 offset:40960
  v_exp_f32 v9, v207
  v_mfma_f32_16x16x32_bf16 v[68:71], a[44:47], v[184:187], v[68:71]
  v_exp_f32 v2, v208
  v_cvt_pk_bf16_f32 v167, v8, v9
  v_mfma_f32_16x16x32_bf16 v[76:79], a[40:43], v[180:183], v[76:79]
  s_waitcnt lgkmcnt(9)
  ds_read_b128 a[36:39], v249 offset:41984
  v_exp_f32 v3, v209
  v_mfma_f32_16x16x32_bf16 v[76:79], a[44:47], v[188:191], v[76:79]
  buffer_load_dwordx4 v25, s[68:71], s85 offen offset:3072 sc1 lds
  v_cndmask_b32 v141, v11, v228, s[10:11]
  v_mfma_f32_16x16x32_bf16 v[80:83], a[48:51], v[176:179], v[80:83]
  v_exp_f32 v4, v210
  v_cvt_pk_bf16_f32 v168, v2, v3
  v_mfma_f32_16x16x32_bf16 v[80:83], a[52:55], v[184:187], v[80:83]
  s_add_u32 m0, s88, 98304
L_hop14:
  s_cbranch_execz L_sm
  ds_read_b128 a[40:43], v249 offset:43008
  v_exp_f32 v5, v211
  v_mfma_f32_16x16x32_bf16 v[88:91], a[48:51], v[180:183], v[88:91]
  s_add_u32 s84, s87, 98304
  ds_read_b128 a[44:47], v249 offset:44032
  v_exp_f32 v6, v212
  v_mfma_f32_16x16x32_bf16 v[88:91], a[52:55], v[188:191], v[88:91]
  buffer_load_dwordx4 v16, s[60:63], s84 offen offset:0 lds
  v_cndmask_b32 v142, v11, v228, s[12:13]
  v_mfma_f32_16x16x32_bf16 v[240:243], a[72:75], v[164:167], v[240:243]
  v_exp_f32 v7, v213
  v_cvt_pk_bf16_f32 v169, v4, v5
  v_mfma_f32_16x16x32_bf16 v[84:87], a[56:59], v[176:179], v[84:87]
  v_exp_f32 v8, v214
  v_cvt_pk_bf16_f32 v170, v6, v7
  v_mfma_f32_16x16x32_bf16 v[84:87], a[60:63], v[184:187], v[84:87]
  ds_read_b128 a[48:51], v249 offset:45056
  v_exp_f32 v9, v215
  v_mfma_f32_16x16x32_bf16 v[92:95], a[56:59], v[180:183], v[92:95]
  buffer_load_dwordx4 v26, s[60:63], s84 offen offset:1024 lds
  v_cndmask_b32 v143, v11, v228, s[14:15]
  v_mfma_f32_16x16x32_bf16 v[92:95], a[60:63], v[188:191], v[92:95]
  s_waitcnt lgkmcnt(9)
  v_exp_f32 v2, v216
  v_cvt_pk_bf16_f32 v171, v8, v9
  v_mfma_f32_16x16x32_bf16 v[136:139], a[0:3], a[176:179], v[136:139]
  ds_read_b128 a[52:55], v249 offset:46080
  v_exp_f32 v3, v217
  v_mfma_f32_16x16x32_bf16 v[136:139], a[4:7], a[180:183], v[136:139]
  s_add_u32 s85, s86, 3072
  ds_read_b128 a[56:59], v249 offset:47104
  v_exp_f32 v4, v218
  v_mfma_f32_16x16x32_bf16 v[136:139], a[8:11], a[184:187], v[136:139]
  buffer_load_dwordx4 v24, s[68:71], s85 offen offset:2048 sc1 lds
  v_cndmask_b32 v152, v11, v228, s[16:17]
  v_mfma_f32_16x16x32_bf16 v[136:139], a[12:15], a[188:191], v[136:139]
  ds_read_b128 a[60:63], v249 offset:48128
  v_exp_f32 v5, v219
  v_mfma_f32_16x16x32_bf16 v[240:243], a[68:71], v[168:171], v[240:243]
  s_waitcnt lgkmcnt(8)
  ds_read_b128 a[0:3], v249 offset:16384
  v_exp_f32 v6, v220
  v_mfma_f32_16x16x32_bf16 v[140:143], a[16:19], a[176:179], v[140:143]
  s_waitcnt lgkmcnt(5)
  ds_read_b128 a[4:7], v249 offset:24576
  v_exp_f32 v7, v221
  v_mfma_f32_16x16x32_bf16 v[140:143], a[20:23], a[180:183], v[140:143]
  buffer_load_dwordx4 v25, s[68:71], s85 offen offset:3072 sc1 lds
  v_cndmask_b32 v153, v11, v228, s[18:19]
  v_cndmask_b32 v154, v11, v228, s[20:21]
  v_cndmask_b32 v155, v11, v228, s[22:23]
  v_mfma_f32_16x16x32_bf16 v[140:143], a[24:27], a[184:187], v[140:143]
  s_add_u32 m0, s88, 81920
  ds_read_b128 a[8:11], v249 offset:17408
  v_exp_f32 v8, v222
  v_mfma_f32_16x16x32_bf16 v[140:143], a[28:31], a[188:191], v[140:143]
  s_add_u32 s84, s87, 131072
  ds_read_b128 a[12:15], v249 offset:25600
  v_exp_f32 v9, v223
  v_mfma_f32_16x16x32_bf16 v[152:155], a[32:35], a[176:179], v[152:155]
  buffer_load_dwordx4 v16, s[60:63], s84 offen offset:0 lds
  v_cvt_pk_bf16_f32 v172, v2, v3
  v_cvt_pk_bf16_f32 v173, v4, v5
  v_cvt_pk_bf16_f32 v174, v6, v7
  v_cvt_pk_bf16_f32 v175, v8, v9
  v_mfma_f32_16x16x32_bf16 v[152:155], a[36:39], a[180:183], v[152:155]
  buffer_load_dwordx4 v26, s[60:63], s84 offen offset:1024 lds
  s_add_u32 s85, s86, 4096
  v_mfma_f32_16x16x32_bf16 v[240:243], a[72:75], v[172:175], v[240:243]
  buffer_load_dwordx4 v24, s[68:71], s85 offen offset:2048 sc1 lds
  v_cndmask_b32 v156, v11, v228, s[24:25]
  v_cndmask_b32 v157, v11, v228, s[26:27]
  v_cndmask_b32 v158, v11, v228, s[28:29]
  v_cndmask_b32 v159, v11, v228, s[30:31]
  v_mfma_f32_16x16x32_bf16 v[152:155], a[40:43], a[184:187], v[152:155]
  buffer_load_dwordx4 v25, s[68:71], s85 offen offset:3072 sc1 lds
  v_mfma_f32_16x16x32_bf16 v[152:155], a[44:47], a[188:191], v[152:155]
  s_waitcnt lgkmcnt(4)
  ds_read_b128 a[16:19], v249 offset:18432
  ds_read_b128 a[20:23], v249 offset:26624
  v_xor_b32 v248, 0x10000, v248
  v_mfma_f32_16x16x32_bf16 v[156:159], a[48:51], a[176:179], v[156:159]
  ds_read_b128 a[24:27], v249 offset:19456
  ds_read_b128 a[28:31], v249 offset:27648
  v_mfma_f32_16x16x32_bf16 v[156:159], a[52:55], a[180:183], v[156:159]
  s_waitcnt lgkmcnt(4)
  v_max_f32 v250, v240, v241
  v_cmp_nge_f32 vcc, s44, v250
  v_mfma_f32_16x16x32_bf16 v[156:159], a[56:59], a[184:187], v[156:159]
  ds_read_b128 a[32:35], v249 offset:20480
  ds_read_b128 a[36:39], v249 offset:28672
  v_mfma_f32_16x16x32_bf16 v[156:159], a[60:63], a[188:191], v[156:159]
  s_cbranch_vccnz L_sm2_rare
L_sm2_back:
  ds_read_b128 a[40:43], v249 offset:21504
  ds_read_b128 a[44:47], v249 offset:29696
L_last:
  s_cbranch_execz L_dx
  v_mfma_f32_16x16x32_bf16 v[32:35], a[0:3], v[160:163], v[32:35]
  ds_read_b128 a[48:51], v248 offset:22528
  v_xor_b32 v249, 0x10000, v249
  v_mfma_f32_16x16x32_bf16 v[32:35], a[4:7], v[168:171], v[32:35]
  ds_read_b128 a[52:55], v248 offset:30720
  ds_read_b128 a[56:59], v248 offset:23552
  v_mfma_f32_16x16x32_bf16 v[40:43], a[0:3], v[164:167], v[40:43]
  s_lshl_b32 s80, s77, 12
  ds_read_b128 a[60:63], v248 offset:31744
  v_rcp_f32 v252, v240
  v_mfma_f32_16x16x32_bf16 v[40:43], a[4:7], v[172:175], v[40:43]
  s_add_u32 s80, s80, s36
  s_add_u32 s82, s80, 704512
  v_exp_f32 v2, v136
  v_mfma_f32_16x16x32_bf16 v[36:39], a[8:11], v[160:163], v[36:39]
  s_xor_b32 s49, s49, 0x10000
  v_exp_f32 v3, v137
  v_mfma_f32_16x16x32_bf16 v[36:39], a[12:15], v[168:171], v[36:39]
  s_waitcnt vmcnt(20)
  s_barrier
  v_mfma_f32_16x16x32_bf16 v[44:47], a[8:11], v[164:167], v[44:47]
  ds_read_b128 a[0:3], v248 offset:49152
  ds_read_b128 a[4:7], v248 offset:57344
  v_mfma_f32_16x16x32_bf16 v[44:47], a[12:15], v[172:175], v[44:47]
  s_waitcnt lgkmcnt(10)
  ds_read_b128 a[8:11], v248 offset:50176
  ds_read_b128 a[12:15], v248 offset:58368
  v_mfma_f32_16x16x32_bf16 v[48:51], a[16:19], v[160:163], v[48:51]
  s_add_u32 m0, s88, 0
  v_exp_f32 v4, v138
  v_mfma_f32_16x16x32_bf16 v[48:51], a[20:23], v[168:171], v[48:51]
  s_add_u32 s84, s87, 163840
  v_exp_f32 v5, v139
  v_cvt_pk_bf16_f32 v180, v2, v3
  v_mfma_f32_16x16x32_bf16 v[56:59], a[16:19], v[164:167], v[56:59]
  buffer_load_dwordx4 v16, s[60:63], s84 offen offset:0 lds
  v_mfma_f32_16x16x32_bf16 v[56:59], a[20:23], v[172:175], v[56:59]
  ds_read_b128 a[16:19], v248 offset:51200
  ds_read_b128 a[20:23], v248 offset:59392
  v_mfma_f32_16x16x32_bf16 v[52:55], a[24:27], v[160:163], v[52:55]
  v_exp_f32 v6, v140
  v_mfma_f32_16x16x32_bf16 v[52:55], a[28:31], v[168:171], v[52:55]
  v_exp_f32 v7, v141
  v_cvt_pk_bf16_f32 v181, v4, v5
  v_mfma_f32_16x16x32_bf16 v[60:63], a[24:27], v[164:167], v[60:63]
  buffer_load_dwordx4 v26, s[60:63], s84 offen offset:1024 lds
  v_mfma_f32_16x16x32_bf16 v[60:63], a[28:31], v[172:175], v[60:63]
  s_waitcnt lgkmcnt(10)
  ds_read_b128 a[24:27], v248 offset:52224
  ds_read_b128 a[28:31], v248 offset:60416
  v_mfma_f32_16x16x32_bf16 v[64:67], a[32:35], v[160:163], v[64:67]
  v_exp_f32 v8, v142
  v_mfma_f32_16x16x32_bf16 v[64:67], a[36:39], v[168:171], v[64:67]
  s_add_u32 s85, s86, 5120
  v_exp_f32 v9, v143
  v_cvt_pk_bf16_f32 v182, v6, v7
  v_mfma_f32_16x16x32_bf16 v[72:75], a[32:35], v[164:167], v[72:75]
  buffer_load_dwordx4 v24, s[68:71], s85 offen offset:2048 sc1 lds
  v_mfma_f32_16x16x32_bf16 v[72:75], a[36:39], v[172:175], v[72:75]
  ds_read_b128 a[32:35], v248 offset:53248
  ds_read_b128 a[36:39], v248 offset:61440
  v_mfma_f32_16x16x32_bf16 v[68:71], a[40:43], v[160:163], v[68:71]
  v_exp_f32 v2, v152
  v_mfma_f32_16x16x32_bf16 v[68:71], a[44:47], v[168:171], v[68:71]
  v_exp_f32 v3, v153
  v_cvt_pk_bf16_f32 v183, v8, v9
  v_mfma_f32_16x16x32_bf16 v[76:79], a[40:43], v[164:167], v[76:79]
  buffer_load_dwordx4 v25, s[68:71], s85 offen offset:3072 sc1 lds
  v_mfma_f32_16x16x32_bf16 v[76:79], a[44:47], v[172:175], v[76:79]
  s_waitcnt lgkmcnt(10)
  ds_read_b128 a[40:43], v248 offset:54272
  ds_read_b128 a[44:47], v248 offset:62464
  v_mfma_f32_16x16x32_bf16 v[80:83], a[48:51], v[160:163], v[80:83]
  v_exp_f32 v4, v154
  v_mfma_f32_16x16x32_bf16 v[80:83], a[52:55], v[168:171], v[80:83]
  v_exp_f32 v5, v155
  v_cvt_pk_bf16_f32 v188, v2, v3
  v_mfma_f32_16x16x32_bf16 v[88:91], a[48:51], v[164:167], v[88:91]
  v_exp_f32 v6, v156
  v_mfma_f32_16x16x32_bf16 v[88:91], a[52:55], v[172:175], v[88:91]
  v_exp_f32 v7, v157
  v_cvt_pk_bf16_f32 v189, v4, v5
  v_mfma_f32_16x16x32_bf16 v[84:87], a[56:59], v[160:163], v[84:87]
  v_exp_f32 v8, v158
  v_mfma_f32_16x16x32_bf16 v[84:87], a[60:63], v[168:171], v[84:87]
  v_exp_f32 v9, v159
  v_cvt_pk_bf16_f32 v190, v6, v7
  v_mfma_f32_16x16x32_bf16 v[92:95], a[56:59], v[164:167], v[92:95]
  v_cvt_pk_bf16_f32 v191, v8, v9
  v_mfma_f32_16x16x32_bf16 v[92:95], a[60:63], v[172:175], v[92:95]
  v_mfma_f32_16x16x32_bf16 v[244:247], a[72:75], v[180:183], v[240:243]
  v_mfma_f32_16x16x32_bf16 v[244:247], a[72:75], v[188:191], v[244:247]
  v_pk_mul_f32 v[32:33], v[32:33], v[252:253] op_sel:[0,0] op_sel_hi:[1,0]
  v_pk_mul_f32 v[34:35], v[34:35], v[252:253] op_sel:[0,0] op_sel_hi:[1,0]
  v_pk_mul_f32 v[36:37], v[36:37], v[252:253] op_sel:[0,0] op_sel_hi:[1,0]
  v_pk_mul_f32 v[38:39], v[38:39], v[252:253] op_sel:[0,0] op_sel_hi:[1,0]
  v_cvt_pk_bf16_f32 v32, v32, v33
  v_cvt_pk_bf16_f32 v33, v34, v35
  v_cvt_pk_bf16_f32 v34, v36, v37
  v_cvt_pk_bf16_f32 v35, v38, v39
  buffer_store_dwordx4 v[32:35], v12, s[68:71], s80 offen offset:0 sc1
  v_pk_mul_f32 v[48:49], v[48:49], v[252:253] op_sel:[0,0] op_sel_hi:[1,0]
  v_pk_mul_f32 v[50:51], v[50:51], v[252:253] op_sel:[0,0] op_sel_hi:[1,0]
  v_pk_mul_f32 v[52:53], v[52:53], v[252:253] op_sel:[0,0] op_sel_hi:[1,0]
  v_pk_mul_f32 v[54:55], v[54:55], v[252:253] op_sel:[0,0] op_sel_hi:[1,0]
  v_cvt_pk_bf16_f32 v48, v48, v49
  v_cvt_pk_bf16_f32 v49, v50, v51
  v_cvt_pk_bf16_f32 v50, v52, v53
  v_cvt_pk_bf16_f32 v51, v54, v55
  buffer_store_dwordx4 v[48:51], v12, s[68:71], s80 offen offset:1024 sc1
  v_pk_mul_f32 v[64:65], v[64:65], v[252:253] op_sel:[0,0] op_sel_hi:[1,0]
  v_pk_mul_f32 v[66:67], v[66:67], v[252:253] op_sel:[0,0] op_sel_hi:[1,0]
  v_pk_mul_f32 v[68:69], v[68:69], v[252:253] op_sel:[0,0] op_sel_hi:[1,0]
  v_pk_mul_f32 v[70:71], v[70:71], v[252:253] op_sel:[0,0] op_sel_hi:[1,0]
  v_cvt_pk_bf16_f32 v64, v64, v65
  v_cvt_pk_bf16_f32 v65, v66, v67
  v_cvt_pk_bf16_f32 v66, v68, v69
  v_cvt_pk_bf16_f32 v67, v70, v71
  buffer_store_dwordx4 v[64:67], v12, s[68:71], s80 offen offset:2048 sc1
  v_pk_mul_f32 v[80:81], v[80:81], v[252:253] op_sel:[0,0] op_sel_hi:[1,0]
  v_pk_mul_f32 v[82:83], v[82:83], v[252:253] op_sel:[0,0] op_sel_hi:[1,0]
  v_pk_mul_f32 v[84:85], v[84:85], v[252:253] op_sel:[0,0] op_sel_hi:[1,0]
  v_pk_mul_f32 v[86:87], v[86:87], v[252:253] op_sel:[0,0] op_sel_hi:[1,0]
  v_cvt_pk_bf16_f32 v80, v80, v81
  v_cvt_pk_bf16_f32 v81, v82, v83
  v_cvt_pk_bf16_f32 v82, v84, v85
  v_cvt_pk_bf16_f32 v83, v86, v87
  buffer_store_dwordx4 v[80:83], v12, s[68:71], s80 offen offset:3072 sc1
  v_max_f32 v250, v244, v245
  v_cmp_nge_f32 vcc, s44, v250
  s_cbranch_vccnz L_last_rare
L_last_back:
  s_waitcnt lgkmcnt(8)
  v_mfma_f32_16x16x32_bf16 v[40:43], a[0:3], v[180:183], v[40:43]
  ds_read_b128 a[48:51], v248 offset:55296
  ds_read_b128 a[52:55], v248 offset:63488
  v_mfma_f32_16x16x32_bf16 v[40:43], a[4:7], v[188:191], v[40:43]
  ds_read_b128 a[56:59], v248 offset:56320
  ds_read_b128 a[60:63], v248 offset:64512
  v_mfma_f32_16x16x32_bf16 v[44:47], a[8:11], v[180:183], v[44:47]
  s_lshl_b32 s80, s77, 12
  v_rcp_f32 v253, v245
  s_add_u32 s80, s80, s36
  v_mfma_f32_16x16x32_bf16 v[44:47], a[12:15], v[188:191], v[44:47]
  s_waitcnt lgkmcnt(8)
  s_add_u32 s82, s80, 704512
  v_add_u32 v192, s59, v12
  v_add_u32 v196, s43, v20
  v_mfma_f32_16x16x32_bf16 v[56:59], a[16:19], v[180:183], v[56:59]
  v_add_u32 v197, s43, v21
  v_add_u32 v198, s43, v22
  v_add_u32 v199, s43, v23
  v_mfma_f32_16x16x32_bf16 v[56:59], a[20:23], v[188:191], v[56:59]
  v_add_u32 v194, 131072, v192
  v_add_u32 v204, 131072, v196
  v_add_u32 v205, 131072, v197
  v_mfma_f32_16x16x32_bf16 v[60:63], a[24:27], v[180:183], v[60:63]
  v_add_u32 v206, 131072, v198
  v_add_u32 v207, 131072, v199
  v_add_u32 v193, 65536, v192
  v_mfma_f32_16x16x32_bf16 v[60:63], a[28:31], v[188:191], v[60:63]
  s_waitcnt lgkmcnt(4)
  v_add_u32 v200, 65536, v196
  v_add_u32 v201, 65536, v197
  v_add_u32 v202, 65536, v198
  v_mfma_f32_16x16x32_bf16 v[72:75], a[32:35], v[180:183], v[72:75]
  v_add_u32 v203, 65536, v199
  v_mul_f32 v40, v40, v253
  v_mul_f32 v41, v41, v253
  v_mfma_f32_16x16x32_bf16 v[72:75], a[36:39], v[188:191], v[72:75]
  v_mul_f32 v42, v42, v253
  v_mul_f32 v43, v43, v253
  v_mul_f32 v44, v44, v253
  v_mfma_f32_16x16x32_bf16 v[76:79], a[40:43], v[180:183], v[76:79]
  v_mul_f32 v45, v45, v253
  v_mul_f32 v46, v46, v253
  v_mul_f32 v47, v47, v253
  v_mfma_f32_16x16x32_bf16 v[76:79], a[44:47], v[188:191], v[76:79]
  s_waitcnt lgkmcnt(0)
  v_cvt_pk_bf16_f32 v40, v40, v41
  v_cvt_pk_bf16_f32 v41, v42, v43
  v_cvt_pk_bf16_f32 v42, v44, v45
  v_mfma_f32_16x16x32_bf16 v[88:91], a[48:51], v[180:183], v[88:91]
  v_cvt_pk_bf16_f32 v43, v46, v47
  buffer_store_dwordx4 v[40:43], v12, s[68:71], s82 offen offset:0 sc1
  v_mfma_f32_16x16x32_bf16 v[88:91], a[52:55], v[188:191], v[88:91]
  v_xor_b32 v248, 0x10000, v248
  v_mfma_f32_16x16x32_bf16 v[92:95], a[56:59], v[180:183], v[92:95]
  v_mfma_f32_16x16x32_bf16 v[92:95], a[60:63], v[188:191], v[92:95]
  v_pk_mul_f32 v[56:57], v[56:57], v[252:253] op_sel:[0,1] op_sel_hi:[1,1]
  v_pk_mul_f32 v[58:59], v[58:59], v[252:253] op_sel:[0,1] op_sel_hi:[1,1]
  v_pk_mul_f32 v[60:61], v[60:61], v[252:253] op_sel:[0,1] op_sel_hi:[1,1]
  v_pk_mul_f32 v[62:63], v[62:63], v[252:253] op_sel:[0,1] op_sel_hi:[1,1]
  v_cvt_pk_bf16_f32 v56, v56, v57
  v_cvt_pk_bf16_f32 v57, v58, v59
  v_cvt_pk_bf16_f32 v58, v60, v61
  v_cvt_pk_bf16_f32 v59, v62, v63
  buffer_store_dwordx4 v[56:59], v12, s[68:71], s82 offen offset:1024 sc1
  v_pk_mul_f32 v[72:73], v[72:73], v[252:253] op_sel:[0,1] op_sel_hi:[1,1]
  v_pk_mul_f32 v[74:75], v[74:75], v[252:253] op_sel:[0,1] op_sel_hi:[1,1]
  v_pk_mul_f32 v[76:77], v[76:77], v[252:253] op_sel:[0,1] op_sel_hi:[1,1]
  v_pk_mul_f32 v[78:79], v[78:79], v[252:253] op_sel:[0,1] op_sel_hi:[1,1]
  v_cvt_pk_bf16_f32 v72, v72, v73
  v_cvt_pk_bf16_f32 v73, v74, v75
  v_cvt_pk_bf16_f32 v74, v76, v77
  v_cvt_pk_bf16_f32 v75, v78, v79
  buffer_store_dwordx4 v[72:75], v12, s[68:71], s82 offen offset:2048 sc1
  v_pk_mul_f32 v[88:89], v[88:89], v[252:253] op_sel:[0,1] op_sel_hi:[1,1]
  v_pk_mul_f32 v[90:91], v[90:91], v[252:253] op_sel:[0,1] op_sel_hi:[1,1]
  v_pk_mul_f32 v[92:93], v[92:93], v[252:253] op_sel:[0,1] op_sel_hi:[1,1]
  v_pk_mul_f32 v[94:95], v[94:95], v[252:253] op_sel:[0,1] op_sel_hi:[1,1]
  v_cvt_pk_bf16_f32 v88, v88, v89
  v_cvt_pk_bf16_f32 v89, v90, v91
  v_cvt_pk_bf16_f32 v90, v92, v93
  v_cvt_pk_bf16_f32 v91, v94, v95
  buffer_store_dwordx4 v[88:91], v12, s[68:71], s82 offen offset:3072 sc1
L_out:
  s_waitcnt vmcnt(20) lgkmcnt(15)
  s_barrier
  ds_read_b64_tr_b16 a[64:65], v204 offset:0
  ds_read_b64_tr_b16 a[66:67], v204 offset:4096
  ds_read_b128 a[80:83], v194 offset:0
  ds_read_b128 a[84:87], v194 offset:1024
  ds_read_b128 a[88:91], v194 offset:4096
  ds_read_b128 a[92:95], v194 offset:5120
  ds_read_b64_tr_b16 a[68:69], v205 offset:0
  ds_read_b64_tr_b16 a[70:71], v205 offset:4096
  ds_read_b64_tr_b16 a[72:73], v206 offset:0
  ds_read_b64_tr_b16 a[74:75], v206 offset:4096
  ds_read_b64_tr_b16 a[76:77], v207 offset:0
  ds_read_b64_tr_b16 a[78:79], v207 offset:4096
  s_waitcnt lgkmcnt(0)
  v_mfma_f32_16x16x32_bf16 v[96:99], a[64:67], a[80:83], 0
  s_mul_i32 s80, s40, 9
  s_add_u32 s80, s80, 8
  s_and_b32 s80, s80, 31
  s_lshl_b32 s81, s80, 12
  v_mfma_f32_16x16x32_bf16 v[112:115], a[64:67], a[84:87], 0
  s_add_u32 m0, s88, 114688
  ds_read_b64_tr_b16 a[96:97], v204 offset:16384
  ds_read_b64_tr_b16 a[98:99], v204 offset:20480
  s_add_u32 s12, s58, s81
  v_mfma_f32_16x16x32_bf16 v[128:131], a[64:67], a[88:91], 0
  s_add_u32 s84, s87, 196608
  ds_read_b64_tr_b16 a[128:129], v200 offset:0
  ds_read_b64_tr_b16 a[130:131], v200 offset:4096
  s_lshl_b32 s81, s80, 17
  v_mfma_f32_16x16x32_bf16 v[144:147], a[64:67], a[92:95], 0
  buffer_load_dwordx4 v16, s[60:63], s84 offen offset:0 lds
  s_add_u32 s20, s57, s81
  v_mfma_f32_16x16x32_bf16 v[100:103], a[68:71], a[80:83], 0
  s_add_u32 s80, s80, 8
  ds_read_b128 a[112:115], v194 offset:16384
  s_and_b32 s80, s80, 31
  s_lshl_b32 s81, s80, 12
  v_mfma_f32_16x16x32_bf16 v[116:119], a[68:71], a[84:87], 0
  s_add_u32 s13, s58, s81
  ds_read_b128 a[144:147], v193 offset:0
  s_lshl_b32 s81, s80, 17
  s_add_u32 s21, s57, s81
  v_mfma_f32_16x16x32_bf16 v[132:135], a[68:71], a[88:91], 0
  s_add_u32 s80, s80, 8
  ds_read_b128 a[116:119], v194 offset:17408
  s_and_b32 s80, s80, 31
  s_lshl_b32 s81, s80, 12
  v_mfma_f32_16x16x32_bf16 v[148:151], a[68:71], a[92:95], 0
  buffer_load_dwordx4 v26, s[60:63], s84 offen offset:1024 lds
  s_add_u32 s14, s58, s81
  v_mfma_f32_16x16x32_bf16 v[104:107], a[72:75], a[80:83], 0
  s_lshl_b32 s81, s80, 17
  ds_read_b128 a[148:151], v193 offset:1024
  s_add_u32 s22, s57, s81
  s_add_u32 s80, s80, 8
  v_mfma_f32_16x16x32_bf16 v[120:123], a[72:75], a[84:87], 0
  s_and_b32 s80, s80, 31
  ds_read_b128 a[120:123], v194 offset:20480
  s_lshl_b32 s81, s80, 12
  s_add_u32 s15, s58, s81
  v_mfma_f32_16x16x32_bf16 v[136:139], a[72:75], a[88:91], 0
  s_lshl_b32 s81, s80, 17
  ds_read_b128 a[152:155], v193 offset:4096
  s_add_u32 s23, s57, s81
  s_add_u32 s85, s86, 6144
  v_mfma_f32_16x16x32_bf16 v[152:155], a[72:75], a[92:95], 0
  buffer_load_dwordx4 v24, s[68:71], s85 offen offset:2048 sc1 lds
  s_add_u32 s80, s80, 12
  v_mfma_f32_16x16x32_bf16 v[108:111], a[76:79], a[80:83], 0
  s_and_b32 s80, s80, 31
  ds_read_b128 a[124:127], v194 offset:21504
  s_lshl_b32 s81, s80, 12
  s_add_u32 s16, s58, s81
  v_mfma_f32_16x16x32_bf16 v[124:127], a[76:79], a[84:87], 0
  s_lshl_b32 s81, s80, 17
  ds_read_b128 a[156:159], v193 offset:5120
  s_add_u32 s24, s57, s81
  s_add_u32 s80, s80, 8
  v_mfma_f32_16x16x32_bf16 v[140:143], a[76:79], a[88:91], 0
  buffer_load_dwordx4 v25, s[68:71], s85 offen offset:3072 sc1 lds
  s_and_b32 s80, s80, 31
  v_mfma_f32_16x16x32_bf16 v[156:159], a[76:79], a[92:95], 0
  s_lshl_b32 s81, s80, 12
  s_add_u32 s17, s58, s81
  s_lshl_b32 s81, s80, 17
  s_waitcnt lgkmcnt(4)
  v_mfma_f32_16x16x32_bf16 v[96:99], a[96:99], a[112:115], v[96:99]
  s_add_u32 s25, s57, s81
  ds_read_b64_tr_b16 a[100:101], v205 offset:16384
  ds_read_b64_tr_b16 a[102:103], v205 offset:20480
  s_add_u32 s80, s80, 8
  v_mfma_f32_16x16x32_bf16 v[96:99], a[128:131], a[144:147], v[96:99]
  s_add_u32 m0, s88, 32768
  ds_read_b64_tr_b16 a[132:133], v201 offset:0
  ds_read_b64_tr_b16 a[134:135], v201 offset:4096
  s_and_b32 s80, s80, 31
  v_mfma_f32_16x16x32_bf16 v[112:115], a[96:99], a[116:119], v[112:115]
  s_add_u32 s84, s87, 229376
  s_lshl_b32 s81, s80, 12
  s_add_u32 s18, s58, s81
  s_waitcnt lgkmcnt(4)
  v_mfma_f32_16x16x32_bf16 v[112:115], a[128:131], a[148:151], v[112:115]
  buffer_load_dwordx4 v16, s[60:63], s84 offen offset:0 lds
  s_lshl_b32 s81, s80, 17
  v_mfma_f32_16x16x32_bf16 v[128:131], a[96:99], a[120:123], v[128:131]
  s_add_u32 s26, s57, s81
  ds_read_b64_tr_b16 a[104:105], v206 offset:16384
  ds_read_b64_tr_b16 a[106:107], v206 offset:20480
  s_add_u32 s80, s80, 8
  v_mfma_f32_16x16x32_bf16 v[128:131], a[128:131], a[152:155], v[128:131]
  s_and_b32 s80, s80, 31
  ds_read_b64_tr_b16 a[136:137], v202 offset:0
  ds_read_b64_tr_b16 a[138:139], v202 offset:4096
  s_lshl_b32 s81, s80, 12
  v_mfma_f32_16x16x32_bf16 v[144:147], a[96:99], a[124:127], v[144:147]
  s_add_u32 s19, s58, s81
  s_lshl_b32 s81, s80, 17
  s_add_u32 s27, s57, s81
  s_waitcnt lgkmcnt(4)
  v_mfma_f32_16x16x32_bf16 v[144:147], a[128:131], a[156:159], v[144:147]
  buffer_load_dwordx4 v26, s[60:63], s84 offen offset:1024 lds
  s_add_u32 s80, s80, 8
  v_mfma_f32_16x16x32_bf16 v[100:103], a[100:103], a[112:115], v[100:103]
  ds_read_b64_tr_b16 a[108:109], v207 offset:16384
  ds_read_b64_tr_b16 a[110:111], v207 offset:20480
  v_mfma_f32_16x16x32_bf16 v[100:103], a[132:135], a[144:147], v[100:103]
  ds_read_b64_tr_b16 a[140:141], v203 offset:0
  ds_read_b64_tr_b16 a[142:143], v203 offset:4096
  v_mfma_f32_16x16x32_bf16 v[116:119], a[100:103], a[116:119], v[116:119]
  s_add_u32 s85, s86, 7168
  v_mfma_f32_16x16x32_bf16 v[116:119], a[132:135], a[148:151], v[116:119]
  buffer_load_dwordx4 v24, s[68:71], s85 offen offset:2048 sc1 lds
  v_mfma_f32_16x16x32_bf16 v[132:135], a[100:103], a[120:123], v[132:135]
  v_mfma_f32_16x16x32_bf16 v[132:135], a[132:135], a[152:155], v[132:135]
  v_mfma_f32_16x16x32_bf16 v[148:151], a[100:103], a[124:127], v[148:151]
  buffer_load_dwordx4 v25, s[68:71], s85 offen offset:3072 sc1 lds
  v_mfma_f32_16x16x32_bf16 v[148:151], a[132:135], a[156:159], v[148:151]
  s_waitcnt lgkmcnt(0)
  v_mfma_f32_16x16x32_bf16 v[104:107], a[104:107], a[112:115], v[104:107]
  s_mov_b32 s93, 3
  s_mov_b64 exec, 0
  s_cmp_eq_u32 s76, 0
  s_cbranch_scc1 L_hop16
  s_cmp_eq_u32 s76, 1
  s_cbranch_scc1 L_hop17
  s_cmp_eq_u32 s76, 2
  s_cbranch_scc1 L_ret2
  s_branch L_ret2
L_ret2:
  s_mov_b64 exec, -1
  s_mov_b32 s93, 0
  s_waitcnt vmcnt(8)
  s_barrier
  v_mfma_f32_16x16x32_bf16 v[104:107], a[136:139], a[144:147], v[104:107]
  ds_read_b64_tr_b16 a[160:161], v200 offset:32768
  ds_read_b64_tr_b16 a[162:163], v200 offset:36864
  v_mfma_f32_16x16x32_bf16 v[120:123], a[104:107], a[116:119], v[120:123]
  s_add_u32 s80, s38, 1024
  ds_read_b64_tr_b16 a[192:193], v200 offset:16384
  ds_read_b64_tr_b16 a[194:195], v200 offset:20480
  v_mov_b32 v10, 1
  v_mfma_f32_16x16x32_bf16 v[120:123], a[136:139], a[148:151], v[120:123]
  buffer_store_dword v10, v17, s[68:71], s80 offen sc1
  v_mfma_f32_16x16x32_bf16 v[136:139], a[104:107], a[120:123], v[136:139]
  s_add_u32 m0, s88, 16384
  ds_read_b128 a[176:179], v193 offset:32768
  s_add_u32 s84, s87, 262144
  v_mfma_f32_16x16x32_bf16 v[136:139], a[136:139], a[152:155], v[136:139]
  ds_read_b128 a[208:211], v193 offset:16384
  buffer_load_dwordx4 v16, s[60:63], s84 offen offset:0 lds
  v_mfma_f32_16x16x32_bf16 v[152:155], a[104:107], a[124:127], v[152:155]
  ds_read_b128 a[180:183], v193 offset:33792
  v_mfma_f32_16x16x32_bf16 v[152:155], a[136:139], a[156:159], v[152:155]
  buffer_load_dwordx4 v26, s[60:63], s84 offen offset:1024 lds
  v_mfma_f32_16x16x32_bf16 v[108:111], a[108:111], a[112:115], v[108:111]
  s_add_u32 s85, s86, 8192
  ds_read_b128 a[212:215], v193 offset:17408
  v_mfma_f32_16x16x32_bf16 v[108:111], a[140:143], a[144:147], v[108:111]
  ds_read_b128 a[184:187], v193 offset:36864
  buffer_load_dwordx4 v24, s[68:71], s85 offen offset:2048 sc1 lds
  v_mfma_f32_16x16x32_bf16 v[124:127], a[108:111], a[116:119], v[124:127]
  ds_read_b128 a[216:219], v193 offset:20480
  v_mfma_f32_16x16x32_bf16 v[124:127], a[140:143], a[148:151], v[124:127]
  buffer_load_dwordx4 v25, s[68:71], s85 offen offset:3072 sc1 lds
  s_add_u32 m0, s88, 49152
  s_add_u32 s84, s87, 294912
  v_mfma_f32_16x16x32_bf16 v[140:143], a[108:111], a[120:123], v[140:143]
  ds_read_b128 a[188:191], v193 offset:37888
  buffer_load_dwordx4 v16, s[60:63], s84 offen offset:0 lds
  v_mfma_f32_16x16x32_bf16 v[140:143], a[140:143], a[152:155], v[140:143]
  ds_read_b128 a[220:223], v193 offset:21504
  buffer_load_dwordx4 v26, s[60:63], s84 offen offset:1024 lds
  s_add_u32 s85, s86, 9216
  v_mfma_f32_16x16x32_bf16 v[156:159], a[108:111], a[124:127], v[156:159]
  buffer_load_dwordx4 v24, s[68:71], s85 offen offset:2048 sc1 lds
  v_mfma_f32_16x16x32_bf16 v[156:159], a[140:143], a[156:159], v[156:159]
  buffer_load_dwordx4 v25, s[68:71], s85 offen offset:3072 sc1 lds
  s_waitcnt lgkmcnt(4)
  v_mfma_f32_16x16x32_bf16 v[96:99], a[160:163], a[176:179], v[96:99]
  s_add_u32 m0, s88, 131072
  ds_read_b64_tr_b16 a[164:165], v201 offset:32768
  ds_read_b64_tr_b16 a[166:167], v201 offset:36864
  v_mfma_f32_16x16x32_bf16 v[96:99], a[192:195], a[208:211], v[96:99]
  s_add_u32 s84, s87, 327680
  ds_read_b64_tr_b16 a[196:197], v201 offset:16384
  ds_read_b64_tr_b16 a[198:199], v201 offset:20480
  v_mfma_f32_16x16x32_bf16 v[112:115], a[160:163], a[180:183], v[112:115]
  buffer_load_dwordx4 v16, s[60:63], s84 offen offset:0 lds
  s_waitcnt lgkmcnt(4)
  v_mfma_f32_16x16x32_bf16 v[112:115], a[192:195], a[212:215], v[112:115]
  buffer_load_dwordx4 v26, s[60:63], s84 offen offset:1024 lds
  v_mfma_f32_16x16x32_bf16 v[128:131], a[160:163], a[184:187], v[128:131]
  s_add_u32 s85, s86, 10240
  ds_read_b64_tr_b16 a[168:169], v202 offset:32768
  ds_read_b64_tr_b16 a[170:171], v202 offset:36864
  v_mfma_f32_16x16x32_bf16 v[128:131], a[192:195], a[216:219], v[128:131]
  s_add_u32 s85, s85, s56
  ds_read_b64_tr_b16 a[200:201], v202 offset:16384
  ds_read_b64_tr_b16 a[202:203], v202 offset:20480
  v_mfma_f32_16x16x32_bf16 v[144:147], a[160:163], a[188:191], v[144:147]
  buffer_load_dwordx4 v24, s[68:71], s85 offen offset:2048 sc1 lds
  s_waitcnt lgkmcnt(4)
  v_mfma_f32_16x16x32_bf16 v[144:147], a[192:195], a[220:223], v[144:147]
  buffer_load_dwordx4 v25, s[68:71], s85 offen offset:3072 sc1 lds
  v_mfma_f32_16x16x32_bf16 v[100:103], a[164:167], a[176:179], v[100:103]
  s_add_u32 m0, s88, 147456
  ds_read_b64_tr_b16 a[172:173], v203 offset:32768
  ds_read_b64_tr_b16 a[174:175], v203 offset:36864
  v_mfma_f32_16x16x32_bf16 v[100:103], a[196:199], a[208:211], v[100:103]
  s_add_u32 s84, s20, 0
  ds_read_b64_tr_b16 a[204:205], v203 offset:16384
  ds_read_b64_tr_b16 a[206:207], v203 offset:20480
  v_mfma_f32_16x16x32_bf16 v[116:119], a[164:167], a[180:183], v[116:119]
  buffer_load_dwordx4 v16, s[52:55], s84 offen offset:0 lds
  v_mfma_f32_16x16x32_bf16 v[116:119], a[196:199], a[212:215], v[116:119]
  buffer_load_dwordx4 v15, s[52:55], s84 offen offset:1024 lds
  v_mfma_f32_16x16x32_bf16 v[132:135], a[164:167], a[184:187], v[132:135]
  v_mfma_f32_16x16x32_bf16 v[132:135], a[196:199], a[216:219], v[132:135]
  v_mfma_f32_16x16x32_bf16 v[148:151], a[164:167], a[188:191], v[148:151]
  v_mfma_f32_16x16x32_bf16 v[148:151], a[196:199], a[220:223], v[148:151]
  s_waitcnt lgkmcnt(0)
  v_mfma_f32_16x16x32_bf16 v[104:107], a[168:171], a[176:179], v[104:107]
  s_waitcnt vmcnt(19)
  s_barrier
  v_mfma_f32_16x16x32_bf16 v[104:107], a[200:203], a[208:211], v[104:107]
  s_add_u32 m0, s88, 65536
  ds_read_b64_tr_b16 a[224:225], v196 offset:0
  ds_read_b64_tr_b16 a[226:227], v196 offset:4096
  v_mfma_f32_16x16x32_bf16 v[120:123], a[168:171], a[180:183], v[120:123]
  s_add_u32 s84, s20, 32768
  ds_read_b64_tr_b16 a[0:1], v200 offset:49152
  ds_read_b64_tr_b16 a[2:3], v200 offset:53248
  v_mfma_f32_16x16x32_bf16 v[120:123], a[200:203], a[212:215], v[120:123]
  buffer_load_dwordx4 v16, s[52:55], s84 offen offset:0 lds
  v_mfma_f32_16x16x32_bf16 v[136:139], a[168:171], a[184:187], v[136:139]
  ds_read_b128 a[240:243], v192 offset:0
  v_mfma_f32_16x16x32_bf16 v[136:139], a[200:203], a[216:219], v[136:139]
  ds_read_b128 a[16:19], v193 offset:49152
  v_mfma_f32_16x16x32_bf16 v[152:155], a[168:171], a[188:191], v[152:155]
  ds_read_b128 a[244:247], v192 offset:1024
  v_mfma_f32_16x16x32_bf16 v[152:155], a[200:203], a[220:223], v[152:155]
  v_mfma_f32_16x16x32_bf16 v[108:111], a[172:175], a[176:179], v[108:111]
  ds_read_b128 a[20:23], v193 offset:50176
  v_mfma_f32_16x16x32_bf16 v[108:111], a[204:207], a[208:211], v[108:111]
  ds_read_b128 a[248:251], v192 offset:4096
  v_mfma_f32_16x16x32_bf16 v[124:127], a[172:175], a[180:183], v[124:127]
  ds_read_b128 a[24:27], v193 offset:53248
  v_mfma_f32_16x16x32_bf16 v[124:127], a[204:207], a[212:215], v[124:127]
  buffer_load_dwordx4 v15, s[52:55], s84 offen offset:1024 lds
  v_mfma_f32_16x16x32_bf16 v[140:143], a[172:175], a[184:187], v[140:143]
  ds_read_b128 a[252:255], v192 offset:5120
  v_mfma_f32_16x16x32_bf16 v[140:143], a[204:207], a[216:219], v[140:143]
  ds_read_b128 a[28:31], v193 offset:54272
  v_mfma_f32_16x16x32_bf16 v[156:159], a[172:175], a[188:191], v[156:159]
  v_mfma_f32_16x16x32_bf16 v[156:159], a[204:207], a[220:223], v[156:159]
  s_waitcnt lgkmcnt(4)
  v_mfma_f32_16x16x32_bf16 v[96:99], a[224:227], a[240:243], v[96:99]
L_hop15:
  s_cbranch_execz L_main
  ds_read_b64_tr_b16 a[228:229], v197 offset:0
  ds_read_b64_tr_b16 a[230:231], v197 offset:4096
  v_mfma_f32_16x16x32_bf16 v[96:99], a[0:3], a[16:19], v[96:99]
  s_add_u32 m0, s88, 98304
  ds_read_b64_tr_b16 a[4:5], v201 offset:49152
  ds_read_b64_tr_b16 a[6:7], v201 offset:53248
  v_mfma_f32_16x16x32_bf16 v[112:115], a[224:227], a[244:247], v[112:115]
  s_add_u32 s84, s20, 65536
  s_waitcnt lgkmcnt(4)
  v_mfma_f32_16x16x32_bf16 v[112:115], a[0:3], a[20:23], v[112:115]
  buffer_load_dwordx4 v16, s[52:55], s84 offen offset:0 lds
  v_mfma_f32_16x16x32_bf16 v[128:131], a[224:227], a[248:251], v[128:131]
  ds_read_b64_tr_b16 a[232:233], v198 offset:0
  ds_read_b64_tr_b16 a[234:235], v198 offset:4096
  v_mfma_f32_16x16x32_bf16 v[128:131], a[0:3], a[24:27], v[128:131]
  ds_read_b64_tr_b16 a[8:9], v202 offset:49152
  ds_read_b64_tr_b16 a[10:11], v202 offset:53248
  v_mfma_f32_16x16x32_bf16 v[144:147], a[224:227], a[252:255], v[144:147]
  s_waitcnt lgkmcnt(4)
  v_mfma_f32_16x16x32_bf16 v[144:147], a[0:3], a[28:31], v[144:147]
  buffer_load_dwordx4 v15, s[52:55], s84 offen offset:1024 lds
  v_mfma_f32_16x16x32_bf16 v[100:103], a[228:231], a[240:243], v[100:103]
  ds_read_b64_tr_b16 a[236:237], v199 offset:0
  ds_read_b64_tr_b16 a[238:239], v199 offset:4096
  v_mfma_f32_16x16x32_bf16 v[100:103], a[4:7], a[16:19], v[100:103]
  ds_read_b64_tr_b16 a[12:13], v203 offset:49152
  ds_read_b64_tr_b16 a[14:15], v203 offset:53248
  v_mfma_f32_16x16x32_bf16 v[116:119], a[228:231], a[244:247], v[116:119]
  s_lshr_b32 s81, s78, 2
  s_xor_b32 s81, s81, 1
  s_lshl_b32 s81, s81, 28
  s_add_u32 s81, s81, s40
  s_lshl_b32 s81, s81, 2
  s_add_u32 s81, s81, s75
  s_sub_u32 s81, s81, 2048
  v_mov_b32 v10, 1
  v_mfma_f32_16x16x32_bf16 v[116:119], a[4:7], a[20:23], v[116:119]
  buffer_store_dword v10, v17, s[68:71], s81 offen sc1
  v_mfma_f32_16x16x32_bf16 v[132:135], a[228:231], a[248:251], v[132:135]
  v_mfma_f32_16x16x32_bf16 v[132:135], a[4:7], a[24:27], v[132:135]
  v_mfma_f32_16x16x32_bf16 v[148:151], a[228:231], a[252:255], v[148:151]
  buffer_store_dword v10, v17, s[68:71], s81 offen offset:2048 sc1
  v_mfma_f32_16x16x32_bf16 v[148:151], a[4:7], a[28:31], v[148:151]
  s_waitcnt lgkmcnt(0)
  v_mfma_f32_16x16x32_bf16 v[104:107], a[232:235], a[240:243], v[104:107]
  s_waitcnt vmcnt(16)
  s_barrier
  v_mfma_f32_16x16x32_bf16 v[104:107], a[8:11], a[16:19], v[104:107]
  s_add_u32 m0, s88, 81920
  ds_read_b64_tr_b16 a[32:33], v196 offset:32768
  ds_read_b64_tr_b16 a[34:35], v196 offset:36864
  v_mfma_f32_16x16x32_bf16 v[120:123], a[232:235], a[244:247], v[120:123]
  s_add_u32 s84, s20, 98304
  ds_read_b64_tr_b16 a[64:65], v196 offset:16384
  ds_read_b64_tr_b16 a[66:67], v196 offset:20480
  v_mfma_f32_16x16x32_bf16 v[120:123], a[8:11], a[20:23], v[120:123]
  buffer_load_dwordx4 v16, s[52:55], s84 offen offset:0 lds
  v_mfma_f32_16x16x32_bf16 v[136:139], a[232:235], a[248:251], v[136:139]
  ds_read_b128 a[48:51], v192 offset:32768
  v_mfma_f32_16x16x32_bf16 v[136:139], a[8:11], a[24:27], v[136:139]
  ds_read_b128 a[80:83], v192 offset:16384
  v_mfma_f32_16x16x32_bf16 v[152:155], a[232:235], a[252:255], v[152:155]
  ds_read_b128 a[52:55], v192 offset:33792
  v_mfma_f32_16x16x32_bf16 v[152:155], a[8:11], a[28:31], v[152:155]
  buffer_load_dwordx4 v15, s[52:55], s84 offen offset:1024 lds
  v_mfma_f32_16x16x32_bf16 v[108:111], a[236:239], a[240:243], v[108:111]
  ds_read_b128 a[84:87], v192 offset:17408
  v_mfma_f32_16x16x32_bf16 v[108:111], a[12:15], a[16:19], v[108:111]
  ds_read_b128 a[56:59], v192 offset:36864
  v_mfma_f32_16x16x32_bf16 v[124:127], a[236:239], a[244:247], v[124:127]
  s_add_u32 s89, s89, 1024
  ds_read_b128 a[88:91], v192 offset:20480
  v_mfma_f32_16x16x32_bf16 v[124:127], a[12:15], a[20:23], v[124:127]
  buffer_load_dword v13, v28, s[68:71], s89 offen sc1
  v_mfma_f32_16x16x32_bf16 v[140:143], a[236:239], a[248:251], v[140:143]
  ds_read_b128 a[60:63], v192 offset:37888
  v_mfma_f32_16x16x32_bf16 v[140:143], a[12:15], a[24:27], v[140:143]
  ds_read_b128 a[92:95], v192 offset:21504
  v_mfma_f32_16x16x32_bf16 v[156:159], a[236:239], a[252:255], v[156:159]
  v_mfma_f32_16x16x32_bf16 v[156:159], a[12:15], a[28:31], v[156:159]
  s_waitcnt lgkmcnt(4)
  v_mfma_f32_16x16x32_bf16 v[96:99], a[32:35], a[48:51], v[96:99]
  ds_read_b64_tr_b16 a[36:37], v197 offset:32768
  ds_read_b64_tr_b16 a[38:39], v197 offset:36864
  v_mfma_f32_16x16x32_bf16 v[96:99], a[64:67], a[80:83], v[96:99]
  s_add_u32 m0, s88, 0
  ds_read_b64_tr_b16 a[68:69], v197 offset:16384
  ds_read_b64_tr_b16 a[70:71], v197 offset:20480
  v_mfma_f32_16x16x32_bf16 v[112:115], a[32:35], a[52:55], v[112:115]
  s_add_u32 s84, s21, 0
  s_waitcnt lgkmcnt(4)
  v_mfma_f32_16x16x32_bf16 v[112:115], a[64:67], a[84:87], v[112:115]
  buffer_load_dwordx4 v16, s[52:55], s84 offen offset:0 lds
  v_mfma_f32_16x16x32_bf16 v[128:131], a[32:35], a[56:59], v[128:131]
  ds_read_b64_tr_b16 a[40:41], v198 offset:32768
  ds_read_b64_tr_b16 a[42:43], v198 offset:36864
  v_mfma_f32_16x16x32_bf16 v[128:131], a[64:67], a[88:91], v[128:131]
  ds_read_b64_tr_b16 a[72:73], v198 offset:16384
  ds_read_b64_tr_b16 a[74:75], v198 offset:20480
  v_mfma_f32_16x16x32_bf16 v[144:147], a[32:35], a[60:63], v[144:147]
  s_waitcnt lgkmcnt(4)
  v_mfma_f32_16x16x32_bf16 v[144:147], a[64:67], a[92:95], v[144:147]
  v_mfma_f32_16x16x32_bf16 v[100:103], a[36:39], a[48:51], v[100:103]
  ds_read_b64_tr_b16 a[44:45], v199 offset:32768
  ds_read_b64_tr_b16 a[46:47], v199 offset:36864
  v_mfma_f32_16x16x32_bf16 v[100:103], a[68:71], a[80:83], v[100:103]
  ds_read_b64_tr_b16 a[76:77], v199 offset:16384
  ds_read_b64_tr_b16 a[78:79], v199 offset:20480
  v_mfma_f32_16x16x32_bf16 v[116:119], a[36:39], a[52:55], v[116:119]
  v_mfma_f32_16x16x32_bf16 v[116:119], a[68:71], a[84:87], v[116:119]
  buffer_load_dwordx4 v15, s[52:55], s84 offen offset:1024 lds
  v_mfma_f32_16x16x32_bf16 v[132:135], a[36:39], a[56:59], v[132:135]
  v_mfma_f32_16x16x32_bf16 v[132:135], a[68:71], a[88:91], v[132:135]
  v_mfma_f32_16x16x32_bf16 v[148:151], a[36:39], a[60:63], v[148:151]
  v_mfma_f32_16x16x32_bf16 v[148:151], a[68:71], a[92:95], v[148:151]
  s_waitcnt vmcnt(2)
  v_cmp_eq_u32 vcc, 1, v13
  s_nop 0
  s_mov_b32 s42, vcc_lo
  s_waitcnt lgkmcnt(0)
  v_mfma_f32_16x16x32_bf16 v[104:107], a[40:43], a[48:51], v[104:107]
  s_waitcnt vmcnt(63)
  s_barrier
  v_mfma_f32_16x16x32_bf16 v[104:107], a[72:75], a[80:83], v[104:107]
  ds_read_b64_tr_b16 a[96:97], v196 offset:49152
  ds_read_b64_tr_b16 a[98:99], v196 offset:53248
  v_mfma_f32_16x16x32_bf16 v[120:123], a[40:43], a[52:55], v[120:123]
  s_add_u32 m0, s88, 147456
  ds_read_b64_tr_b16 a[128:129], v204 offset:0
  ds_read_b64_tr_b16 a[130:131], v204 offset:4096
  s_bitcmp1_b32 s42, 0
  s_cbranch_scc0 L_e0_spin
L_e0_ok:
  s_add_u32 s85, s12, 0
  v_mfma_f32_16x16x32_bf16 v[120:123], a[72:75], a[84:87], v[120:123]
  buffer_load_dwordx4 v24, s[68:71], s85 offen offset:2048 sc1 lds
  v_mfma_f32_16x16x32_bf16 v[136:139], a[40:43], a[56:59], v[136:139]
  ds_read_b128 a[112:115], v192 offset:49152
  v_mfma_f32_16x16x32_bf16 v[136:139], a[72:75], a[88:91], v[136:139]
  ds_read_b128 a[144:147], v194 offset:0
  buffer_load_dwordx4 v25, s[68:71], s85 offen offset:3072 sc1 lds
  v_mfma_f32_16x16x32_bf16 v[152:155], a[40:43], a[60:63], v[152:155]
  s_add_u32 m0, s88, 65536
  ds_read_b128 a[116:119], v192 offset:50176
  s_add_u32 s85, s12, 1024
  v_mfma_f32_16x16x32_bf16 v[152:155], a[72:75], a[92:95], v[152:155]
  buffer_load_dwordx4 v24, s[68:71], s85 offen offset:2048 sc1 lds
  v_mfma_f32_16x16x32_bf16 v[108:111], a[44:47], a[48:51], v[108:111]
  ds_read_b128 a[148:151], v194 offset:1024
  v_mfma_f32_16x16x32_bf16 v[108:111], a[76:79], a[80:83], v[108:111]
  ds_read_b128 a[120:123], v192 offset:53248
  buffer_load_dwordx4 v25, s[68:71], s85 offen offset:3072 sc1 lds
  v_mfma_f32_16x16x32_bf16 v[124:127], a[44:47], a[52:55], v[124:127]
  s_add_u32 m0, s88, 98304
  ds_read_b128 a[152:155], v194 offset:4096
  s_add_u32 s85, s12, 2048
  v_mfma_f32_16x16x32_bf16 v[124:127], a[76:79], a[84:87], v[124:127]
  buffer_load_dwordx4 v24, s[68:71], s85 offen offset:2048 sc1 lds
  v_mfma_f32_16x16x32_bf16 v[140:143], a[44:47], a[56:59], v[140:143]
  ds_read_b128 a[124:127], v192 offset:54272
  buffer_load_dwordx4 v25, s[68:71], s85 offen offset:3072 sc1 lds
  v_mfma_f32_16x16x32_bf16 v[140:143], a[76:79], a[88:91], v[140:143]
  ds_read_b128 a[156:159], v194 offset:5120
  v_mfma_f32_16x16x32_bf16 v[156:159], a[44:47], a[60:63], v[156:159]
  v_mfma_f32_16x16x32_bf16 v[156:159], a[76:79], a[92:95], v[156:159]
  s_waitcnt lgkmcnt(4)
  v_mfma_f32_16x16x32_bf16 v[96:99], a[96:99], a[112:115], v[96:99]
  s_add_u32 m0, s88, 81920
  ds_read_b64_tr_b16 a[100:101], v197 offset:49152
  ds_read_b64_tr_b16 a[102:103], v197 offset:53248
  v_mfma_f32_16x16x32_bf16 v[96:99], a[128:131], a[144:147], v[96:99]
  s_add_u32 s85, s12, 3072
  ds_read_b64_tr_b16 a[132:133], v205 offset:0
  ds_read_b64_tr_b16 a[134:135], v205 offset:4096
  v_mfma_f32_16x16x32_bf16 v[112:115], a[96:99], a[116:119], v[112:115]
  buffer_load_dwordx4 v24, s[68:71], s85 offen offset:2048 sc1 lds
  s_waitcnt lgkmcnt(4)
  v_mfma_f32_16x16x32_bf16 v[112:115], a[128:131], a[148:151], v[112:115]
  buffer_load_dwordx4 v25, s[68:71], s85 offen offset:3072 sc1 lds
  v_mfma_f32_16x16x32_bf16 v[128:131], a[96:99], a[120:123], v[128:131]
  ds_read_b64_tr_b16 a[104:105], v198 offset:49152
  ds_read_b64_tr_b16 a[106:107], v198 offset:53248
  v_mfma_f32_16x16x32_bf16 v[128:131], a[128:131], a[152:155], v[128:131]
  s_add_u32 m0, s88, 0
  ds_read_b64_tr_b16 a[136:137], v206 offset:0
  ds_read_b64_tr_b16 a[138:139], v206 offset:4096
  s_bitcmp1_b32 s42, 1
  s_cbranch_scc0 L_e1_spin
L_e1_ok:
  s_add_u32 s85, s13, 0
  v_mfma_f32_16x16x32_bf16 v[144:147], a[96:99], a[124:127], v[144:147]
  buffer_load_dwordx4 v24, s[68:71], s85 offen offset:2048 sc1 lds
  s_waitcnt lgkmcnt(4)
  v_mfma_f32_16x16x32_bf16 v[144:147], a[128:131], a[156:159], v[144:147]
  buffer_load_dwordx4 v25, s[68:71], s85 offen offset:3072 sc1 lds
  v_mfma_f32_16x16x32_bf16 v[100:103], a[100:103], a[112:115], v[100:103]
  s_add_u32 m0, s88, 114688
  ds_read_b64_tr_b16 a[108:109], v199 offset:49152
  ds_read_b64_tr_b16 a[110:111], v199 offset:53248
  v_mfma_f32_16x16x32_bf16 v[100:103], a[132:135], a[144:147], v[100:103]
  s_add_u32 s84, s21, 32768
  ds_read_b64_tr_b16 a[140:141], v207 offset:0
  ds_read_b64_tr_b16 a[142:143], v207 offset:4096
  v_mfma_f32_16x16x32_bf16 v[116:119], a[100:103], a[116:119], v[116:119]
  buffer_load_dwordx4 v16, s[52:55], s84 offen offset:0 lds
  v_mfma_f32_16x16x32_bf16 v[116:119], a[132:135], a[148:151], v[116:119]
  buffer_load_dwordx4 v15, s[52:55], s84 offen offset:1024 lds
  s_add_u32 s85, s13, 1024
  v_mfma_f32_16x16x32_bf16 v[132:135], a[100:103], a[120:123], v[132:135]
  buffer_load_dwordx4 v24, s[68:71], s85 offen offset:2048 sc1 lds
  v_mfma_f32_16x16x32_bf16 v[132:135], a[132:135], a[152:155], v[132:135]
  buffer_load_dwordx4 v25, s[68:71], s85 offen offset:3072 sc1 lds
  v_mfma_f32_16x16x32_bf16 v[148:151], a[100:103], a[124:127], v[148:151]
  v_mfma_f32_16x16x32_bf16 v[148:151], a[132:135], a[156:159], v[148:151]
  s_waitcnt lgkmcnt(0)
  v_mfma_f32_16x16x32_bf16 v[104:107], a[104:107], a[112:115], v[104:107]
  s_waitcnt vmcnt(10)
  s_barrier
  v_mfma_f32_16x16x32_bf16 v[104:107], a[136:139], a[144:147], v[104:107]
  s_add_u32 m0, s88, 32768
  ds_read_b64_tr_b16 a[160:161], v204 offset:16384
  ds_read_b64_tr_b16 a[162:163], v204 offset:20480
  v_mfma_f32_16x16x32_bf16 v[120:123], a[104:107], a[116:119], v[120:123]
  s_add_u32 s84, s21, 65536
  ds_read_b64_tr_b16 a[192:193], v200 offset:0
  ds_read_b64_tr_b16 a[194:195], v200 offset:4096
  v_mfma_f32_16x16x32_bf16 v[120:123], a[136:139], a[148:151], v[120:123]
  buffer_load_dwordx4 v16, s[52:55], s84 offen offset:0 lds
  v_mfma_f32_16x16x32_bf16 v[136:139], a[104:107], a[120:123], v[136:139]
  ds_read_b128 a[176:179], v194 offset:16384
  v_mfma_f32_16x16x32_bf16 v[136:139], a[136:139], a[152:155], v[136:139]
  ds_read_b128 a[208:211], v193 offset:0
  buffer_load_dwordx4 v15, s[52:55], s84 offen offset:1024 lds
  v_mfma_f32_16x16x32_bf16 v[152:155], a[104:107], a[124:127], v[152:155]
  s_add_u32 s85, s13, 2048
  ds_read_b128 a[180:183], v194 offset:17408
  v_mfma_f32_16x16x32_bf16 v[152:155], a[136:139], a[156:159], v[152:155]
  buffer_load_dwordx4 v24, s[68:71], s85 offen offset:2048 sc1 lds
  v_mfma_f32_16x16x32_bf16 v[108:111], a[108:111], a[112:115], v[108:111]
  ds_read_b128 a[212:215], v193 offset:1024
  v_mfma_f32_16x16x32_bf16 v[108:111], a[140:143], a[144:147], v[108:111]
  ds_read_b128 a[184:187], v194 offset:20480
  buffer_load_dwordx4 v25, s[68:71], s85 offen offset:3072 sc1 lds
  v_mfma_f32_16x16x32_bf16 v[124:127], a[108:111], a[116:119], v[124:127]
  s_add_u32 m0, s88, 16384
  ds_read_b128 a[216:219], v193 offset:4096
  s_add_u32 s84, s21, 98304
  v_mfma_f32_16x16x32_bf16 v[124:127], a[140:143], a[148:151], v[124:127]
  buffer_load_dwordx4 v16, s[52:55], s84 offen offset:0 lds
  v_mfma_f32_16x16x32_bf16 v[140:143], a[108:111], a[120:123], v[140:143]
  ds_read_b128 a[188:191], v194 offset:21504
  buffer_load_dwordx4 v15, s[52:55], s84 offen offset:1024 lds
  s_add_u32 s85, s13, 3072
  v_mfma_f32_16x16x32_bf16 v[140:143], a[140:143], a[152:155], v[140:143]
  ds_read_b128 a[220:223], v193 offset:5120
  buffer_load_dwordx4 v24, s[68:71], s85 offen offset:2048 sc1 lds
  v_mfma_f32_16x16x32_bf16 v[156:159], a[108:111], a[124:127], v[156:159]
  buffer_load_dwordx4 v25, s[68:71], s85 offen offset:3072 sc1 lds
  v_mfma_f32_16x16x32_bf16 v[156:159], a[140:143], a[156:159], v[156:159]
  s_waitcnt lgkmcnt(4)
  v_mfma_f32_16x16x32_bf16 v[96:99], a[160:163], a[176:179], v[96:99]
  ds_read_b64_tr_b16 a[164:165], v205 offset:16384
  ds_read_b64_tr_b16 a[166:167], v205 offset:20480
  v_mfma_f32_16x16x32_bf16 v[96:99], a[192:195], a[208:211], v[96:99]
  s_add_u32 m0, s88, 49152
  ds_read_b64_tr_b16 a[196:197], v201 offset:0
  ds_read_b64_tr_b16 a[198:199], v201 offset:4096
  v_mfma_f32_16x16x32_bf16 v[112:115], a[160:163], a[180:183], v[112:115]
  s_add_u32 s84, s22, 0
  s_waitcnt lgkmcnt(4)
  v_mfma_f32_16x16x32_bf16 v[112:115], a[192:195], a[212:215], v[112:115]
  buffer_load_dwordx4 v16, s[52:55], s84 offen offset:0 lds
  v_mfma_f32_16x16x32_bf16 v[128:131], a[160:163], a[184:187], v[128:131]
  ds_read_b64_tr_b16 a[168:169], v206 offset:16384
  ds_read_b64_tr_b16 a[170:171], v206 offset:20480
  v_mfma_f32_16x16x32_bf16 v[128:131], a[192:195], a[216:219], v[128:131]
  ds_read_b64_tr_b16 a[200:201], v202 offset:0
  ds_read_b64_tr_b16 a[202:203], v202 offset:4096
  v_mfma_f32_16x16x32_bf16 v[144:147], a[160:163], a[188:191], v[144:147]
  s_waitcnt lgkmcnt(4)
  v_mfma_f32_16x16x32_bf16 v[144:147], a[192:195], a[220:223], v[144:147]
  buffer_load_dwordx4 v15, s[52:55], s84 offen offset:1024 lds
  v_mfma_f32_16x16x32_bf16 v[100:103], a[164:167], a[176:179], v[100:103]
  ds_read_b64_tr_b16 a[172:173], v207 offset:16384
  ds_read_b64_tr_b16 a[174:175], v207 offset:20480
  v_mfma_f32_16x16x32_bf16 v[100:103], a[196:199], a[208:211], v[100:103]
  ds_read_b64_tr_b16 a[204:205], v203 offset:0
  ds_read_b64_tr_b16 a[206:207], v203 offset:4096
  v_mfma_f32_16x16x32_bf16 v[116:119], a[164:167], a[180:183], v[116:119]
  s_bitcmp1_b32 s42, 2
  s_cbranch_scc0 L_e2_spin
L_e2_ok:
  s_add_u32 s85, s14, 0
  v_mfma_f32_16x16x32_bf16 v[116:119], a[196:199], a[212:215], v[116:119]
  buffer_load_dwordx4 v24, s[68:71], s85 offen offset:2048 sc1 lds
  v_mfma_f32_16x16x32_bf16 v[132:135], a[164:167], a[184:187], v[132:135]
  v_mfma_f32_16x16x32_bf16 v[132:135], a[196:199], a[216:219], v[132:135]
  v_mfma_f32_16x16x32_bf16 v[148:151], a[164:167], a[188:191], v[148:151]
  buffer_load_dwordx4 v25, s[68:71], s85 offen offset:3072 sc1 lds
  v_mfma_f32_16x16x32_bf16 v[148:151], a[196:199], a[220:223], v[148:151]
  s_waitcnt lgkmcnt(0)
  v_mfma_f32_16x16x32_bf16 v[104:107], a[168:171], a[176:179], v[104:107]
  s_waitcnt vmcnt(18)
  s_barrier
  v_mfma_f32_16x16x32_bf16 v[104:107], a[200:203], a[208:211], v[104:107]
  s_add_u32 m0, s88, 131072
  ds_read_b64_tr_b16 a[224:225], v200 offset:32768
  ds_read_b64_tr_b16 a[226:227], v200 offset:36864
  v_mfma_f32_16x16x32_bf16 v[120:123], a[168:171], a[180:183], v[120:123]
  s_add_u32 s84, s22, 32768
  ds_read_b64_tr_b16 a[0:1], v200 offset:16384
  ds_read_b64_tr_b16 a[2:3], v200 offset:20480
  v_mfma_f32_16x16x32_bf16 v[120:123], a[200:203], a[212:215], v[120:123]
  buffer_load_dwordx4 v16, s[52:55], s84 offen offset:0 lds
  v_mfma_f32_16x16x32_bf16 v[136:139], a[168:171], a[184:187], v[136:139]
  ds_read_b128 a[240:243], v193 offset:32768
  v_mfma_f32_16x16x32_bf16 v[136:139], a[200:203], a[216:219], v[136:139]
  ds_read_b128 a[16:19], v193 offset:16384
  v_mfma_f32_16x16x32_bf16 v[152:155], a[168:171], a[188:191], v[152:155]
  ds_read_b128 a[244:247], v193 offset:33792
  v_mfma_f32_16x16x32_bf16 v[152:155], a[200:203], a[220:223], v[152:155]
  buffer_load_dwordx4 v15, s[52:55], s84 offen offset:1024 lds
  v_mfma_f32_16x16x32_bf16 v[108:111], a[172:175], a[176:179], v[108:111]
  ds_read_b128 a[20:23], v193 offset:17408
  v_mfma_f32_16x16x32_bf16 v[108:111], a[204:207], a[208:211], v[108:111]
  ds_read_b128 a[248:251], v193 offset:36864
  v_mfma_f32_16x16x32_bf16 v[124:127], a[172:175], a[180:183], v[124:127]
  s_add_u32 s85, s14, 1024
  ds_read_b128 a[24:27], v193 offset:20480
  v_mfma_f32_16x16x32_bf16 v[124:127], a[204:207], a[212:215], v[124:127]
  buffer_load_dwordx4 v24, s[68:71], s85 offen offset:2048 sc1 lds
  v_mfma_f32_16x16x32_bf16 v[140:143], a[172:175], a[184:187], v[140:143]
  ds_read_b128 a[252:255], v193 offset:37888
  v_mfma_f32_16x16x32_bf16 v[140:143], a[204:207], a[216:219], v[140:143]
  ds_read_b128 a[28:31], v193 offset:21504
  v_mfma_f32_16x16x32_bf16 v[156:159], a[172:175], a[188:191], v[156:159]
  buffer_load_dwordx4 v25, s[68:71], s85 offen offset:3072 sc1 lds
  v_mfma_f32_16x16x32_bf16 v[156:159], a[204:207], a[220:223], v[156:159]
  s_waitcnt lgkmcnt(4)
  v_mfma_f32_16x16x32_bf16 v[96:99], a[224:227], a[240:243], v[96:99]
  ds_read_b64_tr_b16 a[228:229], v201 offset:32768
  ds_read_b64_tr_b16 a[230:231], v201 offset:36864
  v_mfma_f32_16x16x32_bf16 v[96:99], a[0:3], a[16:19], v[96:99]
  s_add_u32 m0, s88, 147456
  ds_read_b64_tr_b16 a[4:5], v201 offset:16384
  ds_read_b64_tr_b16 a[6:7], v201 offset:20480
  v_mfma_f32_16x16x32_bf16 v[112:115], a[224:227], a[244:247], v[112:115]
  s_add_u32 s84, s22, 65536
  s_waitcnt lgkmcnt(4)
  v_mfma_f32_16x16x32_bf16 v[112:115], a[0:3], a[20:23], v[112:115]
  buffer_load_dwordx4 v16, s[52:55], s84 offen offset:0 lds
  v_mfma_f32_16x16x32_bf16 v[128:131], a[224:227], a[248:251], v[128:131]
  ds_read_b64_tr_b16 a[232:233], v202 offset:32768
  ds_read_b64_tr_b16 a[234:235], v202 offset:36864
  v_mfma_f32_16x16x32_bf16 v[128:131], a[0:3], a[24:27], v[128:131]
  ds_read_b64_tr_b16 a[8:9], v202 offset:16384
  ds_read_b64_tr_b16 a[10:11], v202 offset:20480
  v_mfma_f32_16x16x32_bf16 v[144:147], a[224:227], a[252:255], v[144:147]
  s_waitcnt lgkmcnt(4)
  v_mfma_f32_16x16x32_bf16 v[144:147], a[0:3], a[28:31], v[144:147]
  buffer_load_dwordx4 v15, s[52:55], s84 offen offset:1024 lds
  v_mfma_f32_16x16x32_bf16 v[100:103], a[228:231], a[240:243], v[100:103]
  ds_read_b64_tr_b16 a[236:237], v203 offset:32768
  ds_read_b64_tr_b16 a[238:239], v203 offset:36864
  v_mfma_f32_16x16x32_bf16 v[100:103], a[4:7], a[16:19], v[100:103]
  ds_read_b64_tr_b16 a[12:13], v203 offset:16384
  ds_read_b64_tr_b16 a[14:15], v203 offset:20480
  v_mfma_f32_16x16x32_bf16 v[116:119], a[228:231], a[244:247], v[116:119]
  s_add_u32 s85, s14, 2048
  v_mfma_f32_16x16x32_bf16 v[116:119], a[4:7], a[20:23], v[116:119]
  buffer_load_dwordx4 v24, s[68:71], s85 offen offset:2048 sc1 lds
  v_mfma_f32_16x16x32_bf16 v[132:135], a[228:231], a[248:251], v[132:135]
  v_mfma_f32_16x16x32_bf16 v[132:135], a[4:7], a[24:27], v[132:135]
  v_mfma_f32_16x16x32_bf16 v[148:151], a[228:231], a[252:255], v[148:151]
  buffer_load_dwordx4 v25, s[68:71], s85 offen offset:3072 sc1 lds
  v_mfma_f32_16x16x32_bf16 v[148:151], a[4:7], a[28:31], v[148:151]
  s_waitcnt lgkmcnt(0)
  v_mfma_f32_16x16x32_bf16 v[104:107], a[232:235], a[240:243], v[104:107]
  s_waitcnt vmcnt(20)
  s_barrier
  v_mfma_f32_16x16x32_bf16 v[104:107], a[8:11], a[16:19], v[104:107]
  s_add_u32 m0, s88, 65536
  ds_read_b64_tr_b16 a[32:33], v196 offset:0
  ds_read_b64_tr_b16 a[34:35], v196 offset:4096
  v_mfma_f32_16x16x32_bf16 v[120:123], a[232:235], a[244:247], v[120:123]
  s_add_u32 s84, s22, 98304
  ds_read_b64_tr_b16 a[64:65], v200 offset:49152
  ds_read_b64_tr_b16 a[66:67], v200 offset:53248
  v_mfma_f32_16x16x32_bf16 v[120:123], a[8:11], a[20:23], v[120:123]
  buffer_load_dwordx4 v16, s[52:55], s84 offen offset:0 lds
  v_mfma_f32_16x16x32_bf16 v[136:139], a[232:235], a[248:251], v[136:139]
  ds_read_b128 a[48:51], v192 offset:0
  v_mfma_f32_16x16x32_bf16 v[136:139], a[8:11], a[24:27], v[136:139]
  ds_read_b128 a[80:83], v193 offset:49152
  v_mfma_f32_16x16x32_bf16 v[152:155], a[232:235], a[252:255], v[152:155]
  ds_read_b128 a[52:55], v192 offset:1024
  v_mfma_f32_16x16x32_bf16 v[152:155], a[8:11], a[28:31], v[152:155]
  buffer_load_dwordx4 v15, s[52:55], s84 offen offset:1024 lds
  v_mfma_f32_16x16x32_bf16 v[108:111], a[236:239], a[240:243], v[108:111]
  ds_read_b128 a[84:87], v193 offset:50176
  v_mfma_f32_16x16x32_bf16 v[108:111], a[12:15], a[16:19], v[108:111]
  ds_read_b128 a[56:59], v192 offset:4096
  v_mfma_f32_16x16x32_bf16 v[124:127], a[236:239], a[244:247], v[124:127]
  s_add_u32 s85, s14, 3072
  ds_read_b128 a[88:91], v193 offset:53248
  v_mfma_f32_16x16x32_bf16 v[124:127], a[12:15], a[20:23], v[124:127]
  buffer_load_dwordx4 v24, s[68:71], s85 offen offset:2048 sc1 lds
  v_mfma_f32_16x16x32_bf16 v[140:143], a[236:239], a[248:251], v[140:143]
  ds_read_b128 a[60:63], v192 offset:5120
  v_mfma_f32_16x16x32_bf16 v[140:143], a[12:15], a[24:27], v[140:143]
  ds_read_b128 a[92:95], v193 offset:54272
  v_mfma_f32_16x16x32_bf16 v[156:159], a[236:239], a[252:255], v[156:159]
  buffer_load_dwordx4 v25, s[68:71], s85 offen offset:3072 sc1 lds
  v_mfma_f32_16x16x32_bf16 v[156:159], a[12:15], a[28:31], v[156:159]
  s_waitcnt lgkmcnt(4)
  v_mfma_f32_16x16x32_bf16 v[96:99], a[32:35], a[48:51], v[96:99]
  ds_read_b64_tr_b16 a[36:37], v197 offset:0
  ds_read_b64_tr_b16 a[38:39], v197 offset:4096
  v_mfma_f32_16x16x32_bf16 v[96:99], a[64:67], a[80:83], v[96:99]
  s_add_u32 m0, s88, 98304
  ds_read_b64_tr_b16 a[68:69], v201 offset:49152
  ds_read_b64_tr_b16 a[70:71], v201 offset:53248
  v_mfma_f32_16x16x32_bf16 v[112:115], a[32:35], a[52:55], v[112:115]
  s_add_u32 s84, s23, 0
  s_waitcnt lgkmcnt(4)
  v_mfma_f32_16x16x32_bf16 v[112:115], a[64:67], a[84:87], v[112:115]
  buffer_load_dwordx4 v16, s[52:55], s84 offen offset:0 lds
  v_mfma_f32_16x16x32_bf16 v[128:131], a[32:35], a[56:59], v[128:131]
  ds_read_b64_tr_b16 a[40:41], v198 offset:0
  ds_read_b64_tr_b16 a[42:43], v198 offset:4096
  v_mfma_f32_16x16x32_bf16 v[128:131], a[64:67], a[88:91], v[128:131]
  ds_read_b64_tr_b16 a[72:73], v202 offset:49152
  ds_read_b64_tr_b16 a[74:75], v202 offset:53248
  v_mfma_f32_16x16x32_bf16 v[144:147], a[32:35], a[60:63], v[144:147]
  s_waitcnt lgkmcnt(4)
  v_mfma_f32_16x16x32_bf16 v[144:147], a[64:67], a[92:95], v[144:147]
  buffer_load_dwordx4 v15, s[52:55], s84 offen offset:1024 lds
  v_mfma_f32_16x16x32_bf16 v[100:103], a[36:39], a[48:51], v[100:103]
  ds_read_b64_tr_b16 a[44:45], v199 offset:0
  ds_read_b64_tr_b16 a[46:47], v199 offset:4096
  v_mfma_f32_16x16x32_bf16 v[100:103], a[68:71], a[80:83], v[100:103]
  ds_read_b64_tr_b16 a[76:77], v203 offset:49152
  ds_read_b64_tr_b16 a[78:79], v203 offset:53248
  v_mfma_f32_16x16x32_bf16 v[116:119], a[36:39], a[52:55], v[116:119]
  s_bitcmp1_b32 s42, 3
  s_cbranch_scc0 L_e3_spin
L_e3_ok:
  s_add_u32 s85, s15, 0
  v_mfma_f32_16x16x32_bf16 v[116:119], a[68:71], a[84:87], v[116:119]
  buffer_load_dwordx4 v24, s[68:71], s85 offen offset:2048 sc1 lds
  v_mfma_f32_16x16x32_bf16 v[132:135], a[36:39], a[56:59], v[132:135]
  v_mfma_f32_16x16x32_bf16 v[132:135], a[68:71], a[88:91], v[132:135]
  v_mfma_f32_16x16x32_bf16 v[148:151], a[36:39], a[60:63], v[148:151]
  buffer_load_dwordx4 v25, s[68:71], s85 offen offset:3072 sc1 lds
  v_mfma_f32_16x16x32_bf16 v[148:151], a[68:71], a[92:95], v[148:151]
  buffer_load_dword v13, v28, s[68:71], s89 offen sc1
  s_waitcnt lgkmcnt(0)
  v_mfma_f32_16x16x32_bf16 v[104:107], a[40:43], a[48:51], v[104:107]
  s_waitcnt vmcnt(21)
  s_barrier
  v_mfma_f32_16x16x32_bf16 v[104:107], a[72:75], a[80:83], v[104:107]
  s_add_u32 m0, s88, 81920
  ds_read_b64_tr_b16 a[96:97], v196 offset:32768
  ds_read_b64_tr_b16 a[98:99], v196 offset:36864
  v_mfma_f32_16x16x32_bf16 v[120:123], a[40:43], a[52:55], v[120:123]
  s_add_u32 s84, s23, 32768
  ds_read_b64_tr_b16 a[128:129], v196 offset:16384
  ds_read_b64_tr_b16 a[130:131], v196 offset:20480
  v_mfma_f32_16x16x32_bf16 v[120:123], a[72:75], a[84:87], v[120:123]
  buffer_load_dwordx4 v16, s[52:55], s84 offen offset:0 lds
  v_mfma_f32_16x16x32_bf16 v[136:139], a[40:43], a[56:59], v[136:139]
  ds_read_b128 a[112:115], v192 offset:32768
  v_mfma_f32_16x16x32_bf16 v[136:139], a[72:75], a[88:91], v[136:139]
  ds_read_b128 a[144:147], v192 offset:16384
  v_mfma_f32_16x16x32_bf16 v[152:155], a[40:43], a[60:63], v[152:155]
  ds_read_b128 a[116:119], v192 offset:33792
  v_mfma_f32_16x16x32_bf16 v[152:155], a[72:75], a[92:95], v[152:155]
  buffer_load_dwordx4 v15, s[52:55], s84 offen offset:1024 lds
  v_mfma_f32_16x16x32_bf16 v[108:111], a[44:47], a[48:51], v[108:111]
  ds_read_b128 a[148:151], v192 offset:17408
  v_mfma_f32_16x16x32_bf16 v[108:111], a[76:79], a[80:83], v[108:111]
  ds_read_b128 a[120:123], v192 offset:36864
  v_mfma_f32_16x16x32_bf16 v[124:127], a[44:47], a[52:55], v[124:127]
  s_add_u32 s85, s15, 1024
  ds_read_b128 a[152:155], v192 offset:20480
  v_mfma_f32_16x16x32_bf16 v[124:127], a[76:79], a[84:87], v[124:127]
  buffer_load_dwordx4 v24, s[68:71], s85 offen offset:2048 sc1 lds
  v_mfma_f32_16x16x32_bf16 v[140:143], a[44:47], a[56:59], v[140:143]
  ds_read_b128 a[124:127], v192 offset:37888
  v_mfma_f32_16x16x32_bf16 v[140:143], a[76:79], a[88:91], v[140:143]
  ds_read_b128 a[156:159], v192 offset:21504
  v_mfma_f32_16x16x32_bf16 v[156:159], a[44:47], a[60:63], v[156:159]
  buffer_load_dwordx4 v25, s[68:71], s85 offen offset:3072 sc1 lds
  v_mfma_f32_16x16x32_bf16 v[156:159], a[76:79], a[92:95], v[156:159]
  s_waitcnt lgkmcnt(4)
  v_mfma_f32_16x16x32_bf16 v[96:99], a[96:99], a[112:115], v[96:99]
  ds_read_b64_tr_b16 a[100:101], v197 offset:32768
  ds_read_b64_tr_b16 a[102:103], v197 offset:36864
  v_mfma_f32_16x16x32_bf16 v[96:99], a[128:131], a[144:147], v[96:99]
  s_add_u32 m0, s88, 0
  ds_read_b64_tr_b16 a[132:133], v197 offset:16384
  ds_read_b64_tr_b16 a[134:135], v197 offset:20480
  v_mfma_f32_16x16x32_bf16 v[112:115], a[96:99], a[116:119], v[112:115]
  s_add_u32 s84, s23, 65536
  s_waitcnt lgkmcnt(4)
  v_mfma_f32_16x16x32_bf16 v[112:115], a[128:131], a[148:151], v[112:115]
  buffer_load_dwordx4 v16, s[52:55], s84 offen offset:0 lds
  v_mfma_f32_16x16x32_bf16 v[128:131], a[96:99], a[120:123], v[128:131]
  ds_read_b64_tr_b16 a[104:105], v198 offset:32768
  ds_read_b64_tr_b16 a[106:107], v198 offset:36864
  v_mfma_f32_16x16x32_bf16 v[128:131], a[128:131], a[152:155], v[128:131]
  ds_read_b64_tr_b16 a[136:137], v198 offset:16384
  ds_read_b64_tr_b16 a[138:139], v198 offset:20480
  v_mfma_f32_16x16x32_bf16 v[144:147], a[96:99], a[124:127], v[144:147]
  s_waitcnt lgkmcnt(4)
  v_mfma_f32_16x16x32_bf16 v[144:147], a[128:131], a[156:159], v[144:147]
  buffer_load_dwordx4 v15, s[52:55], s84 offen offset:1024 lds
  v_mfma_f32_16x16x32_bf16 v[100:103], a[100:103], a[112:115], v[100:103]
  ds_read_b64_tr_b16 a[108:109], v199 offset:32768
  ds_read_b64_tr_b16 a[110:111], v199 offset:36864
  v_mfma_f32_16x16x32_bf16 v[100:103], a[132:135], a[144:147], v[100:103]
  ds_read_b64_tr_b16 a[140:141], v199 offset:16384
  ds_read_b64_tr_b16 a[142:143], v199 offset:20480
  v_mfma_f32_16x16x32_bf16 v[116:119], a[100:103], a[116:119], v[116:119]
  s_add_u32 s85, s15, 2048
  v_mfma_f32_16x16x32_bf16 v[116:119], a[132:135], a[148:151], v[116:119]
  buffer_load_dwordx4 v24, s[68:71], s85 offen offset:2048 sc1 lds
  v_mfma_f32_16x16x32_bf16 v[132:135], a[100:103], a[120:123], v[132:135]
  v_mfma_f32_16x16x32_bf16 v[132:135], a[132:135], a[152:155], v[132:135]
  v_mfma_f32_16x16x32_bf16 v[148:151], a[100:103], a[124:127], v[148:151]
  buffer_load_dwordx4 v25, s[68:71], s85 offen offset:3072 sc1 lds
  v_mfma_f32_16x16x32_bf16 v[148:151], a[132:135], a[156:159], v[148:151]
  s_waitcnt lgkmcnt(0)
  v_mfma_f32_16x16x32_bf16 v[104:107], a[104:107], a[112:115], v[104:107]
  s_waitcnt vmcnt(21)
  s_barrier
  v_mfma_f32_16x16x32_bf16 v[104:107], a[136:139], a[144:147], v[104:107]
  s_add_u32 m0, s88, 114688
  ds_read_b64_tr_b16 a[160:161], v196 offset:49152
  ds_read_b64_tr_b16 a[162:163], v196 offset:53248
  v_mfma_f32_16x16x32_bf16 v[120:123], a[104:107], a[116:119], v[120:123]
  s_add_u32 s84, s23, 98304
  ds_read_b64_tr_b16 a[192:193], v204 offset:0
  ds_read_b64_tr_b16 a[194:195], v204 offset:4096
  v_mfma_f32_16x16x32_bf16 v[120:123], a[136:139], a[148:151], v[120:123]
  buffer_load_dwordx4 v16, s[52:55], s84 offen offset:0 lds
  v_mfma_f32_16x16x32_bf16 v[136:139], a[104:107], a[120:123], v[136:139]
  ds_read_b128 a[176:179], v192 offset:49152
  v_mfma_f32_16x16x32_bf16 v[136:139], a[136:139], a[152:155], v[136:139]
L_hop16:
  s_cbranch_execz L_ret2
  ds_read_b128 a[208:211], v194 offset:0
  v_mfma_f32_16x16x32_bf16 v[152:155], a[104:107], a[124:127], v[152:155]
  ds_read_b128 a[180:183], v192 offset:50176
  v_mfma_f32_16x16x32_bf16 v[152:155], a[136:139], a[156:159], v[152:155]
  buffer_load_dwordx4 v15, s[52:55], s84 offen offset:1024 lds
  v_mfma_f32_16x16x32_bf16 v[108:111], a[108:111], a[112:115], v[108:111]
  ds_read_b128 a[212:215], v194 offset:1024
  v_mfma_f32_16x16x32_bf16 v[108:111], a[140:143], a[144:147], v[108:111]
  ds_read_b128 a[184:187], v192 offset:53248
  v_mfma_f32_16x16x32_bf16 v[124:127], a[108:111], a[116:119], v[124:127]
  s_add_u32 s85, s15, 3072
  ds_read_b128 a[216:219], v194 offset:4096
  v_mfma_f32_16x16x32_bf16 v[124:127], a[140:143], a[148:151], v[124:127]
  buffer_load_dwordx4 v24, s[68:71], s85 offen offset:2048 sc1 lds
  v_mfma_f32_16x16x32_bf16 v[140:143], a[108:111], a[120:123], v[140:143]
  ds_read_b128 a[188:191], v192 offset:54272
  v_mfma_f32_16x16x32_bf16 v[140:143], a[140:143], a[152:155], v[140:143]
  ds_read_b128 a[220:223], v194 offset:5120
  v_mfma_f32_16x16x32_bf16 v[156:159], a[108:111], a[124:127], v[156:159]
  buffer_load_dwordx4 v25, s[68:71], s85 offen offset:3072 sc1 lds
  v_mfma_f32_16x16x32_bf16 v[156:159], a[140:143], a[156:159], v[156:159]
  s_waitcnt vmcnt(12)
  v_cmp_eq_u32 vcc, 1, v13
  s_nop 0
  s_mov_b32 s42, vcc_lo
  s_waitcnt lgkmcnt(4)
  v_mfma_f32_16x16x32_bf16 v[96:99], a[160:163], a[176:179], v[96:99]
  ds_read_b64_tr_b16 a[164:165], v197 offset:49152
  ds_read_b64_tr_b16 a[166:167], v197 offset:53248
  v_mfma_f32_16x16x32_bf16 v[96:99], a[192:195], a[208:211], v[96:99]
  s_add_u32 m0, s88, 32768
  ds_read_b64_tr_b16 a[196:197], v205 offset:0
  ds_read_b64_tr_b16 a[198:199], v205 offset:4096
  v_mfma_f32_16x16x32_bf16 v[112:115], a[160:163], a[180:183], v[112:115]
  s_add_u32 s84, s24, 0
  s_waitcnt lgkmcnt(4)
  v_mfma_f32_16x16x32_bf16 v[112:115], a[192:195], a[212:215], v[112:115]
  buffer_load_dwordx4 v16, s[52:55], s84 offen offset:0 lds
  v_mfma_f32_16x16x32_bf16 v[128:131], a[160:163], a[184:187], v[128:131]
  ds_read_b64_tr_b16 a[168:169], v198 offset:49152
  ds_read_b64_tr_b16 a[170:171], v198 offset:53248
  v_mfma_f32_16x16x32_bf16 v[128:131], a[192:195], a[216:219], v[128:131]
  ds_read_b64_tr_b16 a[200:201], v206 offset:0
  ds_read_b64_tr_b16 a[202:203], v206 offset:4096
  v_mfma_f32_16x16x32_bf16 v[144:147], a[160:163], a[188:191], v[144:147]
  s_waitcnt lgkmcnt(4)
  v_mfma_f32_16x16x32_bf16 v[144:147], a[192:195], a[220:223], v[144:147]
  buffer_load_dwordx4 v15, s[52:55], s84 offen offset:1024 lds
  v_mfma_f32_16x16x32_bf16 v[100:103], a[164:167], a[176:179], v[100:103]
  ds_read_b64_tr_b16 a[172:173], v199 offset:49152
  ds_read_b64_tr_b16 a[174:175], v199 offset:53248
  v_mfma_f32_16x16x32_bf16 v[100:103], a[196:199], a[208:211], v[100:103]
  ds_read_b64_tr_b16 a[204:205], v207 offset:0
  ds_read_b64_tr_b16 a[206:207], v207 offset:4096
  v_mfma_f32_16x16x32_bf16 v[116:119], a[164:167], a[180:183], v[116:119]
  s_bitcmp1_b32 s42, 4
  s_cbranch_scc0 L_e4_spin
L_e4_ok:
  s_add_u32 s85, s16, 0
  v_mfma_f32_16x16x32_bf16 v[116:119], a[196:199], a[212:215], v[116:119]
  buffer_load_dwordx4 v24, s[68:71], s85 offen offset:2048 sc1 lds
  v_mfma_f32_16x16x32_bf16 v[132:135], a[164:167], a[184:187], v[132:135]
  v_mfma_f32_16x16x32_bf16 v[132:135], a[196:199], a[216:219], v[132:135]
  v_mfma_f32_16x16x32_bf16 v[148:151], a[164:167], a[188:191], v[148:151]
  buffer_load_dwordx4 v25, s[68:71], s85 offen offset:3072 sc1 lds
  v_mfma_f32_16x16x32_bf16 v[148:151], a[196:199], a[220:223], v[148:151]
  s_waitcnt lgkmcnt(0)
  v_mfma_f32_16x16x32_bf16 v[104:107], a[168:171], a[176:179], v[104:107]
  s_waitcnt vmcnt(63)
  s_barrier
  v_mfma_f32_16x16x32_bf16 v[104:107], a[200:203], a[208:211], v[104:107]
  s_add_u32 m0, s88, 16384
  ds_read_b64_tr_b16 a[224:225], v204 offset:16384
  ds_read_b64_tr_b16 a[226:227], v204 offset:20480
  v_mfma_f32_16x16x32_bf16 v[120:123], a[168:171], a[180:183], v[120:123]
  s_add_u32 s84, s24, 32768
  ds_read_b64_tr_b16 a[0:1], v200 offset:0
  ds_read_b64_tr_b16 a[2:3], v200 offset:4096
  v_mfma_f32_16x16x32_bf16 v[120:123], a[200:203], a[212:215], v[120:123]
  buffer_load_dwordx4 v16, s[52:55], s84 offen offset:0 lds
  v_mfma_f32_16x16x32_bf16 v[136:139], a[168:171], a[184:187], v[136:139]
  ds_read_b128 a[240:243], v194 offset:16384
  v_mfma_f32_16x16x32_bf16 v[136:139], a[200:203], a[216:219], v[136:139]
  ds_read_b128 a[16:19], v193 offset:0
  v_mfma_f32_16x16x32_bf16 v[152:155], a[168:171], a[188:191], v[152:155]
  ds_read_b128 a[244:247], v194 offset:17408
  v_mfma_f32_16x16x32_bf16 v[152:155], a[200:203], a[220:223], v[152:155]
  buffer_load_dwordx4 v15, s[52:55], s84 offen offset:1024 lds
  v_mfma_f32_16x16x32_bf16 v[108:111], a[172:175], a[176:179], v[108:111]
  ds_read_b128 a[20:23], v193 offset:1024
  v_mfma_f32_16x16x32_bf16 v[108:111], a[204:207], a[208:211], v[108:111]
  ds_read_b128 a[248:251], v194 offset:20480
  v_mfma_f32_16x16x32_bf16 v[124:127], a[172:175], a[180:183], v[124:127]
  s_add_u32 s85, s16, 1024
  ds_read_b128 a[24:27], v193 offset:4096
  v_mfma_f32_16x16x32_bf16 v[124:127], a[204:207], a[212:215], v[124:127]
  buffer_load_dwordx4 v24, s[68:71], s85 offen offset:2048 sc1 lds
  v_mfma_f32_16x16x32_bf16 v[140:143], a[172:175], a[184:187], v[140:143]
  ds_read_b128 a[252:255], v194 offset:21504
  v_mfma_f32_16x16x32_bf16 v[140:143], a[204:207], a[216:219], v[140:143]
  ds_read_b128 a[28:31], v193 offset:5120
  v_mfma_f32_16x16x32_bf16 v[156:159], a[172:175], a[188:191], v[156:159]
  buffer_load_dwordx4 v25, s[68:71], s85 offen offset:3072 sc1 lds
  v_mfma_f32_16x16x32_bf16 v[156:159], a[204:207], a[220:223], v[156:159]
  s_waitcnt lgkmcnt(4)
  v_mfma_f32_16x16x32_bf16 v[96:99], a[224:227], a[240:243], v[96:99]
  ds_read_b64_tr_b16 a[228:229], v205 offset:16384
  ds_read_b64_tr_b16 a[230:231], v205 offset:20480
  v_mfma_f32_16x16x32_bf16 v[96:99], a[0:3], a[16:19], v[96:99]
  s_add_u32 m0, s88, 49152
  ds_read_b64_tr_b16 a[4:5], v201 offset:0
  ds_read_b64_tr_b16 a[6:7], v201 offset:4096
  v_mfma_f32_16x16x32_bf16 v[112:115], a[224:227], a[244:247], v[112:115]
  s_add_u32 s84, s24, 65536
  s_waitcnt lgkmcnt(4)
  v_mfma_f32_16x16x32_bf16 v[112:115], a[0:3], a[20:23], v[112:115]
  buffer_load_dwordx4 v16, s[52:55], s84 offen offset:0 lds
  v_mfma_f32_16x16x32_bf16 v[128:131], a[224:227], a[248:251], v[128:131]
  ds_read_b64_tr_b16 a[232:233], v206 offset:16384
  ds_read_b64_tr_b16 a[234:235], v206 offset:20480
  v_mfma_f32_16x16x32_bf16 v[128:131], a[0:3], a[24:27], v[128:131]
  ds_read_b64_tr_b16 a[8:9], v202 offset:0
  ds_read_b64_tr_b16 a[10:11], v202 offset:4096
  v_mfma_f32_16x16x32_bf16 v[144:147], a[224:227], a[252:255], v[144:147]
  s_waitcnt lgkmcnt(4)
  v_mfma_f32_16x16x32_bf16 v[144:147], a[0:3], a[28:31], v[144:147]
  buffer_load_dwordx4 v15, s[52:55], s84 offen offset:1024 lds
  v_mfma_f32_16x16x32_bf16 v[100:103], a[228:231], a[240:243], v[100:103]
  ds_read_b64_tr_b16 a[236:237], v207 offset:16384
  ds_read_b64_tr_b16 a[238:239], v207 offset:20480
  v_mfma_f32_16x16x32_bf16 v[100:103], a[4:7], a[16:19], v[100:103]
  ds_read_b64_tr_b16 a[12:13], v203 offset:0
  ds_read_b64_tr_b16 a[14:15], v203 offset:4096
  v_mfma_f32_16x16x32_bf16 v[116:119], a[228:231], a[244:247], v[116:119]
  s_add_u32 s85, s16, 2048
  v_mfma_f32_16x16x32_bf16 v[116:119], a[4:7], a[20:23], v[116:119]
  buffer_load_dwordx4 v24, s[68:71], s85 offen offset:2048 sc1 lds
  v_mfma_f32_16x16x32_bf16 v[132:135], a[228:231], a[248:251], v[132:135]
  v_mfma_f32_16x16x32_bf16 v[132:135], a[4:7], a[24:27], v[132:135]
  v_mfma_f32_16x16x32_bf16 v[148:151], a[228:231], a[252:255], v[148:151]
  buffer_load_dwordx4 v25, s[68:71], s85 offen offset:3072 sc1 lds
  v_mfma_f32_16x16x32_bf16 v[148:151], a[4:7], a[28:31], v[148:151]
  s_waitcnt lgkmcnt(0)
  v_mfma_f32_16x16x32_bf16 v[104:107], a[232:235], a[240:243], v[104:107]
  s_waitcnt vmcnt(20)
  s_barrier
  v_mfma_f32_16x16x32_bf16 v[104:107], a[8:11], a[16:19], v[104:107]
  s_add_u32 m0, s88, 131072
  ds_read_b64_tr_b16 a[32:33], v200 offset:32768
  ds_read_b64_tr_b16 a[34:35], v200 offset:36864
  v_mfma_f32_16x16x32_bf16 v[120:123], a[232:235], a[244:247], v[120:123]
  s_add_u32 s84, s24, 98304
  ds_read_b64_tr_b16 a[64:65], v200 offset:16384
  ds_read_b64_tr_b16 a[66:67], v200 offset:20480
  v_mfma_f32_16x16x32_bf16 v[120:123], a[8:11], a[20:23], v[120:123]
  buffer_load_dwordx4 v16, s[52:55], s84 offen offset:0 lds
  v_mfma_f32_16x16x32_bf16 v[136:139], a[232:235], a[248:251], v[136:139]
  ds_read_b128 a[48:51], v193 offset:32768
  v_mfma_f32_16x16x32_bf16 v[136:139], a[8:11], a[24:27], v[136:139]
  ds_read_b128 a[80:83], v193 offset:16384
  v_mfma_f32_16x16x32_bf16 v[152:155], a[232:235], a[252:255], v[152:155]
  ds_read_b128 a[52:55], v193 offset:33792
  v_mfma_f32_16x16x32_bf16 v[152:155], a[8:11], a[28:31], v[152:155]
  buffer_load_dwordx4 v15, s[52:55], s84 offen offset:1024 lds
  v_mfma_f32_16x16x32_bf16 v[108:111], a[236:239], a[240:243], v[108:111]
  ds_read_b128 a[84:87], v193 offset:17408
  v_mfma_f32_16x16x32_bf16 v[108:111], a[12:15], a[16:19], v[108:111]
  ds_read_b128 a[56:59], v193 offset:36864
  v_mfma_f32_16x16x32_bf16 v[124:127], a[236:239], a[244:247], v[124:127]
  s_add_u32 s85, s16, 3072
  ds_read_b128 a[88:91], v193 offset:20480
  v_mfma_f32_16x16x32_bf16 v[124:127], a[12:15], a[20:23], v[124:127]
  buffer_load_dwordx4 v24, s[68:71], s85 offen offset:2048 sc1 lds
  v_mfma_f32_16x16x32_bf16 v[140:143], a[236:239], a[248:251], v[140:143]
  ds_read_b128 a[60:63], v193 offset:37888
  v_mfma_f32_16x16x32_bf16 v[140:143], a[12:15], a[24:27], v[140:143]
  ds_read_b128 a[92:95], v193 offset:21504
  v_mfma_f32_16x16x32_bf16 v[156:159], a[236:239], a[252:255], v[156:159]
  buffer_load_dwordx4 v25, s[68:71], s85 offen offset:3072 sc1 lds
  v_mfma_f32_16x16x32_bf16 v[156:159], a[12:15], a[28:31], v[156:159]
  s_waitcnt lgkmcnt(4)
  v_mfma_f32_16x16x32_bf16 v[96:99], a[32:35], a[48:51], v[96:99]
  ds_read_b64_tr_b16 a[36:37], v201 offset:32768
  ds_read_b64_tr_b16 a[38:39], v201 offset:36864
  v_mfma_f32_16x16x32_bf16 v[96:99], a[64:67], a[80:83], v[96:99]
  s_add_u32 m0, s88, 147456
  ds_read_b64_tr_b16 a[68:69], v201 offset:16384
  ds_read_b64_tr_b16 a[70:71], v201 offset:20480
  v_mfma_f32_16x16x32_bf16 v[112:115], a[32:35], a[52:55], v[112:115]
  s_add_u32 s84, s25, 0
  s_waitcnt lgkmcnt(4)
  v_mfma_f32_16x16x32_bf16 v[112:115], a[64:67], a[84:87], v[112:115]
  buffer_load_dwordx4 v16, s[52:55], s84 offen offset:0 lds
  v_mfma_f32_16x16x32_bf16 v[128:131], a[32:35], a[56:59], v[128:131]
  ds_read_b64_tr_b16 a[40:41], v202 offset:32768
  ds_read_b64_tr_b16 a[42:43], v202 offset:36864
  v_mfma_f32_16x16x32_bf16 v[128:131], a[64:67], a[88:91], v[128:131]
  ds_read_b64_tr_b16 a[72:73], v202 offset:16384
  ds_read_b64_tr_b16 a[74:75], v202 offset:20480
  v_mfma_f32_16x16x32_bf16 v[144:147], a[32:35], a[60:63], v[144:147]
  s_waitcnt lgkmcnt(4)
  v_mfma_f32_16x16x32_bf16 v[144:147], a[64:67], a[92:95], v[144:147]
  buffer_load_dwordx4 v15, s[52:55], s84 offen offset:1024 lds
  v_mfma_f32_16x16x32_bf16 v[100:103], a[36:39], a[48:51], v[100:103]
  ds_read_b64_tr_b16 a[44:45], v203 offset:32768
  ds_read_b64_tr_b16 a[46:47], v203 offset:36864
  v_mfma_f32_16x16x32_bf16 v[100:103], a[68:71], a[80:83], v[100:103]
  ds_read_b64_tr_b16 a[76:77], v203 offset:16384
  ds_read_b64_tr_b16 a[78:79], v203 offset:20480
  v_mfma_f32_16x16x32_bf16 v[116:119], a[36:39], a[52:55], v[116:119]
  s_bitcmp1_b32 s42, 5
  s_cbranch_scc0 L_e5_spin
L_e5_ok:
  s_add_u32 s85, s17, 0
  v_mfma_f32_16x16x32_bf16 v[116:119], a[68:71], a[84:87], v[116:119]
  buffer_load_dwordx4 v24, s[68:71], s85 offen offset:2048 sc1 lds
  v_mfma_f32_16x16x32_bf16 v[132:135], a[36:39], a[56:59], v[132:135]
  v_mfma_f32_16x16x32_bf16 v[132:135], a[68:71], a[88:91], v[132:135]
  v_mfma_f32_16x16x32_bf16 v[148:151], a[36:39], a[60:63], v[148:151]
  buffer_load_dwordx4 v25, s[68:71], s85 offen offset:3072 sc1 lds
  v_mfma_f32_16x16x32_bf16 v[148:151], a[68:71], a[92:95], v[148:151]
  s_waitcnt lgkmcnt(0)
  v_mfma_f32_16x16x32_bf16 v[104:107], a[40:43], a[48:51], v[104:107]
  s_waitcnt vmcnt(20)
  s_barrier
  v_mfma_f32_16x16x32_bf16 v[104:107], a[72:75], a[80:83], v[104:107]
  s_add_u32 m0, s88, 65536
  ds_read_b64_tr_b16 a[96:97], v196 offset:0
  ds_read_b64_tr_b16 a[98:99], v196 offset:4096
  v_mfma_f32_16x16x32_bf16 v[120:123], a[40:43], a[52:55], v[120:123]
  s_add_u32 s84, s25, 32768
  ds_read_b64_tr_b16 a[128:129], v200 offset:49152
  ds_read_b64_tr_b16 a[130:131], v200 offset:53248
  v_mfma_f32_16x16x32_bf16 v[120:123], a[72:75], a[84:87], v[120:123]
  buffer_load_dwordx4 v16, s[52:55], s84 offen offset:0 lds
  v_mfma_f32_16x16x32_bf16 v[136:139], a[40:43], a[56:59], v[136:139]
  ds_read_b128 a[112:115], v192 offset:0
  v_mfma_f32_16x16x32_bf16 v[136:139], a[72:75], a[88:91], v[136:139]
  ds_read_b128 a[144:147], v193 offset:49152
  v_mfma_f32_16x16x32_bf16 v[152:155], a[40:43], a[60:63], v[152:155]
  ds_read_b128 a[116:119], v192 offset:1024
  v_mfma_f32_16x16x32_bf16 v[152:155], a[72:75], a[92:95], v[152:155]
  buffer_load_dwordx4 v15, s[52:55], s84 offen offset:1024 lds
  v_mfma_f32_16x16x32_bf16 v[108:111], a[44:47], a[48:51], v[108:111]
  ds_read_b128 a[148:151], v193 offset:50176
  v_mfma_f32_16x16x32_bf16 v[108:111], a[76:79], a[80:83], v[108:111]
  ds_read_b128 a[120:123], v192 offset:4096
  v_mfma_f32_16x16x32_bf16 v[124:127], a[44:47], a[52:55], v[124:127]
  s_add_u32 s85, s17, 1024
  ds_read_b128 a[152:155], v193 offset:53248
  v_mfma_f32_16x16x32_bf16 v[124:127], a[76:79], a[84:87], v[124:127]
  buffer_load_dwordx4 v24, s[68:71], s85 offen offset:2048 sc1 lds
  v_mfma_f32_16x16x32_bf16 v[140:143], a[44:47], a[56:59], v[140:143]
  ds_read_b128 a[124:127], v192 offset:5120
  v_mfma_f32_16x16x32_bf16 v[140:143], a[76:79], a[88:91], v[140:143]
  ds_read_b128 a[156:159], v193 offset:54272
  v_mfma_f32_16x16x32_bf16 v[156:159], a[44:47], a[60:63], v[156:159]
  buffer_load_dwordx4 v25, s[68:71], s85 offen offset:3072 sc1 lds
  v_mfma_f32_16x16x32_bf16 v[156:159], a[76:79], a[92:95], v[156:159]
  s_waitcnt lgkmcnt(4)
  v_mfma_f32_16x16x32_bf16 v[96:99], a[96:99], a[112:115], v[96:99]
  ds_read_b64_tr_b16 a[100:101], v197 offset:0
  ds_read_b64_tr_b16 a[102:103], v197 offset:4096
  v_mfma_f32_16x16x32_bf16 v[96:99], a[128:131], a[144:147], v[96:99]
  s_add_u32 m0, s88, 98304
  ds_read_b64_tr_b16 a[132:133], v201 offset:49152
  ds_read_b64_tr_b16 a[134:135], v201 offset:53248
  v_mfma_f32_16x16x32_bf16 v[112:115], a[96:99], a[116:119], v[112:115]
  s_add_u32 s84, s25, 65536
  s_waitcnt lgkmcnt(4)
  v_mfma_f32_16x16x32_bf16 v[112:115], a[128:131], a[148:151], v[112:115]
  buffer_load_dwordx4 v16, s[52:55], s84 offen offset:0 lds
  v_mfma_f32_16x16x32_bf16 v[128:131], a[96:99], a[120:123], v[128:131]
  ds_read_b64_tr_b16 a[104:105], v198 offset:0
  ds_read_b64_tr_b16 a[106:107], v198 offset:4096
  v_mfma_f32_16x16x32_bf16 v[128:131], a[128:131], a[152:155], v[128:131]
  ds_read_b64_tr_b16 a[136:137], v202 offset:49152
  ds_read_b64_tr_b16 a[138:139], v202 offset:53248
  v_mfma_f32_16x16x32_bf16 v[144:147], a[96:99], a[124:127], v[144:147]
  s_waitcnt lgkmcnt(4)
  v_mfma_f32_16x16x32_bf16 v[144:147], a[128:131], a[156:159], v[144:147]
  buffer_load_dwordx4 v15, s[52:55], s84 offen offset:1024 lds
  v_mfma_f32_16x16x32_bf16 v[100:103], a[100:103], a[112:115], v[100:103]
  ds_read_b64_tr_b16 a[108:109], v199 offset:0
  ds_read_b64_tr_b16 a[110:111], v199 offset:4096
  v_mfma_f32_16x16x32_bf16 v[100:103], a[132:135], a[144:147], v[100:103]
  ds_read_b64_tr_b16 a[140:141], v203 offset:49152
  ds_read_b64_tr_b16 a[142:143], v203 offset:53248
  v_mfma_f32_16x16x32_bf16 v[116:119], a[100:103], a[116:119], v[116:119]
  s_add_u32 s85, s17, 2048
  v_mfma_f32_16x16x32_bf16 v[116:119], a[132:135], a[148:151], v[116:119]
  buffer_load_dwordx4 v24, s[68:71], s85 offen offset:2048 sc1 lds
  v_mfma_f32_16x16x32_bf16 v[132:135], a[100:103], a[120:123], v[132:135]
  v_mfma_f32_16x16x32_bf16 v[132:135], a[132:135], a[152:155], v[132:135]
  v_mfma_f32_16x16x32_bf16 v[148:151], a[100:103], a[124:127], v[148:151]
  buffer_load_dwordx4 v25, s[68:71], s85 offen offset:3072 sc1 lds
  v_mfma_f32_16x16x32_bf16 v[148:151], a[132:135], a[156:159], v[148:151]
  s_waitcnt lgkmcnt(0)
  v_mfma_f32_16x16x32_bf16 v[104:107], a[104:107], a[112:115], v[104:107]
  s_waitcnt vmcnt(20)
  s_barrier
  v_mfma_f32_16x16x32_bf16 v[104:107], a[136:139], a[144:147], v[104:107]
  s_add_u32 m0, s88, 81920
  ds_read_b64_tr_b16 a[160:161], v196 offset:32768
  ds_read_b64_tr_b16 a[162:163], v196 offset:36864
  v_mfma_f32_16x16x32_bf16 v[120:123], a[104:107], a[116:119], v[120:123]
  s_add_u32 s84, s25, 98304
  ds_read_b64_tr_b16 a[192:193], v196 offset:16384
  ds_read_b64_tr_b16 a[194:195], v196 offset:20480
  v_mfma_f32_16x16x32_bf16 v[120:123], a[136:139], a[148:151], v[120:123]
  buffer_load_dwordx4 v16, s[52:55], s84 offen offset:0 lds
  v_mfma_f32_16x16x32_bf16 v[136:139], a[104:107], a[120:123], v[136:139]
  ds_read_b128 a[176:179], v192 offset:32768
  v_mfma_f32_16x16x32_bf16 v[136:139], a[136:139], a[152:155], v[136:139]
  ds_read_b128 a[208:211], v192 offset:16384
  v_mfma_f32_16x16x32_bf16 v[152:155], a[104:107], a[124:127], v[152:155]
  ds_read_b128 a[180:183], v192 offset:33792
  v_mfma_f32_16x16x32_bf16 v[152:155], a[136:139], a[156:159], v[152:155]
  buffer_load_dwordx4 v15, s[52:55], s84 offen offset:1024 lds
  v_mfma_f32_16x16x32_bf16 v[108:111], a[108:111], a[112:115], v[108:111]
  ds_read_b128 a[212:215], v192 offset:17408
  v_mfma_f32_16x16x32_bf16 v[108:111], a[140:143], a[144:147], v[108:111]
  ds_read_b128 a[184:187], v192 offset:36864
  v_mfma_f32_16x16x32_bf16 v[124:127], a[108:111], a[116:119], v[124:127]
  s_add_u32 s85, s17, 3072
  ds_read_b128 a[216:219], v192 offset:20480
  v_mfma_f32_16x16x32_bf16 v[124:127], a[140:143], a[148:151], v[124:127]
  buffer_load_dwordx4 v24, s[68:71], s85 offen offset:2048 sc1 lds
  v_mfma_f32_16x16x32_bf16 v[140:143], a[108:111], a[120:123], v[140:143]
  ds_read_b128 a[188:191], v192 offset:37888
  v_mfma_f32_16x16x32_bf16 v[140:143], a[140:143], a[152:155], v[140:143]
  ds_read_b128 a[220:223], v192 offset:21504
  v_mfma_f32_16x16x32_bf16 v[156:159], a[108:111], a[124:127], v[156:159]
  buffer_load_dwordx4 v25, s[68:71], s85 offen offset:3072 sc1 lds
  v_mfma_f32_16x16x32_bf16 v[156:159], a[140:143], a[156:159], v[156:159]
  s_waitcnt lgkmcnt(4)
  v_mfma_f32_16x16x32_bf16 v[96:99], a[160:163], a[176:179], v[96:99]
  ds_read_b64_tr_b16 a[164:165], v197 offset:32768
  ds_read_b64_tr_b16 a[166:167], v197 offset:36864
  v_mfma_f32_16x16x32_bf16 v[96:99], a[192:195], a[208:211], v[96:99]
  s_add_u32 m0, s88, 0
  ds_read_b64_tr_b16 a[196:197], v197 offset:16384
  ds_read_b64_tr_b16 a[198:199], v197 offset:20480
  v_mfma_f32_16x16x32_bf16 v[112:115], a[160:163], a[180:183], v[112:115]
  s_add_u32 s84, s26, 0
  s_waitcnt lgkmcnt(4)
  v_mfma_f32_16x16x32_bf16 v[112:115], a[192:195], a[212:215], v[112:115]
  buffer_load_dwordx4 v16, s[52:55], s84 offen offset:0 lds
  v_mfma_f32_16x16x32_bf16 v[128:131], a[160:163], a[184:187], v[128:131]
  ds_read_b64_tr_b16 a[168:169], v198 offset:32768
  ds_read_b64_tr_b16 a[170:171], v198 offset:36864
  v_mfma_f32_16x16x32_bf16 v[128:131], a[192:195], a[216:219], v[128:131]
  ds_read_b64_tr_b16 a[200:201], v198 offset:16384
  ds_read_b64_tr_b16 a[202:203], v198 offset:20480
  v_mfma_f32_16x16x32_bf16 v[144:147], a[160:163], a[188:191], v[144:147]
  s_waitcnt lgkmcnt(4)
  v_mfma_f32_16x16x32_bf16 v[144:147], a[192:195], a[220:223], v[144:147]
  buffer_load_dwordx4 v15, s[52:55], s84 offen offset:1024 lds
  v_mfma_f32_16x16x32_bf16 v[100:103], a[164:167], a[176:179], v[100:103]
  ds_read_b64_tr_b16 a[172:173], v199 offset:32768
  ds_read_b64_tr_b16 a[174:175], v199 offset:36864
  v_mfma_f32_16x16x32_bf16 v[100:103], a[196:199], a[208:211], v[100:103]
  ds_read_b64_tr_b16 a[204:205], v199 offset:16384
  ds_read_b64_tr_b16 a[206:207], v199 offset:20480
  v_mfma_f32_16x16x32_bf16 v[116:119], a[164:167], a[180:183], v[116:119]
  s_bitcmp1_b32 s42, 6
  s_cbranch_scc0 L_e6_spin
L_e6_ok:
  s_add_u32 s85, s18, 0
  v_mfma_f32_16x16x32_bf16 v[116:119], a[196:199], a[212:215], v[116:119]
  buffer_load_dwordx4 v24, s[68:71], s85 offen offset:2048 sc1 lds
  v_mfma_f32_16x16x32_bf16 v[132:135], a[164:167], a[184:187], v[132:135]
  v_mfma_f32_16x16x32_bf16 v[132:135], a[196:199], a[216:219], v[132:135]
  v_mfma_f32_16x16x32_bf16 v[148:151], a[164:167], a[188:191], v[148:151]
  buffer_load_dwordx4 v25, s[68:71], s85 offen offset:3072 sc1 lds
  v_mfma_f32_16x16x32_bf16 v[148:151], a[196:199], a[220:223], v[148:151]
  buffer_load_dword v13, v28, s[68:71], s89 offen sc1
  s_waitcnt lgkmcnt(0)
  v_mfma_f32_16x16x32_bf16 v[104:107], a[168:171], a[176:179], v[104:107]
  s_waitcnt vmcnt(21)
  s_barrier
  v_mfma_f32_16x16x32_bf16 v[104:107], a[200:203], a[208:211], v[104:107]
  s_add_u32 m0, s88, 114688
  ds_read_b64_tr_b16 a[224:225], v196 offset:49152
  ds_read_b64_tr_b16 a[226:227], v196 offset:53248
  v_mfma_f32_16x16x32_bf16 v[120:123], a[168:171], a[180:183], v[120:123]
  s_add_u32 s84, s26, 32768
  ds_read_b64_tr_b16 a[0:1], v204 offset:0
  ds_read_b64_tr_b16 a[2:3], v204 offset:4096
  v_mfma_f32_16x16x32_bf16 v[120:123], a[200:203], a[212:215], v[120:123]
  buffer_load_dwordx4 v16, s[52:55], s84 offen offset:0 lds
  v_mfma_f32_16x16x32_bf16 v[136:139], a[168:171], a[184:187], v[136:139]
  ds_read_b128 a[240:243], v192 offset:49152
  v_mfma_f32_16x16x32_bf16 v[136:139], a[200:203], a[216:219], v[136:139]
  ds_read_b128 a[16:19], v194 offset:0
  v_mfma_f32_16x16x32_bf16 v[152:155], a[168:171], a[188:191], v[152:155]
  ds_read_b128 a[244:247], v192 offset:50176
  v_mfma_f32_16x16x32_bf16 v[152:155], a[200:203], a[220:223], v[152:155]
  buffer_load_dwordx4 v15, s[52:55], s84 offen offset:1024 lds
  v_mfma_f32_16x16x32_bf16 v[108:111], a[172:175], a[176:179], v[108:111]
  ds_read_b128 a[20:23], v194 offset:1024
  v_mfma_f32_16x16x32_bf16 v[108:111], a[204:207], a[208:211], v[108:111]
  ds_read_b128 a[248:251], v192 offset:53248
  v_mfma_f32_16x16x32_bf16 v[124:127], a[172:175], a[180:183], v[124:127]
  s_add_u32 s85, s18, 1024
  ds_read_b128 a[24:27], v194 offset:4096
  v_mfma_f32_16x16x32_bf16 v[124:127], a[204:207], a[212:215], v[124:127]
  buffer_load_dwordx4 v24, s[68:71], s85 offen offset:2048 sc1 lds
  v_mfma_f32_16x16x32_bf16 v[140:143], a[172:175], a[184:187], v[140:143]
  ds_read_b128 a[252:255], v192 offset:54272
  v_mfma_f32_16x16x32_bf16 v[140:143], a[204:207], a[216:219], v[140:143]
  ds_read_b128 a[28:31], v194 offset:5120
  v_mfma_f32_16x16x32_bf16 v[156:159], a[172:175], a[188:191], v[156:159]
  buffer_load_dwordx4 v25, s[68:71], s85 offen offset:3072 sc1 lds
  v_mfma_f32_16x16x32_bf16 v[156:159], a[204:207], a[220:223], v[156:159]
  s_waitcnt lgkmcnt(4)
  v_mfma_f32_16x16x32_bf16 v[96:99], a[224:227], a[240:243], v[96:99]
  ds_read_b64_tr_b16 a[228:229], v197 offset:49152
  ds_read_b64_tr_b16 a[230:231], v197 offset:53248
  v_mfma_f32_16x16x32_bf16 v[96:99], a[0:3], a[16:19], v[96:99]
  s_add_u32 m0, s88, 32768
  ds_read_b64_tr_b16 a[4:5], v205 offset:0
  ds_read_b64_tr_b16 a[6:7], v205 offset:4096
  v_mfma_f32_16x16x32_bf16 v[112:115], a[224:227], a[244:247], v[112:115]
  s_add_u32 s84, s26, 65536
  s_waitcnt lgkmcnt(4)
  v_mfma_f32_16x16x32_bf16 v[112:115], a[0:3], a[20:23], v[112:115]
  buffer_load_dwordx4 v16, s[52:55], s84 offen offset:0 lds
  v_mfma_f32_16x16x32_bf16 v[128:131], a[224:227], a[248:251], v[128:131]
  ds_read_b64_tr_b16 a[232:233], v198 offset:49152
  ds_read_b64_tr_b16 a[234:235], v198 offset:53248
  v_mfma_f32_16x16x32_bf16 v[128:131], a[0:3], a[24:27], v[128:131]
  ds_read_b64_tr_b16 a[8:9], v206 offset:0
  ds_read_b64_tr_b16 a[10:11], v206 offset:4096
  v_mfma_f32_16x16x32_bf16 v[144:147], a[224:227], a[252:255], v[144:147]
  s_waitcnt lgkmcnt(4)
  v_mfma_f32_16x16x32_bf16 v[144:147], a[0:3], a[28:31], v[144:147]
  buffer_load_dwordx4 v15, s[52:55], s84 offen offset:1024 lds
  v_mfma_f32_16x16x32_bf16 v[100:103], a[228:231], a[240:243], v[100:103]
  ds_read_b64_tr_b16 a[236:237], v199 offset:49152
  ds_read_b64_tr_b16 a[238:239], v199 offset:53248
  v_mfma_f32_16x16x32_bf16 v[100:103], a[4:7], a[16:19], v[100:103]
  ds_read_b64_tr_b16 a[12:13], v207 offset:0
  ds_read_b64_tr_b16 a[14:15], v207 offset:4096
  v_mfma_f32_16x16x32_bf16 v[116:119], a[228:231], a[244:247], v[116:119]
  s_add_u32 s85, s18, 2048
  v_mfma_f32_16x16x32_bf16 v[116:119], a[4:7], a[20:23], v[116:119]
  buffer_load_dwordx4 v24, s[68:71], s85 offen offset:2048 sc1 lds
  v_mfma_f32_16x16x32_bf16 v[132:135], a[228:231], a[248:251], v[132:135]
  v_mfma_f32_16x16x32_bf16 v[132:135], a[4:7], a[24:27], v[132:135]
  v_mfma_f32_16x16x32_bf16 v[148:151], a[228:231], a[252:255], v[148:151]
  buffer_load_dwordx4 v25, s[68:71], s85 offen offset:3072 sc1 lds
  v_mfma_f32_16x16x32_bf16 v[148:151], a[4:7], a[28:31], v[148:151]
  s_waitcnt lgkmcnt(0)
  v_mfma_f32_16x16x32_bf16 v[104:107], a[232:235], a[240:243], v[104:107]
  s_waitcnt vmcnt(21)
  s_barrier
  v_mfma_f32_16x16x32_bf16 v[104:107], a[8:11], a[16:19], v[104:107]
  s_add_u32 m0, s88, 16384
  ds_read_b64_tr_b16 a[32:33], v204 offset:16384
  ds_read_b64_tr_b16 a[34:35], v204 offset:20480
  s_and_b32 s80, s76, 1
  v_mfma_f32_16x16x32_bf16 v[120:123], a[232:235], a[244:247], v[120:123]
  s_add_u32 s84, s26, 98304
  ds_read_b64_tr_b16 a[64:65], v200 offset:0
  ds_read_b64_tr_b16 a[66:67], v200 offset:4096
  s_lshl_b32 s80, s80, 2
  v_mfma_f32_16x16x32_bf16 v[120:123], a[8:11], a[20:23], v[120:123]
  buffer_load_dwordx4 v16, s[52:55], s84 offen offset:0 lds
  s_add_u32 s80, s80, s41
  v_mfma_f32_16x16x32_bf16 v[136:139], a[232:235], a[248:251], v[136:139]
  s_add_u32 s80, s80, s40
  ds_read_b128 a[48:51], v194 offset:16384
  s_lshl_b32 s80, s80, 14
  s_andn2_b32 s81, 3, s77
  v_mfma_f32_16x16x32_bf16 v[136:139], a[8:11], a[24:27], v[136:139]
  s_lshl_b32 s81, s81, 8
  ds_read_b128 a[80:83], v193 offset:0
  s_add_u32 s80, s80, s81
  s_lshr_b32 s81, s76, 1
  v_mfma_f32_16x16x32_bf16 v[152:155], a[232:235], a[252:255], v[152:155]
  s_lshl_b32 s81, s81, 7
  ds_read_b128 a[52:55], v194 offset:17408
  s_add_u32 s8, s80, s81
  s_add_u32 s80, s40, 1
  v_mfma_f32_16x16x32_bf16 v[152:155], a[8:11], a[28:31], v[152:155]
  buffer_load_dwordx4 v15, s[52:55], s84 offen offset:1024 lds
  s_and_b32 s80, s80, 3
  v_mfma_f32_16x16x32_bf16 v[108:111], a[236:239], a[240:243], v[108:111]
  s_sub_u32 s80, s40, s80
  ds_read_b128 a[84:87], v193 offset:1024
  s_mul_i32 s80, s80, 24576
  s_add_u32 s47, s72, s80
  v_mfma_f32_16x16x32_bf16 v[108:111], a[12:15], a[16:19], v[108:111]
  s_add_u32 s5, s47, 8192
  ds_read_b128 a[56:59], v194 offset:20480
  s_add_u32 s6, s47, 16384
  v_and_b32 v8, 15, v0
  v_mfma_f32_16x16x32_bf16 v[124:127], a[236:239], a[244:247], v[124:127]
  s_add_u32 s85, s18, 3072
  ds_read_b128 a[88:91], v193 offset:4096
  v_bfe_u32 v9, v0, 4, 1
  v_lshlrev_b32 v9, 5, v9
  v_mfma_f32_16x16x32_bf16 v[124:127], a[12:15], a[20:23], v[124:127]
  buffer_load_dwordx4 v24, s[68:71], s85 offen offset:2048 sc1 lds
  v_lshl_add_u32 v8, v8, 10, v9
  v_mfma_f32_16x16x32_bf16 v[140:143], a[236:239], a[248:251], v[140:143]
  ds_read_b128 a[60:63], v194 offset:21504
  v_lshrrev_b32 v9, 5, v0
  v_lshl_add_u32 v8, v9, 4, v8
  v_mfma_f32_16x16x32_bf16 v[140:143], a[12:15], a[24:27], v[140:143]
  ds_read_b128 a[92:95], v193 offset:5120
  v_and_b32 v9, 15, v0
  v_lshrrev_b32 v10, 4, v0
  v_mfma_f32_16x16x32_bf16 v[156:159], a[236:239], a[252:255], v[156:159]
  buffer_load_dwordx4 v25, s[68:71], s85 offen offset:3072 sc1 lds
  v_lshlrev_b32 v10, 3, v10
  v_mfma_f32_16x16x32_bf16 v[156:159], a[12:15], a[28:31], v[156:159]
  s_waitcnt vmcnt(12)
  v_cmp_eq_u32 vcc, 1, v13
  s_nop 0
  s_mov_b32 s42, vcc_lo
  s_waitcnt lgkmcnt(4)
  v_mfma_f32_16x16x32_bf16 v[96:99], a[32:35], a[48:51], v[96:99]
  ds_read_b64_tr_b16 a[36:37], v205 offset:16384
  ds_read_b64_tr_b16 a[38:39], v205 offset:20480
  v_lshl_add_u32 v9, v9, 10, v10
  v_mfma_f32_16x16x32_bf16 v[96:99], a[64:67], a[80:83], v[96:99]
  s_add_u32 m0, s88, 49152
  ds_read_b64_tr_b16 a[68:69], v201 offset:0
  ds_read_b64_tr_b16 a[70:71], v201 offset:4096
  v_mfma_f32_16x16x32_bf16 v[112:115], a[32:35], a[52:55], v[112:115]
  s_add_u32 s84, s27, 0
  s_waitcnt lgkmcnt(4)
  v_mfma_f32_16x16x32_bf16 v[112:115], a[64:67], a[84:87], v[112:115]
  buffer_load_dwordx4 v16, s[52:55], s84 offen offset:0 lds
  v_mfma_f32_16x16x32_bf16 v[128:131], a[32:35], a[56:59], v[128:131]
  ds_read_b64_tr_b16 a[40:41], v206 offset:16384
  ds_read_b64_tr_b16 a[42:43], v206 offset:20480
  v_mfma_f32_16x16x32_bf16 v[128:131], a[64:67], a[88:91], v[128:131]
  ds_read_b64_tr_b16 a[72:73], v202 offset:0
  ds_read_b64_tr_b16 a[74:75], v202 offset:4096
  v_mfma_f32_16x16x32_bf16 v[144:147], a[32:35], a[60:63], v[144:147]
  s_waitcnt lgkmcnt(4)
  v_mfma_f32_16x16x32_bf16 v[144:147], a[64:67], a[92:95], v[144:147]
  buffer_load_dwordx4 v15, s[52:55], s84 offen offset:1024 lds
  v_mfma_f32_16x16x32_bf16 v[100:103], a[36:39], a[48:51], v[100:103]
  ds_read_b64_tr_b16 a[44:45], v207 offset:16384
  ds_read_b64_tr_b16 a[46:47], v207 offset:20480
  v_mfma_f32_16x16x32_bf16 v[100:103], a[68:71], a[80:83], v[100:103]
  ds_read_b64_tr_b16 a[76:77], v203 offset:0
  ds_read_b64_tr_b16 a[78:79], v203 offset:4096
  v_mfma_f32_16x16x32_bf16 v[116:119], a[36:39], a[52:55], v[116:119]
  s_bitcmp1_b32 s42, 7
  s_cbranch_scc0 L_e7_spin
L_e7_ok:
  s_add_u32 s85, s19, 0
  v_mfma_f32_16x16x32_bf16 v[116:119], a[68:71], a[84:87], v[116:119]
  buffer_load_dwordx4 v24, s[68:71], s85 offen offset:2048 sc1 lds
  v_mfma_f32_16x16x32_bf16 v[132:135], a[36:39], a[56:59], v[132:135]
L_hop17:
  s_cbranch_execz L_ret2
  v_mfma_f32_16x16x32_bf16 v[132:135], a[68:71], a[88:91], v[132:135]
  v_mfma_f32_16x16x32_bf16 v[148:151], a[36:39], a[60:63], v[148:151]
  buffer_load_dwordx4 v25, s[68:71], s85 offen offset:3072 sc1 lds
  v_mfma_f32_16x16x32_bf16 v[148:151], a[68:71], a[92:95], v[148:151]
  s_waitcnt lgkmcnt(0)
  v_mfma_f32_16x16x32_bf16 v[104:107], a[40:43], a[48:51], v[104:107]
  s_waitcnt vmcnt(63)
  s_barrier
  v_mfma_f32_16x16x32_bf16 v[104:107], a[72:75], a[80:83], v[104:107]
  s_add_u32 m0, s88, 131072
  ds_read_b64_tr_b16 a[96:97], v200 offset:32768
  ds_read_b64_tr_b16 a[98:99], v200 offset:36864
  v_mfma_f32_16x16x32_bf16 v[120:123], a[40:43], a[52:55], v[120:123]
  s_add_u32 s84, s27, 32768
  ds_read_b64_tr_b16 a[128:129], v200 offset:16384
  ds_read_b64_tr_b16 a[130:131], v200 offset:20480
  v_mfma_f32_16x16x32_bf16 v[120:123], a[72:75], a[84:87], v[120:123]
  buffer_load_dwordx4 v16, s[52:55], s84 offen offset:0 lds
  v_mfma_f32_16x16x32_bf16 v[136:139], a[40:43], a[56:59], v[136:139]
  ds_read_b128 a[112:115], v193 offset:32768
  v_mfma_f32_16x16x32_bf16 v[136:139], a[72:75], a[88:91], v[136:139]
  ds_read_b128 a[144:147], v193 offset:16384
  v_mfma_f32_16x16x32_bf16 v[152:155], a[40:43], a[60:63], v[152:155]
  ds_read_b128 a[116:119], v193 offset:33792
  v_mfma_f32_16x16x32_bf16 v[152:155], a[72:75], a[92:95], v[152:155]
  buffer_load_dwordx4 v15, s[52:55], s84 offen offset:1024 lds
  v_mfma_f32_16x16x32_bf16 v[108:111], a[44:47], a[48:51], v[108:111]
  ds_read_b128 a[148:151], v193 offset:17408
  v_mfma_f32_16x16x32_bf16 v[108:111], a[76:79], a[80:83], v[108:111]
  ds_read_b128 a[120:123], v193 offset:36864
  v_mfma_f32_16x16x32_bf16 v[124:127], a[44:47], a[52:55], v[124:127]
  s_add_u32 s85, s19, 1024
  ds_read_b128 a[152:155], v193 offset:20480
  v_mfma_f32_16x16x32_bf16 v[124:127], a[76:79], a[84:87], v[124:127]
  buffer_load_dwordx4 v24, s[68:71], s85 offen offset:2048 sc1 lds
  v_mfma_f32_16x16x32_bf16 v[140:143], a[44:47], a[56:59], v[140:143]
  ds_read_b128 a[124:127], v193 offset:37888
  v_mfma_f32_16x16x32_bf16 v[140:143], a[76:79], a[88:91], v[140:143]
  ds_read_b128 a[156:159], v193 offset:21504
  v_mfma_f32_16x16x32_bf16 v[156:159], a[44:47], a[60:63], v[156:159]
  buffer_load_dwordx4 v25, s[68:71], s85 offen offset:3072 sc1 lds
  v_mfma_f32_16x16x32_bf16 v[156:159], a[76:79], a[92:95], v[156:159]
  s_waitcnt lgkmcnt(4)
  v_mfma_f32_16x16x32_bf16 v[96:99], a[96:99], a[112:115], v[96:99]
  ds_read_b64_tr_b16 a[100:101], v201 offset:32768
  ds_read_b64_tr_b16 a[102:103], v201 offset:36864
  v_mfma_f32_16x16x32_bf16 v[96:99], a[128:131], a[144:147], v[96:99]
  s_add_u32 m0, s88, 147456
  ds_read_b64_tr_b16 a[132:133], v201 offset:16384
  ds_read_b64_tr_b16 a[134:135], v201 offset:20480
  v_mfma_f32_16x16x32_bf16 v[112:115], a[96:99], a[116:119], v[112:115]
  s_add_u32 s84, s27, 65536
  s_waitcnt lgkmcnt(4)
  v_mfma_f32_16x16x32_bf16 v[112:115], a[128:131], a[148:151], v[112:115]
  buffer_load_dwordx4 v16, s[52:55], s84 offen offset:0 lds
  v_mfma_f32_16x16x32_bf16 v[128:131], a[96:99], a[120:123], v[128:131]
  ds_read_b64_tr_b16 a[104:105], v202 offset:32768
  ds_read_b64_tr_b16 a[106:107], v202 offset:36864
  v_mfma_f32_16x16x32_bf16 v[128:131], a[128:131], a[152:155], v[128:131]
  ds_read_b64_tr_b16 a[136:137], v202 offset:16384
  ds_read_b64_tr_b16 a[138:139], v202 offset:20480
  v_mfma_f32_16x16x32_bf16 v[144:147], a[96:99], a[124:127], v[144:147]
  s_waitcnt lgkmcnt(4)
  v_mfma_f32_16x16x32_bf16 v[144:147], a[128:131], a[156:159], v[144:147]
  buffer_load_dwordx4 v15, s[52:55], s84 offen offset:1024 lds
  v_mfma_f32_16x16x32_bf16 v[100:103], a[100:103], a[112:115], v[100:103]
  ds_read_b64_tr_b16 a[108:109], v203 offset:32768
  ds_read_b64_tr_b16 a[110:111], v203 offset:36864
  v_mfma_f32_16x16x32_bf16 v[100:103], a[132:135], a[144:147], v[100:103]
  ds_read_b64_tr_b16 a[140:141], v203 offset:16384
  ds_read_b64_tr_b16 a[142:143], v203 offset:20480
  v_mfma_f32_16x16x32_bf16 v[116:119], a[100:103], a[116:119], v[116:119]
  s_add_u32 s85, s19, 2048
  v_mfma_f32_16x16x32_bf16 v[116:119], a[132:135], a[148:151], v[116:119]
  buffer_load_dwordx4 v24, s[68:71], s85 offen offset:2048 sc1 lds
  v_mfma_f32_16x16x32_bf16 v[132:135], a[100:103], a[120:123], v[132:135]
  v_mfma_f32_16x16x32_bf16 v[132:135], a[132:135], a[152:155], v[132:135]
  v_mfma_f32_16x16x32_bf16 v[148:151], a[100:103], a[124:127], v[148:151]
  buffer_load_dwordx4 v25, s[68:71], s85 offen offset:3072 sc1 lds
  v_mfma_f32_16x16x32_bf16 v[148:151], a[132:135], a[156:159], v[148:151]
  s_waitcnt lgkmcnt(0)
  v_mfma_f32_16x16x32_bf16 v[104:107], a[104:107], a[112:115], v[104:107]
  s_waitcnt vmcnt(20)
  s_barrier
  v_mfma_f32_16x16x32_bf16 v[104:107], a[136:139], a[144:147], v[104:107]
  s_add_u32 m0, s88, 65536
  ds_read_b64_tr_b16 a[160:161], v196 offset:0
  ds_read_b64_tr_b16 a[162:163], v196 offset:4096
  v_mfma_f32_16x16x32_bf16 v[120:123], a[104:107], a[116:119], v[120:123]
  s_add_u32 s84, s27, 98304
  ds_read_b64_tr_b16 a[192:193], v200 offset:49152
  ds_read_b64_tr_b16 a[194:195], v200 offset:53248
  v_mfma_f32_16x16x32_bf16 v[120:123], a[136:139], a[148:151], v[120:123]
  buffer_load_dwordx4 v16, s[52:55], s84 offen offset:0 lds
  v_mfma_f32_16x16x32_bf16 v[136:139], a[104:107], a[120:123], v[136:139]
  ds_read_b128 a[176:179], v192 offset:0
  v_mfma_f32_16x16x32_bf16 v[136:139], a[136:139], a[152:155], v[136:139]
  ds_read_b128 a[208:211], v193 offset:49152
  v_mfma_f32_16x16x32_bf16 v[152:155], a[104:107], a[124:127], v[152:155]
  ds_read_b128 a[180:183], v192 offset:1024
  v_mfma_f32_16x16x32_bf16 v[152:155], a[136:139], a[156:159], v[152:155]
  buffer_load_dwordx4 v15, s[52:55], s84 offen offset:1024 lds
  v_mfma_f32_16x16x32_bf16 v[108:111], a[108:111], a[112:115], v[108:111]
  ds_read_b128 a[212:215], v193 offset:50176
  v_mfma_f32_16x16x32_bf16 v[108:111], a[140:143], a[144:147], v[108:111]
  ds_read_b128 a[184:187], v192 offset:4096
  v_mfma_f32_16x16x32_bf16 v[124:127], a[108:111], a[116:119], v[124:127]
  s_add_u32 s85, s19, 3072
  ds_read_b128 a[216:219], v193 offset:53248
  v_mfma_f32_16x16x32_bf16 v[124:127], a[140:143], a[148:151], v[124:127]
  buffer_load_dwordx4 v24, s[68:71], s85 offen offset:2048 sc1 lds
  v_mfma_f32_16x16x32_bf16 v[140:143], a[108:111], a[120:123], v[140:143]
  ds_read_b128 a[188:191], v192 offset:5120
  v_mfma_f32_16x16x32_bf16 v[140:143], a[140:143], a[152:155], v[140:143]
  ds_read_b128 a[220:223], v193 offset:54272
  v_mfma_f32_16x16x32_bf16 v[156:159], a[108:111], a[124:127], v[156:159]
  buffer_load_dwordx4 v25, s[68:71], s85 offen offset:3072 sc1 lds
  v_mfma_f32_16x16x32_bf16 v[156:159], a[140:143], a[156:159], v[156:159]
  buffer_load_dword v13, v27, s[68:71], s75 offen sc1
  s_waitcnt lgkmcnt(4)
  v_mfma_f32_16x16x32_bf16 v[96:99], a[160:163], a[176:179], v[96:99]
  ds_read_b64_tr_b16 a[164:165], v197 offset:0
  ds_read_b64_tr_b16 a[166:167], v197 offset:4096
  v_mfma_f32_16x16x32_bf16 v[96:99], a[192:195], a[208:211], v[96:99]
  ds_read_b64_tr_b16 a[196:197], v201 offset:49152
  ds_read_b64_tr_b16 a[198:199], v201 offset:53248
  v_mfma_f32_16x16x32_bf16 v[112:115], a[160:163], a[180:183], v[112:115]
  s_waitcnt lgkmcnt(4)
  v_mfma_f32_16x16x32_bf16 v[112:115], a[192:195], a[212:215], v[112:115]
  buffer_load_dwordx2 v[32:33], v9, s[32:35], s8 offen offset:0
  v_mfma_f32_16x16x32_bf16 v[128:131], a[160:163], a[184:187], v[128:131]
  ds_read_b64_tr_b16 a[168:169], v198 offset:0
  ds_read_b64_tr_b16 a[170:171], v198 offset:4096
  v_mfma_f32_16x16x32_bf16 v[128:131], a[192:195], a[216:219], v[128:131]
  ds_read_b64_tr_b16 a[200:201], v202 offset:49152
  ds_read_b64_tr_b16 a[202:203], v202 offset:53248
  v_mfma_f32_16x16x32_bf16 v[144:147], a[160:163], a[188:191], v[144:147]
  s_waitcnt lgkmcnt(4)
  v_mfma_f32_16x16x32_bf16 v[144:147], a[192:195], a[220:223], v[144:147]
  buffer_load_dwordx2 v[34:35], v9, s[32:35], s8 offen offset:32
  v_mfma_f32_16x16x32_bf16 v[100:103], a[164:167], a[176:179], v[100:103]
  ds_read_b64_tr_b16 a[172:173], v199 offset:0
  ds_read_b64_tr_b16 a[174:175], v199 offset:4096
  v_mfma_f32_16x16x32_bf16 v[100:103], a[196:199], a[208:211], v[100:103]
  ds_read_b64_tr_b16 a[204:205], v203 offset:49152
  ds_read_b64_tr_b16 a[206:207], v203 offset:53248
  v_mfma_f32_16x16x32_bf16 v[116:119], a[164:167], a[180:183], v[116:119]
  v_mfma_f32_16x16x32_bf16 v[116:119], a[196:199], a[212:215], v[116:119]
  buffer_load_dwordx2 v[36:37], v9, s[32:35], s8 offen offset:64
  v_mfma_f32_16x16x32_bf16 v[132:135], a[164:167], a[184:187], v[132:135]
  v_mfma_f32_16x16x32_bf16 v[132:135], a[196:199], a[216:219], v[132:135]
  v_mfma_f32_16x16x32_bf16 v[148:151], a[164:167], a[188:191], v[148:151]
  buffer_load_dwordx2 v[38:39], v9, s[32:35], s8 offen offset:96
  v_mfma_f32_16x16x32_bf16 v[148:151], a[196:199], a[220:223], v[148:151]
  s_waitcnt lgkmcnt(0)
  v_mfma_f32_16x16x32_bf16 v[104:107], a[168:171], a[176:179], v[104:107]
  s_waitcnt vmcnt(21)
  s_barrier
  v_mfma_f32_16x16x32_bf16 v[104:107], a[200:203], a[208:211], v[104:107]
  ds_read_b64_tr_b16 a[224:225], v196 offset:32768
  ds_read_b64_tr_b16 a[226:227], v196 offset:36864
  v_mfma_f32_16x16x32_bf16 v[120:123], a[168:171], a[180:183], v[120:123]
  ds_read_b64_tr_b16 a[0:1], v196 offset:16384
  ds_read_b64_tr_b16 a[2:3], v196 offset:20480
  v_mfma_f32_16x16x32_bf16 v[120:123], a[200:203], a[212:215], v[120:123]
  v_mfma_f32_16x16x32_bf16 v[136:139], a[168:171], a[184:187], v[136:139]
  ds_read_b128 a[240:243], v192 offset:32768
  v_mfma_f32_16x16x32_bf16 v[136:139], a[200:203], a[216:219], v[136:139]
  ds_read_b128 a[16:19], v192 offset:16384
  v_mfma_f32_16x16x32_bf16 v[152:155], a[168:171], a[188:191], v[152:155]
  ds_read_b128 a[244:247], v192 offset:33792
  v_mfma_f32_16x16x32_bf16 v[152:155], a[200:203], a[220:223], v[152:155]
  v_mfma_f32_16x16x32_bf16 v[108:111], a[172:175], a[176:179], v[108:111]
  ds_read_b128 a[20:23], v192 offset:17408
  v_mfma_f32_16x16x32_bf16 v[108:111], a[204:207], a[208:211], v[108:111]
  ds_read_b128 a[248:251], v192 offset:36864
  v_mfma_f32_16x16x32_bf16 v[124:127], a[172:175], a[180:183], v[124:127]
  ds_read_b128 a[24:27], v192 offset:20480
  v_mfma_f32_16x16x32_bf16 v[124:127], a[204:207], a[212:215], v[124:127]
  v_mfma_f32_16x16x32_bf16 v[140:143], a[172:175], a[184:187], v[140:143]
  ds_read_b128 a[252:255], v192 offset:37888
  v_mfma_f32_16x16x32_bf16 v[140:143], a[204:207], a[216:219], v[140:143]
  ds_read_b128 a[28:31], v192 offset:21504
  v_mfma_f32_16x16x32_bf16 v[156:159], a[172:175], a[188:191], v[156:159]
  v_mfma_f32_16x16x32_bf16 v[156:159], a[204:207], a[220:223], v[156:159]
  s_waitcnt lgkmcnt(4)
  v_mfma_f32_16x16x32_bf16 v[96:99], a[224:227], a[240:243], v[96:99]
  ds_read_b64_tr_b16 a[228:229], v197 offset:32768
  ds_read_b64_tr_b16 a[230:231], v197 offset:36864
  v_mfma_f32_16x16x32_bf16 v[96:99], a[0:3], a[16:19], v[96:99]
  ds_read_b64_tr_b16 a[4:5], v197 offset:16384
  ds_read_b64_tr_b16 a[6:7], v197 offset:20480
  v_mfma_f32_16x16x32_bf16 v[112:115], a[224:227], a[244:247], v[112:115]
  s_waitcnt lgkmcnt(4)
  v_mfma_f32_16x16x32_bf16 v[112:115], a[0:3], a[20:23], v[112:115]
  v_mfma_f32_16x16x32_bf16 v[128:131], a[224:227], a[248:251], v[128:131]
  ds_read_b64_tr_b16 a[232:233], v198 offset:32768
  ds_read_b64_tr_b16 a[234:235], v198 offset:36864
  v_mfma_f32_16x16x32_bf16 v[128:131], a[0:3], a[24:27], v[128:131]
  ds_read_b64_tr_b16 a[8:9], v198 offset:16384
  ds_read_b64_tr_b16 a[10:11], v198 offset:20480
  v_mfma_f32_16x16x32_bf16 v[144:147], a[224:227], a[252:255], v[144:147]
  s_waitcnt lgkmcnt(4)
  v_mfma_f32_16x16x32_bf16 v[144:147], a[0:3], a[28:31], v[144:147]
  v_mfma_f32_16x16x32_bf16 v[100:103], a[228:231], a[240:243], v[100:103]
  ds_read_b64_tr_b16 a[236:237], v199 offset:32768
  ds_read_b64_tr_b16 a[238:239], v199 offset:36864
  v_mfma_f32_16x16x32_bf16 v[100:103], a[4:7], a[16:19], v[100:103]
  ds_read_b64_tr_b16 a[12:13], v199 offset:16384
  ds_read_b64_tr_b16 a[14:15], v199 offset:20480
  v_mfma_f32_16x16x32_bf16 v[116:119], a[228:231], a[244:247], v[116:119]
  v_mfma_f32_16x16x32_bf16 v[116:119], a[4:7], a[20:23], v[116:119]
  v_mfma_f32_16x16x32_bf16 v[132:135], a[228:231], a[248:251], v[132:135]
  v_mfma_f32_16x16x32_bf16 v[132:135], a[4:7], a[24:27], v[132:135]
  v_mfma_f32_16x16x32_bf16 v[148:151], a[228:231], a[252:255], v[148:151]
  s_waitcnt vmcnt(4)
  v_cmp_eq_u32 vcc, 1, v13
  s_nop 0
  s_and_b32 s80, vcc_lo, 15
  s_cmp_eq_u32 s80, 15
  s_cbranch_scc0 L_x_spin
L_x_ok:
  v_mfma_f32_16x16x32_bf16 v[148:151], a[4:7], a[28:31], v[148:151]
  s_waitcnt lgkmcnt(0)
  v_mfma_f32_16x16x32_bf16 v[104:107], a[232:235], a[240:243], v[104:107]
  s_waitcnt vmcnt(63)
  s_barrier
  v_mfma_f32_16x16x32_bf16 v[104:107], a[8:11], a[16:19], v[104:107]
  ds_read_b128 a[52:55], v192 offset:50176
  ds_read_b128 a[84:87], v194 offset:1024
  v_mfma_f32_16x16x32_bf16 v[120:123], a[232:235], a[244:247], v[120:123]
  ds_read_b64_tr_b16 a[32:33], v196 offset:49152
  ds_read_b64_tr_b16 a[34:35], v196 offset:53248
  v_mfma_f32_16x16x32_bf16 v[120:123], a[8:11], a[20:23], v[120:123]
  ds_read_b64_tr_b16 a[64:65], v204 offset:0
  ds_read_b64_tr_b16 a[66:67], v204 offset:4096
  v_mfma_f32_16x16x32_bf16 v[136:139], a[232:235], a[248:251], v[136:139]
  ds_read_b64_tr_b16 a[36:37], v197 offset:49152
  ds_read_b64_tr_b16 a[38:39], v197 offset:53248
  v_mfma_f32_16x16x32_bf16 v[136:139], a[8:11], a[24:27], v[136:139]
  ds_read_b64_tr_b16 a[68:69], v205 offset:0
  ds_read_b64_tr_b16 a[70:71], v205 offset:4096
  v_mfma_f32_16x16x32_bf16 v[152:155], a[232:235], a[252:255], v[152:155]
  ds_read_b64_tr_b16 a[40:41], v198 offset:49152
  ds_read_b64_tr_b16 a[42:43], v198 offset:53248
  v_mfma_f32_16x16x32_bf16 v[152:155], a[8:11], a[28:31], v[152:155]
  ds_read_b64_tr_b16 a[72:73], v206 offset:0
  ds_read_b64_tr_b16 a[74:75], v206 offset:4096
  v_mfma_f32_16x16x32_bf16 v[108:111], a[236:239], a[240:243], v[108:111]
  ds_read_b64_tr_b16 a[44:45], v199 offset:49152
  ds_read_b64_tr_b16 a[46:47], v199 offset:53248
  v_mfma_f32_16x16x32_bf16 v[108:111], a[12:15], a[16:19], v[108:111]
  ds_read_b64_tr_b16 a[76:77], v207 offset:0
  ds_read_b64_tr_b16 a[78:79], v207 offset:4096
  v_mfma_f32_16x16x32_bf16 v[124:127], a[236:239], a[244:247], v[124:127]
  ds_read_b128 a[116:119], v194 offset:17408
  ds_read_b128 a[148:151], v193 offset:1024
  v_mfma_f32_16x16x32_bf16 v[124:127], a[12:15], a[20:23], v[124:127]
  ds_read_b64_tr_b16 a[96:97], v204 offset:16384
  ds_read_b64_tr_b16 a[98:99], v204 offset:20480
  v_mfma_f32_16x16x32_bf16 v[140:143], a[236:239], a[248:251], v[140:143]
  ds_read_b64_tr_b16 a[128:129], v200 offset:0
  ds_read_b64_tr_b16 a[130:131], v200 offset:4096
  v_mfma_f32_16x16x32_bf16 v[140:143], a[12:15], a[24:27], v[140:143]
  ds_read_b64_tr_b16 a[100:101], v205 offset:16384
  ds_read_b64_tr_b16 a[102:103], v205 offset:20480
  v_mfma_f32_16x16x32_bf16 v[156:159], a[236:239], a[252:255], v[156:159]
  ds_read_b64_tr_b16 a[132:133], v201 offset:0
  ds_read_b64_tr_b16 a[134:135], v201 offset:4096
  v_mfma_f32_16x16x32_bf16 v[156:159], a[12:15], a[28:31], v[156:159]
  s_waitcnt lgkmcnt(10)
  ds_read_b64_tr_b16 a[104:105], v206 offset:16384
  ds_read_b64_tr_b16 a[106:107], v206 offset:20480
  v_mfma_f32_16x16x32_bf16 v[112:115], a[32:35], a[52:55], v[112:115]
  ds_read_b64_tr_b16 a[136:137], v202 offset:0
  ds_read_b64_tr_b16 a[138:139], v202 offset:4096
  v_mfma_f32_16x16x32_bf16 v[112:115], a[64:67], a[84:87], v[112:115]
  ds_read_b64_tr_b16 a[108:109], v207 offset:16384
  ds_read_b64_tr_b16 a[110:111], v207 offset:20480
  v_mfma_f32_16x16x32_bf16 v[116:119], a[36:39], a[52:55], v[116:119]
  ds_read_b64_tr_b16 a[140:141], v203 offset:0
  ds_read_b64_tr_b16 a[142:143], v203 offset:4096
  v_mfma_f32_16x16x32_bf16 v[116:119], a[68:71], a[84:87], v[116:119]
  ds_read_b128 a[56:59], v192 offset:53248
  v_mfma_f32_16x16x32_bf16 v[120:123], a[40:43], a[52:55], v[120:123]
  ds_read_b128 a[88:91], v194 offset:4096
  v_mfma_f32_16x16x32_bf16 v[120:123], a[72:75], a[84:87], v[120:123]
  ds_read_b128 a[120:123], v194 offset:20480
  v_mfma_f32_16x16x32_bf16 v[124:127], a[44:47], a[52:55], v[124:127]
  ds_read_b128 a[152:155], v193 offset:4096
  v_mfma_f32_16x16x32_bf16 v[124:127], a[76:79], a[84:87], v[124:127]
  s_waitcnt lgkmcnt(4)
  ds_read_b128 a[60:63], v192 offset:54272
  v_mfma_f32_16x16x32_bf16 v[112:115], a[96:99], a[116:119], v[112:115]
  ds_read_b128 a[92:95], v194 offset:5120
  v_mfma_f32_16x16x32_bf16 v[112:115], a[128:131], a[148:151], v[112:115]
  ds_read_b128 a[124:127], v194 offset:21504
  v_mfma_f32_16x16x32_bf16 v[116:119], a[100:103], a[116:119], v[116:119]
  ds_read_b128 a[156:159], v193 offset:5120
  v_mfma_f32_16x16x32_bf16 v[116:119], a[132:135], a[148:151], v[116:119]
  ds_read_b128 a[48:51], v192 offset:49152
  v_mfma_f32_16x16x32_bf16 v[120:123], a[104:107], a[116:119], v[120:123]
  ds_read_b128 a[80:83], v194 offset:0
  v_mfma_f32_16x16x32_bf16 v[120:123], a[136:139], a[148:151], v[120:123]
  ds_read_b128 a[112:115], v194 offset:16384
  v_mfma_f32_16x16x32_bf16 v[124:127], a[108:111], a[116:119], v[124:127]
  ds_read_b128 a[144:147], v193 offset:0
  v_mfma_f32_16x16x32_bf16 v[124:127], a[140:143], a[148:151], v[124:127]
  s_waitcnt lgkmcnt(8)
  v_cvt_pk_bf16_f32 v40, v112, v113
  v_cvt_pk_bf16_f32 v41, v114, v115
  v_mfma_f32_16x16x32_bf16 v[128:131], a[32:35], a[56:59], v[128:131]
  v_cvt_pk_bf16_f32 v42, v116, v117
  v_cvt_pk_bf16_f32 v43, v118, v119
  v_mfma_f32_16x16x32_bf16 v[128:131], a[64:67], a[88:91], v[128:131]
  buffer_store_dwordx4 v[40:43], v12, s[68:71], s72 offen offset:0 sc1
  v_mfma_f32_16x16x32_bf16 v[132:135], a[36:39], a[56:59], v[132:135]
  v_mfma_f32_16x16x32_bf16 v[132:135], a[68:71], a[88:91], v[132:135]
  v_cvt_pk_bf16_f32 v44, v120, v121
  v_cvt_pk_bf16_f32 v45, v122, v123
  v_mfma_f32_16x16x32_bf16 v[136:139], a[40:43], a[56:59], v[136:139]
  v_cvt_pk_bf16_f32 v46, v124, v125
  v_cvt_pk_bf16_f32 v47, v126, v127
  v_mfma_f32_16x16x32_bf16 v[136:139], a[72:75], a[88:91], v[136:139]
  buffer_store_dwordx4 v[44:47], v12, s[68:71], s72 offen offset:1024 sc1
  v_mfma_f32_16x16x32_bf16 v[140:143], a[44:47], a[56:59], v[140:143]
  v_mfma_f32_16x16x32_bf16 v[140:143], a[76:79], a[88:91], v[140:143]
  v_mfma_f32_16x16x32_bf16 v[128:131], a[96:99], a[120:123], v[128:131]
  v_mfma_f32_16x16x32_bf16 v[128:131], a[128:131], a[152:155], v[128:131]
  v_mfma_f32_16x16x32_bf16 v[132:135], a[100:103], a[120:123], v[132:135]
  v_mfma_f32_16x16x32_bf16 v[132:135], a[132:135], a[152:155], v[132:135]
  v_mfma_f32_16x16x32_bf16 v[136:139], a[104:107], a[120:123], v[136:139]
  v_mfma_f32_16x16x32_bf16 v[136:139], a[136:139], a[152:155], v[136:139]
  v_mfma_f32_16x16x32_bf16 v[140:143], a[108:111], a[120:123], v[140:143]
  v_mfma_f32_16x16x32_bf16 v[140:143], a[140:143], a[152:155], v[140:143]
  s_waitcnt lgkmcnt(4)
  s_nop 0
  v_cvt_pk_bf16_f32 v48, v128, v129
  v_cvt_pk_bf16_f32 v49, v130, v131
  v_mfma_f32_16x16x32_bf16 v[144:147], a[32:35], a[60:63], v[144:147]
  v_cvt_pk_bf16_f32 v50, v132, v133
  v_cvt_pk_bf16_f32 v51, v134, v135
  v_mfma_f32_16x16x32_bf16 v[144:147], a[64:67], a[92:95], v[144:147]
  buffer_store_dwordx4 v[48:51], v12, s[68:71], s73 offen offset:0 sc1
  v_mfma_f32_16x16x32_bf16 v[148:151], a[36:39], a[60:63], v[148:151]
  v_mfma_f32_16x16x32_bf16 v[148:151], a[68:71], a[92:95], v[148:151]
  v_cvt_pk_bf16_f32 v52, v136, v137
  v_cvt_pk_bf16_f32 v53, v138, v139
  v_mfma_f32_16x16x32_bf16 v[152:155], a[40:43], a[60:63], v[152:155]
  v_cvt_pk_bf16_f32 v54, v140, v141
  v_cvt_pk_bf16_f32 v55, v142, v143
  v_mfma_f32_16x16x32_bf16 v[152:155], a[72:75], a[92:95], v[152:155]
  buffer_store_dwordx4 v[52:55], v12, s[68:71], s73 offen offset:1024 sc1
  v_mfma_f32_16x16x32_bf16 v[156:159], a[44:47], a[60:63], v[156:159]
  v_mfma_f32_16x16x32_bf16 v[156:159], a[76:79], a[92:95], v[156:159]
  v_mfma_f32_16x16x32_bf16 v[144:147], a[96:99], a[124:127], v[144:147]
  v_mfma_f32_16x16x32_bf16 v[144:147], a[128:131], a[156:159], v[144:147]
  v_mfma_f32_16x16x32_bf16 v[148:151], a[100:103], a[124:127], v[148:151]
  v_mfma_f32_16x16x32_bf16 v[148:151], a[132:135], a[156:159], v[148:151]
  v_mfma_f32_16x16x32_bf16 v[152:155], a[104:107], a[124:127], v[152:155]
  v_mfma_f32_16x16x32_bf16 v[152:155], a[136:139], a[156:159], v[152:155]
  v_mfma_f32_16x16x32_bf16 v[156:159], a[108:111], a[124:127], v[156:159]
  v_mfma_f32_16x16x32_bf16 v[156:159], a[140:143], a[156:159], v[156:159]
  s_waitcnt lgkmcnt(0)
  s_nop 0
  v_cvt_pk_bf16_f32 v56, v144, v145
  v_cvt_pk_bf16_f32 v57, v146, v147
  v_mfma_f32_16x16x32_bf16 v[96:99], a[32:35], a[48:51], v[96:99]
  v_cvt_pk_bf16_f32 v58, v148, v149
  v_cvt_pk_bf16_f32 v59, v150, v151
  v_mfma_f32_16x16x32_bf16 v[96:99], a[64:67], a[80:83], v[96:99]
  buffer_store_dwordx4 v[56:59], v12, s[68:71], s74 offen offset:0 sc1
  v_mfma_f32_16x16x32_bf16 v[100:103], a[36:39], a[48:51], v[100:103]
  v_mfma_f32_16x16x32_bf16 v[100:103], a[68:71], a[80:83], v[100:103]
  v_cvt_pk_bf16_f32 v60, v152, v153
  v_cvt_pk_bf16_f32 v61, v154, v155
  v_mfma_f32_16x16x32_bf16 v[104:107], a[40:43], a[48:51], v[104:107]
  v_cvt_pk_bf16_f32 v62, v156, v157
  v_cvt_pk_bf16_f32 v63, v158, v159
  v_mfma_f32_16x16x32_bf16 v[104:107], a[72:75], a[80:83], v[104:107]
  buffer_store_dwordx4 v[60:63], v12, s[68:71], s74 offen offset:1024 sc1
  v_mfma_f32_16x16x32_bf16 v[108:111], a[44:47], a[48:51], v[108:111]
  v_mfma_f32_16x16x32_bf16 v[108:111], a[76:79], a[80:83], v[108:111]
  v_mfma_f32_16x16x32_bf16 v[96:99], a[96:99], a[112:115], v[96:99]
  v_mfma_f32_16x16x32_bf16 v[96:99], a[128:131], a[144:147], v[96:99]
  v_mfma_f32_16x16x32_bf16 v[100:103], a[100:103], a[112:115], v[100:103]
  v_mfma_f32_16x16x32_bf16 v[100:103], a[132:135], a[144:147], v[100:103]
  v_mfma_f32_16x16x32_bf16 v[104:107], a[104:107], a[112:115], v[104:107]
  v_mfma_f32_16x16x32_bf16 v[104:107], a[136:139], a[144:147], v[104:107]
  v_mfma_f32_16x16x32_bf16 v[108:111], a[108:111], a[112:115], v[108:111]
  v_mfma_f32_16x16x32_bf16 v[108:111], a[140:143], a[144:147], v[108:111]
  buffer_load_dwordx4 v[64:67], v12, s[68:71], s47 offen offset:0 sc1
  buffer_load_dwordx4 v[68:71], v12, s[68:71], s47 offen offset:1024 sc1
  buffer_load_dwordx4 v[72:75], v12, s[68:71], s5 offen offset:0 sc1
  buffer_load_dwordx4 v[76:79], v12, s[68:71], s5 offen offset:1024 sc1
  buffer_load_dwordx4 v[80:83], v12, s[68:71], s6 offen offset:0 sc1
  buffer_load_dwordx4 v[84:87], v12, s[68:71], s6 offen offset:1024 sc1
  s_waitcnt vmcnt(12)
  v_lshlrev_b32 v10, 16, v32
  v_and_b32 v11, 0xffff0000, v32
  v_pk_add_f32 v[96:97], v[96:97], v[10:11]
  v_lshlrev_b32 v88, 16, v33
  v_and_b32 v89, 0xffff0000, v33
  v_pk_add_f32 v[98:99], v[98:99], v[88:89]
  v_lshlrev_b32 v10, 16, v34
  v_and_b32 v11, 0xffff0000, v34
  v_pk_add_f32 v[100:101], v[100:101], v[10:11]
  v_lshlrev_b32 v88, 16, v35
  v_and_b32 v89, 0xffff0000, v35
  v_pk_add_f32 v[102:103], v[102:103], v[88:89]
  v_lshlrev_b32 v10, 16, v36
  v_and_b32 v11, 0xffff0000, v36
  v_pk_add_f32 v[104:105], v[104:105], v[10:11]
  v_lshlrev_b32 v88, 16, v37
  v_and_b32 v89, 0xffff0000, v37
  v_pk_add_f32 v[106:107], v[106:107], v[88:89]
  v_lshlrev_b32 v10, 16, v38
  v_and_b32 v11, 0xffff0000, v38
  v_pk_add_f32 v[108:109], v[108:109], v[10:11]
  v_lshlrev_b32 v88, 16, v39
  v_and_b32 v89, 0xffff0000, v39
  v_pk_add_f32 v[110:111], v[110:111], v[88:89]
  s_waitcnt vmcnt(0)
  v_max3_u32 v10, v64, v65, v66
  v_max3_u32 v11, v67, v68, v69
  v_max3_u32 v10, v10, v70, v71
  v_max_u32 v10, v10, v11
  v_cmp_eq_u32 s[10:11], -1, v10
  v_max3_u32 v10, v72, v73, v74
  v_max3_u32 v11, v75, v76, v77
  v_max3_u32 v10, v10, v78, v79
  v_max_u32 v10, v10, v11
  v_cmp_eq_u32 s[12:13], -1, v10
  v_max3_u32 v10, v80, v81, v82
  v_max3_u32 v11, v83, v84, v85
  v_max3_u32 v10, v10, v86, v87
  v_max_u32 v10, v10, v11
  v_cmp_eq_u32 s[14:15], -1, v10
  s_or_b64 vcc, s[10:11], s[12:13]
  s_or_b64 vcc, vcc, s[14:15]
  s_cbranch_scc1 L_y_spin
L_y_ok:
  v_lshlrev_b32 v10, 16, v64
  v_and_b32 v11, 0xffff0000, v64
  v_pk_add_f32 v[96:97], v[96:97], v[10:11]
  v_lshlrev_b32 v88, 16, v65
  v_and_b32 v89, 0xffff0000, v65
  v_pk_add_f32 v[98:99], v[98:99], v[88:89]
  v_lshlrev_b32 v10, 16, v66
  v_and_b32 v11, 0xffff0000, v66
  v_pk_add_f32 v[100:101], v[100:101], v[10:11]
  v_lshlrev_b32 v88, 16, v67
  v_and_b32 v89, 0xffff0000, v67
  v_pk_add_f32 v[102:103], v[102:103], v[88:89]
  v_lshlrev_b32 v10, 16, v68
  v_and_b32 v11, 0xffff0000, v68
  v_pk_add_f32 v[104:105], v[104:105], v[10:11]
  v_lshlrev_b32 v88, 16, v69
  v_and_b32 v89, 0xffff0000, v69
  v_pk_add_f32 v[106:107], v[106:107], v[88:89]
  v_lshlrev_b32 v10, 16, v70
  v_and_b32 v11, 0xffff0000, v70
  v_pk_add_f32 v[108:109], v[108:109], v[10:11]
  v_lshlrev_b32 v88, 16, v71
  v_and_b32 v89, 0xffff0000, v71
  v_pk_add_f32 v[110:111], v[110:111], v[88:89]
  v_lshlrev_b32 v10, 16, v72
  v_and_b32 v11, 0xffff0000, v72
  v_pk_add_f32 v[96:97], v[96:97], v[10:11]
  v_lshlrev_b32 v88, 16, v73
  v_and_b32 v89, 0xffff0000, v73
  v_pk_add_f32 v[98:99], v[98:99], v[88:89]
  v_lshlrev_b32 v10, 16, v74
  v_and_b32 v11, 0xffff0000, v74
  v_pk_add_f32 v[100:101], v[100:101], v[10:11]
  v_lshlrev_b32 v88, 16, v75
  v_and_b32 v89, 0xffff0000, v75
  v_pk_add_f32 v[102:103], v[102:103], v[88:89]
  v_lshlrev_b32 v10, 16, v76
  v_and_b32 v11, 0xffff0000, v76
  v_pk_add_f32 v[104:105], v[104:105], v[10:11]
  v_lshlrev_b32 v88, 16, v77
  v_and_b32 v89, 0xffff0000, v77
  v_pk_add_f32 v[106:107], v[106:107], v[88:89]
  v_lshlrev_b32 v10, 16, v78
  v_and_b32 v11, 0xffff0000, v78
  v_pk_add_f32 v[108:109], v[108:109], v[10:11]
  v_lshlrev_b32 v88, 16, v79
  v_and_b32 v89, 0xffff0000, v79
  v_pk_add_f32 v[110:111], v[110:111], v[88:89]
  v_lshlrev_b32 v10, 16, v80
  v_and_b32 v11, 0xffff0000, v80
  v_pk_add_f32 v[96:97], v[96:97], v[10:11]
  v_lshlrev_b32 v88, 16, v81
  v_and_b32 v89, 0xffff0000, v81
  v_pk_add_f32 v[98:99], v[98:99], v[88:89]
  v_lshlrev_b32 v10, 16, v82
  v_and_b32 v11, 0xffff0000, v82
  v_pk_add_f32 v[100:101], v[100:101], v[10:11]
  v_lshlrev_b32 v88, 16, v83
  v_and_b32 v89, 0xffff0000, v83
  v_pk_add_f32 v[102:103], v[102:103], v[88:89]
  v_lshlrev_b32 v10, 16, v84
  v_and_b32 v11, 0xffff0000, v84
  v_pk_add_f32 v[104:105], v[104:105], v[10:11]
  v_lshlrev_b32 v88, 16, v85
  v_and_b32 v89, 0xffff0000, v85
  v_pk_add_f32 v[106:107], v[106:107], v[88:89]
  v_lshlrev_b32 v10, 16, v86
  v_and_b32 v11, 0xffff0000, v86
  v_pk_add_f32 v[108:109], v[108:109], v[10:11]
  v_lshlrev_b32 v88, 16, v87
  v_and_b32 v89, 0xffff0000, v87
  v_pk_add_f32 v[110:111], v[110:111], v[88:89]
  v_cvt_pk_bf16_f32 v40, v96, v97
  v_cvt_pk_bf16_f32 v41, v98, v99
  v_cvt_pk_bf16_f32 v42, v100, v101
  v_cvt_pk_bf16_f32 v43, v102, v103
  v_cvt_pk_bf16_f32 v44, v104, v105
  v_cvt_pk_bf16_f32 v45, v106, v107
  v_cvt_pk_bf16_f32 v46, v108, v109
  v_cvt_pk_bf16_f32 v47, v110, v111
  v_permlane16_swap_b32 v40, v42
  v_permlane16_swap_b32 v41, v43
  buffer_store_dwordx4 v[40:43], v8, s[64:67], s8 offen offset:0 sc1
  v_permlane16_swap_b32 v44, v46
  v_permlane16_swap_b32 v45, v47
  buffer_store_dwordx4 v[44:47], v8, s[64:67], s8 offen offset:64 sc1
L_end:
  s_endpgm
L_cold:
L_y_spin:
  s_mov_b32 s92, 0x40000
L_y_loop:
  s_cmp_eq_u64 s[10:11], 0
  s_cbranch_scc1 L_y_s0
  buffer_load_dwordx4 v[64:67], v12, s[68:71], s47 offen offset:0 sc1
  buffer_load_dwordx4 v[68:71], v12, s[68:71], s47 offen offset:1024 sc1
L_y_s0:
  s_cmp_eq_u64 s[12:13], 0
  s_cbranch_scc1 L_y_s1
  buffer_load_dwordx4 v[72:75], v12, s[68:71], s5 offen offset:0 sc1
  buffer_load_dwordx4 v[76:79], v12, s[68:71], s5 offen offset:1024 sc1
L_y_s1:
  s_cmp_eq_u64 s[14:15], 0
  s_cbranch_scc1 L_y_s2
  buffer_load_dwordx4 v[80:83], v12, s[68:71], s6 offen offset:0 sc1
  buffer_load_dwordx4 v[84:87], v12, s[68:71], s6 offen offset:1024 sc1
L_y_s2:
  s_waitcnt vmcnt(0)
  v_max3_u32 v10, v64, v65, v66
  v_max3_u32 v11, v67, v68, v69
  v_max3_u32 v10, v10, v70, v71
  v_max_u32 v10, v10, v11
  v_cmp_eq_u32 s[10:11], -1, v10
  v_max3_u32 v10, v72, v73, v74
  v_max3_u32 v11, v75, v76, v77
  v_max3_u32 v10, v10, v78, v79
  v_max_u32 v10, v10, v11
  v_cmp_eq_u32 s[12:13], -1, v10
  v_max3_u32 v10, v80, v81, v82
  v_max3_u32 v11, v83, v84, v85
  v_max3_u32 v10, v10, v86, v87
  v_max_u32 v10, v10, v11
  v_cmp_eq_u32 s[14:15], -1, v10
  s_or_b64 vcc, s[10:11], s[12:13]
  s_or_b64 vcc, vcc, s[14:15]
  s_cbranch_scc0 L_y_ok
  s_sub_u32 s92, s92, 1
  s_cmp_lg_u32 s92, 0
  s_cbranch_scc1 L_y_loop
  s_branch L_y_ok
L_dxm:
  s_cbranch_execz L_dm
  buffer_load_dword v13, v27, s[68:71], s89 offen sc1
  v_mfma_f32_16x16x32_bf16 v[32:35], a[0:3], v[160:163], v[32:35]
  s_xor_b32 s49, s49, 0x10000
  v_exp_f32 v2, v128
  v_xor_b32 v249, 0x10000, v249
  v_mfma_f32_16x16x32_bf16 v[40:43], a[0:3], v[164:167], v[40:43]
  s_waitcnt vmcnt(16)
  s_barrier
  v_mfma_f32_16x16x32_bf16 a[200:203], a[0:3], v[172:175], a[200:203]
  ds_read_b128 a[32:35], v249 offset:0
  ds_read_b128 a[36:39], v249 offset:1024
  ds_read_b128 a[40:43], v249 offset:2048
  v_mfma_f32_16x16x32_bf16 v[36:39], a[4:7], v[160:163], v[36:39]
  s_add_u32 s48, s39, 16384
  ds_read_b128 a[44:47], v249 offset:3072
  v_exp_f32 v3, v129
  v_mfma_f32_16x16x32_bf16 v[44:47], a[4:7], v[164:167], v[44:47]
  ds_read_b128 a[48:51], v249 offset:4096
  v_cvt_pk_bf16_f32 v176, v2, v3
  v_cndmask_b32 v192, v11, v224, s[0:1]
  v_mfma_f32_16x16x32_bf16 a[204:207], a[4:7], v[172:175], a[204:207]
  v_exp_f32 v4, v130
  v_cndmask_b32 v193, v11, v224, s[2:3]
  v_mfma_f32_16x16x32_bf16 v[48:51], a[8:11], v[160:163], v[48:51]
  ds_read_b128 a[52:55], v249 offset:5120
  ds_read_b128 a[56:59], v249 offset:6144
  v_cndmask_b32 v194, v11, v224, s[4:5]
  v_mfma_f32_16x16x32_bf16 v[56:59], a[8:11], v[164:167], v[56:59]
  v_exp_f32 v5, v131
  v_cndmask_b32 v195, v11, v224, s[6:7]
  v_mfma_f32_16x16x32_bf16 a[216:219], a[8:11], v[172:175], a[216:219]
  ds_read_b128 a[60:63], v249 offset:7168
  v_cvt_pk_bf16_f32 v177, v4, v5
  v_cndmask_b32 v196, v11, v224, s[8:9]
  v_mfma_f32_16x16x32_bf16 v[52:55], a[12:15], v[160:163], v[52:55]
  s_xor_b32 m0, s49, 114688
  v_exp_f32 v6, v132
  v_cndmask_b32 v197, v11, v224, s[10:11]
  v_mfma_f32_16x16x32_bf16 v[60:63], a[12:15], v[164:167], v[60:63]
  buffer_load_dwordx4 v12, s[68:71], s48 offen offset:0 sc1 lds
  v_cndmask_b32 v198, v11, v224, s[12:13]
  v_mfma_f32_16x16x32_bf16 a[220:223], a[12:15], v[172:175], a[220:223]
  s_waitcnt lgkmcnt(8)
  v_exp_f32 v7, v133
  v_cndmask_b32 v199, v11, v224, s[14:15]
  v_mfma_f32_16x16x32_bf16 v[64:67], a[16:19], v[160:163], v[64:67]
  ds_read_b128 a[0:3], v249 offset:8192
  v_cvt_pk_bf16_f32 v178, v6, v7
  v_cndmask_b32 v208, v11, v224, s[16:17]
  v_mfma_f32_16x16x32_bf16 v[72:75], a[16:19], v[164:167], v[72:75]
  v_exp_f32 v8, v134
  v_cndmask_b32 v209, v11, v224, s[18:19]
  v_mfma_f32_16x16x32_bf16 a[232:235], a[16:19], v[172:175], a[232:235]
  buffer_load_dwordx4 v12, s[68:71], s48 offen offset:1024 sc1 lds
  v_cndmask_b32 v210, v11, v224, s[20:21]
  v_mfma_f32_16x16x32_bf16 v[68:71], a[20:23], v[160:163], v[68:71]
  v_exp_f32 v9, v135
  v_cndmask_b32 v211, v11, v224, s[22:23]
  v_mfma_f32_16x16x32_bf16 v[76:79], a[20:23], v[164:167], v[76:79]
  ds_read_b128 a[4:7], v249 offset:9216
  v_cvt_pk_bf16_f32 v179, v8, v9
  v_cndmask_b32 v212, v11, v224, s[24:25]
  v_mfma_f32_16x16x32_bf16 a[236:239], a[20:23], v[172:175], a[236:239]
  v_exp_f32 v2, v136
  v_cndmask_b32 v213, v11, v224, s[26:27]
  v_mfma_f32_16x16x32_bf16 v[80:83], a[24:27], v[160:163], v[80:83]
  buffer_load_dwordx4 v12, s[68:71], s48 offen offset:2048 sc1 lds
  v_cndmask_b32 v214, v11, v224, s[28:29]
  v_mfma_f32_16x16x32_bf16 v[88:91], a[24:27], v[164:167], v[88:91]
  v_exp_f32 v3, v137
  v_cndmask_b32 v215, v11, v224, s[30:31]
  v_mfma_f32_16x16x32_bf16 v[244:247], a[68:71], v[176:179], v[240:243]
  buffer_load_dwordx4 v12, s[68:71], s48 offen offset:3072 sc1 lds
  v_mfma_f32_16x16x32_bf16 a[248:251], a[24:27], v[172:175], a[248:251]
  v_exp_f32 v4, v138
  v_mfma_f32_16x16x32_bf16 v[84:87], a[28:31], v[160:163], v[84:87]
  ds_read_b128 a[8:11], v249 offset:10240
  ds_read_b128 a[12:15], v249 offset:11264
  v_mfma_f32_16x16x32_bf16 v[92:95], a[28:31], v[164:167], v[92:95]
  s_waitcnt lgkmcnt(8)
  v_exp_f32 v5, v139
  v_mfma_f32_16x16x32_bf16 a[252:255], a[28:31], v[172:175], a[252:255]
  v_cvt_pk_bf16_f32 v180, v2, v3
  v_cvt_pk_bf16_f32 v181, v4, v5
  v_mfma_f32_16x16x32_bf16 v[192:195], a[32:35], a[160:163], v[192:195]
  ds_read_b128 a[16:19], v249 offset:12288
  ds_read_b128 a[20:23], v249 offset:13312
  v_mfma_f32_16x16x32_bf16 v[192:195], a[36:39], a[164:167], v[192:195]
  s_waitcnt vmcnt(4)
  v_exp_f32 v6, v140
  v_cmp_eq_u32 vcc, 1, v13
  s_nop 0
  s_cmp_eq_u32 vcc_lo, -1
  s_cbranch_scc0 L_h2_spin
L_h2_ok:
  s_add_u32 m0, s88, 131072
  s_add_u32 s84, s87, 0
  v_mfma_f32_16x16x32_bf16 v[192:195], a[40:43], a[168:171], v[192:195]
  buffer_load_dwordx4 v16, s[60:63], s84 offen offset:0 lds
  v_mfma_f32_16x16x32_bf16 v[192:195], a[44:47], a[172:175], v[192:195]
  v_exp_f32 v7, v141
  v_mfma_f32_16x16x32_bf16 v[200:203], a[32:35], a[176:179], v[228:231]
  ds_read_b128 a[24:27], v249 offset:14336
  v_cvt_pk_bf16_f32 v182, v6, v7
  v_mfma_f32_16x16x32_bf16 v[200:203], a[36:39], a[180:183], v[200:203]
  v_exp_f32 v8, v142
  v_mfma_f32_16x16x32_bf16 v[200:203], a[40:43], a[184:187], v[200:203]
  buffer_load_dwordx4 v26, s[60:63], s84 offen offset:1024 lds
  v_mfma_f32_16x16x32_bf16 v[200:203], a[44:47], a[188:191], v[200:203]
  s_waitcnt lgkmcnt(7)
  v_exp_f32 v9, v143
  v_mfma_f32_16x16x32_bf16 v[196:199], a[48:51], a[160:163], v[196:199]
  ds_read_b128 a[28:31], v249 offset:15360
  v_cvt_pk_bf16_f32 v183, v8, v9
  v_mfma_f32_16x16x32_bf16 v[196:199], a[52:55], a[164:167], v[196:199]
  s_add_u32 s85, s86, 0
  v_exp_f32 v2, v152
  v_mfma_f32_16x16x32_bf16 v[196:199], a[56:59], a[168:171], v[196:199]
  buffer_load_dwordx4 v24, s[68:71], s85 offen offset:2048 sc1 lds
  v_mfma_f32_16x16x32_bf16 v[196:199], a[60:63], a[172:175], v[196:199]
  v_exp_f32 v3, v153
  v_mfma_f32_16x16x32_bf16 v[244:247], a[72:75], v[180:183], v[244:247]
  ds_read_b128 a[32:35], v248 offset:57344
  v_cvt_pk_bf16_f32 v188, v2, v3
  v_mfma_f32_16x16x32_bf16 v[204:207], a[48:51], a[176:179], v[228:231]
  v_exp_f32 v4, v154
  v_mfma_f32_16x16x32_bf16 v[204:207], a[52:55], a[180:183], v[204:207]
  buffer_load_dwordx4 v25, s[68:71], s85 offen offset:3072 sc1 lds
  v_mfma_f32_16x16x32_bf16 v[204:207], a[56:59], a[184:187], v[204:207]
  s_waitcnt lgkmcnt(5)
  v_exp_f32 v5, v155
  s_add_u32 m0, s88, 147456
  s_add_u32 s84, s87, 32768
  v_mfma_f32_16x16x32_bf16 v[204:207], a[60:63], a[188:191], v[204:207]
  buffer_load_dwordx4 v16, s[60:63], s84 offen offset:0 lds
  v_mfma_f32_16x16x32_bf16 v[208:211], a[0:3], a[160:163], v[208:211]
  v_exp_f32 v6, v156
  v_mfma_f32_16x16x32_bf16 v[208:211], a[4:7], a[164:167], v[208:211]
  ds_read_b128 a[36:39], v248 offset:58368
  v_cvt_pk_bf16_f32 v189, v4, v5
  v_mfma_f32_16x16x32_bf16 v[208:211], a[8:11], a[168:171], v[208:211]
  v_exp_f32 v7, v157
  v_mfma_f32_16x16x32_bf16 v[208:211], a[12:15], a[172:175], v[208:211]
  buffer_load_dwordx4 v26, s[60:63], s84 offen offset:1024 lds
  v_mfma_f32_16x16x32_bf16 v[216:219], a[0:3], a[176:179], v[228:231]
  s_waitcnt lgkmcnt(2)
  v_exp_f32 v8, v158
  v_mfma_f32_16x16x32_bf16 v[216:219], a[4:7], a[180:183], v[216:219]
  ds_read_b128 a[40:43], v248 offset:59392
  v_cvt_pk_bf16_f32 v190, v6, v7
  v_mfma_f32_16x16x32_bf16 v[216:219], a[8:11], a[184:187], v[216:219]
  s_add_u32 s85, s86, 1024
  v_exp_f32 v9, v159
  v_mfma_f32_16x16x32_bf16 v[216:219], a[12:15], a[188:191], v[216:219]
  buffer_load_dwordx4 v24, s[68:71], s85 offen offset:2048 sc1 lds
  v_cvt_pk_bf16_f32 v191, v8, v9
  v_mfma_f32_16x16x32_bf16 v[212:215], a[16:19], a[160:163], v[212:215]
  ds_read_b128 a[44:47], v248 offset:60416
  ds_read_b128 a[48:51], v248 offset:61440
  v_mfma_f32_16x16x32_bf16 v[244:247], a[80:83], v[188:191], v[244:247]
  ds_read_b128 a[52:55], v248 offset:62464
  ds_read_b128 a[56:59], v248 offset:63488
  v_mfma_f32_16x16x32_bf16 v[212:215], a[20:23], a[164:167], v[212:215]
  buffer_load_dwordx4 v25, s[68:71], s85 offen offset:3072 sc1 lds
  v_mfma_f32_16x16x32_bf16 v[212:215], a[24:27], a[168:171], v[212:215]
  ds_read_b128 a[60:63], v248 offset:64512
  v_mfma_f32_16x16x32_bf16 v[212:215], a[28:31], a[172:175], v[212:215]
  v_mfma_f32_16x16x32_bf16 v[220:223], a[16:19], a[176:179], v[228:231]
  v_max3_f32 v250, v244, v245, v246
  v_mfma_f32_16x16x32_bf16 v[220:223], a[20:23], a[180:183], v[220:223]
  s_waitcnt lgkmcnt(4)
  v_max_f32 v250, v250, v247
  v_cmp_nge_f32 vcc, s44, v250
  v_mfma_f32_16x16x32_bf16 v[220:223], a[24:27], a[184:187], v[220:223]
  v_mfma_f32_16x16x32_bf16 v[220:223], a[28:31], a[188:191], v[220:223]
  s_cbranch_vccnz L_dxm1_rare
L_dxm1_back:
  v_mfma_f32_16x16x32_bf16 v[32:35], a[32:35], v[176:179], v[32:35]
  v_exp_f32 v2, v192
  v_mfma_f32_16x16x32_bf16 v[40:43], a[32:35], v[180:183], v[40:43]
  s_waitcnt vmcnt(63)
  s_barrier
  v_mfma_f32_16x16x32_bf16 a[200:203], a[32:35], v[188:191], a[200:203]
  ds_read_b128 a[0:3], v249 offset:32768
  v_exp_f32 v3, v193
  v_mfma_f32_16x16x32_bf16 v[36:39], a[36:39], v[176:179], v[36:39]
  v_exp_f32 v4, v194
  v_cvt_pk_bf16_f32 v160, v2, v3
  v_mfma_f32_16x16x32_bf16 v[44:47], a[36:39], v[180:183], v[44:47]
  ds_read_b128 a[4:7], v249 offset:33792
  v_exp_f32 v5, v195
  v_mfma_f32_16x16x32_bf16 a[204:207], a[36:39], v[188:191], a[204:207]
  v_exp_f32 v6, v196
  v_cvt_pk_bf16_f32 v161, v4, v5
  v_mfma_f32_16x16x32_bf16 v[48:51], a[40:43], v[176:179], v[48:51]
  ds_read_b128 a[8:11], v249 offset:34816
  v_exp_f32 v7, v197
  v_mfma_f32_16x16x32_bf16 v[56:59], a[40:43], v[180:183], v[56:59]
  v_exp_f32 v8, v198
  v_cvt_pk_bf16_f32 v162, v6, v7
  v_mfma_f32_16x16x32_bf16 a[216:219], a[40:43], v[188:191], a[216:219]
  s_lshl_b32 s80, s77, 12
  v_exp_f32 v9, v199
  v_rcp_f32 v252, v246
  v_rcp_f32 v253, v247
  s_add_u32 s80, s80, s37
  s_add_u32 s82, s80, 704512
  s_add_u32 m0, s88, 65536
  s_add_u32 s84, s87, 65536
  v_mfma_f32_16x16x32_bf16 v[52:55], a[44:47], v[176:179], v[52:55]
  buffer_load_dwordx4 v16, s[60:63], s84 offen offset:0 lds
  v_cndmask_b32 v136, v11, v228, s[0:1]
  v_mfma_f32_16x16x32_bf16 v[60:63], a[44:47], v[180:183], v[60:63]
  v_exp_f32 v2, v200
  v_cvt_pk_bf16_f32 v163, v8, v9
  v_mfma_f32_16x16x32_bf16 a[220:223], a[44:47], v[188:191], a[220:223]
  s_waitcnt lgkmcnt(3)
  ds_read_b128 a[12:15], v249 offset:35840
  v_exp_f32 v3, v201
  v_mfma_f32_16x16x32_bf16 v[64:67], a[48:51], v[176:179], v[64:67]
  v_exp_f32 v4, v202
  v_cvt_pk_bf16_f32 v164, v2, v3
  v_mfma_f32_16x16x32_bf16 v[72:75], a[48:51], v[180:183], v[72:75]
  ds_read_b128 a[16:19], v249 offset:36864
  v_exp_f32 v5, v203
  v_mfma_f32_16x16x32_bf16 a[232:235], a[48:51], v[188:191], a[232:235]
  v_exp_f32 v6, v204
  v_cvt_pk_bf16_f32 v165, v4, v5
  v_mfma_f32_16x16x32_bf16 v[68:71], a[52:55], v[176:179], v[68:71]
  ds_read_b128 a[20:23], v249 offset:37888
  v_exp_f32 v7, v205
  v_mfma_f32_16x16x32_bf16 v[240:243], a[68:71], v[160:163], v[244:247]
  v_exp_f32 v8, v206
  v_cvt_pk_bf16_f32 v166, v6, v7
  v_mfma_f32_16x16x32_bf16 v[76:79], a[52:55], v[180:183], v[76:79]
  ds_read_b128 a[24:27], v249 offset:38912
  v_exp_f32 v9, v207
  v_mfma_f32_16x16x32_bf16 a[236:239], a[52:55], v[188:191], a[236:239]
  ds_read_b128 a[28:31], v249 offset:39936
  v_exp_f32 v2, v208
  v_mfma_f32_16x16x32_bf16 v[80:83], a[56:59], v[176:179], v[80:83]
  v_exp_f32 v3, v209
  v_cvt_pk_bf16_f32 v167, v8, v9
  v_mfma_f32_16x16x32_bf16 v[88:91], a[56:59], v[180:183], v[88:91]
  ds_read_b128 a[32:35], v249 offset:40960
  v_exp_f32 v4, v210
  v_mfma_f32_16x16x32_bf16 a[248:251], a[56:59], v[188:191], a[248:251]
  ds_read_b128 a[36:39], v249 offset:41984
  v_exp_f32 v5, v211
  v_mfma_f32_16x16x32_bf16 v[84:87], a[60:63], v[176:179], v[84:87]
  ds_read_b128 a[40:43], v249 offset:43008
  v_exp_f32 v6, v212
  v_mfma_f32_16x16x32_bf16 v[92:95], a[60:63], v[180:183], v[92:95]
  ds_read_b128 a[44:47], v249 offset:44032
  v_exp_f32 v7, v213
  v_cndmask_b32 v137, v11, v228, s[2:3]
  v_cndmask_b32 v138, v11, v228, s[4:5]
  v_cndmask_b32 v139, v11, v228, s[6:7]
  v_mfma_f32_16x16x32_bf16 a[252:255], a[60:63], v[188:191], a[252:255]
  v_exp_f32 v8, v214
  v_cvt_pk_bf16_f32 v168, v2, v3
  v_mfma_f32_16x16x32_bf16 v[240:243], a[72:75], v[164:167], v[240:243]
  s_waitcnt lgkmcnt(8)
  v_exp_f32 v9, v215
  v_cvt_pk_bf16_f32 v169, v4, v5
  v_mfma_f32_16x16x32_bf16 v[136:139], a[0:3], a[176:179], v[136:139]
  buffer_load_dwordx4 v26, s[60:63], s84 offen offset:1024 lds
  v_cndmask_b32 v140, v11, v228, s[8:9]
  v_mfma_f32_16x16x32_bf16 v[136:139], a[4:7], a[180:183], v[136:139]
  v_exp_f32 v2, v216
  v_cvt_pk_bf16_f32 v170, v6, v7
  v_mfma_f32_16x16x32_bf16 v[136:139], a[8:11], a[184:187], v[136:139]
  v_exp_f32 v3, v217
  v_cvt_pk_bf16_f32 v171, v8, v9
  v_cndmask_b32 v141, v11, v228, s[10:11]
  v_cndmask_b32 v142, v11, v228, s[12:13]
  v_cndmask_b32 v143, v11, v228, s[14:15]
  v_mfma_f32_16x16x32_bf16 v[136:139], a[12:15], a[188:191], v[136:139]
  ds_read_b128 a[48:51], v249 offset:45056
  v_exp_f32 v4, v218
  v_mfma_f32_16x16x32_bf16 v[240:243], a[68:71], v[168:171], v[240:243]
  s_waitcnt lgkmcnt(5)
  ds_read_b128 a[52:55], v249 offset:46080
  v_exp_f32 v5, v219
  v_mfma_f32_16x16x32_bf16 v[140:143], a[16:19], a[176:179], v[140:143]
  ds_read_b128 a[56:59], v249 offset:47104
  ds_read_b128 a[60:63], v249 offset:48128
  v_exp_f32 v6, v220
  v_mfma_f32_16x16x32_bf16 v[140:143], a[20:23], a[180:183], v[140:143]
  ds_read_b128 a[0:3], v249 offset:16384
  v_exp_f32 v7, v221
  v_cndmask_b32 v152, v11, v228, s[16:17]
  v_cndmask_b32 v153, v11, v228, s[18:19]
  v_cndmask_b32 v154, v11, v228, s[20:21]
  v_cndmask_b32 v155, v11, v228, s[22:23]
  v_mfma_f32_16x16x32_bf16 v[140:143], a[24:27], a[184:187], v[140:143]
  s_waitcnt lgkmcnt(5)
  ds_read_b128 a[4:7], v249 offset:24576
  v_exp_f32 v8, v222
  v_mfma_f32_16x16x32_bf16 v[140:143], a[28:31], a[188:191], v[140:143]
  s_add_u32 s85, s86, 2048
  ds_read_b128 a[8:11], v249 offset:17408
  v_exp_f32 v9, v223
  v_mfma_f32_16x16x32_bf16 v[152:155], a[32:35], a[176:179], v[152:155]
  buffer_load_dwordx4 v24, s[68:71], s85 offen offset:2048 sc1 lds
  ds_read_b128 a[12:15], v249 offset:25600
  v_cvt_pk_bf16_f32 v172, v2, v3
  v_cvt_pk_bf16_f32 v173, v4, v5
  v_cvt_pk_bf16_f32 v174, v6, v7
  v_cvt_pk_bf16_f32 v175, v8, v9
  v_mfma_f32_16x16x32_bf16 v[152:155], a[36:39], a[180:183], v[152:155]
  buffer_load_dwordx4 v25, s[68:71], s85 offen offset:3072 sc1 lds
  s_add_u32 m0, s88, 98304
  s_add_u32 s84, s87, 98304
  v_mfma_f32_16x16x32_bf16 v[240:243], a[72:75], v[172:175], v[240:243]
  buffer_load_dwordx4 v16, s[60:63], s84 offen offset:0 lds
  v_cndmask_b32 v156, v11, v228, s[24:25]
  v_cndmask_b32 v157, v11, v228, s[26:27]
  v_cndmask_b32 v158, v11, v228, s[28:29]
  v_cndmask_b32 v159, v11, v228, s[30:31]
  v_mfma_f32_16x16x32_bf16 v[152:155], a[40:43], a[184:187], v[152:155]
  buffer_load_dwordx4 v26, s[60:63], s84 offen offset:1024 lds
  s_add_u32 s85, s86, 3072
  v_mfma_f32_16x16x32_bf16 v[152:155], a[44:47], a[188:191], v[152:155]
  buffer_load_dwordx4 v24, s[68:71], s85 offen offset:2048 sc1 lds
  s_waitcnt lgkmcnt(4)
  v_mfma_f32_16x16x32_bf16 v[156:159], a[48:51], a[176:179], v[156:159]
  buffer_load_dwordx4 v25, s[68:71], s85 offen offset:3072 sc1 lds
  v_mfma_f32_16x16x32_bf16 v[156:159], a[52:55], a[180:183], v[156:159]
  s_waitcnt lgkmcnt(0)
  v_max_f32 v250, v240, v241
  v_cmp_nge_f32 vcc, s44, v250
  v_xor_b32 v248, 0x10000, v248
  v_mfma_f32_16x16x32_bf16 v[156:159], a[56:59], a[184:187], v[156:159]
  ds_read_b128 a[16:19], v249 offset:18432
  ds_read_b128 a[20:23], v249 offset:26624
  ds_read_b128 a[24:27], v249 offset:19456
  v_mfma_f32_16x16x32_bf16 v[156:159], a[60:63], a[188:191], v[156:159]
  s_cbranch_vccnz L_dxm2_rare
L_dxm2_back:
  ds_read_b128 a[28:31], v249 offset:27648
  ds_read_b128 a[32:35], v249 offset:20480
  ds_read_b128 a[36:39], v249 offset:28672
  ds_read_b128 a[40:43], v249 offset:21504
  ds_read_b128 a[44:47], v249 offset:29696
  v_accvgpr_read_b32 v112, a192
  v_accvgpr_read_b32 v113, a193
  v_accvgpr_read_b32 v114, a194
  v_accvgpr_read_b32 v115, a195
  v_accvgpr_read_b32 v116, a196
  v_accvgpr_read_b32 v117, a197
  v_accvgpr_read_b32 v118, a198
  v_accvgpr_read_b32 v119, a199
  v_pk_mul_f32 v[112:113], v[112:113], v[252:253] op_sel:[0,0] op_sel_hi:[1,0]
  v_pk_mul_f32 v[114:115], v[114:115], v[252:253] op_sel:[0,0] op_sel_hi:[1,0]
  v_pk_mul_f32 v[116:117], v[116:117], v[252:253] op_sel:[0,0] op_sel_hi:[1,0]
  v_pk_mul_f32 v[118:119], v[118:119], v[252:253] op_sel:[0,0] op_sel_hi:[1,0]
  v_cvt_pk_bf16_f32 v96, v112, v113
  v_cvt_pk_bf16_f32 v97, v114, v115
  v_cvt_pk_bf16_f32 v98, v116, v117
  v_cvt_pk_bf16_f32 v99, v118, v119
  buffer_store_dwordx4 v[96:99], v12, s[68:71], s80 offen offset:0 sc1
  v_accvgpr_read_b32 v120, a200
  v_accvgpr_read_b32 v121, a201
  v_accvgpr_read_b32 v122, a202
  v_accvgpr_read_b32 v123, a203
  v_accvgpr_read_b32 v124, a204
  v_accvgpr_read_b32 v125, a205
  v_accvgpr_read_b32 v126, a206
  v_accvgpr_read_b32 v127, a207
  v_pk_mul_f32 v[120:121], v[120:121], v[252:253] op_sel:[0,1] op_sel_hi:[1,1]
  v_pk_mul_f32 v[122:123], v[122:123], v[252:253] op_sel:[0,1] op_sel_hi:[1,1]
  s_add_u32 m0, s88, 81920
  s_add_u32 s84, s87, 131072
  buffer_load_dwordx4 v16, s[60:63], s84 offen offset:0 lds
  v_pk_mul_f32 v[124:125], v[124:125], v[252:253] op_sel:[0,1] op_sel_hi:[1,1]
  v_pk_mul_f32 v[126:127], v[126:127], v[252:253] op_sel:[0,1] op_sel_hi:[1,1]
  v_cvt_pk_bf16_f32 v100, v120, v121
  v_cvt_pk_bf16_f32 v101, v122, v123
  v_cvt_pk_bf16_f32 v102, v124, v125
  v_cvt_pk_bf16_f32 v103, v126, v127
  buffer_store_dwordx4 v[100:103], v12, s[68:71], s82 offen offset:0 sc1
  v_accvgpr_read_b32 v112, a208
  v_accvgpr_read_b32 v113, a209
  v_accvgpr_read_b32 v114, a210
  v_accvgpr_read_b32 v115, a211
  v_accvgpr_read_b32 v116, a212
  v_accvgpr_read_b32 v117, a213
  v_accvgpr_read_b32 v118, a214
  v_accvgpr_read_b32 v119, a215
  v_pk_mul_f32 v[112:113], v[112:113], v[252:253] op_sel:[0,0] op_sel_hi:[1,0]
  v_pk_mul_f32 v[114:115], v[114:115], v[252:253] op_sel:[0,0] op_sel_hi:[1,0]
  v_pk_mul_f32 v[116:117], v[116:117], v[252:253] op_sel:[0,0] op_sel_hi:[1,0]
  v_pk_mul_f32 v[118:119], v[118:119], v[252:253] op_sel:[0,0] op_sel_hi:[1,0]
  v_cvt_pk_bf16_f32 v104, v112, v113
  v_cvt_pk_bf16_f32 v105, v114, v115
  v_cvt_pk_bf16_f32 v106, v116, v117
  v_cvt_pk_bf16_f32 v107, v118, v119
  buffer_store_dwordx4 v[104:107], v12, s[68:71], s80 offen offset:1024 sc1
  v_accvgpr_read_b32 v120, a216
  v_accvgpr_read_b32 v121, a217
  v_accvgpr_read_b32 v122, a218
  buffer_load_dwordx4 v26, s[60:63], s84 offen offset:1024 lds
  v_accvgpr_read_b32 v123, a219
  v_accvgpr_read_b32 v124, a220
  v_accvgpr_read_b32 v125, a221
  v_accvgpr_read_b32 v126, a222
  v_accvgpr_read_b32 v127, a223
  v_pk_mul_f32 v[120:121], v[120:121], v[252:253] op_sel:[0,1] op_sel_hi:[1,1]
  v_pk_mul_f32 v[122:123], v[122:123], v[252:253] op_sel:[0,1] op_sel_hi:[1,1]
  v_pk_mul_f32 v[124:125], v[124:125], v[252:253] op_sel:[0,1] op_sel_hi:[1,1]
  v_pk_mul_f32 v[126:127], v[126:127], v[252:253] op_sel:[0,1] op_sel_hi:[1,1]
  v_cvt_pk_bf16_f32 v108, v120, v121
  v_cvt_pk_bf16_f32 v109, v122, v123
  v_cvt_pk_bf16_f32 v110, v124, v125
  v_cvt_pk_bf16_f32 v111, v126, v127
  buffer_store_dwordx4 v[108:111], v12, s[68:71], s82 offen offset:1024 sc1
  v_accvgpr_read_b32 v112, a224
  v_accvgpr_read_b32 v113, a225
  v_accvgpr_read_b32 v114, a226
  v_accvgpr_read_b32 v115, a227
  v_accvgpr_read_b32 v116, a228
  v_accvgpr_read_b32 v117, a229
  v_accvgpr_read_b32 v118, a230
  v_accvgpr_read_b32 v119, a231
  v_pk_mul_f32 v[112:113], v[112:113], v[252:253] op_sel:[0,0] op_sel_hi:[1,0]
  v_pk_mul_f32 v[114:115], v[114:115], v[252:253] op_sel:[0,0] op_sel_hi:[1,0]
  v_pk_mul_f32 v[116:117], v[116:117], v[252:253] op_sel:[0,0] op_sel_hi:[1,0]
  v_pk_mul_f32 v[118:119], v[118:119], v[252:253] op_sel:[0,0] op_sel_hi:[1,0]
  v_cvt_pk_bf16_f32 v96, v112, v113
  s_add_u32 s85, s86, 4096
  buffer_load_dwordx4 v24, s[68:71], s85 offen offset:2048 sc1 lds
  v_cvt_pk_bf16_f32 v97, v114, v115
  v_cvt_pk_bf16_f32 v98, v116, v117
  v_cvt_pk_bf16_f32 v99, v118, v119
  buffer_store_dwordx4 v[96:99], v12, s[68:71], s80 offen offset:2048 sc1
  v_accvgpr_read_b32 v120, a232
  v_accvgpr_read_b32 v121, a233
  v_accvgpr_read_b32 v122, a234
  v_accvgpr_read_b32 v123, a235
  v_accvgpr_read_b32 v124, a236
  v_accvgpr_read_b32 v125, a237
  v_accvgpr_read_b32 v126, a238
  v_accvgpr_read_b32 v127, a239
  v_pk_mul_f32 v[120:121], v[120:121], v[252:253] op_sel:[0,1] op_sel_hi:[1,1]
  v_pk_mul_f32 v[122:123], v[122:123], v[252:253] op_sel:[0,1] op_sel_hi:[1,1]
  v_pk_mul_f32 v[124:125], v[124:125], v[252:253] op_sel:[0,1] op_sel_hi:[1,1]
  v_pk_mul_f32 v[126:127], v[126:127], v[252:253] op_sel:[0,1] op_sel_hi:[1,1]
  v_cvt_pk_bf16_f32 v100, v120, v121
  v_cvt_pk_bf16_f32 v101, v122, v123
  v_cvt_pk_bf16_f32 v102, v124, v125
  v_cvt_pk_bf16_f32 v103, v126, v127
  buffer_store_dwordx4 v[100:103], v12, s[68:71], s82 offen offset:2048 sc1
  v_accvgpr_read_b32 v112, a240
  v_accvgpr_read_b32 v113, a241
  v_accvgpr_read_b32 v114, a242
  v_accvgpr_read_b32 v115, a243
  v_accvgpr_read_b32 v116, a244
  v_accvgpr_read_b32 v117, a245
  buffer_load_dwordx4 v25, s[68:71], s85 offen offset:3072 sc1 lds
  v_accvgpr_read_b32 v118, a246
  v_accvgpr_read_b32 v119, a247
  v_pk_mul_f32 v[112:113], v[112:113], v[252:253] op_sel:[0,0] op_sel_hi:[1,0]
  v_pk_mul_f32 v[114:115], v[114:115], v[252:253] op_sel:[0,0] op_sel_hi:[1,0]
  v_pk_mul_f32 v[116:117], v[116:117], v[252:253] op_sel:[0,0] op_sel_hi:[1,0]
  v_pk_mul_f32 v[118:119], v[118:119], v[252:253] op_sel:[0,0] op_sel_hi:[1,0]
  v_cvt_pk_bf16_f32 v104, v112, v113
  v_cvt_pk_bf16_f32 v105, v114, v115
  v_cvt_pk_bf16_f32 v106, v116, v117
  v_cvt_pk_bf16_f32 v107, v118, v119
  buffer_store_dwordx4 v[104:107], v12, s[68:71], s80 offen offset:3072 sc1
  v_accvgpr_read_b32 v120, a248
  v_accvgpr_read_b32 v121, a249
  v_accvgpr_read_b32 v122, a250
  v_accvgpr_read_b32 v123, a251
  v_accvgpr_read_b32 v124, a252
  v_accvgpr_read_b32 v125, a253
  v_accvgpr_read_b32 v126, a254
  v_accvgpr_read_b32 v127, a255
  v_pk_mul_f32 v[120:121], v[120:121], v[252:253] op_sel:[0,1] op_sel_hi:[1,1]
  v_pk_mul_f32 v[122:123], v[122:123], v[252:253] op_sel:[0,1] op_sel_hi:[1,1]
  v_pk_mul_f32 v[124:125], v[124:125], v[252:253] op_sel:[0,1] op_sel_hi:[1,1]
  v_pk_mul_f32 v[126:127], v[126:127], v[252:253] op_sel:[0,1] op_sel_hi:[1,1]
  v_cvt_pk_bf16_f32 v108, v120, v121
  v_cvt_pk_bf16_f32 v109, v122, v123
  v_cvt_pk_bf16_f32 v110, v124, v125
  v_cvt_pk_bf16_f32 v111, v126, v127
  buffer_store_dwordx4 v[108:111], v12, s[68:71], s82 offen offset:3072 sc1
  s_branch L_last
L_xn_spin:
  s_mov_b32 s92, 0x40000
L_xn_loop:
  buffer_load_dword v13, v4, s[72:75], 0 offen sc1
  s_waitcnt vmcnt(0)
  v_readlane_b32 s80, v13, 0
  v_readlane_b32 s81, v13, 1
  s_nop 0
  s_add_u32 s80, s80, s81
  s_cmp_ge_u32 s80, 256
  s_cbranch_scc1 L_xn_ok
  s_sub_u32 s92, s92, 1
  s_cmp_lg_u32 s92, 0
  s_cbranch_scc1 L_xn_loop
  s_branch L_xn_ok
L_kv_spin:
  s_mov_b32 s92, 0x40000
L_kv_loop:
  buffer_load_dword v13, v18, s[68:71], s82 offen sc1
  s_waitcnt vmcnt(0)
  v_cmp_le_u32 vcc, 1, v13
  s_nop 0
  s_and_b32 s80, vcc_lo, 257
  s_cmp_eq_u32 s80, 257
  s_cbranch_scc1 L_kv_ok
  s_sub_u32 s92, s92, 1
  s_cmp_lg_u32 s92, 0
  s_cbranch_scc1 L_kv_loop
  s_branch L_kv_ok
L_kv2_spin:
  s_mov_b32 s92, 0x40000
L_kv2_loop:
  buffer_load_dword v13, v18, s[68:71], s82 offen sc1
  s_waitcnt vmcnt(0)
  v_cmp_le_u32 vcc, 2, v13
  s_nop 0
  s_and_b32 s80, vcc_lo, 257
  s_cmp_eq_u32 s80, 257
  s_cbranch_scc1 L_kv2_ok
  s_sub_u32 s92, s92, 1
  s_cmp_lg_u32 s92, 0
  s_cbranch_scc1 L_kv2_loop
  s_branch L_kv2_ok
L_kv3_spin:
  s_mov_b32 s92, 0x40000
L_kv3_loop:
  buffer_load_dword v13, v18, s[68:71], s82 offen sc1
  s_waitcnt vmcnt(0)
  v_cmp_le_u32 vcc, 2, v13
  s_nop 0
  s_and_b32 s80, vcc_lo, 65535
  s_cmp_eq_u32 s80, 65535
  s_cbranch_scc1 L_kv3_ok
  s_sub_u32 s92, s92, 1
  s_cmp_lg_u32 s92, 0
  s_cbranch_scc1 L_kv3_loop
  s_branch L_kv3_ok
L_g1_rare:
  s_call_b64 s[94:95], L_rare1100d
  s_branch L_g1_back
L_g2_rare:
  s_call_b64 s[94:95], L_rare0100d
  s_branch L_g2_back
L_dl0_rare:
  s_call_b64 s[94:95], L_rare1100d
  s_branch L_dl0_back
L_dl1_rare:
  s_call_b64 s[94:95], L_rare0100d
  s_branch L_dl1_back
L_dl2_rare:
  s_call_b64 s[94:95], L_rare1100d
  s_branch L_dl2_back
L_dl3_rare:
  s_call_b64 s[94:95], L_rare0100d
  s_branch L_dl3_back
L_dm0_rare:
  s_call_b64 s[94:95], L_rare1100d
  s_branch L_dm0_back
L_dm1_rare:
  s_call_b64 s[94:95], L_rare0100d
  s_branch L_dm1_back
L_dm2_rare:
  s_call_b64 s[94:95], L_rare1100d
  s_branch L_dm2_back
L_dm3_rare:
  s_call_b64 s[94:95], L_rare068d
  s_branch L_dm3_back
L_dx1_rare:
  s_call_b64 s[94:95], L_rare168s
  s_branch L_dx1_back
L_dx2_rare:
  s_call_b64 s[94:95], L_rare0115s
  s_branch L_dx2_back
L_sl1_rare:
  s_call_b64 s[94:95], L_rare1115s
  s_branch L_sl1_back
L_sl2_rare:
  s_call_b64 s[94:95], L_rare0115s
  s_branch L_sl2_back
L_h_spin:
  s_mov_b32 s92, 0x40000
L_h_loop:
  buffer_load_dword v13, v27, s[68:71], s89 offen sc1
  s_waitcnt vmcnt(0)
  v_cmp_eq_u32 vcc, 1, v13
  s_nop 0
  s_cmp_eq_u32 vcc_lo, -1
  s_cbranch_scc1 L_h_ok
  s_sub_u32 s92, s92, 1
  s_cmp_lg_u32 s92, 0
  s_cbranch_scc1 L_h_loop
  s_branch L_h_ok
L_sm1_rare:
  s_call_b64 s[94:95], L_rare1115s
  s_branch L_sm1_back
L_sm2_rare:
  s_call_b64 s[94:95], L_rare0115s
  s_branch L_sm2_back
L_last_rare:
  s_call_b64 s[94:95], L_rare183n
  s_branch L_last_back
L_h2_spin:
  s_mov_b32 s92, 0x40000
L_h2_loop:
  buffer_load_dword v13, v27, s[68:71], s89 offen sc1
  s_waitcnt vmcnt(0)
  v_cmp_eq_u32 vcc, 1, v13
  s_nop 0
  s_cmp_eq_u32 vcc_lo, -1
  s_cbranch_scc1 L_h2_ok
  s_sub_u32 s92, s92, 1
  s_cmp_lg_u32 s92, 0
  s_cbranch_scc1 L_h2_loop
  s_branch L_h2_ok
L_dxm1_rare:
  s_call_b64 s[94:95], L_rare168s
  s_branch L_dxm1_back
L_dxm2_rare:
  s_call_b64 s[94:95], L_rare0115s
  s_branch L_dxm2_back
L_e0_spin:
  s_mov_b32 s92, 0x40000
L_e0_loop:
  buffer_load_dword v13, v28, s[68:71], s89 offen sc1
  s_waitcnt vmcnt(0)
  v_cmp_eq_u32 vcc, 1, v13
  s_nop 0
  s_mov_b32 s42, vcc_lo
  s_bitcmp1_b32 s42, 0
  s_cbranch_scc1 L_e0_ok
  s_sub_u32 s92, s92, 1
  s_cmp_lg_u32 s92, 0
  s_cbranch_scc1 L_e0_loop
  s_branch L_e0_ok
L_e1_spin:
  s_mov_b32 s92, 0x40000
L_e1_loop:
  buffer_load_dword v13, v28, s[68:71], s89 offen sc1
  s_waitcnt vmcnt(0)
  v_cmp_eq_u32 vcc, 1, v13
  s_nop 0
  s_mov_b32 s42, vcc_lo
  s_bitcmp1_b32 s42, 1
  s_cbranch_scc1 L_e1_ok
  s_sub_u32 s92, s92, 1
  s_cmp_lg_u32 s92, 0
  s_cbranch_scc1 L_e1_loop
  s_branch L_e1_ok
L_e2_spin:
  s_mov_b32 s92, 0x40000
L_e2_loop:
  buffer_load_dword v13, v28, s[68:71], s89 offen sc1
  s_waitcnt vmcnt(0)
  v_cmp_eq_u32 vcc, 1, v13
  s_nop 0
  s_mov_b32 s42, vcc_lo
  s_bitcmp1_b32 s42, 2
  s_cbranch_scc1 L_e2_ok
  s_sub_u32 s92, s92, 1
  s_cmp_lg_u32 s92, 0
  s_cbranch_scc1 L_e2_loop
  s_branch L_e2_ok
L_e3_spin:
  s_mov_b32 s92, 0x40000
L_e3_loop:
  buffer_load_dword v13, v28, s[68:71], s89 offen sc1
  s_waitcnt vmcnt(0)
  v_cmp_eq_u32 vcc, 1, v13
  s_nop 0
  s_mov_b32 s42, vcc_lo
  s_bitcmp1_b32 s42, 3
  s_cbranch_scc1 L_e3_ok
  s_sub_u32 s92, s92, 1
  s_cmp_lg_u32 s92, 0
  s_cbranch_scc1 L_e3_loop
  s_branch L_e3_ok
L_e4_spin:
  s_mov_b32 s92, 0x40000
L_e4_loop:
  buffer_load_dword v13, v28, s[68:71], s89 offen sc1
  s_waitcnt vmcnt(0)
  v_cmp_eq_u32 vcc, 1, v13
  s_nop 0
  s_mov_b32 s42, vcc_lo
  s_bitcmp1_b32 s42, 4
  s_cbranch_scc1 L_e4_ok
  s_sub_u32 s92, s92, 1
  s_cmp_lg_u32 s92, 0
  s_cbranch_scc1 L_e4_loop
  s_branch L_e4_ok
L_e5_spin:
  s_mov_b32 s92, 0x40000
L_e5_loop:
  buffer_load_dword v13, v28, s[68:71], s89 offen sc1
  s_waitcnt vmcnt(0)
  v_cmp_eq_u32 vcc, 1, v13
  s_nop 0
  s_mov_b32 s42, vcc_lo
  s_bitcmp1_b32 s42, 5
  s_cbranch_scc1 L_e5_ok
  s_sub_u32 s92, s92, 1
  s_cmp_lg_u32 s92, 0
  s_cbranch_scc1 L_e5_loop
  s_branch L_e5_ok
L_e6_spin:
  s_mov_b32 s92, 0x40000
L_e6_loop:
  buffer_load_dword v13, v28, s[68:71], s89 offen sc1
  s_waitcnt vmcnt(0)
  v_cmp_eq_u32 vcc, 1, v13
  s_nop 0
  s_mov_b32 s42, vcc_lo
  s_bitcmp1_b32 s42, 6
  s_cbranch_scc1 L_e6_ok
  s_sub_u32 s92, s92, 1
  s_cmp_lg_u32 s92, 0
  s_cbranch_scc1 L_e6_loop
  s_branch L_e6_ok
L_e7_spin:
  s_mov_b32 s92, 0x40000
L_e7_loop:
  buffer_load_dword v13, v28, s[68:71], s89 offen sc1
  s_waitcnt vmcnt(0)
  v_cmp_eq_u32 vcc, 1, v13
  s_nop 0
  s_mov_b32 s42, vcc_lo
  s_bitcmp1_b32 s42, 7
  s_cbranch_scc1 L_e7_ok
  s_sub_u32 s92, s92, 1
  s_cmp_lg_u32 s92, 0
  s_cbranch_scc1 L_e7_loop
  s_branch L_e7_ok
L_x_spin:
  s_mov_b32 s92, 0x40000
L_x_loop:
  buffer_load_dword v13, v27, s[68:71], s75 offen sc1
  s_waitcnt vmcnt(0)
  v_cmp_eq_u32 vcc, 1, v13
  s_nop 0
  s_and_b32 s80, vcc_lo, 15
  s_cmp_eq_u32 s80, 15
  s_cbranch_scc1 L_x_ok
  s_sub_u32 s92, s92, 1
  s_cmp_lg_u32 s92, 0
  s_cbranch_scc1 L_x_loop
  s_branch L_x_ok
L_rare1100d:
  s_nop 15
  v_max3_f32 v250, v128, v129, v130
  v_max3_f32 v250, v250, v131, v132
  v_max3_f32 v250, v250, v133, v134
  v_max_f32 v250, v250, v135
  v_mov_b32 v251, v250
  s_nop 1
  v_permlane32_swap_b32 v250, v251
  v_max_f32 v250, v250, v251
  v_mov_b32 v251, v250
  s_nop 1
  v_permlane16_swap_b32 v250, v251
  v_max_f32 v250, v250, v251
  v_log_f32 v251, v240
  s_nop 0
  v_add_f32 v251, 0xc1300000, v251
  v_max3_f32 v250, 0, v250, v251
  v_sub_f32 v251, 0, v250
  v_exp_f32 v251, v251
  v_sub_f32 v128, v128, v250
  v_sub_f32 v129, v129, v250
  v_sub_f32 v130, v130, v250
  v_sub_f32 v131, v131, v250
  v_sub_f32 v132, v132, v250
  v_sub_f32 v133, v133, v250
  v_sub_f32 v134, v134, v250
  v_sub_f32 v135, v135, v250
  v_sub_f32 v224, v224, v250
  v_sub_f32 v225, v225, v250
  v_sub_f32 v226, v226, v250
  v_sub_f32 v227, v227, v250
  v_sub_f32 v192, v192, v250
  v_sub_f32 v193, v193, v250
  v_sub_f32 v194, v194, v250
  v_sub_f32 v195, v195, v250
  v_sub_f32 v196, v196, v250
  v_sub_f32 v197, v197, v250
  v_sub_f32 v198, v198, v250
  v_sub_f32 v199, v199, v250
  v_mul_f32 v32, v32, v251
  v_mul_f32 v33, v33, v251
  v_mul_f32 v34, v34, v251
  v_mul_f32 v35, v35, v251
  v_mul_f32 v36, v36, v251
  v_mul_f32 v37, v37, v251
  v_mul_f32 v38, v38, v251
  v_mul_f32 v39, v39, v251
  v_mul_f32 v48, v48, v251
  v_mul_f32 v49, v49, v251
  v_mul_f32 v50, v50, v251
  v_mul_f32 v51, v51, v251
  v_mul_f32 v52, v52, v251
  v_mul_f32 v53, v53, v251
  v_mul_f32 v54, v54, v251
  v_mul_f32 v55, v55, v251
  v_mul_f32 v64, v64, v251
  v_mul_f32 v65, v65, v251
  v_mul_f32 v66, v66, v251
  v_mul_f32 v67, v67, v251
  v_mul_f32 v68, v68, v251
  v_mul_f32 v69, v69, v251
  v_mul_f32 v70, v70, v251
  v_mul_f32 v71, v71, v251
  v_mul_f32 v80, v80, v251
  v_mul_f32 v81, v81, v251
  v_mul_f32 v82, v82, v251
  v_mul_f32 v83, v83, v251
  v_mul_f32 v84, v84, v251
  v_mul_f32 v85, v85, v251
  v_mul_f32 v86, v86, v251
  v_mul_f32 v87, v87, v251
  v_mul_f32 v240, v240, v251
  v_max3_f32 v250, v136, v137, v138
  v_max3_f32 v250, v250, v139, v140
  v_max3_f32 v250, v250, v141, v142
  v_max_f32 v250, v250, v143
  v_mov_b32 v251, v250
  s_nop 1
  v_permlane32_swap_b32 v250, v251
  v_max_f32 v250, v250, v251
  v_mov_b32 v251, v250
  s_nop 1
  v_permlane16_swap_b32 v250, v251
  v_max_f32 v250, v250, v251
  v_log_f32 v251, v241
  s_nop 0
  v_add_f32 v251, 0xc1300000, v251
  v_max3_f32 v250, 0, v250, v251
  v_sub_f32 v251, 0, v250
  v_exp_f32 v251, v251
  v_sub_f32 v136, v136, v250
  v_sub_f32 v137, v137, v250
  v_sub_f32 v138, v138, v250
  v_sub_f32 v139, v139, v250
  v_sub_f32 v140, v140, v250
  v_sub_f32 v141, v141, v250
  v_sub_f32 v142, v142, v250
  v_sub_f32 v143, v143, v250
  v_sub_f32 v228, v228, v250
  v_sub_f32 v229, v229, v250
  v_sub_f32 v230, v230, v250
  v_sub_f32 v231, v231, v250
  v_sub_f32 v200, v200, v250
  v_sub_f32 v201, v201, v250
  v_sub_f32 v202, v202, v250
  v_sub_f32 v203, v203, v250
  v_sub_f32 v204, v204, v250
  v_sub_f32 v205, v205, v250
  v_sub_f32 v206, v206, v250
  v_sub_f32 v207, v207, v250
  v_mul_f32 v40, v40, v251
  v_mul_f32 v41, v41, v251
  v_mul_f32 v42, v42, v251
  v_mul_f32 v43, v43, v251
  v_mul_f32 v44, v44, v251
  v_mul_f32 v45, v45, v251
  v_mul_f32 v46, v46, v251
  v_mul_f32 v47, v47, v251
  v_mul_f32 v56, v56, v251
  v_mul_f32 v57, v57, v251
  v_mul_f32 v58, v58, v251
  v_mul_f32 v59, v59, v251
  v_mul_f32 v60, v60, v251
  v_mul_f32 v61, v61, v251
  v_mul_f32 v62, v62, v251
  v_mul_f32 v63, v63, v251
  v_mul_f32 v72, v72, v251
  v_mul_f32 v73, v73, v251
  v_mul_f32 v74, v74, v251
  v_mul_f32 v75, v75, v251
  v_mul_f32 v76, v76, v251
  v_mul_f32 v77, v77, v251
  v_mul_f32 v78, v78, v251
  v_mul_f32 v79, v79, v251
  v_mul_f32 v88, v88, v251
  v_mul_f32 v89, v89, v251
  v_mul_f32 v90, v90, v251
  v_mul_f32 v91, v91, v251
  v_mul_f32 v92, v92, v251
  v_mul_f32 v93, v93, v251
  v_mul_f32 v94, v94, v251
  v_mul_f32 v95, v95, v251
  v_mul_f32 v241, v241, v251
  v_max3_f32 v250, v144, v145, v146
  v_max3_f32 v250, v250, v147, v148
  v_max3_f32 v250, v250, v149, v150
  v_max_f32 v250, v250, v151
  v_mov_b32 v251, v250
  s_nop 1
  v_permlane32_swap_b32 v250, v251
  v_max_f32 v250, v250, v251
  v_mov_b32 v251, v250
  s_nop 1
  v_permlane16_swap_b32 v250, v251
  v_max_f32 v250, v250, v251
  v_log_f32 v251, v242
  s_nop 0
  v_add_f32 v251, 0xc1300000, v251
  v_max3_f32 v250, 0, v250, v251
  v_sub_f32 v251, 0, v250
  v_exp_f32 v251, v251
  v_sub_f32 v144, v144, v250
  v_sub_f32 v145, v145, v250
  v_sub_f32 v146, v146, v250
  v_sub_f32 v147, v147, v250
  v_sub_f32 v148, v148, v250
  v_sub_f32 v149, v149, v250
  v_sub_f32 v150, v150, v250
  v_sub_f32 v151, v151, v250
  v_sub_f32 v232, v232, v250
  v_sub_f32 v233, v233, v250
  v_sub_f32 v234, v234, v250
  v_sub_f32 v235, v235, v250
  v_sub_f32 v208, v208, v250
  v_sub_f32 v209, v209, v250
  v_sub_f32 v210, v210, v250
  v_sub_f32 v211, v211, v250
  v_sub_f32 v212, v212, v250
  v_sub_f32 v213, v213, v250
  v_sub_f32 v214, v214, v250
  v_sub_f32 v215, v215, v250
  v_accvgpr_read_b32 v2, a192
  v_mul_f32 v2, v2, v251
  v_accvgpr_write_b32 a192, v2
  v_accvgpr_read_b32 v3, a193
  v_mul_f32 v3, v3, v251
  v_accvgpr_write_b32 a193, v3
  v_accvgpr_read_b32 v4, a194
  v_mul_f32 v4, v4, v251
  v_accvgpr_write_b32 a194, v4
  v_accvgpr_read_b32 v5, a195
  v_mul_f32 v5, v5, v251
  v_accvgpr_write_b32 a195, v5
  v_accvgpr_read_b32 v2, a196
  v_mul_f32 v2, v2, v251
  v_accvgpr_write_b32 a196, v2
  v_accvgpr_read_b32 v3, a197
  v_mul_f32 v3, v3, v251
  v_accvgpr_write_b32 a197, v3
  v_accvgpr_read_b32 v4, a198
  v_mul_f32 v4, v4, v251
  v_accvgpr_write_b32 a198, v4
  v_accvgpr_read_b32 v5, a199
  v_mul_f32 v5, v5, v251
  v_accvgpr_write_b32 a199, v5
  v_accvgpr_read_b32 v2, a208
  v_mul_f32 v2, v2, v251
  v_accvgpr_write_b32 a208, v2
  v_accvgpr_read_b32 v3, a209
  v_mul_f32 v3, v3, v251
  v_accvgpr_write_b32 a209, v3
  v_accvgpr_read_b32 v4, a210
  v_mul_f32 v4, v4, v251
  v_accvgpr_write_b32 a210, v4
  v_accvgpr_read_b32 v5, a211
  v_mul_f32 v5, v5, v251
  v_accvgpr_write_b32 a211, v5
  v_accvgpr_read_b32 v2, a212
  v_mul_f32 v2, v2, v251
  v_accvgpr_write_b32 a212, v2
  v_accvgpr_read_b32 v3, a213
  v_mul_f32 v3, v3, v251
  v_accvgpr_write_b32 a213, v3
  v_accvgpr_read_b32 v4, a214
  v_mul_f32 v4, v4, v251
  v_accvgpr_write_b32 a214, v4
  v_accvgpr_read_b32 v5, a215
  v_mul_f32 v5, v5, v251
  v_accvgpr_write_b32 a215, v5
  v_accvgpr_read_b32 v2, a224
  v_mul_f32 v2, v2, v251
  v_accvgpr_write_b32 a224, v2
  v_accvgpr_read_b32 v3, a225
  v_mul_f32 v3, v3, v251
  v_accvgpr_write_b32 a225, v3
  v_accvgpr_read_b32 v4, a226
  v_mul_f32 v4, v4, v251
  v_accvgpr_write_b32 a226, v4
  v_accvgpr_read_b32 v5, a227
  v_mul_f32 v5, v5, v251
  v_accvgpr_write_b32 a227, v5
  v_accvgpr_read_b32 v2, a228
  v_mul_f32 v2, v2, v251
  v_accvgpr_write_b32 a228, v2
  v_accvgpr_read_b32 v3, a229
  v_mul_f32 v3, v3, v251
  v_accvgpr_write_b32 a229, v3
  v_accvgpr_read_b32 v4, a230
  v_mul_f32 v4, v4, v251
  v_accvgpr_write_b32 a230, v4
  v_accvgpr_read_b32 v5, a231
  v_mul_f32 v5, v5, v251
  v_accvgpr_write_b32 a231, v5
  v_accvgpr_read_b32 v2, a240
  v_mul_f32 v2, v2, v251
  v_accvgpr_write_b32 a240, v2
  v_accvgpr_read_b32 v3, a241
  v_mul_f32 v3, v3, v251
  v_accvgpr_write_b32 a241, v3
  v_accvgpr_read_b32 v4, a242
  v_mul_f32 v4, v4, v251
  v_accvgpr_write_b32 a242, v4
  v_accvgpr_read_b32 v5, a243
  v_mul_f32 v5, v5, v251
  v_accvgpr_write_b32 a243, v5
  v_accvgpr_read_b32 v2, a244
  v_mul_f32 v2, v2, v251
  v_accvgpr_write_b32 a244, v2
  v_accvgpr_read_b32 v3, a245
  v_mul_f32 v3, v3, v251
  v_accvgpr_write_b32 a245, v3
  v_accvgpr_read_b32 v4, a246
  v_mul_f32 v4, v4, v251
  v_accvgpr_write_b32 a246, v4
  v_accvgpr_read_b32 v5, a247
  v_mul_f32 v5, v5, v251
  v_accvgpr_write_b32 a247, v5
  v_mul_f32 v242, v242, v251
  v_max3_f32 v250, v152, v153, v154
  v_max3_f32 v250, v250, v155, v156
  v_max3_f32 v250, v250, v157, v158
  v_max_f32 v250, v250, v159
  v_mov_b32 v251, v250
  s_nop 1
  v_permlane32_swap_b32 v250, v251
  v_max_f32 v250, v250, v251
  v_mov_b32 v251, v250
  s_nop 1
  v_permlane16_swap_b32 v250, v251
  v_max_f32 v250, v250, v251
  v_log_f32 v251, v243
  s_nop 0
  v_add_f32 v251, 0xc1300000, v251
  v_max3_f32 v250, 0, v250, v251
  v_sub_f32 v251, 0, v250
  v_exp_f32 v251, v251
  v_sub_f32 v152, v152, v250
  v_sub_f32 v153, v153, v250
  v_sub_f32 v154, v154, v250
  v_sub_f32 v155, v155, v250
  v_sub_f32 v156, v156, v250
  v_sub_f32 v157, v157, v250
  v_sub_f32 v158, v158, v250
  v_sub_f32 v159, v159, v250
  v_sub_f32 v236, v236, v250
  v_sub_f32 v237, v237, v250
  v_sub_f32 v238, v238, v250
  v_sub_f32 v239, v239, v250
  v_sub_f32 v216, v216, v250
  v_sub_f32 v217, v217, v250
  v_sub_f32 v218, v218, v250
  v_sub_f32 v219, v219, v250
  v_sub_f32 v220, v220, v250
  v_sub_f32 v221, v221, v250
  v_sub_f32 v222, v222, v250
  v_sub_f32 v223, v223, v250
  v_accvgpr_read_b32 v2, a200
  v_mul_f32 v2, v2, v251
  v_accvgpr_write_b32 a200, v2
  v_accvgpr_read_b32 v3, a201
  v_mul_f32 v3, v3, v251
  v_accvgpr_write_b32 a201, v3
  v_accvgpr_read_b32 v4, a202
  v_mul_f32 v4, v4, v251
  v_accvgpr_write_b32 a202, v4
  v_accvgpr_read_b32 v5, a203
  v_mul_f32 v5, v5, v251
  v_accvgpr_write_b32 a203, v5
  v_accvgpr_read_b32 v2, a204
  v_mul_f32 v2, v2, v251
  v_accvgpr_write_b32 a204, v2
  v_accvgpr_read_b32 v3, a205
  v_mul_f32 v3, v3, v251
  v_accvgpr_write_b32 a205, v3
  v_accvgpr_read_b32 v4, a206
  v_mul_f32 v4, v4, v251
  v_accvgpr_write_b32 a206, v4
  v_accvgpr_read_b32 v5, a207
  v_mul_f32 v5, v5, v251
  v_accvgpr_write_b32 a207, v5
  v_accvgpr_read_b32 v2, a216
  v_mul_f32 v2, v2, v251
  v_accvgpr_write_b32 a216, v2
  v_accvgpr_read_b32 v3, a217
  v_mul_f32 v3, v3, v251
  v_accvgpr_write_b32 a217, v3
  v_accvgpr_read_b32 v4, a218
  v_mul_f32 v4, v4, v251
  v_accvgpr_write_b32 a218, v4
  v_accvgpr_read_b32 v5, a219
  v_mul_f32 v5, v5, v251
  v_accvgpr_write_b32 a219, v5
  v_accvgpr_read_b32 v2, a220
  v_mul_f32 v2, v2, v251
  v_accvgpr_write_b32 a220, v2
  v_accvgpr_read_b32 v3, a221
  v_mul_f32 v3, v3, v251
  v_accvgpr_write_b32 a221, v3
  v_accvgpr_read_b32 v4, a222
  v_mul_f32 v4, v4, v251
  v_accvgpr_write_b32 a222, v4
  v_accvgpr_read_b32 v5, a223
  v_mul_f32 v5, v5, v251
  v_accvgpr_write_b32 a223, v5
  v_accvgpr_read_b32 v2, a232
  v_mul_f32 v2, v2, v251
  v_accvgpr_write_b32 a232, v2
  v_accvgpr_read_b32 v3, a233
  v_mul_f32 v3, v3, v251
  v_accvgpr_write_b32 a233, v3
  v_accvgpr_read_b32 v4, a234
  v_mul_f32 v4, v4, v251
  v_accvgpr_write_b32 a234, v4
  v_accvgpr_read_b32 v5, a235
  v_mul_f32 v5, v5, v251
  v_accvgpr_write_b32 a235, v5
  v_accvgpr_read_b32 v2, a236
  v_mul_f32 v2, v2, v251
  v_accvgpr_write_b32 a236, v2
  v_accvgpr_read_b32 v3, a237
  v_mul_f32 v3, v3, v251
  v_accvgpr_write_b32 a237, v3
  v_accvgpr_read_b32 v4, a238
  v_mul_f32 v4, v4, v251
  v_accvgpr_write_b32 a238, v4
  v_accvgpr_read_b32 v5, a239
  v_mul_f32 v5, v5, v251
  v_accvgpr_write_b32 a239, v5
  v_accvgpr_read_b32 v2, a248
  v_mul_f32 v2, v2, v251
  v_accvgpr_write_b32 a248, v2
  v_accvgpr_read_b32 v3, a249
  v_mul_f32 v3, v3, v251
  v_accvgpr_write_b32 a249, v3
  v_accvgpr_read_b32 v4, a250
  v_mul_f32 v4, v4, v251
  v_accvgpr_write_b32 a250, v4
  v_accvgpr_read_b32 v5, a251
  v_mul_f32 v5, v5, v251
  v_accvgpr_write_b32 a251, v5
  v_accvgpr_read_b32 v2, a252
  v_mul_f32 v2, v2, v251
  v_accvgpr_write_b32 a252, v2
  v_accvgpr_read_b32 v3, a253
  v_mul_f32 v3, v3, v251
  v_accvgpr_write_b32 a253, v3
  v_accvgpr_read_b32 v4, a254
  v_mul_f32 v4, v4, v251
  v_accvgpr_write_b32 a254, v4
  v_accvgpr_read_b32 v5, a255
  v_mul_f32 v5, v5, v251
  v_accvgpr_write_b32 a255, v5
  v_mul_f32 v243, v243, v251
  v_exp_f32 v2, v128
  v_exp_f32 v3, v129
  v_exp_f32 v4, v130
  v_exp_f32 v5, v131
  v_cvt_pk_bf16_f32 v176, v2, v3
  v_exp_f32 v6, v132
  v_exp_f32 v7, v133
  v_cvt_pk_bf16_f32 v177, v4, v5
  v_exp_f32 v8, v134
  v_exp_f32 v9, v135
  v_cvt_pk_bf16_f32 v178, v6, v7
  v_exp_f32 v2, v136
  v_exp_f32 v3, v137
  v_cvt_pk_bf16_f32 v179, v8, v9
  v_exp_f32 v4, v138
  v_exp_f32 v5, v139
  v_cvt_pk_bf16_f32 v180, v2, v3
  v_mfma_f32_16x16x32_bf16 v[244:247], a[68:71], v[176:179], v[240:243]
  v_exp_f32 v6, v140
  v_exp_f32 v7, v141
  v_cvt_pk_bf16_f32 v181, v4, v5
  v_exp_f32 v8, v142
  v_exp_f32 v9, v143
  v_cvt_pk_bf16_f32 v182, v6, v7
  v_exp_f32 v2, v144
  v_exp_f32 v3, v145
  v_cvt_pk_bf16_f32 v183, v8, v9
  v_exp_f32 v4, v146
  v_exp_f32 v5, v147
  v_cvt_pk_bf16_f32 v184, v2, v3
  v_mfma_f32_16x16x32_bf16 v[244:247], a[72:75], v[180:183], v[244:247]
  v_exp_f32 v6, v148
  v_exp_f32 v7, v149
  v_cvt_pk_bf16_f32 v185, v4, v5
  v_exp_f32 v8, v150
  v_exp_f32 v9, v151
  v_cvt_pk_bf16_f32 v186, v6, v7
  v_exp_f32 v2, v152
  v_exp_f32 v3, v153
  v_cvt_pk_bf16_f32 v187, v8, v9
  v_exp_f32 v4, v154
  v_exp_f32 v5, v155
  v_cvt_pk_bf16_f32 v188, v2, v3
  v_mfma_f32_16x16x32_bf16 v[244:247], a[76:79], v[184:187], v[244:247]
  v_exp_f32 v6, v156
  v_exp_f32 v7, v157
  v_cvt_pk_bf16_f32 v189, v4, v5
  v_exp_f32 v8, v158
  v_exp_f32 v9, v159
  v_cvt_pk_bf16_f32 v190, v6, v7
  v_cvt_pk_bf16_f32 v191, v8, v9
  s_nop 1
  v_mfma_f32_16x16x32_bf16 v[244:247], a[80:83], v[188:191], v[244:247]
  s_nop 7
  s_setpc_b64 s[94:95]
L_rare0100d:
  s_nop 15
  v_max3_f32 v250, v192, v193, v194
  v_max3_f32 v250, v250, v195, v196
  v_max3_f32 v250, v250, v197, v198
  v_max_f32 v250, v250, v199
  v_mov_b32 v251, v250
  s_nop 1
  v_permlane32_swap_b32 v250, v251
  v_max_f32 v250, v250, v251
  v_mov_b32 v251, v250
  s_nop 1
  v_permlane16_swap_b32 v250, v251
  v_max_f32 v250, v250, v251
  v_log_f32 v251, v244
  s_nop 0
  v_add_f32 v251, 0xc1300000, v251
  v_max3_f32 v250, 0, v250, v251
  v_sub_f32 v251, 0, v250
  v_exp_f32 v251, v251
  v_sub_f32 v192, v192, v250
  v_sub_f32 v193, v193, v250
  v_sub_f32 v194, v194, v250
  v_sub_f32 v195, v195, v250
  v_sub_f32 v196, v196, v250
  v_sub_f32 v197, v197, v250
  v_sub_f32 v198, v198, v250
  v_sub_f32 v199, v199, v250
  v_sub_f32 v224, v224, v250
  v_sub_f32 v225, v225, v250
  v_sub_f32 v226, v226, v250
  v_sub_f32 v227, v227, v250
  v_sub_f32 v128, v128, v250
  v_sub_f32 v129, v129, v250
  v_sub_f32 v130, v130, v250
  v_sub_f32 v131, v131, v250
  v_sub_f32 v132, v132, v250
  v_sub_f32 v133, v133, v250
  v_sub_f32 v134, v134, v250
  v_sub_f32 v135, v135, v250
  v_mul_f32 v32, v32, v251
  v_mul_f32 v33, v33, v251
  v_mul_f32 v34, v34, v251
  v_mul_f32 v35, v35, v251
  v_mul_f32 v36, v36, v251
  v_mul_f32 v37, v37, v251
  v_mul_f32 v38, v38, v251
  v_mul_f32 v39, v39, v251
  v_mul_f32 v48, v48, v251
  v_mul_f32 v49, v49, v251
  v_mul_f32 v50, v50, v251
  v_mul_f32 v51, v51, v251
  v_mul_f32 v52, v52, v251
  v_mul_f32 v53, v53, v251
  v_mul_f32 v54, v54, v251
  v_mul_f32 v55, v55, v251
  v_mul_f32 v64, v64, v251
  v_mul_f32 v65, v65, v251
  v_mul_f32 v66, v66, v251
  v_mul_f32 v67, v67, v251
  v_mul_f32 v68, v68, v251
  v_mul_f32 v69, v69, v251
  v_mul_f32 v70, v70, v251
  v_mul_f32 v71, v71, v251
  v_mul_f32 v80, v80, v251
  v_mul_f32 v81, v81, v251
  v_mul_f32 v82, v82, v251
  v_mul_f32 v83, v83, v251
  v_mul_f32 v84, v84, v251
  v_mul_f32 v85, v85, v251
  v_mul_f32 v86, v86, v251
  v_mul_f32 v87, v87, v251
  v_mul_f32 v244, v244, v251
  v_max3_f32 v250, v200, v201, v202
  v_max3_f32 v250, v250, v203, v204
  v_max3_f32 v250, v250, v205, v206
  v_max_f32 v250, v250, v207
  v_mov_b32 v251, v250
  s_nop 1
  v_permlane32_swap_b32 v250, v251
  v_max_f32 v250, v250, v251
  v_mov_b32 v251, v250
  s_nop 1
  v_permlane16_swap_b32 v250, v251
  v_max_f32 v250, v250, v251
  v_log_f32 v251, v245
  s_nop 0
  v_add_f32 v251, 0xc1300000, v251
  v_max3_f32 v250, 0, v250, v251
  v_sub_f32 v251, 0, v250
  v_exp_f32 v251, v251
  v_sub_f32 v200, v200, v250
  v_sub_f32 v201, v201, v250
  v_sub_f32 v202, v202, v250
  v_sub_f32 v203, v203, v250
  v_sub_f32 v204, v204, v250
  v_sub_f32 v205, v205, v250
  v_sub_f32 v206, v206, v250
  v_sub_f32 v207, v207, v250
  v_sub_f32 v228, v228, v250
  v_sub_f32 v229, v229, v250
  v_sub_f32 v230, v230, v250
  v_sub_f32 v231, v231, v250
  v_sub_f32 v136, v136, v250
  v_sub_f32 v137, v137, v250
  v_sub_f32 v138, v138, v250
  v_sub_f32 v139, v139, v250
  v_sub_f32 v140, v140, v250
  v_sub_f32 v141, v141, v250
  v_sub_f32 v142, v142, v250
  v_sub_f32 v143, v143, v250
  v_mul_f32 v40, v40, v251
  v_mul_f32 v41, v41, v251
  v_mul_f32 v42, v42, v251
  v_mul_f32 v43, v43, v251
  v_mul_f32 v44, v44, v251
  v_mul_f32 v45, v45, v251
  v_mul_f32 v46, v46, v251
  v_mul_f32 v47, v47, v251
  v_mul_f32 v56, v56, v251
  v_mul_f32 v57, v57, v251
  v_mul_f32 v58, v58, v251
  v_mul_f32 v59, v59, v251
  v_mul_f32 v60, v60, v251
  v_mul_f32 v61, v61, v251
  v_mul_f32 v62, v62, v251
  v_mul_f32 v63, v63, v251
  v_mul_f32 v72, v72, v251
  v_mul_f32 v73, v73, v251
  v_mul_f32 v74, v74, v251
  v_mul_f32 v75, v75, v251
  v_mul_f32 v76, v76, v251
  v_mul_f32 v77, v77, v251
  v_mul_f32 v78, v78, v251
  v_mul_f32 v79, v79, v251
  v_mul_f32 v88, v88, v251
  v_mul_f32 v89, v89, v251
  v_mul_f32 v90, v90, v251
  v_mul_f32 v91, v91, v251
  v_mul_f32 v92, v92, v251
  v_mul_f32 v93, v93, v251
  v_mul_f32 v94, v94, v251
  v_mul_f32 v95, v95, v251
  v_mul_f32 v245, v245, v251
  v_max3_f32 v250, v208, v209, v210
  v_max3_f32 v250, v250, v211, v212
  v_max3_f32 v250, v250, v213, v214
  v_max_f32 v250, v250, v215
  v_mov_b32 v251, v250
  s_nop 1
  v_permlane32_swap_b32 v250, v251
  v_max_f32 v250, v250, v251
  v_mov_b32 v251, v250
  s_nop 1
  v_permlane16_swap_b32 v250, v251
  v_max_f32 v250, v250, v251
  v_log_f32 v251, v246
  s_nop 0
  v_add_f32 v251, 0xc1300000, v251
  v_max3_f32 v250, 0, v250, v251
  v_sub_f32 v251, 0, v250
  v_exp_f32 v251, v251
  v_sub_f32 v208, v208, v250
  v_sub_f32 v209, v209, v250
  v_sub_f32 v210, v210, v250
  v_sub_f32 v211, v211, v250
  v_sub_f32 v212, v212, v250
  v_sub_f32 v213, v213, v250
  v_sub_f32 v214, v214, v250
  v_sub_f32 v215, v215, v250
  v_sub_f32 v232, v232, v250
  v_sub_f32 v233, v233, v250
  v_sub_f32 v234, v234, v250
  v_sub_f32 v235, v235, v250
  v_sub_f32 v144, v144, v250
  v_sub_f32 v145, v145, v250
  v_sub_f32 v146, v146, v250
  v_sub_f32 v147, v147, v250
  v_sub_f32 v148, v148, v250
  v_sub_f32 v149, v149, v250
  v_sub_f32 v150, v150, v250
  v_sub_f32 v151, v151, v250
  v_accvgpr_read_b32 v2, a192
  v_mul_f32 v2, v2, v251
  v_accvgpr_write_b32 a192, v2
  v_accvgpr_read_b32 v3, a193
  v_mul_f32 v3, v3, v251
  v_accvgpr_write_b32 a193, v3
  v_accvgpr_read_b32 v4, a194
  v_mul_f32 v4, v4, v251
  v_accvgpr_write_b32 a194, v4
  v_accvgpr_read_b32 v5, a195
  v_mul_f32 v5, v5, v251
  v_accvgpr_write_b32 a195, v5
  v_accvgpr_read_b32 v2, a196
  v_mul_f32 v2, v2, v251
  v_accvgpr_write_b32 a196, v2
  v_accvgpr_read_b32 v3, a197
  v_mul_f32 v3, v3, v251
  v_accvgpr_write_b32 a197, v3
  v_accvgpr_read_b32 v4, a198
  v_mul_f32 v4, v4, v251
  v_accvgpr_write_b32 a198, v4
  v_accvgpr_read_b32 v5, a199
  v_mul_f32 v5, v5, v251
  v_accvgpr_write_b32 a199, v5
  v_accvgpr_read_b32 v2, a208
  v_mul_f32 v2, v2, v251
  v_accvgpr_write_b32 a208, v2
  v_accvgpr_read_b32 v3, a209
  v_mul_f32 v3, v3, v251
  v_accvgpr_write_b32 a209, v3
  v_accvgpr_read_b32 v4, a210
  v_mul_f32 v4, v4, v251
  v_accvgpr_write_b32 a210, v4
  v_accvgpr_read_b32 v5, a211
  v_mul_f32 v5, v5, v251
  v_accvgpr_write_b32 a211, v5
  v_accvgpr_read_b32 v2, a212
  v_mul_f32 v2, v2, v251
  v_accvgpr_write_b32 a212, v2
  v_accvgpr_read_b32 v3, a213
  v_mul_f32 v3, v3, v251
  v_accvgpr_write_b32 a213, v3
  v_accvgpr_read_b32 v4, a214
  v_mul_f32 v4, v4, v251
  v_accvgpr_write_b32 a214, v4
  v_accvgpr_read_b32 v5, a215
  v_mul_f32 v5, v5, v251
  v_accvgpr_write_b32 a215, v5
  v_accvgpr_read_b32 v2, a224
  v_mul_f32 v2, v2, v251
  v_accvgpr_write_b32 a224, v2
  v_accvgpr_read_b32 v3, a225
  v_mul_f32 v3, v3, v251
  v_accvgpr_write_b32 a225, v3
  v_accvgpr_read_b32 v4, a226
  v_mul_f32 v4, v4, v251
  v_accvgpr_write_b32 a226, v4
  v_accvgpr_read_b32 v5, a227
  v_mul_f32 v5, v5, v251
  v_accvgpr_write_b32 a227, v5
  v_accvgpr_read_b32 v2, a228
  v_mul_f32 v2, v2, v251
  v_accvgpr_write_b32 a228, v2
  v_accvgpr_read_b32 v3, a229
  v_mul_f32 v3, v3, v251
  v_accvgpr_write_b32 a229, v3
  v_accvgpr_read_b32 v4, a230
  v_mul_f32 v4, v4, v251
  v_accvgpr_write_b32 a230, v4
  v_accvgpr_read_b32 v5, a231
  v_mul_f32 v5, v5, v251
  v_accvgpr_write_b32 a231, v5
  v_accvgpr_read_b32 v2, a240
  v_mul_f32 v2, v2, v251
  v_accvgpr_write_b32 a240, v2
  v_accvgpr_read_b32 v3, a241
  v_mul_f32 v3, v3, v251
  v_accvgpr_write_b32 a241, v3
  v_accvgpr_read_b32 v4, a242
  v_mul_f32 v4, v4, v251
  v_accvgpr_write_b32 a242, v4
  v_accvgpr_read_b32 v5, a243
  v_mul_f32 v5, v5, v251
  v_accvgpr_write_b32 a243, v5
  v_accvgpr_read_b32 v2, a244
  v_mul_f32 v2, v2, v251
  v_accvgpr_write_b32 a244, v2
  v_accvgpr_read_b32 v3, a245
  v_mul_f32 v3, v3, v251
  v_accvgpr_write_b32 a245, v3
  v_accvgpr_read_b32 v4, a246
  v_mul_f32 v4, v4, v251
  v_accvgpr_write_b32 a246, v4
  v_accvgpr_read_b32 v5, a247
  v_mul_f32 v5, v5, v251
  v_accvgpr_write_b32 a247, v5
  v_mul_f32 v246, v246, v251
  v_max3_f32 v250, v216, v217, v218
  v_max3_f32 v250, v250, v219, v220
  v_max3_f32 v250, v250, v221, v222
  v_max_f32 v250, v250, v223
  v_mov_b32 v251, v250
  s_nop 1
  v_permlane32_swap_b32 v250, v251
  v_max_f32 v250, v250, v251
  v_mov_b32 v251, v250
  s_nop 1
  v_permlane16_swap_b32 v250, v251
  v_max_f32 v250, v250, v251
  v_log_f32 v251, v247
  s_nop 0
  v_add_f32 v251, 0xc1300000, v251
  v_max3_f32 v250, 0, v250, v251
  v_sub_f32 v251, 0, v250
  v_exp_f32 v251, v251
  v_sub_f32 v216, v216, v250
  v_sub_f32 v217, v217, v250
  v_sub_f32 v218, v218, v250
  v_sub_f32 v219, v219, v250
  v_sub_f32 v220, v220, v250
  v_sub_f32 v221, v221, v250
  v_sub_f32 v222, v222, v250
  v_sub_f32 v223, v223, v250
  v_sub_f32 v236, v236, v250
  v_sub_f32 v237, v237, v250
  v_sub_f32 v238, v238, v250
  v_sub_f32 v239, v239, v250
  v_sub_f32 v152, v152, v250
  v_sub_f32 v153, v153, v250
  v_sub_f32 v154, v154, v250
  v_sub_f32 v155, v155, v250
  v_sub_f32 v156, v156, v250
  v_sub_f32 v157, v157, v250
  v_sub_f32 v158, v158, v250
  v_sub_f32 v159, v159, v250
  v_accvgpr_read_b32 v2, a200
  v_mul_f32 v2, v2, v251
  v_accvgpr_write_b32 a200, v2
  v_accvgpr_read_b32 v3, a201
  v_mul_f32 v3, v3, v251
  v_accvgpr_write_b32 a201, v3
  v_accvgpr_read_b32 v4, a202
  v_mul_f32 v4, v4, v251
  v_accvgpr_write_b32 a202, v4
  v_accvgpr_read_b32 v5, a203
  v_mul_f32 v5, v5, v251
  v_accvgpr_write_b32 a203, v5
  v_accvgpr_read_b32 v2, a204
  v_mul_f32 v2, v2, v251
  v_accvgpr_write_b32 a204, v2
  v_accvgpr_read_b32 v3, a205
  v_mul_f32 v3, v3, v251
  v_accvgpr_write_b32 a205, v3
  v_accvgpr_read_b32 v4, a206
  v_mul_f32 v4, v4, v251
  v_accvgpr_write_b32 a206, v4
  v_accvgpr_read_b32 v5, a207
  v_mul_f32 v5, v5, v251
  v_accvgpr_write_b32 a207, v5
  v_accvgpr_read_b32 v2, a216
  v_mul_f32 v2, v2, v251
  v_accvgpr_write_b32 a216, v2
  v_accvgpr_read_b32 v3, a217
  v_mul_f32 v3, v3, v251
  v_accvgpr_write_b32 a217, v3
  v_accvgpr_read_b32 v4, a218
  v_mul_f32 v4, v4, v251
  v_accvgpr_write_b32 a218, v4
  v_accvgpr_read_b32 v5, a219
  v_mul_f32 v5, v5, v251
  v_accvgpr_write_b32 a219, v5
  v_accvgpr_read_b32 v2, a220
  v_mul_f32 v2, v2, v251
  v_accvgpr_write_b32 a220, v2
  v_accvgpr_read_b32 v3, a221
  v_mul_f32 v3, v3, v251
  v_accvgpr_write_b32 a221, v3
  v_accvgpr_read_b32 v4, a222
  v_mul_f32 v4, v4, v251
  v_accvgpr_write_b32 a222, v4
  v_accvgpr_read_b32 v5, a223
  v_mul_f32 v5, v5, v251
  v_accvgpr_write_b32 a223, v5
  v_accvgpr_read_b32 v2, a232
  v_mul_f32 v2, v2, v251
  v_accvgpr_write_b32 a232, v2
  v_accvgpr_read_b32 v3, a233
  v_mul_f32 v3, v3, v251
  v_accvgpr_write_b32 a233, v3
  v_accvgpr_read_b32 v4, a234
  v_mul_f32 v4, v4, v251
  v_accvgpr_write_b32 a234, v4
  v_accvgpr_read_b32 v5, a235
  v_mul_f32 v5, v5, v251
  v_accvgpr_write_b32 a235, v5
  v_accvgpr_read_b32 v2, a236
  v_mul_f32 v2, v2, v251
  v_accvgpr_write_b32 a236, v2
  v_accvgpr_read_b32 v3, a237
  v_mul_f32 v3, v3, v251
  v_accvgpr_write_b32 a237, v3
  v_accvgpr_read_b32 v4, a238
  v_mul_f32 v4, v4, v251
  v_accvgpr_write_b32 a238, v4
  v_accvgpr_read_b32 v5, a239
  v_mul_f32 v5, v5, v251
  v_accvgpr_write_b32 a239, v5
  v_accvgpr_read_b32 v2, a248
  v_mul_f32 v2, v2, v251
  v_accvgpr_write_b32 a248, v2
  v_accvgpr_read_b32 v3, a249
  v_mul_f32 v3, v3, v251
  v_accvgpr_write_b32 a249, v3
  v_accvgpr_read_b32 v4, a250
  v_mul_f32 v4, v4, v251
  v_accvgpr_write_b32 a250, v4
  v_accvgpr_read_b32 v5, a251
  v_mul_f32 v5, v5, v251
  v_accvgpr_write_b32 a251, v5
  v_accvgpr_read_b32 v2, a252
  v_mul_f32 v2, v2, v251
  v_accvgpr_write_b32 a252, v2
  v_accvgpr_read_b32 v3, a253
  v_mul_f32 v3, v3, v251
  v_accvgpr_write_b32 a253, v3
  v_accvgpr_read_b32 v4, a254
  v_mul_f32 v4, v4, v251
  v_accvgpr_write_b32 a254, v4
  v_accvgpr_read_b32 v5, a255
  v_mul_f32 v5, v5, v251
  v_accvgpr_write_b32 a255, v5
  v_mul_f32 v247, v247, v251
  v_exp_f32 v2, v192
  v_exp_f32 v3, v193
  v_exp_f32 v4, v194
  v_exp_f32 v5, v195
  v_cvt_pk_bf16_f32 v160, v2, v3
  v_exp_f32 v6, v196
  v_exp_f32 v7, v197
  v_cvt_pk_bf16_f32 v161, v4, v5
  v_exp_f32 v8, v198
  v_exp_f32 v9, v199
  v_cvt_pk_bf16_f32 v162, v6, v7
  v_exp_f32 v2, v200
  v_exp_f32 v3, v201
  v_cvt_pk_bf16_f32 v163, v8, v9
  v_exp_f32 v4, v202
  v_exp_f32 v5, v203
  v_cvt_pk_bf16_f32 v164, v2, v3
  v_mfma_f32_16x16x32_bf16 v[240:243], a[68:71], v[160:163], v[244:247]
  v_exp_f32 v6, v204
  v_exp_f32 v7, v205
  v_cvt_pk_bf16_f32 v165, v4, v5
  v_exp_f32 v8, v206
  v_exp_f32 v9, v207
  v_cvt_pk_bf16_f32 v166, v6, v7
  v_exp_f32 v2, v208
  v_exp_f32 v3, v209
  v_cvt_pk_bf16_f32 v167, v8, v9
  v_exp_f32 v4, v210
  v_exp_f32 v5, v211
  v_cvt_pk_bf16_f32 v168, v2, v3
  v_mfma_f32_16x16x32_bf16 v[240:243], a[72:75], v[164:167], v[240:243]
  v_exp_f32 v6, v212
  v_exp_f32 v7, v213
  v_cvt_pk_bf16_f32 v169, v4, v5
  v_exp_f32 v8, v214
  v_exp_f32 v9, v215
  v_cvt_pk_bf16_f32 v170, v6, v7
  v_exp_f32 v2, v216
  v_exp_f32 v3, v217
  v_cvt_pk_bf16_f32 v171, v8, v9
  v_exp_f32 v4, v218
  v_exp_f32 v5, v219
  v_cvt_pk_bf16_f32 v172, v2, v3
  v_mfma_f32_16x16x32_bf16 v[240:243], a[76:79], v[168:171], v[240:243]
  v_exp_f32 v6, v220
  v_exp_f32 v7, v221
  v_cvt_pk_bf16_f32 v173, v4, v5
  v_exp_f32 v8, v222
  v_exp_f32 v9, v223
  v_cvt_pk_bf16_f32 v174, v6, v7
  v_cvt_pk_bf16_f32 v175, v8, v9
  s_nop 1
  v_mfma_f32_16x16x32_bf16 v[240:243], a[80:83], v[172:175], v[240:243]
  s_nop 7
  s_setpc_b64 s[94:95]
L_rare068d:
  s_nop 15
  v_max3_f32 v250, v192, v193, v194
  v_max3_f32 v250, v250, v195, v196
  v_max3_f32 v250, v250, v197, v198
  v_max_f32 v250, v250, v199
  v_mov_b32 v251, v250
  s_nop 1
  v_permlane32_swap_b32 v250, v251
  v_max_f32 v250, v250, v251
  v_mov_b32 v251, v250
  s_nop 1
  v_permlane16_swap_b32 v250, v251
  v_max_f32 v250, v250, v251
  v_log_f32 v251, v244
  s_nop 0
  v_add_f32 v251, 0xc1300000, v251
  v_max3_f32 v250, 0, v250, v251
  v_sub_f32 v251, 0, v250
  v_exp_f32 v251, v251
  v_sub_f32 v192, v192, v250
  v_sub_f32 v193, v193, v250
  v_sub_f32 v194, v194, v250
  v_sub_f32 v195, v195, v250
  v_sub_f32 v196, v196, v250
  v_sub_f32 v197, v197, v250
  v_sub_f32 v198, v198, v250
  v_sub_f32 v199, v199, v250
  v_sub_f32 v224, v224, v250
  v_sub_f32 v225, v225, v250
  v_sub_f32 v226, v226, v250
  v_sub_f32 v227, v227, v250
  v_sub_f32 v128, v128, v250
  v_sub_f32 v129, v129, v250
  v_sub_f32 v130, v130, v250
  v_sub_f32 v131, v131, v250
  v_sub_f32 v132, v132, v250
  v_sub_f32 v133, v133, v250
  v_sub_f32 v134, v134, v250
  v_sub_f32 v135, v135, v250
  v_mul_f32 v32, v32, v251
  v_mul_f32 v33, v33, v251
  v_mul_f32 v34, v34, v251
  v_mul_f32 v35, v35, v251
  v_mul_f32 v36, v36, v251
  v_mul_f32 v37, v37, v251
  v_mul_f32 v38, v38, v251
  v_mul_f32 v39, v39, v251
  v_mul_f32 v48, v48, v251
  v_mul_f32 v49, v49, v251
  v_mul_f32 v50, v50, v251
  v_mul_f32 v51, v51, v251
  v_mul_f32 v52, v52, v251
  v_mul_f32 v53, v53, v251
  v_mul_f32 v54, v54, v251
  v_mul_f32 v55, v55, v251
  v_mul_f32 v64, v64, v251
  v_mul_f32 v65, v65, v251
  v_mul_f32 v66, v66, v251
  v_mul_f32 v67, v67, v251
  v_mul_f32 v68, v68, v251
  v_mul_f32 v69, v69, v251
  v_mul_f32 v70, v70, v251
  v_mul_f32 v71, v71, v251
  v_mul_f32 v80, v80, v251
  v_mul_f32 v81, v81, v251
  v_mul_f32 v82, v82, v251
  v_mul_f32 v83, v83, v251
  v_mul_f32 v84, v84, v251
  v_mul_f32 v85, v85, v251
  v_mul_f32 v86, v86, v251
  v_mul_f32 v87, v87, v251
  v_mul_f32 v244, v244, v251
  v_max3_f32 v250, v200, v201, v202
  v_max3_f32 v250, v250, v203, v204
  v_max3_f32 v250, v250, v205, v206
  v_max_f32 v250, v250, v207
  v_mov_b32 v251, v250
  s_nop 1
  v_permlane32_swap_b32 v250, v251
  v_max_f32 v250, v250, v251
  v_mov_b32 v251, v250
  s_nop 1
  v_permlane16_swap_b32 v250, v251
  v_max_f32 v250, v250, v251
  v_log_f32 v251, v245
  s_nop 0
  v_add_f32 v251, 0xc1300000, v251
  v_max3_f32 v250, 0, v250, v251
  v_sub_f32 v251, 0, v250
  v_exp_f32 v251, v251
  v_sub_f32 v200, v200, v250
  v_sub_f32 v201, v201, v250
  v_sub_f32 v202, v202, v250
  v_sub_f32 v203, v203, v250
  v_sub_f32 v204, v204, v250
  v_sub_f32 v205, v205, v250
  v_sub_f32 v206, v206, v250
  v_sub_f32 v207, v207, v250
  v_sub_f32 v228, v228, v250
  v_sub_f32 v229, v229, v250
  v_sub_f32 v230, v230, v250
  v_sub_f32 v231, v231, v250
  v_sub_f32 v136, v136, v250
  v_sub_f32 v137, v137, v250
  v_sub_f32 v138, v138, v250
  v_sub_f32 v139, v139, v250
  v_sub_f32 v140, v140, v250
  v_sub_f32 v141, v141, v250
  v_sub_f32 v142, v142, v250
  v_sub_f32 v143, v143, v250
  v_mul_f32 v40, v40, v251
  v_mul_f32 v41, v41, v251
  v_mul_f32 v42, v42, v251
  v_mul_f32 v43, v43, v251
  v_mul_f32 v44, v44, v251
  v_mul_f32 v45, v45, v251
  v_mul_f32 v46, v46, v251
  v_mul_f32 v47, v47, v251
  v_mul_f32 v56, v56, v251
  v_mul_f32 v57, v57, v251
  v_mul_f32 v58, v58, v251
  v_mul_f32 v59, v59, v251
  v_mul_f32 v60, v60, v251
  v_mul_f32 v61, v61, v251
  v_mul_f32 v62, v62, v251
  v_mul_f32 v63, v63, v251
  v_mul_f32 v72, v72, v251
  v_mul_f32 v73, v73, v251
  v_mul_f32 v74, v74, v251
  v_mul_f32 v75, v75, v251
  v_mul_f32 v76, v76, v251
  v_mul_f32 v77, v77, v251
  v_mul_f32 v78, v78, v251
  v_mul_f32 v79, v79, v251
  v_mul_f32 v88, v88, v251
  v_mul_f32 v89, v89, v251
  v_mul_f32 v90, v90, v251
  v_mul_f32 v91, v91, v251
  v_mul_f32 v92, v92, v251
  v_mul_f32 v93, v93, v251
  v_mul_f32 v94, v94, v251
  v_mul_f32 v95, v95, v251
  v_mul_f32 v245, v245, v251
  v_max3_f32 v250, v216, v217, v218
  v_max3_f32 v250, v250, v219, v220
  v_max3_f32 v250, v250, v221, v222
  v_max_f32 v250, v250, v223
  v_mov_b32 v251, v250
  s_nop 1
  v_permlane32_swap_b32 v250, v251
  v_max_f32 v250, v250, v251
  v_mov_b32 v251, v250
  s_nop 1
  v_permlane16_swap_b32 v250, v251
  v_max_f32 v250, v250, v251
  v_log_f32 v251, v247
  s_nop 0
  v_add_f32 v251, 0xc1300000, v251
  v_max3_f32 v250, 0, v250, v251
  v_sub_f32 v251, 0, v250
  v_exp_f32 v251, v251
  v_sub_f32 v216, v216, v250
  v_sub_f32 v217, v217, v250
  v_sub_f32 v218, v218, v250
  v_sub_f32 v219, v219, v250
  v_sub_f32 v220, v220, v250
  v_sub_f32 v221, v221, v250
  v_sub_f32 v222, v222, v250
  v_sub_f32 v223, v223, v250
  v_sub_f32 v236, v236, v250
  v_sub_f32 v237, v237, v250
  v_sub_f32 v238, v238, v250
  v_sub_f32 v239, v239, v250
  v_sub_f32 v152, v152, v250
  v_sub_f32 v153, v153, v250
  v_sub_f32 v154, v154, v250
  v_sub_f32 v155, v155, v250
  v_sub_f32 v156, v156, v250
  v_sub_f32 v157, v157, v250
  v_sub_f32 v158, v158, v250
  v_sub_f32 v159, v159, v250
  v_accvgpr_read_b32 v2, a200
  v_mul_f32 v2, v2, v251
  v_accvgpr_write_b32 a200, v2
  v_accvgpr_read_b32 v3, a201
  v_mul_f32 v3, v3, v251
  v_accvgpr_write_b32 a201, v3
  v_accvgpr_read_b32 v4, a202
  v_mul_f32 v4, v4, v251
  v_accvgpr_write_b32 a202, v4
  v_accvgpr_read_b32 v5, a203
  v_mul_f32 v5, v5, v251
  v_accvgpr_write_b32 a203, v5
  v_accvgpr_read_b32 v2, a204
  v_mul_f32 v2, v2, v251
  v_accvgpr_write_b32 a204, v2
  v_accvgpr_read_b32 v3, a205
  v_mul_f32 v3, v3, v251
  v_accvgpr_write_b32 a205, v3
  v_accvgpr_read_b32 v4, a206
  v_mul_f32 v4, v4, v251
  v_accvgpr_write_b32 a206, v4
  v_accvgpr_read_b32 v5, a207
  v_mul_f32 v5, v5, v251
  v_accvgpr_write_b32 a207, v5
  v_accvgpr_read_b32 v2, a216
  v_mul_f32 v2, v2, v251
  v_accvgpr_write_b32 a216, v2
  v_accvgpr_read_b32 v3, a217
  v_mul_f32 v3, v3, v251
  v_accvgpr_write_b32 a217, v3
  v_accvgpr_read_b32 v4, a218
  v_mul_f32 v4, v4, v251
  v_accvgpr_write_b32 a218, v4
  v_accvgpr_read_b32 v5, a219
  v_mul_f32 v5, v5, v251
  v_accvgpr_write_b32 a219, v5
  v_accvgpr_read_b32 v2, a220
  v_mul_f32 v2, v2, v251
  v_accvgpr_write_b32 a220, v2
  v_accvgpr_read_b32 v3, a221
  v_mul_f32 v3, v3, v251
  v_accvgpr_write_b32 a221, v3
  v_accvgpr_read_b32 v4, a222
  v_mul_f32 v4, v4, v251
  v_accvgpr_write_b32 a222, v4
  v_accvgpr_read_b32 v5, a223
  v_mul_f32 v5, v5, v251
  v_accvgpr_write_b32 a223, v5
  v_accvgpr_read_b32 v2, a232
  v_mul_f32 v2, v2, v251
  v_accvgpr_write_b32 a232, v2
  v_accvgpr_read_b32 v3, a233
  v_mul_f32 v3, v3, v251
  v_accvgpr_write_b32 a233, v3
  v_accvgpr_read_b32 v4, a234
  v_mul_f32 v4, v4, v251
  v_accvgpr_write_b32 a234, v4
  v_accvgpr_read_b32 v5, a235
  v_mul_f32 v5, v5, v251
  v_accvgpr_write_b32 a235, v5
  v_accvgpr_read_b32 v2, a236
  v_mul_f32 v2, v2, v251
  v_accvgpr_write_b32 a236, v2
  v_accvgpr_read_b32 v3, a237
  v_mul_f32 v3, v3, v251
  v_accvgpr_write_b32 a237, v3
  v_accvgpr_read_b32 v4, a238
  v_mul_f32 v4, v4, v251
  v_accvgpr_write_b32 a238, v4
  v_accvgpr_read_b32 v5, a239
  v_mul_f32 v5, v5, v251
  v_accvgpr_write_b32 a239, v5
  v_accvgpr_read_b32 v2, a248
  v_mul_f32 v2, v2, v251
  v_accvgpr_write_b32 a248, v2
  v_accvgpr_read_b32 v3, a249
  v_mul_f32 v3, v3, v251
  v_accvgpr_write_b32 a249, v3
  v_accvgpr_read_b32 v4, a250
  v_mul_f32 v4, v4, v251
  v_accvgpr_write_b32 a250, v4
  v_accvgpr_read_b32 v5, a251
  v_mul_f32 v5, v5, v251
  v_accvgpr_write_b32 a251, v5
  v_accvgpr_read_b32 v2, a252
  v_mul_f32 v2, v2, v251
  v_accvgpr_write_b32 a252, v2
  v_accvgpr_read_b32 v3, a253
  v_mul_f32 v3, v3, v251
  v_accvgpr_write_b32 a253, v3
  v_accvgpr_read_b32 v4, a254
  v_mul_f32 v4, v4, v251
  v_accvgpr_write_b32 a254, v4
  v_accvgpr_read_b32 v5, a255
  v_mul_f32 v5, v5, v251
  v_accvgpr_write_b32 a255, v5
  v_mul_f32 v247, v247, v251
  v_exp_f32 v2, v192
  v_exp_f32 v3, v193
  v_exp_f32 v4, v194
  v_exp_f32 v5, v195
  v_cvt_pk_bf16_f32 v160, v2, v3
  v_exp_f32 v6, v196
  v_exp_f32 v7, v197
  v_cvt_pk_bf16_f32 v161, v4, v5
  v_exp_f32 v8, v198
  v_exp_f32 v9, v199
  v_cvt_pk_bf16_f32 v162, v6, v7
  v_exp_f32 v2, v200
  v_exp_f32 v3, v201
  v_cvt_pk_bf16_f32 v163, v8, v9
  v_exp_f32 v4, v202
  v_exp_f32 v5, v203
  v_cvt_pk_bf16_f32 v164, v2, v3
  v_mfma_f32_16x16x32_bf16 v[240:243], a[68:71], v[160:163], v[244:247]
  v_exp_f32 v6, v204
  v_exp_f32 v7, v205
  v_cvt_pk_bf16_f32 v165, v4, v5
  v_exp_f32 v8, v206
  v_exp_f32 v9, v207
  v_cvt_pk_bf16_f32 v166, v6, v7
  v_exp_f32 v2, v216
  v_exp_f32 v3, v217
  v_cvt_pk_bf16_f32 v167, v8, v9
  v_exp_f32 v4, v218
  v_exp_f32 v5, v219
  v_cvt_pk_bf16_f32 v172, v2, v3
  v_mfma_f32_16x16x32_bf16 v[240:243], a[72:75], v[164:167], v[240:243]
  v_exp_f32 v6, v220
  v_exp_f32 v7, v221
  v_cvt_pk_bf16_f32 v173, v4, v5
  v_exp_f32 v8, v222
  v_exp_f32 v9, v223
  v_cvt_pk_bf16_f32 v174, v6, v7
  v_cvt_pk_bf16_f32 v175, v8, v9
  s_nop 1
  v_mfma_f32_16x16x32_bf16 v[240:243], a[80:83], v[172:175], v[240:243]
  s_nop 7
  s_setpc_b64 s[94:95]
L_rare168s:
  s_nop 15
  v_max3_f32 v250, v128, v129, v130
  v_max3_f32 v250, v250, v131, v132
  v_max3_f32 v250, v250, v133, v134
  v_max_f32 v250, v250, v135
  v_mov_b32 v251, v250
  s_nop 1
  v_permlane32_swap_b32 v250, v251
  v_max_f32 v250, v250, v251
  v_mov_b32 v251, v250
  s_nop 1
  v_permlane16_swap_b32 v250, v251
  v_max_f32 v250, v250, v251
  v_log_f32 v251, v240
  s_nop 0
  v_add_f32 v251, 0xc1300000, v251
  v_max3_f32 v250, 0, v250, v251
  v_sub_f32 v251, 0, v250
  v_exp_f32 v251, v251
  v_sub_f32 v128, v128, v250
  v_sub_f32 v129, v129, v250
  v_sub_f32 v130, v130, v250
  v_sub_f32 v131, v131, v250
  v_sub_f32 v132, v132, v250
  v_sub_f32 v133, v133, v250
  v_sub_f32 v134, v134, v250
  v_sub_f32 v135, v135, v250
  v_sub_f32 v224, v224, v250
  v_sub_f32 v225, v225, v250
  v_sub_f32 v226, v226, v250
  v_sub_f32 v227, v227, v250
  v_sub_f32 v192, v192, v250
  v_sub_f32 v193, v193, v250
  v_sub_f32 v194, v194, v250
  v_sub_f32 v195, v195, v250
  v_sub_f32 v196, v196, v250
  v_sub_f32 v197, v197, v250
  v_sub_f32 v198, v198, v250
  v_sub_f32 v199, v199, v250
  v_sub_f32 v208, v208, v250
  v_sub_f32 v209, v209, v250
  v_sub_f32 v210, v210, v250
  v_sub_f32 v211, v211, v250
  v_sub_f32 v212, v212, v250
  v_sub_f32 v213, v213, v250
  v_sub_f32 v214, v214, v250
  v_sub_f32 v215, v215, v250
  v_mul_f32 v32, v32, v251
  v_mul_f32 v33, v33, v251
  v_mul_f32 v34, v34, v251
  v_mul_f32 v35, v35, v251
  v_mul_f32 v36, v36, v251
  v_mul_f32 v37, v37, v251
  v_mul_f32 v38, v38, v251
  v_mul_f32 v39, v39, v251
  v_mul_f32 v48, v48, v251
  v_mul_f32 v49, v49, v251
  v_mul_f32 v50, v50, v251
  v_mul_f32 v51, v51, v251
  v_mul_f32 v52, v52, v251
  v_mul_f32 v53, v53, v251
  v_mul_f32 v54, v54, v251
  v_mul_f32 v55, v55, v251
  v_mul_f32 v64, v64, v251
  v_mul_f32 v65, v65, v251
  v_mul_f32 v66, v66, v251
  v_mul_f32 v67, v67, v251
  v_mul_f32 v68, v68, v251
  v_mul_f32 v69, v69, v251
  v_mul_f32 v70, v70, v251
  v_mul_f32 v71, v71, v251
  v_mul_f32 v80, v80, v251
  v_mul_f32 v81, v81, v251
  v_mul_f32 v82, v82, v251
  v_mul_f32 v83, v83, v251
  v_mul_f32 v84, v84, v251
  v_mul_f32 v85, v85, v251
  v_mul_f32 v86, v86, v251
  v_mul_f32 v87, v87, v251
  v_mul_f32 v240, v240, v251
  v_max3_f32 v250, v136, v137, v138
  v_max3_f32 v250, v250, v139, v140
  v_max3_f32 v250, v250, v141, v142
  v_max_f32 v250, v250, v143
  v_mov_b32 v251, v250
  s_nop 1
  v_permlane32_swap_b32 v250, v251
  v_max_f32 v250, v250, v251
  v_mov_b32 v251, v250
  s_nop 1
  v_permlane16_swap_b32 v250, v251
  v_max_f32 v250, v250, v251
  v_log_f32 v251, v241
  s_nop 0
  v_add_f32 v251, 0xc1300000, v251
  v_max3_f32 v250, 0, v250, v251
  v_sub_f32 v251, 0, v250
  v_exp_f32 v251, v251
  v_sub_f32 v136, v136, v250
  v_sub_f32 v137, v137, v250
  v_sub_f32 v138, v138, v250
  v_sub_f32 v139, v139, v250
  v_sub_f32 v140, v140, v250
  v_sub_f32 v141, v141, v250
  v_sub_f32 v142, v142, v250
  v_sub_f32 v143, v143, v250
  v_sub_f32 v228, v228, v250
  v_sub_f32 v229, v229, v250
  v_sub_f32 v230, v230, v250
  v_sub_f32 v231, v231, v250
  v_sub_f32 v200, v200, v250
  v_sub_f32 v201, v201, v250
  v_sub_f32 v202, v202, v250
  v_sub_f32 v203, v203, v250
  v_sub_f32 v204, v204, v250
  v_sub_f32 v205, v205, v250
  v_sub_f32 v206, v206, v250
  v_sub_f32 v207, v207, v250
  v_sub_f32 v216, v216, v250
  v_sub_f32 v217, v217, v250
  v_sub_f32 v218, v218, v250
  v_sub_f32 v219, v219, v250
  v_sub_f32 v220, v220, v250
  v_sub_f32 v221, v221, v250
  v_sub_f32 v222, v222, v250
  v_sub_f32 v223, v223, v250
  v_mul_f32 v40, v40, v251
  v_mul_f32 v41, v41, v251
  v_mul_f32 v42, v42, v251
  v_mul_f32 v43, v43, v251
  v_mul_f32 v44, v44, v251
  v_mul_f32 v45, v45, v251
  v_mul_f32 v46, v46, v251
  v_mul_f32 v47, v47, v251
  v_mul_f32 v56, v56, v251
  v_mul_f32 v57, v57, v251
  v_mul_f32 v58, v58, v251
  v_mul_f32 v59, v59, v251
  v_mul_f32 v60, v60, v251
  v_mul_f32 v61, v61, v251
  v_mul_f32 v62, v62, v251
  v_mul_f32 v63, v63, v251
  v_mul_f32 v72, v72, v251
  v_mul_f32 v73, v73, v251
  v_mul_f32 v74, v74, v251
  v_mul_f32 v75, v75, v251
  v_mul_f32 v76, v76, v251
  v_mul_f32 v77, v77, v251
  v_mul_f32 v78, v78, v251
  v_mul_f32 v79, v79, v251
  v_mul_f32 v88, v88, v251
  v_mul_f32 v89, v89, v251
  v_mul_f32 v90, v90, v251
  v_mul_f32 v91, v91, v251
  v_mul_f32 v92, v92, v251
  v_mul_f32 v93, v93, v251
  v_mul_f32 v94, v94, v251
  v_mul_f32 v95, v95, v251
  v_mul_f32 v241, v241, v251
  v_max3_f32 v250, v152, v153, v154
  v_max3_f32 v250, v250, v155, v156
  v_max3_f32 v250, v250, v157, v158
  v_max_f32 v250, v250, v159
  v_mov_b32 v251, v250
  s_nop 1
  v_permlane32_swap_b32 v250, v251
  v_max_f32 v250, v250, v251
  v_mov_b32 v251, v250
  s_nop 1
  v_permlane16_swap_b32 v250, v251
  v_max_f32 v250, v250, v251
  v_log_f32 v251, v243
  s_nop 0
  v_add_f32 v251, 0xc1300000, v251
  v_max3_f32 v250, 0, v250, v251
  v_sub_f32 v251, 0, v250
  v_exp_f32 v251, v251
  v_sub_f32 v152, v152, v250
  v_sub_f32 v153, v153, v250
  v_sub_f32 v154, v154, v250
  v_sub_f32 v155, v155, v250
  v_sub_f32 v156, v156, v250
  v_sub_f32 v157, v157, v250
  v_sub_f32 v158, v158, v250
  v_sub_f32 v159, v159, v250
  v_sub_f32 v236, v236, v250
  v_sub_f32 v237, v237, v250
  v_sub_f32 v238, v238, v250
  v_sub_f32 v239, v239, v250
  v_accvgpr_read_b32 v2, a200
  v_mul_f32 v2, v2, v251
  v_accvgpr_write_b32 a200, v2
  v_accvgpr_read_b32 v3, a201
  v_mul_f32 v3, v3, v251
  v_accvgpr_write_b32 a201, v3
  v_accvgpr_read_b32 v4, a202
  v_mul_f32 v4, v4, v251
  v_accvgpr_write_b32 a202, v4
  v_accvgpr_read_b32 v5, a203
  v_mul_f32 v5, v5, v251
  v_accvgpr_write_b32 a203, v5
  v_accvgpr_read_b32 v2, a204
  v_mul_f32 v2, v2, v251
  v_accvgpr_write_b32 a204, v2
  v_accvgpr_read_b32 v3, a205
  v_mul_f32 v3, v3, v251
  v_accvgpr_write_b32 a205, v3
  v_accvgpr_read_b32 v4, a206
  v_mul_f32 v4, v4, v251
  v_accvgpr_write_b32 a206, v4
  v_accvgpr_read_b32 v5, a207
  v_mul_f32 v5, v5, v251
  v_accvgpr_write_b32 a207, v5
  v_accvgpr_read_b32 v2, a216
  v_mul_f32 v2, v2, v251
  v_accvgpr_write_b32 a216, v2
  v_accvgpr_read_b32 v3, a217
  v_mul_f32 v3, v3, v251
  v_accvgpr_write_b32 a217, v3
  v_accvgpr_read_b32 v4, a218
  v_mul_f32 v4, v4, v251
  v_accvgpr_write_b32 a218, v4
  v_accvgpr_read_b32 v5, a219
  v_mul_f32 v5, v5, v251
  v_accvgpr_write_b32 a219, v5
  v_accvgpr_read_b32 v2, a220
  v_mul_f32 v2, v2, v251
  v_accvgpr_write_b32 a220, v2
  v_accvgpr_read_b32 v3, a221
  v_mul_f32 v3, v3, v251
  v_accvgpr_write_b32 a221, v3
  v_accvgpr_read_b32 v4, a222
  v_mul_f32 v4, v4, v251
  v_accvgpr_write_b32 a222, v4
  v_accvgpr_read_b32 v5, a223
  v_mul_f32 v5, v5, v251
  v_accvgpr_write_b32 a223, v5
  v_accvgpr_read_b32 v2, a232
  v_mul_f32 v2, v2, v251
  v_accvgpr_write_b32 a232, v2
  v_accvgpr_read_b32 v3, a233
  v_mul_f32 v3, v3, v251
  v_accvgpr_write_b32 a233, v3
  v_accvgpr_read_b32 v4, a234
  v_mul_f32 v4, v4, v251
  v_accvgpr_write_b32 a234, v4
  v_accvgpr_read_b32 v5, a235
  v_mul_f32 v5, v5, v251
  v_accvgpr_write_b32 a235, v5
  v_accvgpr_read_b32 v2, a236
  v_mul_f32 v2, v2, v251
  v_accvgpr_write_b32 a236, v2
  v_accvgpr_read_b32 v3, a237
  v_mul_f32 v3, v3, v251
  v_accvgpr_write_b32 a237, v3
  v_accvgpr_read_b32 v4, a238
  v_mul_f32 v4, v4, v251
  v_accvgpr_write_b32 a238, v4
  v_accvgpr_read_b32 v5, a239
  v_mul_f32 v5, v5, v251
  v_accvgpr_write_b32 a239, v5
  v_accvgpr_read_b32 v2, a248
  v_mul_f32 v2, v2, v251
  v_accvgpr_write_b32 a248, v2
  v_accvgpr_read_b32 v3, a249
  v_mul_f32 v3, v3, v251
  v_accvgpr_write_b32 a249, v3
  v_accvgpr_read_b32 v4, a250
  v_mul_f32 v4, v4, v251
  v_accvgpr_write_b32 a250, v4
  v_accvgpr_read_b32 v5, a251
  v_mul_f32 v5, v5, v251
  v_accvgpr_write_b32 a251, v5
  v_accvgpr_read_b32 v2, a252
  v_mul_f32 v2, v2, v251
  v_accvgpr_write_b32 a252, v2
  v_accvgpr_read_b32 v3, a253
  v_mul_f32 v3, v3, v251
  v_accvgpr_write_b32 a253, v3
  v_accvgpr_read_b32 v4, a254
  v_mul_f32 v4, v4, v251
  v_accvgpr_write_b32 a254, v4
  v_accvgpr_read_b32 v5, a255
  v_mul_f32 v5, v5, v251
  v_accvgpr_write_b32 a255, v5
  v_mul_f32 v243, v243, v251
  v_exp_f32 v2, v128
  v_exp_f32 v3, v129
  v_exp_f32 v4, v130
  v_exp_f32 v5, v131
  v_cvt_pk_bf16_f32 v176, v2, v3
  v_exp_f32 v6, v132
  v_exp_f32 v7, v133
  v_cvt_pk_bf16_f32 v177, v4, v5
  v_exp_f32 v8, v134
  v_exp_f32 v9, v135
  v_cvt_pk_bf16_f32 v178, v6, v7
  v_exp_f32 v2, v136
  v_exp_f32 v3, v137
  v_cvt_pk_bf16_f32 v179, v8, v9
  v_exp_f32 v4, v138
  v_exp_f32 v5, v139
  v_cvt_pk_bf16_f32 v180, v2, v3
  v_mfma_f32_16x16x32_bf16 v[244:247], a[68:71], v[176:179], v[240:243]
  v_exp_f32 v6, v140
  v_exp_f32 v7, v141
  v_cvt_pk_bf16_f32 v181, v4, v5
  v_exp_f32 v8, v142
  v_exp_f32 v9, v143
  v_cvt_pk_bf16_f32 v182, v6, v7
  v_exp_f32 v2, v152
  v_exp_f32 v3, v153
  v_cvt_pk_bf16_f32 v183, v8, v9
  v_exp_f32 v4, v154
  v_exp_f32 v5, v155
  v_cvt_pk_bf16_f32 v188, v2, v3
  v_mfma_f32_16x16x32_bf16 v[244:247], a[72:75], v[180:183], v[244:247]
  v_exp_f32 v6, v156
  v_exp_f32 v7, v157
  v_cvt_pk_bf16_f32 v189, v4, v5
  v_exp_f32 v8, v158
  v_exp_f32 v9, v159
  v_cvt_pk_bf16_f32 v190, v6, v7
  v_cvt_pk_bf16_f32 v191, v8, v9
  s_nop 1
  v_mfma_f32_16x16x32_bf16 v[244:247], a[80:83], v[188:191], v[244:247]
  s_nop 7
  s_setpc_b64 s[94:95]
L_rare0115s:
  s_nop 15
  v_max3_f32 v250, v192, v193, v194
  v_max3_f32 v250, v250, v195, v196
  v_max3_f32 v250, v250, v197, v198
  v_max3_f32 v250, v250, v199, v208
  v_max3_f32 v250, v250, v209, v210
  v_max3_f32 v250, v250, v211, v212
  v_max3_f32 v250, v250, v213, v214
  v_max_f32 v250, v250, v215
  v_mov_b32 v251, v250
  s_nop 1
  v_permlane32_swap_b32 v250, v251
  v_max_f32 v250, v250, v251
  v_mov_b32 v251, v250
  s_nop 1
  v_permlane16_swap_b32 v250, v251
  v_max_f32 v250, v250, v251
  v_log_f32 v251, v244
  s_nop 0
  v_add_f32 v251, 0xc1300000, v251
  v_max3_f32 v250, 0, v250, v251
  v_sub_f32 v251, 0, v250
  v_exp_f32 v251, v251
  v_sub_f32 v192, v192, v250
  v_sub_f32 v193, v193, v250
  v_sub_f32 v194, v194, v250
  v_sub_f32 v195, v195, v250
  v_sub_f32 v196, v196, v250
  v_sub_f32 v197, v197, v250
  v_sub_f32 v198, v198, v250
  v_sub_f32 v199, v199, v250
  v_sub_f32 v208, v208, v250
  v_sub_f32 v209, v209, v250
  v_sub_f32 v210, v210, v250
  v_sub_f32 v211, v211, v250
  v_sub_f32 v212, v212, v250
  v_sub_f32 v213, v213, v250
  v_sub_f32 v214, v214, v250
  v_sub_f32 v215, v215, v250
  v_sub_f32 v224, v224, v250
  v_sub_f32 v225, v225, v250
  v_sub_f32 v226, v226, v250
  v_sub_f32 v227, v227, v250
  v_sub_f32 v128, v128, v250
  v_sub_f32 v129, v129, v250
  v_sub_f32 v130, v130, v250
  v_sub_f32 v131, v131, v250
  v_sub_f32 v132, v132, v250
  v_sub_f32 v133, v133, v250
  v_sub_f32 v134, v134, v250
  v_sub_f32 v135, v135, v250
  v_sub_f32 v144, v144, v250
  v_sub_f32 v145, v145, v250
  v_sub_f32 v146, v146, v250
  v_sub_f32 v147, v147, v250
  v_sub_f32 v148, v148, v250
  v_sub_f32 v149, v149, v250
  v_sub_f32 v150, v150, v250
  v_sub_f32 v151, v151, v250
  v_mul_f32 v32, v32, v251
  v_mul_f32 v33, v33, v251
  v_mul_f32 v34, v34, v251
  v_mul_f32 v35, v35, v251
  v_mul_f32 v36, v36, v251
  v_mul_f32 v37, v37, v251
  v_mul_f32 v38, v38, v251
  v_mul_f32 v39, v39, v251
  v_mul_f32 v48, v48, v251
  v_mul_f32 v49, v49, v251
  v_mul_f32 v50, v50, v251
  v_mul_f32 v51, v51, v251
  v_mul_f32 v52, v52, v251
  v_mul_f32 v53, v53, v251
  v_mul_f32 v54, v54, v251
  v_mul_f32 v55, v55, v251
  v_mul_f32 v64, v64, v251
  v_mul_f32 v65, v65, v251
  v_mul_f32 v66, v66, v251
  v_mul_f32 v67, v67, v251
  v_mul_f32 v68, v68, v251
  v_mul_f32 v69, v69, v251
  v_mul_f32 v70, v70, v251
  v_mul_f32 v71, v71, v251
  v_mul_f32 v80, v80, v251
  v_mul_f32 v81, v81, v251
  v_mul_f32 v82, v82, v251
  v_mul_f32 v83, v83, v251
  v_mul_f32 v84, v84, v251
  v_mul_f32 v85, v85, v251
  v_mul_f32 v86, v86, v251
  v_mul_f32 v87, v87, v251
  v_mul_f32 v244, v244, v251
  v_max3_f32 v250, v200, v201, v202
  v_max3_f32 v250, v250, v203, v204
  v_max3_f32 v250, v250, v205, v206
  v_max3_f32 v250, v250, v207, v216
  v_max3_f32 v250, v250, v217, v218
  v_max3_f32 v250, v250, v219, v220
  v_max3_f32 v250, v250, v221, v222
  v_max_f32 v250, v250, v223
  v_mov_b32 v251, v250
  s_nop 1
  v_permlane32_swap_b32 v250, v251
  v_max_f32 v250, v250, v251
  v_mov_b32 v251, v250
  s_nop 1
  v_permlane16_swap_b32 v250, v251
  v_max_f32 v250, v250, v251
  v_log_f32 v251, v245
  s_nop 0
  v_add_f32 v251, 0xc1300000, v251
  v_max3_f32 v250, 0, v250, v251
  v_sub_f32 v251, 0, v250
  v_exp_f32 v251, v251
  v_sub_f32 v200, v200, v250
  v_sub_f32 v201, v201, v250
  v_sub_f32 v202, v202, v250
  v_sub_f32 v203, v203, v250
  v_sub_f32 v204, v204, v250
  v_sub_f32 v205, v205, v250
  v_sub_f32 v206, v206, v250
  v_sub_f32 v207, v207, v250
  v_sub_f32 v216, v216, v250
  v_sub_f32 v217, v217, v250
  v_sub_f32 v218, v218, v250
  v_sub_f32 v219, v219, v250
  v_sub_f32 v220, v220, v250
  v_sub_f32 v221, v221, v250
  v_sub_f32 v222, v222, v250
  v_sub_f32 v223, v223, v250
  v_sub_f32 v228, v228, v250
  v_sub_f32 v229, v229, v250
  v_sub_f32 v230, v230, v250
  v_sub_f32 v231, v231, v250
  v_sub_f32 v136, v136, v250
  v_sub_f32 v137, v137, v250
  v_sub_f32 v138, v138, v250
  v_sub_f32 v139, v139, v250
  v_sub_f32 v140, v140, v250
  v_sub_f32 v141, v141, v250
  v_sub_f32 v142, v142, v250
  v_sub_f32 v143, v143, v250
  v_sub_f32 v152, v152, v250
  v_sub_f32 v153, v153, v250
  v_sub_f32 v154, v154, v250
  v_sub_f32 v155, v155, v250
  v_sub_f32 v156, v156, v250
  v_sub_f32 v157, v157, v250
  v_sub_f32 v158, v158, v250
  v_sub_f32 v159, v159, v250
  v_mul_f32 v40, v40, v251
  v_mul_f32 v41, v41, v251
  v_mul_f32 v42, v42, v251
  v_mul_f32 v43, v43, v251
  v_mul_f32 v44, v44, v251
  v_mul_f32 v45, v45, v251
  v_mul_f32 v46, v46, v251
  v_mul_f32 v47, v47, v251
  v_mul_f32 v56, v56, v251
  v_mul_f32 v57, v57, v251
  v_mul_f32 v58, v58, v251
  v_mul_f32 v59, v59, v251
  v_mul_f32 v60, v60, v251
  v_mul_f32 v61, v61, v251
  v_mul_f32 v62, v62, v251
  v_mul_f32 v63, v63, v251
  v_mul_f32 v72, v72, v251
  v_mul_f32 v73, v73, v251
  v_mul_f32 v74, v74, v251
  v_mul_f32 v75, v75, v251
  v_mul_f32 v76, v76, v251
  v_mul_f32 v77, v77, v251
  v_mul_f32 v78, v78, v251
  v_mul_f32 v79, v79, v251
  v_mul_f32 v88, v88, v251
  v_mul_f32 v89, v89, v251
  v_mul_f32 v90, v90, v251
  v_mul_f32 v91, v91, v251
  v_mul_f32 v92, v92, v251
  v_mul_f32 v93, v93, v251
  v_mul_f32 v94, v94, v251
  v_mul_f32 v95, v95, v251
  v_mul_f32 v245, v245, v251
  v_exp_f32 v2, v192
  v_exp_f32 v3, v193
  v_exp_f32 v4, v194
  v_exp_f32 v5, v195
  v_cvt_pk_bf16_f32 v160, v2, v3
  v_exp_f32 v6, v196
  v_exp_f32 v7, v197
  v_cvt_pk_bf16_f32 v161, v4, v5
  v_exp_f32 v8, v198
  v_exp_f32 v9, v199
  v_cvt_pk_bf16_f32 v162, v6, v7
  v_exp_f32 v2, v200
  v_exp_f32 v3, v201
  v_cvt_pk_bf16_f32 v163, v8, v9
  v_exp_f32 v4, v202
  v_exp_f32 v5, v203
  v_cvt_pk_bf16_f32 v164, v2, v3
  v_mfma_f32_16x16x32_bf16 v[240:243], a[68:71], v[160:163], v[244:247]
  v_exp_f32 v6, v204
  v_exp_f32 v7, v205
  v_cvt_pk_bf16_f32 v165, v4, v5
  v_exp_f32 v8, v206
  v_exp_f32 v9, v207
  v_cvt_pk_bf16_f32 v166, v6, v7
  v_exp_f32 v2, v208
  v_exp_f32 v3, v209
  v_cvt_pk_bf16_f32 v167, v8, v9
  v_exp_f32 v4, v210
  v_exp_f32 v5, v211
  v_cvt_pk_bf16_f32 v168, v2, v3
  v_mfma_f32_16x16x32_bf16 v[240:243], a[72:75], v[164:167], v[240:243]
  v_exp_f32 v6, v212
  v_exp_f32 v7, v213
  v_cvt_pk_bf16_f32 v169, v4, v5
  v_exp_f32 v8, v214
  v_exp_f32 v9, v215
  v_cvt_pk_bf16_f32 v170, v6, v7
  v_exp_f32 v2, v216
  v_exp_f32 v3, v217
  v_cvt_pk_bf16_f32 v171, v8, v9
  v_exp_f32 v4, v218
  v_exp_f32 v5, v219
  v_cvt_pk_bf16_f32 v172, v2, v3
  v_mfma_f32_16x16x32_bf16 v[240:243], a[68:71], v[168:171], v[240:243]
  v_exp_f32 v6, v220
  v_exp_f32 v7, v221
  v_cvt_pk_bf16_f32 v173, v4, v5
  v_exp_f32 v8, v222
  v_exp_f32 v9, v223
  v_cvt_pk_bf16_f32 v174, v6, v7
  v_cvt_pk_bf16_f32 v175, v8, v9
  s_nop 1
  v_mfma_f32_16x16x32_bf16 v[240:243], a[72:75], v[172:175], v[240:243]
  s_nop 7
  s_setpc_b64 s[94:95]
L_rare1115s:
  s_nop 15
  v_max3_f32 v250, v128, v129, v130
  v_max3_f32 v250, v250, v131, v132
  v_max3_f32 v250, v250, v133, v134
  v_max3_f32 v250, v250, v135, v144
  v_max3_f32 v250, v250, v145, v146
  v_max3_f32 v250, v250, v147, v148
  v_max3_f32 v250, v250, v149, v150
  v_max_f32 v250, v250, v151
  v_mov_b32 v251, v250
  s_nop 1
  v_permlane32_swap_b32 v250, v251
  v_max_f32 v250, v250, v251
  v_mov_b32 v251, v250
  s_nop 1
  v_permlane16_swap_b32 v250, v251
  v_max_f32 v250, v250, v251
  v_log_f32 v251, v240
  s_nop 0
  v_add_f32 v251, 0xc1300000, v251
  v_max3_f32 v250, 0, v250, v251
  v_sub_f32 v251, 0, v250
  v_exp_f32 v251, v251
  v_sub_f32 v128, v128, v250
  v_sub_f32 v129, v129, v250
  v_sub_f32 v130, v130, v250
  v_sub_f32 v131, v131, v250
  v_sub_f32 v132, v132, v250
  v_sub_f32 v133, v133, v250
  v_sub_f32 v134, v134, v250
  v_sub_f32 v135, v135, v250
  v_sub_f32 v144, v144, v250
  v_sub_f32 v145, v145, v250
  v_sub_f32 v146, v146, v250
  v_sub_f32 v147, v147, v250
  v_sub_f32 v148, v148, v250
  v_sub_f32 v149, v149, v250
  v_sub_f32 v150, v150, v250
  v_sub_f32 v151, v151, v250
  v_sub_f32 v224, v224, v250
  v_sub_f32 v225, v225, v250
  v_sub_f32 v226, v226, v250
  v_sub_f32 v227, v227, v250
  v_sub_f32 v192, v192, v250
  v_sub_f32 v193, v193, v250
  v_sub_f32 v194, v194, v250
  v_sub_f32 v195, v195, v250
  v_sub_f32 v196, v196, v250
  v_sub_f32 v197, v197, v250
  v_sub_f32 v198, v198, v250
  v_sub_f32 v199, v199, v250
  v_sub_f32 v208, v208, v250
  v_sub_f32 v209, v209, v250
  v_sub_f32 v210, v210, v250
  v_sub_f32 v211, v211, v250
  v_sub_f32 v212, v212, v250
  v_sub_f32 v213, v213, v250
  v_sub_f32 v214, v214, v250
  v_sub_f32 v215, v215, v250
  v_mul_f32 v32, v32, v251
  v_mul_f32 v33, v33, v251
  v_mul_f32 v34, v34, v251
  v_mul_f32 v35, v35, v251
  v_mul_f32 v36, v36, v251
  v_mul_f32 v37, v37, v251
  v_mul_f32 v38, v38, v251
  v_mul_f32 v39, v39, v251
  v_mul_f32 v48, v48, v251
  v_mul_f32 v49, v49, v251
  v_mul_f32 v50, v50, v251
  v_mul_f32 v51, v51, v251
  v_mul_f32 v52, v52, v251
  v_mul_f32 v53, v53, v251
  v_mul_f32 v54, v54, v251
  v_mul_f32 v55, v55, v251
  v_mul_f32 v64, v64, v251
  v_mul_f32 v65, v65, v251
  v_mul_f32 v66, v66, v251
  v_mul_f32 v67, v67, v251
  v_mul_f32 v68, v68, v251
  v_mul_f32 v69, v69, v251
  v_mul_f32 v70, v70, v251
  v_mul_f32 v71, v71, v251
  v_mul_f32 v80, v80, v251
  v_mul_f32 v81, v81, v251
  v_mul_f32 v82, v82, v251
  v_mul_f32 v83, v83, v251
  v_mul_f32 v84, v84, v251
  v_mul_f32 v85, v85, v251
  v_mul_f32 v86, v86, v251
  v_mul_f32 v87, v87, v251
  v_mul_f32 v240, v240, v251
  v_max3_f32 v250, v136, v137, v138
  v_max3_f32 v250, v250, v139, v140
  v_max3_f32 v250, v250, v141, v142
  v_max3_f32 v250, v250, v143, v152
  v_max3_f32 v250, v250, v153, v154
  v_max3_f32 v250, v250, v155, v156
  v_max3_f32 v250, v250, v157, v158
  v_max_f32 v250, v250, v159
  v_mov_b32 v251, v250
  s_nop 1
  v_permlane32_swap_b32 v250, v251
  v_max_f32 v250, v250, v251
  v_mov_b32 v251, v250
  s_nop 1
  v_permlane16_swap_b32 v250, v251
  v_max_f32 v250, v250, v251
  v_log_f32 v251, v241
  s_nop 0
  v_add_f32 v251, 0xc1300000, v251
  v_max3_f32 v250, 0, v250, v251
  v_sub_f32 v251, 0, v250
  v_exp_f32 v251, v251
  v_sub_f32 v136, v136, v250
  v_sub_f32 v137, v137, v250
  v_sub_f32 v138, v138, v250
  v_sub_f32 v139, v139, v250
  v_sub_f32 v140, v140, v250
  v_sub_f32 v141, v141, v250
  v_sub_f32 v142, v142, v250
  v_sub_f32 v143, v143, v250
  v_sub_f32 v152, v152, v250
  v_sub_f32 v153, v153, v250
  v_sub_f32 v154, v154, v250
  v_sub_f32 v155, v155, v250
  v_sub_f32 v156, v156, v250
  v_sub_f32 v157, v157, v250
  v_sub_f32 v158, v158, v250
  v_sub_f32 v159, v159, v250
  v_sub_f32 v228, v228, v250
  v_sub_f32 v229, v229, v250
  v_sub_f32 v230, v230, v250
  v_sub_f32 v231, v231, v250
  v_sub_f32 v200, v200, v250
  v_sub_f32 v201, v201, v250
  v_sub_f32 v202, v202, v250
  v_sub_f32 v203, v203, v250
  v_sub_f32 v204, v204, v250
  v_sub_f32 v205, v205, v250
  v_sub_f32 v206, v206, v250
  v_sub_f32 v207, v207, v250
  v_sub_f32 v216, v216, v250
  v_sub_f32 v217, v217, v250
  v_sub_f32 v218, v218, v250
  v_sub_f32 v219, v219, v250
  v_sub_f32 v220, v220, v250
  v_sub_f32 v221, v221, v250
  v_sub_f32 v222, v222, v250
  v_sub_f32 v223, v223, v250
  v_mul_f32 v40, v40, v251
  v_mul_f32 v41, v41, v251
  v_mul_f32 v42, v42, v251
  v_mul_f32 v43, v43, v251
  v_mul_f32 v44, v44, v251
  v_mul_f32 v45, v45, v251
  v_mul_f32 v46, v46, v251
  v_mul_f32 v47, v47, v251
  v_mul_f32 v56, v56, v251
  v_mul_f32 v57, v57, v251
  v_mul_f32 v58, v58, v251
  v_mul_f32 v59, v59, v251
  v_mul_f32 v60, v60, v251
  v_mul_f32 v61, v61, v251
  v_mul_f32 v62, v62, v251
  v_mul_f32 v63, v63, v251
  v_mul_f32 v72, v72, v251
  v_mul_f32 v73, v73, v251
  v_mul_f32 v74, v74, v251
  v_mul_f32 v75, v75, v251
  v_mul_f32 v76, v76, v251
  v_mul_f32 v77, v77, v251
  v_mul_f32 v78, v78, v251
  v_mul_f32 v79, v79, v251
  v_mul_f32 v88, v88, v251
  v_mul_f32 v89, v89, v251
  v_mul_f32 v90, v90, v251
  v_mul_f32 v91, v91, v251
  v_mul_f32 v92, v92, v251
  v_mul_f32 v93, v93, v251
  v_mul_f32 v94, v94, v251
  v_mul_f32 v95, v95, v251
  v_mul_f32 v241, v241, v251
  v_exp_f32 v2, v128
  v_exp_f32 v3, v129
  v_exp_f32 v4, v130
  v_exp_f32 v5, v131
  v_cvt_pk_bf16_f32 v176, v2, v3
  v_exp_f32 v6, v132
  v_exp_f32 v7, v133
  v_cvt_pk_bf16_f32 v177, v4, v5
  v_exp_f32 v8, v134
  v_exp_f32 v9, v135
  v_cvt_pk_bf16_f32 v178, v6, v7
  v_exp_f32 v2, v136
  v_exp_f32 v3, v137
  v_cvt_pk_bf16_f32 v179, v8, v9
  v_exp_f32 v4, v138
  v_exp_f32 v5, v139
  v_cvt_pk_bf16_f32 v180, v2, v3
  v_mfma_f32_16x16x32_bf16 v[244:247], a[68:71], v[176:179], v[240:243]
  v_exp_f32 v6, v140
  v_exp_f32 v7, v141
  v_cvt_pk_bf16_f32 v181, v4, v5
  v_exp_f32 v8, v142
  v_exp_f32 v9, v143
  v_cvt_pk_bf16_f32 v182, v6, v7
  v_exp_f32 v2, v144
  v_exp_f32 v3, v145
  v_cvt_pk_bf16_f32 v183, v8, v9
  v_exp_f32 v4, v146
  v_exp_f32 v5, v147
  v_cvt_pk_bf16_f32 v184, v2, v3
  v_mfma_f32_16x16x32_bf16 v[244:247], a[72:75], v[180:183], v[244:247]
  v_exp_f32 v6, v148
  v_exp_f32 v7, v149
  v_cvt_pk_bf16_f32 v185, v4, v5
  v_exp_f32 v8, v150
  v_exp_f32 v9, v151
  v_cvt_pk_bf16_f32 v186, v6, v7
  v_exp_f32 v2, v152
  v_exp_f32 v3, v153
  v_cvt_pk_bf16_f32 v187, v8, v9
  v_exp_f32 v4, v154
  v_exp_f32 v5, v155
  v_cvt_pk_bf16_f32 v188, v2, v3
  v_mfma_f32_16x16x32_bf16 v[244:247], a[68:71], v[184:187], v[244:247]
  v_exp_f32 v6, v156
  v_exp_f32 v7, v157
  v_cvt_pk_bf16_f32 v189, v4, v5
  v_exp_f32 v8, v158
  v_exp_f32 v9, v159
  v_cvt_pk_bf16_f32 v190, v6, v7
  v_cvt_pk_bf16_f32 v191, v8, v9
  s_nop 1
  v_mfma_f32_16x16x32_bf16 v[244:247], a[72:75], v[188:191], v[244:247]
  s_nop 7
  s_setpc_b64 s[94:95]
L_rare183n:
  s_nop 15
  v_max3_f32 v250, v136, v137, v138
  v_max3_f32 v250, v250, v139, v140
  v_max3_f32 v250, v250, v141, v142
  v_max3_f32 v250, v250, v143, v152
  v_max3_f32 v250, v250, v153, v154
  v_max3_f32 v250, v250, v155, v156
  v_max3_f32 v250, v250, v157, v158
  v_max_f32 v250, v250, v159
  v_mov_b32 v251, v250
  s_nop 1
  v_permlane32_swap_b32 v250, v251
  v_max_f32 v250, v250, v251
  v_mov_b32 v251, v250
  s_nop 1
  v_permlane16_swap_b32 v250, v251
  v_max_f32 v250, v250, v251
  v_log_f32 v251, v241
  s_nop 0
  v_add_f32 v251, 0xc1300000, v251
  v_max3_f32 v250, 0, v250, v251
  v_sub_f32 v251, 0, v250
  v_exp_f32 v251, v251
  v_sub_f32 v136, v136, v250
  v_sub_f32 v137, v137, v250
  v_sub_f32 v138, v138, v250
  v_sub_f32 v139, v139, v250
  v_sub_f32 v140, v140, v250
  v_sub_f32 v141, v141, v250
  v_sub_f32 v142, v142, v250
  v_sub_f32 v143, v143, v250
  v_sub_f32 v152, v152, v250
  v_sub_f32 v153, v153, v250
  v_sub_f32 v154, v154, v250
  v_sub_f32 v155, v155, v250
  v_sub_f32 v156, v156, v250
  v_sub_f32 v157, v157, v250
  v_sub_f32 v158, v158, v250
  v_sub_f32 v159, v159, v250
  v_sub_f32 v228, v228, v250
  v_sub_f32 v229, v229, v250
  v_sub_f32 v230, v230, v250
  v_sub_f32 v231, v231, v250
  v_mul_f32 v40, v40, v251
  v_mul_f32 v41, v41, v251
  v_mul_f32 v42, v42, v251
  v_mul_f32 v43, v43, v251
  v_mul_f32 v44, v44, v251
  v_mul_f32 v45, v45, v251
  v_mul_f32 v46, v46, v251
  v_mul_f32 v47, v47, v251
  v_mul_f32 v56, v56, v251
  v_mul_f32 v57, v57, v251
  v_mul_f32 v58, v58, v251
  v_mul_f32 v59, v59, v251
  v_mul_f32 v60, v60, v251
  v_mul_f32 v61, v61, v251
  v_mul_f32 v62, v62, v251
  v_mul_f32 v63, v63, v251
  v_mul_f32 v72, v72, v251
  v_mul_f32 v73, v73, v251
  v_mul_f32 v74, v74, v251
  v_mul_f32 v75, v75, v251
  v_mul_f32 v76, v76, v251
  v_mul_f32 v77, v77, v251
  v_mul_f32 v78, v78, v251
  v_mul_f32 v79, v79, v251
  v_mul_f32 v88, v88, v251
  v_mul_f32 v89, v89, v251
  v_mul_f32 v90, v90, v251
  v_mul_f32 v91, v91, v251
  v_mul_f32 v92, v92, v251
  v_mul_f32 v93, v93, v251
  v_mul_f32 v94, v94, v251
  v_mul_f32 v95, v95, v251
  v_mul_f32 v241, v241, v251
  v_exp_f32 v2, v136
  v_exp_f32 v3, v137
  v_exp_f32 v4, v138
  v_exp_f32 v5, v139
  v_cvt_pk_bf16_f32 v180, v2, v3
  v_exp_f32 v6, v140
  v_exp_f32 v7, v141
  v_cvt_pk_bf16_f32 v181, v4, v5
  v_exp_f32 v8, v142
  v_exp_f32 v9, v143
  v_cvt_pk_bf16_f32 v182, v6, v7
  v_exp_f32 v2, v152
  v_exp_f32 v3, v153
  v_cvt_pk_bf16_f32 v183, v8, v9
  v_exp_f32 v4, v154
  v_exp_f32 v5, v155
  v_cvt_pk_bf16_f32 v188, v2, v3
  v_mfma_f32_16x16x32_bf16 v[244:247], a[72:75], v[180:183], v[240:243]
  v_exp_f32 v6, v156
  v_exp_f32 v7, v157
  v_cvt_pk_bf16_f32 v189, v4, v5
  v_exp_f32 v8, v158
  v_exp_f32 v9, v159
  v_cvt_pk_bf16_f32 v190, v6, v7
  v_cvt_pk_bf16_f32 v191, v8, v9
  s_nop 1
  v_mfma_f32_16x16x32_bf16 v[244:247], a[72:75], v[188:191], v[244:247]
  s_nop 7
  s_setpc_b64 s[94:95]
.p2align 8
L_pad:
.fill 64, 4, 0xbf810000
.section .rodata,"a"
.p2align 6
.amdhsa_kernel parallel_sum__compressed_kv_cla__glu_gated_glu__prompt_kernel
  .amdhsa_next_free_vgpr 512
  .amdhsa_next_free_sgpr 102
  .amdhsa_accum_offset 256
  .amdhsa_group_segment_fixed_size 0
  .amdhsa_kernarg_size 104
  .amdhsa_user_sgpr_count 2
  .amdhsa_user_sgpr_kernarg_segment_ptr 1
  .amdhsa_system_sgpr_workgroup_id_x 1
.end_amdhsa_kernel
```
